```python
import torch

def _softmax(x, axis=-1):
    return torch.softmax(x, dim=axis)

def _gelu(x):
    return torch.nn.functional.gelu(x, approximate='tanh')

def _silu(x):
    return torch.nn.functional.silu(x)

def _sigmoid(x):
    return torch.sigmoid(x)

def _layernorm(x, axis=-1, eps=1e-05):
    m = x.mean(dim=axis, keepdim=True)
    v = x.var(dim=axis, keepdim=True, unbiased=False)
    return (x - m) / torch.sqrt(v + eps)

def _scatter_add(tgt, idx, src, axis=0):
    return tgt.clone().index_add_(axis, idx, src)

def _segment_sum(src, seg, n):
    out = torch.zeros((n,) + src.shape[1:], dtype=src.dtype)
    return out.index_add_(0, seg, src)

def _pad(x, pw):
    flat = tuple((v for pair in reversed(pw) for v in pair))
    return torch.nn.functional.pad(x, flat)
kernel_name = 'adaLN_cond__gqa_block_cached__swiglu_ffn__prompt'

def setup_inputs():

    _w = lambda a: (lambda t: t.to(torch.bfloat16) if t.is_floating_point() else t)(torch.as_tensor(a))

    def _A_setup():
        B, Sq, D = (1, 2048, 448)
        Hq, Hkv, Sk, Dh = (16, 8, 2048, 256)
        assert Hq % Hkv == 0, (Hq, Hkv)
        return {'x': _w((lambda *s: torch.randn(*s, dtype=torch.bfloat16) * 0.05)(B, Sq, D)), 'k_cache': _w((lambda *s: torch.randn(*s, dtype=torch.bfloat16) * 3.2)(B, Hkv, Sk, Dh)), 'v_cache': _w((lambda *s: torch.randn(*s, dtype=torch.bfloat16) * 0.4)(B, Hkv, Sk, Dh)), 'wq': _w((lambda *s: torch.randn(*s, dtype=torch.bfloat16) * 3.2)(D, Hq * Dh) * D ** (-0.5)), 'wo': _w((lambda *s: torch.randn(*s, dtype=torch.bfloat16) * 0.4)(Hq * Dh, D) * (Hq * Dh) ** (-0.5))}
    _A_in = _A_setup()

    def _B_setup():
        B, S, D, F = (1, 2048, 448, 1792)
        return {'x': _w((lambda *s: torch.randn(*s, dtype=torch.bfloat16) * 0.05)(B, S, D)), 'w_gate': _w((lambda *s: torch.randn(*s, dtype=torch.bfloat16) * 0.05)(D, F)), 'w_up': _w((lambda *s: torch.randn(*s, dtype=torch.bfloat16) * 0.05)(D, F)), 'w_down': _w((lambda *s: torch.randn(*s, dtype=torch.bfloat16) * 0.05)(F, D))}
    _B_in = _B_setup()
    return {'A_x': _A_in['x'], 'A_k_cache': _A_in['k_cache'], 'A_v_cache': _A_in['v_cache'], 'A_wq': _A_in['wq'], 'A_wo': _A_in['wo'], 'B_x': _B_in['x'], 'B_w_gate': _B_in['w_gate'], 'B_w_up': _B_in['w_up'], 'B_w_down': _B_in['w_down'], 'c': _w((lambda *s: torch.randn(*s, dtype=torch.bfloat16) * 0.2)(1, 448) * 8.0), 'w_mod': _w((lambda *s: torch.randn(*s, dtype=torch.bfloat16) * 0.2)(448, 6 * 448) * 448 ** (-0.5) * 8.0)}

def reference(A_x, A_k_cache, A_v_cache, A_wq, A_wo, B_x, B_w_gate, B_w_up, B_w_down, c, w_mod):

    def _A_ref(x, k_cache, v_cache, wq, wo):
        B, Sq, D = x.shape
        Hq, Dh = (16, 256)
        Hkv = k_cache.shape[1]
        rep = Hq // Hkv
        q = (lambda x, *d: x.permute(*d))((x @ wq).reshape(B, Sq, Hq, Dh), 0, 2, 1, 3)
        k = (lambda x, n, axis: torch.repeat_interleave(x, n, dim=axis))(k_cache, rep, axis=1)
        v = (lambda x, n, axis: torch.repeat_interleave(x, n, dim=axis))(v_cache, rep, axis=1)
        scores = torch.einsum('bhqd,bhkd->bhqk', q, k) * Dh ** (-0.5)
        p = _softmax(scores, axis=-1)
        o = torch.einsum('bhqk,bhkd->bhqd', p, v)
        return (lambda x, *d: x.permute(*d))(o, 0, 2, 1, 3).reshape(B, Sq, Hq * Dh) @ wo

    def _B_ref(x, w_gate, w_up, w_down):
        g = _silu(x @ w_gate)
        u = x @ w_up
        return g * u @ w_down
    x = A_x
    mod = (_silu(c) @ w_mod).reshape(c.shape[0], 6, 1, -1)
    sa, ca, ga, sb, cb, gb = (mod[:, 0].clone(), mod[:, 1].clone(), mod[:, 2].clone(), mod[:, 3].clone(), mod[:, 4].clone(), mod[:, 5].clone())
    h = _layernorm(x, axis=-1) * (1 + ca) + sa
    x = x + ga * _A_ref(h, A_k_cache, A_v_cache, A_wq, A_wo)
    h = _layernorm(x, axis=-1) * (1 + cb) + sb
    x = x + gb * _B_ref(h, B_w_gate, B_w_up, B_w_down)
    return x
```

```asm
; @launch grid=(256,1,1) block=(256,1,1) lds=163840
.amdgcn_target "amdgcn-amd-amdhsa--gfx950"
.text
.globl adaLN_cond__gqa_block_cached__swiglu_ffn__prompt_kernel
.p2align 8
.type adaLN_cond__gqa_block_cached__swiglu_ffn__prompt_kernel,@function
adaLN_cond__gqa_block_cached__swiglu_ffn__prompt_kernel:
    s_cmp_ge_u32 s2, 256
    s_cbranch_scc1 ALL_END
    s_load_dwordx4 s[4:7], s[0:1], 72
    s_load_dwordx4 s[72:75], s[0:1], 96
    s_load_dwordx8 s[36:43], s[0:1], 0
    s_load_dwordx2 s[44:45], s[0:1], 104
    v_lshrrev_b32 v1, 6, v0
    s_nop 0
    v_readfirstlane_b32 s28, v1
    s_lshr_b32 s56, s2, 4
    s_lshl_b32 s88, s56, 3
    s_and_b32 s30, s2, 7
    s_add_u32 s88, s88, s30
    s_bitcmp1_b32 s2, 3
    s_cselect_b32 s88, 0x7fff, s88
    v_and_b32 v1, 3, v0
    v_lshrrev_b32 v2, 2, v0
    v_mul_u32_u24 v3, 7, v2
    v_lshlrev_b32 v4, 1, v3
    v_mul_u32_u24 v5, 5376, v3
    v_lshl_add_u32 v5, v1, 4, v5
    s_lshl_b32 s30, s88, 6
    v_bfe_u32 v251, v0, 3, 3
    v_and_b32 v250, 7, v0
    v_xor_b32 v250, v250, v251
    v_lshlrev_b32 v250, 4, v250
    v_mul_u32_u24 v251, 896, v251
    v_add_u32 v250, v250, v251
    s_lshl_b32 s56, s56, 2
    s_add_u32 s56, s56, s28
    s_mul_i32 s58, s56, 28672
    s_mul_i32 s57, s28, 28672
    s_add_u32 s57, s57, 16384
    s_waitcnt lgkmcnt(0)
    s_cmp_ge_u32 s88, 28
    s_cbranch_scc1 FR_NM
    s_mov_b32 s12, s4
    s_mov_b32 s13, s5
    s_mov_b32 s14, 896
    s_mov_b32 s15, 0x00020000
    s_mov_b32 s16, s6
    s_mov_b32 s17, s7
    s_mov_b32 s18, 2408448
    s_mov_b32 s19, 0x00020000
    buffer_load_ushort v10, v4, s[12:15], 0 offen offset:0
    buffer_load_ushort v11, v4, s[12:15], 0 offen offset:2
    buffer_load_ushort v12, v4, s[12:15], 0 offen offset:4
    buffer_load_ushort v13, v4, s[12:15], 0 offen offset:6
    buffer_load_ushort v14, v4, s[12:15], 0 offen offset:8
    buffer_load_ushort v15, v4, s[12:15], 0 offen offset:10
    buffer_load_ushort v16, v4, s[12:15], 0 offen offset:12
    buffer_load_dwordx4 v[20:23], v5, s[16:19], s30 offen
    s_add_u32 s30, s30, 5376
    buffer_load_dwordx4 v[24:27], v5, s[16:19], s30 offen
    s_add_u32 s30, s30, 5376
    buffer_load_dwordx4 v[28:31], v5, s[16:19], s30 offen
    s_add_u32 s30, s30, 5376
    buffer_load_dwordx4 v[32:35], v5, s[16:19], s30 offen
    s_add_u32 s30, s30, 5376
    buffer_load_dwordx4 v[36:39], v5, s[16:19], s30 offen
    s_add_u32 s30, s30, 5376
    buffer_load_dwordx4 v[40:43], v5, s[16:19], s30 offen
    s_add_u32 s30, s30, 5376
    buffer_load_dwordx4 v[44:47], v5, s[16:19], s30 offen
    s_mov_b32 s64, s72
    s_mov_b32 s65, s73
    s_mov_b32 s66, 256
    s_mov_b32 s67, 0x00020000
    s_add_u32 s68, s74, 131072
    s_addc_u32 s69, s75, 0
    s_mov_b32 s70, 20480
    s_mov_b32 s71, 0x00020000
    s_add_u32 s84, s74, 196608
    s_addc_u32 s85, s75, 0
    s_mov_b32 s86, 16384
    s_mov_b32 s87, 0x00020000
    s_mov_b32 s60, s36
    s_mov_b32 s61, s37
    s_mov_b32 s62, 1835008
    s_mov_b32 s63, 0x00020000
    s_mov_b32 s20, s44
    s_mov_b32 s21, s45
    s_mov_b32 s22, 10752
    s_mov_b32 s23, 0x00020000
    s_mov_b32 s46, 0xbfb8aa3b
    s_cmp_ge_u32 s88, 14
    s_cselect_b32 s47, 1.0, 0
    s_lshl_b32 s31, s88, 7
    v_bfe_u32 v6, v0, 4, 2
    v_lshlrev_b32 v6, 3, v6
    v_lshl_add_u32 v6, v1, 5, v6
    s_lshl_b32 s32, s28, 7
    v_add_u32 v6, s32, v6
    v_and_b32 v7, 31, v0
    v_lshlrev_b32 v7, 8, v7
    v_add_u32 v7, 12288, v7
    v_mov_b32 v8, 1
    v_lshlrev_b32 v9, 2, v0
    s_mov_b32 s33, 0
    s_waitcnt vmcnt(7)
    buffer_load_dword v63, off, s[64:67], 0 sc1
    v_lshlrev_b32 v10, 16, v10
    v_lshlrev_b32 v11, 16, v11
    v_lshlrev_b32 v12, 16, v12
    v_lshlrev_b32 v13, 16, v13
    v_lshlrev_b32 v14, 16, v14
    v_lshlrev_b32 v15, 16, v15
    v_lshlrev_b32 v16, 16, v16
    v_mul_f32 v64, s46, v10
    v_mul_f32 v65, s46, v11
    v_mul_f32 v66, s46, v12
    v_mul_f32 v67, s46, v13
    v_mul_f32 v68, s46, v14
    v_mul_f32 v69, s46, v15
    v_mul_f32 v70, s46, v16
    v_exp_f32 v64, v64
    v_exp_f32 v65, v65
    v_exp_f32 v66, v66
    v_exp_f32 v67, v67
    v_exp_f32 v68, v68
    v_exp_f32 v69, v69
    v_exp_f32 v70, v70
    v_add_f32 v64, 1.0, v64
    v_add_f32 v65, 1.0, v65
    v_add_f32 v66, 1.0, v66
    v_add_f32 v67, 1.0, v67
    v_add_f32 v68, 1.0, v68
    v_add_f32 v69, 1.0, v69
    v_add_f32 v70, 1.0, v70
    v_rcp_f32 v64, v64
    v_rcp_f32 v65, v65
    v_rcp_f32 v66, v66
    v_rcp_f32 v67, v67
    v_rcp_f32 v68, v68
    v_rcp_f32 v69, v69
    v_rcp_f32 v70, v70
    v_mul_f32 v64, v10, v64
    v_mul_f32 v65, v11, v65
    v_mul_f32 v66, v12, v66
    v_mul_f32 v67, v13, v67
    v_mul_f32 v68, v14, v68
    v_mul_f32 v69, v15, v69
    v_mul_f32 v70, v16, v70
    v_cvt_pk_bf16_f32 v10, 0, v64
    v_cvt_pk_bf16_f32 v11, 0, v65
    v_cvt_pk_bf16_f32 v12, 0, v66
    v_cvt_pk_bf16_f32 v13, 0, v67
    v_cvt_pk_bf16_f32 v14, 0, v68
    v_cvt_pk_bf16_f32 v15, 0, v69
    v_cvt_pk_bf16_f32 v16, 0, v70
    s_waitcnt vmcnt(7)
    v_lshlrev_b32 v60, 16, v20
    v_and_b32 v61, 0xffff0000, v20
    v_mul_f32 v50, v10, v60
    v_mul_f32 v51, v10, v61
    v_lshlrev_b32 v62, 16, v21
    v_and_b32 v72, 0xffff0000, v21
    v_mul_f32 v52, v10, v62
    v_mul_f32 v53, v10, v72
    v_lshlrev_b32 v60, 16, v22
    v_and_b32 v61, 0xffff0000, v22
    v_mul_f32 v54, v10, v60
    v_mul_f32 v55, v10, v61
    v_lshlrev_b32 v62, 16, v23
    v_and_b32 v72, 0xffff0000, v23
    v_mul_f32 v56, v10, v62
    v_mul_f32 v57, v10, v72
    s_waitcnt vmcnt(6)
    v_lshlrev_b32 v60, 16, v24
    v_and_b32 v61, 0xffff0000, v24
    v_fmac_f32 v50, v11, v60
    v_fmac_f32 v51, v11, v61
    v_lshlrev_b32 v62, 16, v25
    v_and_b32 v72, 0xffff0000, v25
    v_fmac_f32 v52, v11, v62
    v_fmac_f32 v53, v11, v72
    v_lshlrev_b32 v60, 16, v26
    v_and_b32 v61, 0xffff0000, v26
    v_fmac_f32 v54, v11, v60
    v_fmac_f32 v55, v11, v61
    v_lshlrev_b32 v62, 16, v27
    v_and_b32 v72, 0xffff0000, v27
    v_fmac_f32 v56, v11, v62
    v_fmac_f32 v57, v11, v72
    s_waitcnt vmcnt(5)
    v_lshlrev_b32 v60, 16, v28
    v_and_b32 v61, 0xffff0000, v28
    v_fmac_f32 v50, v12, v60
    v_fmac_f32 v51, v12, v61
    v_lshlrev_b32 v62, 16, v29
    v_and_b32 v72, 0xffff0000, v29
    v_fmac_f32 v52, v12, v62
    v_fmac_f32 v53, v12, v72
    v_lshlrev_b32 v60, 16, v30
    v_and_b32 v61, 0xffff0000, v30
    v_fmac_f32 v54, v12, v60
    v_fmac_f32 v55, v12, v61
    v_lshlrev_b32 v62, 16, v31
    v_and_b32 v72, 0xffff0000, v31
    v_fmac_f32 v56, v12, v62
    v_fmac_f32 v57, v12, v72
    s_waitcnt vmcnt(4)
    v_lshlrev_b32 v60, 16, v32
    v_and_b32 v61, 0xffff0000, v32
    v_fmac_f32 v50, v13, v60
    v_fmac_f32 v51, v13, v61
    v_lshlrev_b32 v62, 16, v33
    v_and_b32 v72, 0xffff0000, v33
    v_fmac_f32 v52, v13, v62
    v_fmac_f32 v53, v13, v72
    v_lshlrev_b32 v60, 16, v34
    v_and_b32 v61, 0xffff0000, v34
    v_fmac_f32 v54, v13, v60
    v_fmac_f32 v55, v13, v61
    v_lshlrev_b32 v62, 16, v35
    v_and_b32 v72, 0xffff0000, v35
    v_fmac_f32 v56, v13, v62
    v_fmac_f32 v57, v13, v72
    s_waitcnt vmcnt(3)
    v_lshlrev_b32 v60, 16, v36
    v_and_b32 v61, 0xffff0000, v36
    v_fmac_f32 v50, v14, v60
    v_fmac_f32 v51, v14, v61
    v_lshlrev_b32 v62, 16, v37
    v_and_b32 v72, 0xffff0000, v37
    v_fmac_f32 v52, v14, v62
    v_fmac_f32 v53, v14, v72
    v_lshlrev_b32 v60, 16, v38
    v_and_b32 v61, 0xffff0000, v38
    v_fmac_f32 v54, v14, v60
    v_fmac_f32 v55, v14, v61
    v_lshlrev_b32 v62, 16, v39
    v_and_b32 v72, 0xffff0000, v39
    v_fmac_f32 v56, v14, v62
    v_fmac_f32 v57, v14, v72
    s_waitcnt vmcnt(2)
    v_lshlrev_b32 v60, 16, v40
    v_and_b32 v61, 0xffff0000, v40
    v_fmac_f32 v50, v15, v60
    v_fmac_f32 v51, v15, v61
    v_lshlrev_b32 v62, 16, v41
    v_and_b32 v72, 0xffff0000, v41
    v_fmac_f32 v52, v15, v62
    v_fmac_f32 v53, v15, v72
    v_lshlrev_b32 v60, 16, v42
    v_and_b32 v61, 0xffff0000, v42
    v_fmac_f32 v54, v15, v60
    v_fmac_f32 v55, v15, v61
    v_lshlrev_b32 v62, 16, v43
    v_and_b32 v72, 0xffff0000, v43
    v_fmac_f32 v56, v15, v62
    v_fmac_f32 v57, v15, v72
    s_waitcnt vmcnt(1)
    v_lshlrev_b32 v60, 16, v44
    v_and_b32 v61, 0xffff0000, v44
    v_fmac_f32 v50, v16, v60
    v_fmac_f32 v51, v16, v61
    v_lshlrev_b32 v62, 16, v45
    v_and_b32 v72, 0xffff0000, v45
    v_fmac_f32 v52, v16, v62
    v_fmac_f32 v53, v16, v72
    v_lshlrev_b32 v60, 16, v46
    v_and_b32 v61, 0xffff0000, v46
    v_fmac_f32 v54, v16, v60
    v_fmac_f32 v55, v16, v61
    v_lshlrev_b32 v62, 16, v47
    v_and_b32 v72, 0xffff0000, v47
    v_fmac_f32 v56, v16, v62
    v_fmac_f32 v57, v16, v72
    s_nop 1
    v_permlane32_swap_b32 v50, v54
    v_permlane32_swap_b32 v51, v55
    v_permlane32_swap_b32 v52, v56
    v_permlane32_swap_b32 v53, v57
    v_add_f32 v50, v50, v54
    v_add_f32 v51, v51, v55
    v_add_f32 v52, v52, v56
    v_add_f32 v53, v53, v57
    s_nop 1
    v_permlane16_swap_b32 v50, v52
    v_permlane16_swap_b32 v51, v53
    v_add_f32 v50, v50, v52
    v_add_f32 v51, v51, v53
    s_nop 1
    v_add_f32_dpp v50, v50, v50 row_ror:4 row_mask:0xf bank_mask:0xf
    v_add_f32_dpp v51, v51, v51 row_ror:4 row_mask:0xf bank_mask:0xf
    s_nop 1
    v_add_f32_dpp v50, v50, v50 row_ror:8 row_mask:0xf bank_mask:0xf
    v_add_f32_dpp v51, v51, v51 row_ror:8 row_mask:0xf bank_mask:0xf
    s_mov_b32 exec_lo, 0x000f000f
    s_mov_b32 exec_hi, 0x000f000f
    ds_write_b64 v6, v[50:51]
    s_mov_b64 exec, -1
    s_cmp_lg_u32 s28, 0
    s_waitcnt lgkmcnt(0)
    s_barrier
    s_cbranch_scc1 FR_MX
    s_mov_b32 exec_hi, 0
    ds_read_b32 v20, v9 offset:0
    ds_read_b32 v21, v9 offset:128
    ds_read_b32 v22, v9 offset:256
    ds_read_b32 v23, v9 offset:384
    s_waitcnt lgkmcnt(0)
    v_add_f32 v20, v20, v21
    v_add_f32 v22, v22, v23
    v_add_f32 v20, v20, v22
    v_cvt_pk_bf16_f32 v20, 0, v20
    v_add_f32 v20, s47, v20
    v_cvt_pk_bf16_f32 v20, 0, v20
    buffer_store_dword v20, v9, s[20:23], s31 offen sc1
FR_ARM:
    s_waitcnt vmcnt(0)
    v_readfirstlane_b32 s32, v63
    s_cmp_lg_u32 s32, 1
    s_cbranch_scc1 FR_RETRY
FR_SIG:
    buffer_atomic_add v8, v7, s[68:71], 0 offen sc1
    s_mov_b64 exec, -1
FR_MX:
    s_add_u32 m0, s57, 0
    s_add_u32 s90, s58, 0
    buffer_load_dwordx4 v250, s[60:63], s90 offen lds
    s_add_u32 m0, s57, 1024
    s_add_u32 s90, s58, 7168
    buffer_load_dwordx4 v250, s[60:63], s90 offen lds
    s_add_u32 m0, s57, 2048
    s_add_u32 s90, s58, 14336
    buffer_load_dwordx4 v250, s[60:63], s90 offen lds
    s_add_u32 m0, s57, 3072
    s_add_u32 s90, s58, 21504
    buffer_load_dwordx4 v250, s[60:63], s90 offen lds
    s_add_u32 m0, s57, 4096
    s_add_u32 s90, s58, 128
    buffer_load_dwordx4 v250, s[60:63], s90 offen lds
    s_add_u32 m0, s57, 5120
    s_add_u32 s90, s58, 7296
    buffer_load_dwordx4 v250, s[60:63], s90 offen lds
    s_add_u32 m0, s57, 6144
    s_add_u32 s90, s58, 14464
    buffer_load_dwordx4 v250, s[60:63], s90 offen lds
    s_add_u32 m0, s57, 7168
    s_add_u32 s90, s58, 21632
    buffer_load_dwordx4 v250, s[60:63], s90 offen lds
    s_add_u32 m0, s57, 8192
    s_add_u32 s90, s58, 256
    buffer_load_dwordx4 v250, s[60:63], s90 offen lds
    s_add_u32 m0, s57, 9216
    s_add_u32 s90, s58, 7424
    buffer_load_dwordx4 v250, s[60:63], s90 offen lds
    s_add_u32 m0, s57, 10240
    s_add_u32 s90, s58, 14592
    buffer_load_dwordx4 v250, s[60:63], s90 offen lds
    s_add_u32 m0, s57, 11264
    s_add_u32 s90, s58, 21760
    buffer_load_dwordx4 v250, s[60:63], s90 offen lds
    s_add_u32 m0, s57, 12288
    s_add_u32 s90, s58, 384
    buffer_load_dwordx4 v250, s[60:63], s90 offen lds
    s_add_u32 m0, s57, 13312
    s_add_u32 s90, s58, 7552
    buffer_load_dwordx4 v250, s[60:63], s90 offen lds
    s_add_u32 m0, s57, 14336
    s_add_u32 s90, s58, 14720
    buffer_load_dwordx4 v250, s[60:63], s90 offen lds
    s_add_u32 m0, s57, 15360
    s_add_u32 s90, s58, 21888
    buffer_load_dwordx4 v250, s[60:63], s90 offen lds
    s_add_u32 m0, s57, 16384
    s_add_u32 s90, s58, 512
    buffer_load_dwordx4 v250, s[60:63], s90 offen lds
    s_add_u32 m0, s57, 17408
    s_add_u32 s90, s58, 7680
    buffer_load_dwordx4 v250, s[60:63], s90 offen lds
    s_add_u32 m0, s57, 18432
    s_add_u32 s90, s58, 14848
    buffer_load_dwordx4 v250, s[60:63], s90 offen lds
    s_add_u32 m0, s57, 19456
    s_add_u32 s90, s58, 22016
    buffer_load_dwordx4 v250, s[60:63], s90 offen lds
    s_add_u32 m0, s57, 20480
    s_add_u32 s90, s58, 640
    buffer_load_dwordx4 v250, s[60:63], s90 offen lds
    s_add_u32 m0, s57, 21504
    s_add_u32 s90, s58, 7808
    buffer_load_dwordx4 v250, s[60:63], s90 offen lds
    s_add_u32 m0, s57, 22528
    s_add_u32 s90, s58, 14976
    buffer_load_dwordx4 v250, s[60:63], s90 offen lds
    s_add_u32 m0, s57, 23552
    s_add_u32 s90, s58, 22144
    buffer_load_dwordx4 v250, s[60:63], s90 offen lds
    s_add_u32 m0, s57, 24576
    s_add_u32 s90, s58, 768
    buffer_load_dwordx4 v250, s[60:63], s90 offen lds
    s_add_u32 m0, s57, 25600
    s_add_u32 s90, s58, 7936
    buffer_load_dwordx4 v250, s[60:63], s90 offen lds
    s_add_u32 m0, s57, 26624
    s_add_u32 s90, s58, 15104
    buffer_load_dwordx4 v250, s[60:63], s90 offen lds
    s_add_u32 m0, s57, 27648
    s_add_u32 s90, s58, 22272
    buffer_load_dwordx4 v250, s[60:63], s90 offen lds
    s_branch FR_JOIN
FR_RETRY:
    s_sleep 2
    buffer_load_dword v63, off, s[64:67], 0 sc1
    s_add_u32 s33, s33, 1
    s_cmp_lt_u32 s33, 0x400000
    s_cbranch_scc1 FR_ARM
    s_branch FR_SIG
FR_NM:
    s_mov_b32 s64, s72
    s_mov_b32 s65, s73
    s_mov_b32 s66, 256
    s_mov_b32 s67, 0x00020000
    s_add_u32 s68, s74, 131072
    s_addc_u32 s69, s75, 0
    s_mov_b32 s70, 20480
    s_mov_b32 s71, 0x00020000
    s_add_u32 s84, s74, 196608
    s_addc_u32 s85, s75, 0
    s_mov_b32 s86, 16384
    s_mov_b32 s87, 0x00020000
    s_mov_b32 s60, s36
    s_mov_b32 s61, s37
    s_mov_b32 s62, 1835008
    s_mov_b32 s63, 0x00020000
    s_cmp_lg_u32 s2, 255
    s_cbranch_scc1 NOZERO
    s_cmp_lg_u32 s28, 0
    s_cbranch_scc1 NOZERO1
    v_lshlrev_b32 v1, 8, v0
    v_mov_b32 v2, 0
    v_add_u32 v3, 16384, v1
    buffer_store_dword v2, v1, s[68:71], 0 offen sc1
    s_mov_b64 exec, 0xffff
    buffer_store_dword v2, v3, s[68:71], 0 offen sc1
    s_mov_b64 exec, 1
    v_mov_b32 v3, 1
    s_waitcnt vmcnt(0)
    buffer_store_dword v3, v2, s[64:67], 0 offen sc1
    s_mov_b64 exec, -1
NOZERO1:
    s_barrier
NOZERO:
    s_bitcmp1_b32 s2, 3
    s_cselect_b32 s92, s56, 0x7fff
    s_cmp_ge_u32 s92, 28
    s_cbranch_scc1 NOTOUCH
    s_mov_b32 s96, s42
    s_mov_b32 s97, s43
    s_mov_b32 s98, 3670016
    s_mov_b32 s99, 0x00020000
    v_bfe_u32 v246, v0, 3, 3
    v_lshlrev_b32 v246, 13, v246
    v_and_b32 v247, 7, v0
    v_lshl_add_u32 v246, v247, 7, v246
    s_lshl_b32 s91, s92, 17
    s_and_b32 s93, s2, 7
    s_lshl_b32 s93, s93, 10
    s_add_u32 s91, s91, s93
    buffer_load_dword v127, v246, s[96:99], s91 offen
    s_add_u32 s91, s91, 65536
    buffer_load_dword v126, v246, s[96:99], s91 offen
NOTOUCH:
    s_add_u32 m0, s57, 0
    s_add_u32 s90, s58, 0
    buffer_load_dwordx4 v250, s[60:63], s90 offen lds
    s_add_u32 m0, s57, 1024
    s_add_u32 s90, s58, 7168
    buffer_load_dwordx4 v250, s[60:63], s90 offen lds
    s_add_u32 m0, s57, 2048
    s_add_u32 s90, s58, 14336
    buffer_load_dwordx4 v250, s[60:63], s90 offen lds
    s_add_u32 m0, s57, 3072
    s_add_u32 s90, s58, 21504
    buffer_load_dwordx4 v250, s[60:63], s90 offen lds
    s_add_u32 m0, s57, 4096
    s_add_u32 s90, s58, 128
    buffer_load_dwordx4 v250, s[60:63], s90 offen lds
    s_add_u32 m0, s57, 5120
    s_add_u32 s90, s58, 7296
    buffer_load_dwordx4 v250, s[60:63], s90 offen lds
    s_add_u32 m0, s57, 6144
    s_add_u32 s90, s58, 14464
    buffer_load_dwordx4 v250, s[60:63], s90 offen lds
    s_add_u32 m0, s57, 7168
    s_add_u32 s90, s58, 21632
    buffer_load_dwordx4 v250, s[60:63], s90 offen lds
    s_add_u32 m0, s57, 8192
    s_add_u32 s90, s58, 256
    buffer_load_dwordx4 v250, s[60:63], s90 offen lds
    s_add_u32 m0, s57, 9216
    s_add_u32 s90, s58, 7424
    buffer_load_dwordx4 v250, s[60:63], s90 offen lds
    s_add_u32 m0, s57, 10240
    s_add_u32 s90, s58, 14592
    buffer_load_dwordx4 v250, s[60:63], s90 offen lds
    s_add_u32 m0, s57, 11264
    s_add_u32 s90, s58, 21760
    buffer_load_dwordx4 v250, s[60:63], s90 offen lds
    s_add_u32 m0, s57, 12288
    s_add_u32 s90, s58, 384
    buffer_load_dwordx4 v250, s[60:63], s90 offen lds
    s_add_u32 m0, s57, 13312
    s_add_u32 s90, s58, 7552
    buffer_load_dwordx4 v250, s[60:63], s90 offen lds
    s_add_u32 m0, s57, 14336
    s_add_u32 s90, s58, 14720
    buffer_load_dwordx4 v250, s[60:63], s90 offen lds
    s_add_u32 m0, s57, 15360
    s_add_u32 s90, s58, 21888
    buffer_load_dwordx4 v250, s[60:63], s90 offen lds
    s_add_u32 m0, s57, 16384
    s_add_u32 s90, s58, 512
    buffer_load_dwordx4 v250, s[60:63], s90 offen lds
    s_add_u32 m0, s57, 17408
    s_add_u32 s90, s58, 7680
    buffer_load_dwordx4 v250, s[60:63], s90 offen lds
    s_add_u32 m0, s57, 18432
    s_add_u32 s90, s58, 14848
    buffer_load_dwordx4 v250, s[60:63], s90 offen lds
    s_add_u32 m0, s57, 19456
    s_add_u32 s90, s58, 22016
    buffer_load_dwordx4 v250, s[60:63], s90 offen lds
    s_add_u32 m0, s57, 20480
    s_add_u32 s90, s58, 640
    buffer_load_dwordx4 v250, s[60:63], s90 offen lds
    s_add_u32 m0, s57, 21504
    s_add_u32 s90, s58, 7808
    buffer_load_dwordx4 v250, s[60:63], s90 offen lds
    s_add_u32 m0, s57, 22528
    s_add_u32 s90, s58, 14976
    buffer_load_dwordx4 v250, s[60:63], s90 offen lds
    s_add_u32 m0, s57, 23552
    s_add_u32 s90, s58, 22144
    buffer_load_dwordx4 v250, s[60:63], s90 offen lds
    s_add_u32 m0, s57, 24576
    s_add_u32 s90, s58, 768
    buffer_load_dwordx4 v250, s[60:63], s90 offen lds
    s_add_u32 m0, s57, 25600
    s_add_u32 s90, s58, 7936
    buffer_load_dwordx4 v250, s[60:63], s90 offen lds
    s_add_u32 m0, s57, 26624
    s_add_u32 s90, s58, 15104
    buffer_load_dwordx4 v250, s[60:63], s90 offen lds
    s_add_u32 m0, s57, 27648
    s_add_u32 s90, s58, 22272
    buffer_load_dwordx4 v250, s[60:63], s90 offen lds
FR_JOIN:
    buffer_load_dword v12, off, s[64:67], 0 sc1
    s_mov_b64 exec, -1
    v_mbcnt_lo_u32_b32 v0, -1, 0
    v_mbcnt_hi_u32_b32 v0, -1, v0
    s_lshl_b32 s72, s28, 6
    v_or_b32 v0, s72, v0
    v_and_b32 v240, 63, v0
    v_and_b32 v241, 31, v240
    v_lshrrev_b32 v242, 5, v240
    s_and_b32 s51, s2, 7
    s_lshr_b32 s52, s2, 3
    s_and_b32 s53, s52, 1
    s_lshr_b32 s54, s52, 1
    s_lshl_b32 s55, s51, 1
    s_add_u32 s55, s55, s53
    s_lshl_b32 s56, s54, 2
    s_add_u32 s56, s56, s28
    v_lshlrev_b32 v244, 4, v240
    s_lshl_b32 s29, s55, 9
    s_lshr_b32 s30, s28, 1
    s_lshl_b32 s30, s30, 8
    s_add_u32 s29, s29, s30
    s_and_b32 s30, s28, 1
    s_lshl_b32 s30, s30, 18
    s_add_u32 s29, s29, s30
    s_waitcnt lgkmcnt(0)
    s_add_u32 s4, s44, 29360128
    s_addc_u32 s5, s45, 0
    s_mov_b32 s6, 1835008
    s_mov_b32 s7, 0x00020000
    s_mov_b32 s8, s42
    s_mov_b32 s9, s43
    s_mov_b32 s10, 3670016
    s_mov_b32 s11, 0x00020000
    s_lshl_b32 s30, s51, 20
    s_add_u32 s12, s38, s30
    s_addc_u32 s13, s39, 0
    s_mov_b32 s14, 0x100000
    s_mov_b32 s15, 0x00020000
    s_add_u32 s16, s40, s30
    s_addc_u32 s17, s41, 0
    s_mov_b32 s18, 0x100000
    s_mov_b32 s19, 0x00020000
    s_mov_b32 s20, s44
    s_mov_b32 s21, s45
    s_mov_b32 s22, 10752
    s_mov_b32 s23, 0x00020000
    s_add_u32 s24, s44, 1048576
    s_addc_u32 s25, s45, 0
    s_mov_b32 s26, 16777216
    s_mov_b32 s27, 0x00020000
    s_lshl_b32 s49, s28, 12
    s_and_b32 s47, s52, 3
    s_mul_i32 s47, s47, 262144
    s_mov_b32 s48, s47
    s_mov_b32 s46, 0x3db8aa3b
    s_mov_b32 s96, s8
    s_mov_b32 s97, s9
    s_mov_b32 s98, s10
    s_mov_b32 s99, s11
    s_lshr_b32 s88, s2, 4
    s_lshl_b32 s88, s88, 3
    s_add_u32 s88, s88, s51
    s_cmp_eq_u32 s53, 0
    s_cselect_b32 s88, s88, 0x7fff
    v_lshrrev_b32 v246, 3, v240
    v_lshlrev_b32 v246, 13, v246
    v_and_b32 v247, 7, v240
    v_lshl_add_u32 v246, v247, 7, v246
    s_lshl_b32 s92, s54, 2
    s_add_u32 s92, s92, s28
    s_lshl_b32 s91, s92, 17
    s_lshl_b32 s93, s51, 10
    s_add_u32 s91, s91, s93
    s_cmp_eq_u32 s53, 1
    s_cselect_b32 s92, s92, 0x7fff
    s_mov_b32 s60, s36
    s_mov_b32 s61, s37
    s_mov_b32 s62, 1835008
    s_mov_b32 s63, 0x00020000
    s_lshl_b32 s57, s56, 5
    v_add_u32 v250, s57, v241
    v_mul_u32_u24 v250, 896, v250
    v_lshl_add_u32 v250, v242, 4, v250
    v_lshrrev_b32 v251, 3, v240
    v_and_b32 v250, 7, v240
    v_xor_b32 v250, v250, v251
    v_lshlrev_b32 v250, 4, v250
    v_mul_u32_u24 v251, 896, v251
    v_add_u32 v250, v250, v251
    s_mul_i32 s58, s56, 28672
    s_mul_i32 s75, s28, 28672
    s_add_u32 s75, s75, 16384
    s_add_u32 s94, s54, 12
    s_cmp_eq_u32 s53, 1
    s_cselect_b32 s94, s54, s94
    s_cselect_b32 s89, 1, 0
    s_cmp_ge_u32 s54, 4
    s_cselect_b32 s89, 1, s89
    s_cmp_eq_u32 s28, 0
    s_cselect_b32 s89, 0, s89
    s_mul_i32 s94, s94, 3
    s_add_u32 s94, s94, s28
    s_sub_u32 s94, s94, 1
    s_cmp_ge_u32 s94, 42
    s_cselect_b32 s95, 42, 0
    s_cselect_b32 s93, 1, 0
    s_sub_u32 s94, s94, s95
    s_mul_i32 s94, s94, 24576
    s_mov_b32 s89, 0
    v_lshrrev_b32 v0, 4, v240
    v_and_b32 v1, 15, v240
    v_lshlrev_b32 v2, 2, v0
    v_xor_b32 v1, v1, v2
    v_lshlrev_b32 v1, 4, v1
    s_mov_b32 s30, 8192
    v_mul_lo_u32 v245, v0, s30
    v_add_u32 v245, v245, v1
    s_lshr_b32 s31, s28, 1
    s_lshl_b32 s31, s31, 14
    s_and_b32 s32, s28, 1
    s_lshl_b32 s32, s32, 13
    s_add_u32 s31, s31, s32
    v_lshrrev_b32 v0, 4, v240
    v_and_b32 v1, 15, v240
    v_lshrrev_b32 v2, 2, v1
    v_lshrrev_b32 v3, 1, v0
    v_lshl_add_u32 v3, v3, 3, v2
    v_lshlrev_b32 v3, 8, v3
    v_and_b32 v4, 1, v0
    v_lshl_add_u32 v3, v4, 5, v3
    v_and_b32 v4, 1, v1
    v_lshl_add_u32 v3, v4, 4, v3
    v_and_b32 v4, 2, v1
    v_lshl_add_u32 v3, v4, 2, v3
    v_add_u32 v3, 16384, v3
    v_xor_b32 v4, 0, v2
    v_lshl_add_u32 v246, v4, 6, v3
    v_xor_b32 v4, 1, v2
    v_lshl_add_u32 v247, v4, 6, v3
    v_xor_b32 v4, 2, v2
    v_lshl_add_u32 v248, v4, 6, v3
    v_xor_b32 v4, 3, v2
    v_lshl_add_u32 v249, v4, 6, v3
    v_lshlrev_b32 v243, 5, v242
    v_lshlrev_b32 v0, 3, s28
    v_add_u32 v0, v0, v242
    v_add_u32 v1, 0, v0
    v_and_b32 v1, 15, v1
    v_xor_b32 v1, v1, v241
    v_lshlrev_b32 v250, 4, v1
    v_lshl_add_u32 v250, v0, 9, v250
    v_add_u32 v1, 2, v0
    v_and_b32 v1, 15, v1
    v_xor_b32 v1, v1, v241
    v_lshlrev_b32 v251, 4, v1
    v_lshl_add_u32 v251, v0, 9, v251
    v_add_u32 v1, 4, v0
    v_and_b32 v1, 15, v1
    v_xor_b32 v1, v1, v241
    v_lshlrev_b32 v252, 4, v1
    v_lshl_add_u32 v252, v0, 9, v252
    v_add_u32 v1, 6, v0
    v_and_b32 v1, 15, v1
    v_xor_b32 v1, v1, v241
    v_lshlrev_b32 v253, 4, v1
    v_lshl_add_u32 v253, v0, 9, v253
    v_add_u32 v1, 0, v242
    v_lshlrev_b32 v1, 2, v1
    v_xor_b32 v1, v1, v241
    v_lshlrev_b32 v254, 4, v1
    v_lshl_add_u32 v254, v0, 9, v254
    v_add_u32 v1, 2, v242
    v_lshlrev_b32 v1, 2, v1
    v_xor_b32 v1, v1, v241
    v_lshlrev_b32 v255, 4, v1
    v_lshl_add_u32 v255, v0, 9, v255
    s_and_b32 s74, s2, 31
    s_lshl_b32 s74, s74, 8
    s_add_u32 s74, s74, 12288
    v_mov_b32 v13, 0
    v_lshrrev_b32 v0, 3, v241
    v_lshlrev_b32 v0, 10, v0
    v_and_b32 v1, 7, v241
    v_lshl_add_u32 v0, v1, 7, v0
    v_add_u32 v0, s75, v0
    v_xor_b32 v1, v1, v242
    v_xor_b32 v2, 0, v1
    v_lshl_add_u32 v4, v2, 4, v0
    v_xor_b32 v2, 2, v1
    v_lshl_add_u32 v5, v2, 4, v0
    v_xor_b32 v2, 4, v1
    v_lshl_add_u32 v6, v2, 4, v0
    v_xor_b32 v2, 6, v1
    v_lshl_add_u32 v7, v2, 4, v0
    s_waitcnt vmcnt(1)
    ds_read_b128 v[128:131], v4 offset:0
    ds_read_b128 v[132:135], v5 offset:0
    ds_read_b128 v[136:139], v6 offset:0
    ds_read_b128 v[140:143], v7 offset:0
    ds_read_b128 v[144:147], v4 offset:4096
    ds_read_b128 v[148:151], v5 offset:4096
    ds_read_b128 v[152:155], v6 offset:4096
    ds_read_b128 v[156:159], v7 offset:4096
    ds_read_b128 v[160:163], v4 offset:8192
    ds_read_b128 v[164:167], v5 offset:8192
    ds_read_b128 v[168:171], v6 offset:8192
    ds_read_b128 v[172:175], v7 offset:8192
    ds_read_b128 v[176:179], v4 offset:12288
    ds_read_b128 v[180:183], v5 offset:12288
    ds_read_b128 v[184:187], v6 offset:12288
    ds_read_b128 v[188:191], v7 offset:12288
    ds_read_b128 v[192:195], v4 offset:16384
    ds_read_b128 v[196:199], v5 offset:16384
    ds_read_b128 v[200:203], v6 offset:16384
    ds_read_b128 v[204:207], v7 offset:16384
    ds_read_b128 v[208:211], v4 offset:20480
    ds_read_b128 v[212:215], v5 offset:20480
    ds_read_b128 v[216:219], v6 offset:20480
    ds_read_b128 v[220:223], v7 offset:20480
    ds_read_b128 v[224:227], v4 offset:24576
    ds_read_b128 v[228:231], v5 offset:24576
    ds_read_b128 v[232:235], v6 offset:24576
    ds_read_b128 v[236:239], v7 offset:24576
    s_waitcnt vmcnt(0)
    v_readfirstlane_b32 s73, v12
    s_cmp_lg_u32 s73, 1
    s_cbranch_scc1 EP1
    buffer_load_dword v13, off, s[68:71], s74 sc1
EP1:
    s_add_u32 m0, s31, 131072
    s_add_u32 s33, s29, 1048576
    buffer_load_dwordx4 v245, s[8:11], s33 offen lds
    s_add_u32 m0, s31, 132096
    s_add_u32 s33, s29, 1081344
    buffer_load_dwordx4 v245, s[8:11], s33 offen lds
    s_add_u32 m0, s31, 133120
    s_add_u32 s33, s29, 1114112
    buffer_load_dwordx4 v245, s[8:11], s33 offen lds
    s_add_u32 m0, s31, 134144
    s_add_u32 s33, s29, 1146880
    buffer_load_dwordx4 v245, s[8:11], s33 offen lds
    s_add_u32 m0, s31, 135168
    s_add_u32 s33, s29, 1179648
    buffer_load_dwordx4 v245, s[8:11], s33 offen lds
    s_add_u32 m0, s31, 136192
    s_add_u32 s33, s29, 1212416
    buffer_load_dwordx4 v245, s[8:11], s33 offen lds
    s_add_u32 m0, s31, 137216
    s_add_u32 s33, s29, 1245184
    buffer_load_dwordx4 v245, s[8:11], s33 offen lds
    s_add_u32 m0, s31, 138240
    s_add_u32 s33, s29, 1277952
    buffer_load_dwordx4 v245, s[8:11], s33 offen lds
    v_mov_b32 v8, 0x3f803f80
    v_mov_b32 v9, 0x3f803f80
    v_mov_b32 v10, 0x3f803f80
    v_mov_b32 v11, 0x3f803f80
    v_mov_b32 v2, 0
    v_mov_b32 v3, 0
    s_waitcnt lgkmcnt(15)
    v_mfma_f32_32x32x16_bf16 v[16:31], v[8:11], v[128:131], 0
    v_dot2_f32_bf16 v2, v128, v128, v2
    v_dot2_f32_bf16 v3, v129, v129, v3
    v_dot2_f32_bf16 v2, v130, v130, v2
    v_dot2_f32_bf16 v3, v131, v131, v3
    v_mfma_f32_32x32x16_bf16 v[32:47], v[8:11], v[132:135], 0
    v_dot2_f32_bf16 v2, v132, v132, v2
    v_dot2_f32_bf16 v3, v133, v133, v3
    v_dot2_f32_bf16 v2, v134, v134, v2
    v_dot2_f32_bf16 v3, v135, v135, v3
    v_mfma_f32_32x32x16_bf16 v[16:31], v[8:11], v[136:139], v[16:31]
    v_dot2_f32_bf16 v2, v136, v136, v2
    v_dot2_f32_bf16 v3, v137, v137, v3
    v_dot2_f32_bf16 v2, v138, v138, v2
    v_dot2_f32_bf16 v3, v139, v139, v3
    v_mfma_f32_32x32x16_bf16 v[32:47], v[8:11], v[140:143], v[32:47]
    v_dot2_f32_bf16 v2, v140, v140, v2
    v_dot2_f32_bf16 v3, v141, v141, v3
    v_dot2_f32_bf16 v2, v142, v142, v2
    v_dot2_f32_bf16 v3, v143, v143, v3
    v_mfma_f32_32x32x16_bf16 v[16:31], v[8:11], v[144:147], v[16:31]
    v_dot2_f32_bf16 v2, v144, v144, v2
    v_dot2_f32_bf16 v3, v145, v145, v3
    v_dot2_f32_bf16 v2, v146, v146, v2
    v_dot2_f32_bf16 v3, v147, v147, v3
    v_mfma_f32_32x32x16_bf16 v[32:47], v[8:11], v[148:151], v[32:47]
    v_dot2_f32_bf16 v2, v148, v148, v2
    v_dot2_f32_bf16 v3, v149, v149, v3
    v_dot2_f32_bf16 v2, v150, v150, v2
    v_dot2_f32_bf16 v3, v151, v151, v3
    v_mfma_f32_32x32x16_bf16 v[16:31], v[8:11], v[152:155], v[16:31]
    v_dot2_f32_bf16 v2, v152, v152, v2
    v_dot2_f32_bf16 v3, v153, v153, v3
    v_dot2_f32_bf16 v2, v154, v154, v2
    v_dot2_f32_bf16 v3, v155, v155, v3
    v_mfma_f32_32x32x16_bf16 v[32:47], v[8:11], v[156:159], v[32:47]
    v_dot2_f32_bf16 v2, v156, v156, v2
    v_dot2_f32_bf16 v3, v157, v157, v3
    v_dot2_f32_bf16 v2, v158, v158, v2
    v_dot2_f32_bf16 v3, v159, v159, v3
    s_waitcnt lgkmcnt(0)
    s_barrier
    v_mfma_f32_32x32x16_bf16 v[16:31], v[8:11], v[160:163], v[16:31]
    v_dot2_f32_bf16 v2, v160, v160, v2
    v_dot2_f32_bf16 v3, v161, v161, v3
    s_add_u32 m0, s31, 16384
    s_add_u32 s33, s29, 0
    buffer_load_dwordx4 v245, s[8:11], s33 offen lds
    v_dot2_f32_bf16 v2, v162, v162, v2
    v_dot2_f32_bf16 v3, v163, v163, v3
    v_mfma_f32_32x32x16_bf16 v[32:47], v[8:11], v[164:167], v[32:47]
    v_dot2_f32_bf16 v2, v164, v164, v2
    v_dot2_f32_bf16 v3, v165, v165, v3
    s_add_u32 m0, s31, 17408
    s_add_u32 s33, s29, 32768
    buffer_load_dwordx4 v245, s[8:11], s33 offen lds
    v_dot2_f32_bf16 v2, v166, v166, v2
    v_dot2_f32_bf16 v3, v167, v167, v3
    v_mfma_f32_32x32x16_bf16 v[16:31], v[8:11], v[168:171], v[16:31]
    v_dot2_f32_bf16 v2, v168, v168, v2
    v_dot2_f32_bf16 v3, v169, v169, v3
    s_add_u32 m0, s31, 18432
    s_add_u32 s33, s29, 65536
    buffer_load_dwordx4 v245, s[8:11], s33 offen lds
    v_dot2_f32_bf16 v2, v170, v170, v2
    v_dot2_f32_bf16 v3, v171, v171, v3
    v_mfma_f32_32x32x16_bf16 v[32:47], v[8:11], v[172:175], v[32:47]
    v_dot2_f32_bf16 v2, v172, v172, v2
    v_dot2_f32_bf16 v3, v173, v173, v3
    s_add_u32 m0, s31, 19456
    s_add_u32 s33, s29, 98304
    buffer_load_dwordx4 v245, s[8:11], s33 offen lds
    v_dot2_f32_bf16 v2, v174, v174, v2
    v_dot2_f32_bf16 v3, v175, v175, v3
    v_mfma_f32_32x32x16_bf16 v[16:31], v[8:11], v[176:179], v[16:31]
    v_dot2_f32_bf16 v2, v176, v176, v2
    v_dot2_f32_bf16 v3, v177, v177, v3
    s_add_u32 m0, s31, 20480
    s_add_u32 s33, s29, 131072
    buffer_load_dwordx4 v245, s[8:11], s33 offen lds
    v_dot2_f32_bf16 v2, v178, v178, v2
    v_dot2_f32_bf16 v3, v179, v179, v3
    v_mfma_f32_32x32x16_bf16 v[32:47], v[8:11], v[180:183], v[32:47]
    v_dot2_f32_bf16 v2, v180, v180, v2
    v_dot2_f32_bf16 v3, v181, v181, v3
    s_add_u32 m0, s31, 21504
    s_add_u32 s33, s29, 163840
    buffer_load_dwordx4 v245, s[8:11], s33 offen lds
    v_dot2_f32_bf16 v2, v182, v182, v2
    v_dot2_f32_bf16 v3, v183, v183, v3
    v_mfma_f32_32x32x16_bf16 v[16:31], v[8:11], v[184:187], v[16:31]
    v_dot2_f32_bf16 v2, v184, v184, v2
    v_dot2_f32_bf16 v3, v185, v185, v3
    s_add_u32 m0, s31, 22528
    s_add_u32 s33, s29, 196608
    buffer_load_dwordx4 v245, s[8:11], s33 offen lds
    v_dot2_f32_bf16 v2, v186, v186, v2
    v_dot2_f32_bf16 v3, v187, v187, v3
    v_mfma_f32_32x32x16_bf16 v[32:47], v[8:11], v[188:191], v[32:47]
    v_dot2_f32_bf16 v2, v188, v188, v2
    v_dot2_f32_bf16 v3, v189, v189, v3
    s_add_u32 m0, s31, 23552
    s_add_u32 s33, s29, 229376
    buffer_load_dwordx4 v245, s[8:11], s33 offen lds
    v_dot2_f32_bf16 v2, v190, v190, v2
    v_dot2_f32_bf16 v3, v191, v191, v3
    v_mfma_f32_32x32x16_bf16 v[16:31], v[8:11], v[192:195], v[16:31]
    v_dot2_f32_bf16 v2, v192, v192, v2
    v_dot2_f32_bf16 v3, v193, v193, v3
    s_waitcnt vmcnt(16)
    v_readfirstlane_b32 s95, v13
    s_cmp_lt_u32 s95, 28
    s_cbranch_scc1 EP2
    s_lshl_b32 s32, s28, 10
    s_add_u32 m0, s32, 49152
    s_add_u32 s33, s32, 0
    buffer_load_dwordx4 v244, s[20:23], s33 offen sc1 lds
EP2:
    v_dot2_f32_bf16 v2, v194, v194, v2
    v_dot2_f32_bf16 v3, v195, v195, v3
    v_mfma_f32_32x32x16_bf16 v[32:47], v[8:11], v[196:199], v[32:47]
    v_dot2_f32_bf16 v2, v196, v196, v2
    v_dot2_f32_bf16 v3, v197, v197, v3
    s_add_u32 m0, s31, 98304
    s_add_u32 s33, s29, 524288
    buffer_load_dwordx4 v245, s[8:11], s33 offen lds
    v_dot2_f32_bf16 v2, v198, v198, v2
    v_dot2_f32_bf16 v3, v199, v199, v3
    v_mfma_f32_32x32x16_bf16 v[16:31], v[8:11], v[200:203], v[16:31]
    v_dot2_f32_bf16 v2, v200, v200, v2
    v_dot2_f32_bf16 v3, v201, v201, v3
    s_add_u32 m0, s31, 99328
    s_add_u32 s33, s29, 557056
    buffer_load_dwordx4 v245, s[8:11], s33 offen lds
    v_dot2_f32_bf16 v2, v202, v202, v2
    v_dot2_f32_bf16 v3, v203, v203, v3
    v_mfma_f32_32x32x16_bf16 v[32:47], v[8:11], v[204:207], v[32:47]
    v_dot2_f32_bf16 v2, v204, v204, v2
    v_dot2_f32_bf16 v3, v205, v205, v3
    s_add_u32 m0, s31, 100352
    s_add_u32 s33, s29, 589824
    buffer_load_dwordx4 v245, s[8:11], s33 offen lds
    v_dot2_f32_bf16 v2, v206, v206, v2
    v_dot2_f32_bf16 v3, v207, v207, v3
    v_mfma_f32_32x32x16_bf16 v[16:31], v[8:11], v[208:211], v[16:31]
    v_dot2_f32_bf16 v2, v208, v208, v2
    v_dot2_f32_bf16 v3, v209, v209, v3
    s_add_u32 m0, s31, 101376
    s_add_u32 s33, s29, 622592
    buffer_load_dwordx4 v245, s[8:11], s33 offen lds
    v_dot2_f32_bf16 v2, v210, v210, v2
    v_dot2_f32_bf16 v3, v211, v211, v3
    v_mfma_f32_32x32x16_bf16 v[32:47], v[8:11], v[212:215], v[32:47]
    v_dot2_f32_bf16 v2, v212, v212, v2
    v_dot2_f32_bf16 v3, v213, v213, v3
    s_add_u32 m0, s31, 102400
    s_add_u32 s33, s29, 655360
    buffer_load_dwordx4 v245, s[8:11], s33 offen lds
    v_dot2_f32_bf16 v2, v214, v214, v2
    v_dot2_f32_bf16 v3, v215, v215, v3
    v_mfma_f32_32x32x16_bf16 v[16:31], v[8:11], v[216:219], v[16:31]
    v_dot2_f32_bf16 v2, v216, v216, v2
    v_dot2_f32_bf16 v3, v217, v217, v3
    s_add_u32 m0, s31, 103424
    s_add_u32 s33, s29, 688128
    buffer_load_dwordx4 v245, s[8:11], s33 offen lds
    v_dot2_f32_bf16 v2, v218, v218, v2
    v_dot2_f32_bf16 v3, v219, v219, v3
    v_mfma_f32_32x32x16_bf16 v[32:47], v[8:11], v[220:223], v[32:47]
    v_dot2_f32_bf16 v2, v220, v220, v2
    v_dot2_f32_bf16 v3, v221, v221, v3
    s_add_u32 m0, s31, 104448
    s_add_u32 s33, s29, 720896
    buffer_load_dwordx4 v245, s[8:11], s33 offen lds
    v_dot2_f32_bf16 v2, v222, v222, v2
    v_dot2_f32_bf16 v3, v223, v223, v3
    v_mfma_f32_32x32x16_bf16 v[16:31], v[8:11], v[224:227], v[16:31]
    v_dot2_f32_bf16 v2, v224, v224, v2
    v_dot2_f32_bf16 v3, v225, v225, v3
    s_add_u32 m0, s31, 105472
    s_add_u32 s33, s29, 753664
    buffer_load_dwordx4 v245, s[8:11], s33 offen lds
    v_dot2_f32_bf16 v2, v226, v226, v2
    v_dot2_f32_bf16 v3, v227, v227, v3
    v_mfma_f32_32x32x16_bf16 v[32:47], v[8:11], v[228:231], v[32:47]
    v_dot2_f32_bf16 v2, v228, v228, v2
    v_dot2_f32_bf16 v3, v229, v229, v3
    v_dot2_f32_bf16 v2, v230, v230, v2
    v_dot2_f32_bf16 v3, v231, v231, v3
    v_mfma_f32_32x32x16_bf16 v[16:31], v[8:11], v[232:235], v[16:31]
    v_dot2_f32_bf16 v2, v232, v232, v2
    v_dot2_f32_bf16 v3, v233, v233, v3
    v_dot2_f32_bf16 v2, v234, v234, v2
    v_dot2_f32_bf16 v3, v235, v235, v3
    v_mfma_f32_32x32x16_bf16 v[32:47], v[8:11], v[236:239], v[32:47]
    v_dot2_f32_bf16 v2, v236, v236, v2
    v_dot2_f32_bf16 v3, v237, v237, v3
    v_dot2_f32_bf16 v2, v238, v238, v2
    v_dot2_f32_bf16 v3, v239, v239, v3
    s_nop 2
    v_add_f32 v2, v2, v3
    s_nop 0
    v_mov_b32 v3, v2
    s_nop 1
    v_permlane32_swap_b32 v2, v3
    s_mov_b32 s36, 0x3b124925
    v_add_f32 v2, v2, v3
    s_nop 7
    v_mul_f32 v2, s36, v2
    s_nop 3
    v_add_f32 v0, v16, v32
    v_mul_f32 v0, s36, v0
    v_fma_f32 v2, -v0, v0, v2
    v_max_f32 v2, 0, v2
    v_cvt_pk_bf16_f32 v0, 0, v0
    v_cvt_pk_bf16_f32 v2, 0, v2
    v_add_f32 v2, 0x3727c5ac, v2
    v_cvt_pk_bf16_f32 v2, 0, v2
    v_sqrt_f32 v2, v2
    s_nop 0
    v_cvt_pk_bf16_f32 v2, 0, v2
    v_rcp_f32 v14, v2
    s_nop 0
    v_mul_f32 v15, v0, v14
    v_sub_f32 v15, 0, v15
    s_cmp_ge_u32 s95, 28
    s_cbranch_scc1 EP5
    s_mov_b32 s72, 0
EP3:
    s_cmp_eq_u32 s73, 1
    s_cbranch_scc1 EP4
    s_sleep 2
    buffer_load_dword v12, off, s[64:67], 0 sc1
    s_waitcnt vmcnt(0)
    v_readfirstlane_b32 s73, v12
    s_add_u32 s72, s72, 1
    s_cmp_lt_u32 s72, 0x400000
    s_cbranch_scc1 EP3
EP4:
    buffer_load_dword v13, off, s[68:71], s74 sc1
    s_waitcnt vmcnt(0)
    v_readfirstlane_b32 s95, v13
    s_cmp_ge_u32 s95, 28
    s_cbranch_scc1 EP6
    s_sleep 2
    s_add_u32 s72, s72, 1
    s_cmp_lt_u32 s72, 0x800000
    s_cbranch_scc1 EP4
EP6:
    s_lshl_b32 s32, s28, 10
    s_add_u32 m0, s32, 49152
    s_add_u32 s33, s32, 0
    buffer_load_dwordx4 v244, s[20:23], s33 offen sc1 lds
    s_waitcnt vmcnt(0)
EP5:
    s_waitcnt vmcnt(8)
    s_barrier
    ds_read_b128 v[16:19], v243 offset:50944
    ds_read_b128 v[24:27], v243 offset:49152
    ds_read_b128 v[20:23], v243 offset:50960
    ds_read_b128 v[28:31], v243 offset:49168
    ds_read_b128 v[32:35], v243 offset:51008
    ds_read_b128 v[40:43], v243 offset:49216
    ds_read_b128 v[36:39], v243 offset:51024
    ds_read_b128 v[44:47], v243 offset:49232
    ds_read_b128 v[48:51], v243 offset:51072
    ds_read_b128 v[56:59], v243 offset:49280
    ds_read_b128 v[52:55], v243 offset:51088
    ds_read_b128 v[60:63], v243 offset:49296
    ds_read_b128 v[64:67], v243 offset:51136
    ds_read_b128 v[72:75], v243 offset:49344
    ds_read_b128 v[68:71], v243 offset:51152
    ds_read_b128 v[76:79], v243 offset:49360
    ds_read_b64_tr_b16 a[64:65], v246 offset:0
    ds_read_b64_tr_b16 a[66:67], v246 offset:1024
    ds_read_b64_tr_b16 a[68:69], v247 offset:0
    ds_read_b64_tr_b16 a[70:71], v247 offset:1024
    ds_read_b64_tr_b16 a[72:73], v248 offset:0
    ds_read_b64_tr_b16 a[74:75], v248 offset:1024
    ds_read_b64_tr_b16 a[76:77], v249 offset:0
    ds_read_b64_tr_b16 a[78:79], v249 offset:1024
    ds_read_b64_tr_b16 a[80:81], v246 offset:16384
    ds_read_b64_tr_b16 a[82:83], v246 offset:17408
    ds_read_b64_tr_b16 a[84:85], v247 offset:16384
    ds_read_b64_tr_b16 a[86:87], v247 offset:17408
    ds_read_b64_tr_b16 a[88:89], v248 offset:16384
    ds_read_b64_tr_b16 a[90:91], v248 offset:17408
    s_waitcnt lgkmcnt(15)
    v_lshlrev_b32 v112, 16, v128
    v_and_b32 v113, 0xffff0000, v128
    v_fma_f32 v112, v112, v14, v15
    v_fma_f32 v113, v113, v14, v15
    v_fma_f32 v112, v112, v16, v24
    v_fma_f32 v113, v113, v17, v25
    v_cvt_pk_bf16_f32 v128, v112, v113
    v_lshlrev_b32 v114, 16, v129
    v_and_b32 v115, 0xffff0000, v129
    v_fma_f32 v114, v114, v14, v15
    v_fma_f32 v115, v115, v14, v15
    v_fma_f32 v114, v114, v18, v26
    v_fma_f32 v115, v115, v19, v27
    v_cvt_pk_bf16_f32 v129, v114, v115
    v_lshlrev_b32 v116, 16, v130
    v_and_b32 v117, 0xffff0000, v130
    v_fma_f32 v116, v116, v14, v15
    v_fma_f32 v117, v117, v14, v15
    v_fma_f32 v116, v116, v20, v28
    v_fma_f32 v117, v117, v21, v29
    v_cvt_pk_bf16_f32 v130, v116, v117
    v_lshlrev_b32 v118, 16, v131
    v_and_b32 v119, 0xffff0000, v131
    v_fma_f32 v118, v118, v14, v15
    v_fma_f32 v119, v119, v14, v15
    v_fma_f32 v118, v118, v22, v30
    v_fma_f32 v119, v119, v23, v31
    v_cvt_pk_bf16_f32 v131, v118, v119
    v_lshlrev_b32 v120, 16, v132
    v_and_b32 v121, 0xffff0000, v132
    v_fma_f32 v120, v120, v14, v15
    v_fma_f32 v121, v121, v14, v15
    v_fma_f32 v120, v120, v32, v40
    v_fma_f32 v121, v121, v33, v41
    v_cvt_pk_bf16_f32 v132, v120, v121
    v_lshlrev_b32 v122, 16, v133
    v_and_b32 v123, 0xffff0000, v133
    v_fma_f32 v122, v122, v14, v15
    v_fma_f32 v123, v123, v14, v15
    v_fma_f32 v122, v122, v34, v42
    v_fma_f32 v123, v123, v35, v43
    v_cvt_pk_bf16_f32 v133, v122, v123
    v_lshlrev_b32 v124, 16, v134
    v_and_b32 v125, 0xffff0000, v134
    v_fma_f32 v124, v124, v14, v15
    v_fma_f32 v125, v125, v14, v15
    v_fma_f32 v124, v124, v36, v44
    v_fma_f32 v125, v125, v37, v45
    v_cvt_pk_bf16_f32 v134, v124, v125
    v_lshlrev_b32 v126, 16, v135
    v_and_b32 v127, 0xffff0000, v135
    v_fma_f32 v126, v126, v14, v15
    v_fma_f32 v127, v127, v14, v15
    v_fma_f32 v126, v126, v38, v46
    v_fma_f32 v127, v127, v39, v47
    v_cvt_pk_bf16_f32 v135, v126, v127
    v_lshlrev_b32 v112, 16, v136
    v_and_b32 v113, 0xffff0000, v136
    v_fma_f32 v112, v112, v14, v15
    v_fma_f32 v113, v113, v14, v15
    v_fma_f32 v112, v112, v48, v56
    v_fma_f32 v113, v113, v49, v57
    v_cvt_pk_bf16_f32 v136, v112, v113
    v_lshlrev_b32 v114, 16, v137
    v_and_b32 v115, 0xffff0000, v137
    v_fma_f32 v114, v114, v14, v15
    v_fma_f32 v115, v115, v14, v15
    v_fma_f32 v114, v114, v50, v58
    v_fma_f32 v115, v115, v51, v59
    v_cvt_pk_bf16_f32 v137, v114, v115
    v_lshlrev_b32 v116, 16, v138
    v_and_b32 v117, 0xffff0000, v138
    v_fma_f32 v116, v116, v14, v15
    v_fma_f32 v117, v117, v14, v15
    v_fma_f32 v116, v116, v52, v60
    v_fma_f32 v117, v117, v53, v61
    v_cvt_pk_bf16_f32 v138, v116, v117
    v_lshlrev_b32 v118, 16, v139
    v_and_b32 v119, 0xffff0000, v139
    v_fma_f32 v118, v118, v14, v15
    v_fma_f32 v119, v119, v14, v15
    v_fma_f32 v118, v118, v54, v62
    v_fma_f32 v119, v119, v55, v63
    v_cvt_pk_bf16_f32 v139, v118, v119
    s_waitcnt lgkmcnt(14)
    v_lshlrev_b32 v120, 16, v140
    v_and_b32 v121, 0xffff0000, v140
    v_fma_f32 v120, v120, v14, v15
    v_fma_f32 v121, v121, v14, v15
    v_fma_f32 v120, v120, v64, v72
    v_fma_f32 v121, v121, v65, v73
    v_cvt_pk_bf16_f32 v140, v120, v121
    v_lshlrev_b32 v122, 16, v141
    v_and_b32 v123, 0xffff0000, v141
    v_fma_f32 v122, v122, v14, v15
    v_fma_f32 v123, v123, v14, v15
    v_fma_f32 v122, v122, v66, v74
    v_fma_f32 v123, v123, v67, v75
    v_cvt_pk_bf16_f32 v141, v122, v123
    v_lshlrev_b32 v124, 16, v142
    v_and_b32 v125, 0xffff0000, v142
    v_fma_f32 v124, v124, v14, v15
    v_fma_f32 v125, v125, v14, v15
    v_fma_f32 v124, v124, v68, v76
    v_fma_f32 v125, v125, v69, v77
    v_cvt_pk_bf16_f32 v142, v124, v125
    v_lshlrev_b32 v126, 16, v143
    v_and_b32 v127, 0xffff0000, v143
    v_fma_f32 v126, v126, v14, v15
    v_fma_f32 v127, v127, v14, v15
    v_fma_f32 v126, v126, v70, v78
    v_fma_f32 v127, v127, v71, v79
    v_cvt_pk_bf16_f32 v143, v126, v127
    s_waitcnt lgkmcnt(6)
    v_mfma_f32_32x32x16_bf16 a[128:143], a[64:67], v[128:131], 0
    ds_read_b64_tr_b16 a[92:93], v249 offset:16384
    ds_read_b64_tr_b16 a[94:95], v249 offset:17408
    ds_read_b128 v[80:83], v243 offset:51200
    ds_read_b128 v[88:91], v243 offset:49408
    ds_read_b128 v[84:87], v243 offset:51216
    ds_read_b128 v[92:95], v243 offset:49424
    v_mfma_f32_32x32x16_bf16 a[144:159], a[68:71], v[128:131], 0
    ds_read_b64_tr_b16 a[64:65], v246 offset:4096
    ds_read_b64_tr_b16 a[66:67], v246 offset:5120
    s_add_u32 m0, s31, 65536
    s_add_u32 s33, s29, 1572864
    buffer_load_dwordx4 v245, s[8:11], s33 offen lds
    v_mfma_f32_32x32x16_bf16 a[160:175], a[72:75], v[128:131], 0
    ds_read_b64_tr_b16 a[68:69], v247 offset:4096
    ds_read_b64_tr_b16 a[70:71], v247 offset:5120
    v_mfma_f32_32x32x16_bf16 a[176:191], a[76:79], v[128:131], 0
    ds_read_b64_tr_b16 a[72:73], v248 offset:4096
    ds_read_b64_tr_b16 a[74:75], v248 offset:5120
    s_add_u32 m0, s31, 66560
    s_add_u32 s33, s29, 1605632
    buffer_load_dwordx4 v245, s[8:11], s33 offen lds
    s_waitcnt lgkmcnt(6)
    v_lshlrev_b32 v112, 16, v144
    v_mfma_f32_32x32x16_bf16 a[192:207], a[80:83], v[128:131], 0
    ds_read_b64_tr_b16 a[76:77], v249 offset:4096
    ds_read_b64_tr_b16 a[78:79], v249 offset:5120
    s_add_u32 m0, s49, 0
    s_nop 0
    buffer_load_dwordx4 v250, s[12:15], s47 offen offset:0 lds
    v_and_b32 v113, 0xffff0000, v144
    v_fma_f32 v112, v112, v14, v15
    v_mfma_f32_32x32x16_bf16 a[208:223], a[84:87], v[128:131], 0
    ds_read_b64_tr_b16 a[80:81], v246 offset:20480
    ds_read_b64_tr_b16 a[82:83], v246 offset:21504
    v_fma_f32 v113, v113, v14, v15
    v_fma_f32 v112, v112, v80, v88
    v_fma_f32 v113, v113, v81, v89
    v_cvt_pk_bf16_f32 v144, v112, v113
    v_lshlrev_b32 v114, 16, v145
    v_mfma_f32_32x32x16_bf16 a[224:239], a[88:91], v[128:131], 0
    ds_read_b64_tr_b16 a[84:85], v247 offset:20480
    ds_read_b64_tr_b16 a[86:87], v247 offset:21504
    ds_read_b128 v[96:99], v243 offset:51264
    ds_read_b128 v[104:107], v243 offset:49472
    ds_read_b128 v[100:103], v243 offset:51280
    ds_read_b128 v[108:111], v243 offset:49488
    s_add_u32 m0, s31, 67584
    s_add_u32 s33, s29, 1638400
    buffer_load_dwordx4 v245, s[8:11], s33 offen lds
    v_mfma_f32_32x32x16_bf16 a[240:255], a[92:95], v[128:131], 0
    ds_read_b64_tr_b16 a[88:89], v248 offset:20480
    ds_read_b64_tr_b16 a[90:91], v248 offset:21504
    v_and_b32 v115, 0xffff0000, v145
    v_fma_f32 v114, v114, v14, v15
    v_fma_f32 v115, v115, v14, v15
    v_fma_f32 v114, v114, v82, v90
    s_waitcnt lgkmcnt(10)
    v_mfma_f32_32x32x16_bf16 a[128:143], a[64:67], v[132:135], a[128:143]
    ds_read_b64_tr_b16 a[92:93], v249 offset:20480
    ds_read_b64_tr_b16 a[94:95], v249 offset:21504
    s_add_u32 m0, s31, 68608
    s_add_u32 s33, s29, 1671168
    buffer_load_dwordx4 v245, s[8:11], s33 offen lds
    v_fma_f32 v115, v115, v83, v91
    v_cvt_pk_bf16_f32 v145, v114, v115
    v_mfma_f32_32x32x16_bf16 a[144:159], a[68:71], v[132:135], a[144:159]
    ds_read_b64_tr_b16 a[64:65], v246 offset:8192
    ds_read_b64_tr_b16 a[66:67], v246 offset:9216
    v_lshlrev_b32 v116, 16, v146
    v_and_b32 v117, 0xffff0000, v146
    v_fma_f32 v116, v116, v14, v15
    v_fma_f32 v117, v117, v14, v15
    v_fma_f32 v116, v116, v84, v92
    v_mfma_f32_32x32x16_bf16 a[160:175], a[72:75], v[132:135], a[160:175]
    ds_read_b64_tr_b16 a[68:69], v247 offset:8192
    ds_read_b64_tr_b16 a[70:71], v247 offset:9216
    s_add_u32 m0, s49, 0
    s_nop 0
    buffer_load_dwordx4 v251, s[12:15], s47 offen offset:1024 lds
    v_fma_f32 v117, v117, v85, v93
    v_cvt_pk_bf16_f32 v146, v116, v117
    v_mfma_f32_32x32x16_bf16 a[176:191], a[76:79], v[132:135], a[176:191]
    ds_read_b64_tr_b16 a[72:73], v248 offset:8192
    ds_read_b64_tr_b16 a[74:75], v248 offset:9216
    v_lshlrev_b32 v118, 16, v147
    v_and_b32 v119, 0xffff0000, v147
    v_fma_f32 v118, v118, v14, v15
    v_fma_f32 v119, v119, v14, v15
    s_waitcnt lgkmcnt(6)
    v_mfma_f32_32x32x16_bf16 a[192:207], a[80:83], v[132:135], a[192:207]
    ds_read_b64_tr_b16 a[76:77], v249 offset:8192
    ds_read_b64_tr_b16 a[78:79], v249 offset:9216
    ds_read_b128 v[16:19], v243 offset:51328
    ds_read_b128 v[24:27], v243 offset:49536
    ds_read_b128 v[20:23], v243 offset:51344
    ds_read_b128 v[28:31], v243 offset:49552
    s_waitcnt vmcnt(6)
    s_barrier
    s_add_u32 m0, s31, 69632
    s_add_u32 s33, s29, 1703936
    buffer_load_dwordx4 v245, s[8:11], s33 offen lds
    v_mfma_f32_32x32x16_bf16 a[208:223], a[84:87], v[132:135], a[208:223]
    ds_read_b64_tr_b16 a[80:81], v246 offset:24576
    ds_read_b64_tr_b16 a[82:83], v246 offset:25600
    v_fma_f32 v118, v118, v86, v94
    v_fma_f32 v119, v119, v87, v95
    v_cvt_pk_bf16_f32 v147, v118, v119
    v_lshlrev_b32 v120, 16, v148
    v_and_b32 v121, 0xffff0000, v148
    v_mfma_f32_32x32x16_bf16 a[224:239], a[88:91], v[132:135], a[224:239]
    ds_read_b64_tr_b16 a[84:85], v247 offset:24576
    ds_read_b64_tr_b16 a[86:87], v247 offset:25600
    s_add_u32 m0, s31, 70656
    s_add_u32 s33, s29, 1736704
    buffer_load_dwordx4 v245, s[8:11], s33 offen lds
    v_fma_f32 v120, v120, v14, v15
    v_fma_f32 v121, v121, v14, v15
    v_mfma_f32_32x32x16_bf16 a[240:255], a[92:95], v[132:135], a[240:255]
    ds_read_b64_tr_b16 a[88:89], v248 offset:24576
    ds_read_b64_tr_b16 a[90:91], v248 offset:25600
    v_fma_f32 v120, v120, v96, v104
    v_fma_f32 v121, v121, v97, v105
    v_cvt_pk_bf16_f32 v148, v120, v121
    v_lshlrev_b32 v122, 16, v149
    s_waitcnt lgkmcnt(10)
    v_mfma_f32_32x32x16_bf16 a[128:143], a[64:67], v[136:139], a[128:143]
    ds_read_b64_tr_b16 a[92:93], v249 offset:24576
    ds_read_b64_tr_b16 a[94:95], v249 offset:25600
    s_add_u32 m0, s49, 0
    s_nop 0
    buffer_load_dwordx4 v252, s[12:15], s47 offen offset:2048 lds
    v_and_b32 v123, 0xffff0000, v149
    v_fma_f32 v122, v122, v14, v15
    v_mfma_f32_32x32x16_bf16 a[144:159], a[68:71], v[136:139], a[144:159]
    ds_read_b64_tr_b16 a[64:65], v246 offset:12288
    ds_read_b64_tr_b16 a[66:67], v246 offset:13312
    v_fma_f32 v123, v123, v14, v15
    v_fma_f32 v122, v122, v98, v106
    v_fma_f32 v123, v123, v99, v107
    v_cvt_pk_bf16_f32 v149, v122, v123
    v_lshlrev_b32 v124, 16, v150
    v_mfma_f32_32x32x16_bf16 a[160:175], a[72:75], v[136:139], a[160:175]
    ds_read_b64_tr_b16 a[68:69], v247 offset:12288
    ds_read_b64_tr_b16 a[70:71], v247 offset:13312
    ds_read_b128 v[32:35], v243 offset:51392
    ds_read_b128 v[40:43], v243 offset:49600
    ds_read_b128 v[36:39], v243 offset:51408
    ds_read_b128 v[44:47], v243 offset:49616
    s_add_u32 m0, s31, 71680
    s_add_u32 s33, s29, 1769472
    buffer_load_dwordx4 v245, s[8:11], s33 offen lds
    v_mfma_f32_32x32x16_bf16 a[176:191], a[76:79], v[136:139], a[176:191]
    ds_read_b64_tr_b16 a[72:73], v248 offset:12288
    ds_read_b64_tr_b16 a[74:75], v248 offset:13312
    v_and_b32 v125, 0xffff0000, v150
    v_fma_f32 v124, v124, v14, v15
    v_fma_f32 v125, v125, v14, v15
    v_fma_f32 v124, v124, v100, v108
    s_waitcnt lgkmcnt(10)
    v_mfma_f32_32x32x16_bf16 a[192:207], a[80:83], v[136:139], a[192:207]
    ds_read_b64_tr_b16 a[76:77], v249 offset:12288
    ds_read_b64_tr_b16 a[78:79], v249 offset:13312
    s_add_u32 m0, s31, 72704
    s_add_u32 s33, s29, 1802240
    buffer_load_dwordx4 v245, s[8:11], s33 offen lds
    v_fma_f32 v125, v125, v101, v109
    v_cvt_pk_bf16_f32 v150, v124, v125
    v_mfma_f32_32x32x16_bf16 a[208:223], a[84:87], v[136:139], a[208:223]
    ds_read_b64_tr_b16 a[80:81], v246 offset:28672
    ds_read_b64_tr_b16 a[82:83], v246 offset:29696
    v_lshlrev_b32 v126, 16, v151
    v_and_b32 v127, 0xffff0000, v151
    v_fma_f32 v126, v126, v14, v15
    v_fma_f32 v127, v127, v14, v15
    v_fma_f32 v126, v126, v102, v110
    v_mfma_f32_32x32x16_bf16 a[224:239], a[88:91], v[136:139], a[224:239]
    ds_read_b64_tr_b16 a[84:85], v247 offset:28672
    ds_read_b64_tr_b16 a[86:87], v247 offset:29696
    s_add_u32 m0, s49, 0
    s_nop 0
    buffer_load_dwordx4 v253, s[12:15], s47 offen offset:3072 lds
    s_add_u32 s47, s47, 16384
    s_and_b32 s47, s47, 0xfffff
    v_fma_f32 v127, v127, v103, v111
    v_cvt_pk_bf16_f32 v151, v126, v127
    v_mfma_f32_32x32x16_bf16 a[240:255], a[92:95], v[136:139], a[240:255]
    ds_read_b64_tr_b16 a[88:89], v248 offset:28672
    ds_read_b64_tr_b16 a[90:91], v248 offset:29696
    v_lshlrev_b32 v112, 16, v152
    v_and_b32 v113, 0xffff0000, v152
    v_fma_f32 v112, v112, v14, v15
    v_fma_f32 v113, v113, v14, v15
    s_waitcnt lgkmcnt(6)
    v_mfma_f32_32x32x16_bf16 a[128:143], a[64:67], v[140:143], a[128:143]
    ds_read_b64_tr_b16 a[92:93], v249 offset:28672
    ds_read_b64_tr_b16 a[94:95], v249 offset:29696
    v_fma_f32 v112, v112, v16, v24
    v_fma_f32 v113, v113, v17, v25
    v_cvt_pk_bf16_f32 v152, v112, v113
    v_lshlrev_b32 v114, 16, v153
    v_and_b32 v115, 0xffff0000, v153
    v_mfma_f32_32x32x16_bf16 a[144:159], a[68:71], v[140:143], a[144:159]
    v_add_u32 v246, 0x14000, v246
    v_add_u32 v247, 0x14000, v247
    v_add_u32 v248, 0x14000, v248
    v_add_u32 v249, 0x14000, v249
    ds_read_b64_tr_b16 a[64:65], v246 offset:0
    ds_read_b64_tr_b16 a[66:67], v246 offset:1024
    v_fma_f32 v114, v114, v14, v15
    v_fma_f32 v115, v115, v14, v15
    v_fma_f32 v114, v114, v18, v26
    v_fma_f32 v115, v115, v19, v27
    v_cvt_pk_bf16_f32 v153, v114, v115
    v_mfma_f32_32x32x16_bf16 a[160:175], a[72:75], v[140:143], a[160:175]
    ds_read_b64_tr_b16 a[68:69], v247 offset:0
    ds_read_b64_tr_b16 a[70:71], v247 offset:1024
    v_lshlrev_b32 v116, 16, v154
    v_and_b32 v117, 0xffff0000, v154
    v_fma_f32 v116, v116, v14, v15
    v_fma_f32 v117, v117, v14, v15
    v_fma_f32 v116, v116, v20, v28
    v_mfma_f32_32x32x16_bf16 a[176:191], a[76:79], v[140:143], a[176:191]
    ds_read_b64_tr_b16 a[72:73], v248 offset:0
    ds_read_b64_tr_b16 a[74:75], v248 offset:1024
    v_fma_f32 v117, v117, v21, v29
    v_cvt_pk_bf16_f32 v154, v116, v117
    v_lshlrev_b32 v118, 16, v155
    v_and_b32 v119, 0xffff0000, v155
    s_waitcnt lgkmcnt(6)
    v_mfma_f32_32x32x16_bf16 a[192:207], a[80:83], v[140:143], a[192:207]
    ds_read_b64_tr_b16 a[76:77], v249 offset:0
    ds_read_b64_tr_b16 a[78:79], v249 offset:1024
    v_fma_f32 v118, v118, v14, v15
    v_fma_f32 v119, v119, v14, v15
    v_fma_f32 v118, v118, v22, v30
    v_fma_f32 v119, v119, v23, v31
    v_cvt_pk_bf16_f32 v155, v118, v119
    v_mfma_f32_32x32x16_bf16 a[208:223], a[84:87], v[140:143], a[208:223]
    ds_read_b64_tr_b16 a[80:81], v246 offset:16384
    ds_read_b64_tr_b16 a[82:83], v246 offset:17408
    v_lshlrev_b32 v120, 16, v156
    v_and_b32 v121, 0xffff0000, v156
    v_fma_f32 v120, v120, v14, v15
    v_fma_f32 v121, v121, v14, v15
    v_fma_f32 v120, v120, v32, v40
    v_mfma_f32_32x32x16_bf16 a[224:239], a[88:91], v[140:143], a[224:239]
    ds_read_b64_tr_b16 a[84:85], v247 offset:16384
    ds_read_b64_tr_b16 a[86:87], v247 offset:17408
    v_fma_f32 v121, v121, v33, v41
    v_cvt_pk_bf16_f32 v156, v120, v121
    v_lshlrev_b32 v122, 16, v157
    v_and_b32 v123, 0xffff0000, v157
    v_fma_f32 v122, v122, v14, v15
    v_fma_f32 v123, v123, v14, v15
    v_fma_f32 v122, v122, v34, v42
    v_fma_f32 v123, v123, v35, v43
    v_cvt_pk_bf16_f32 v157, v122, v123
    v_lshlrev_b32 v124, 16, v158
    v_and_b32 v125, 0xffff0000, v158
    v_fma_f32 v124, v124, v14, v15
    v_fma_f32 v125, v125, v14, v15
    v_fma_f32 v124, v124, v36, v44
    v_fma_f32 v125, v125, v37, v45
    v_cvt_pk_bf16_f32 v158, v124, v125
    v_lshlrev_b32 v126, 16, v159
    v_and_b32 v127, 0xffff0000, v159
    v_fma_f32 v126, v126, v14, v15
    v_fma_f32 v127, v127, v14, v15
    v_fma_f32 v126, v126, v38, v46
    v_fma_f32 v127, v127, v39, v47
    v_cvt_pk_bf16_f32 v159, v126, v127
    v_mfma_f32_32x32x16_bf16 a[240:255], a[92:95], v[140:143], a[240:255]
    ds_read_b64_tr_b16 a[88:89], v248 offset:16384
    ds_read_b64_tr_b16 a[90:91], v248 offset:17408
    s_waitcnt lgkmcnt(6)
    v_mfma_f32_32x32x16_bf16 a[128:143], a[64:67], v[144:147], a[128:143]
    ds_read_b64_tr_b16 a[92:93], v249 offset:16384
    ds_read_b64_tr_b16 a[94:95], v249 offset:17408
    ds_read_b128 v[48:51], v243 offset:51456
    ds_read_b128 v[56:59], v243 offset:49664
    ds_read_b128 v[52:55], v243 offset:51472
    ds_read_b128 v[60:63], v243 offset:49680
    v_mfma_f32_32x32x16_bf16 a[144:159], a[68:71], v[144:147], a[144:159]
    ds_read_b64_tr_b16 a[64:65], v246 offset:4096
    ds_read_b64_tr_b16 a[66:67], v246 offset:5120
    v_mfma_f32_32x32x16_bf16 a[160:175], a[72:75], v[144:147], a[160:175]
    ds_read_b64_tr_b16 a[68:69], v247 offset:4096
    ds_read_b64_tr_b16 a[70:71], v247 offset:5120
    v_mfma_f32_32x32x16_bf16 a[176:191], a[76:79], v[144:147], a[176:191]
    ds_read_b64_tr_b16 a[72:73], v248 offset:4096
    ds_read_b64_tr_b16 a[74:75], v248 offset:5120
    s_waitcnt lgkmcnt(6)
    v_lshlrev_b32 v112, 16, v160
    v_and_b32 v113, 0xffff0000, v160
    v_fma_f32 v112, v112, v14, v15
    v_fma_f32 v113, v113, v14, v15
    v_mfma_f32_32x32x16_bf16 a[192:207], a[80:83], v[144:147], a[192:207]
    ds_read_b64_tr_b16 a[76:77], v249 offset:4096
    ds_read_b64_tr_b16 a[78:79], v249 offset:5120
    v_fma_f32 v112, v112, v48, v56
    v_fma_f32 v113, v113, v49, v57
    v_cvt_pk_bf16_f32 v160, v112, v113
    v_lshlrev_b32 v114, 16, v161
    v_and_b32 v115, 0xffff0000, v161
    v_mfma_f32_32x32x16_bf16 a[208:223], a[84:87], v[144:147], a[208:223]
    ds_read_b64_tr_b16 a[80:81], v246 offset:20480
    ds_read_b64_tr_b16 a[82:83], v246 offset:21504
    v_fma_f32 v114, v114, v14, v15
    v_fma_f32 v115, v115, v14, v15
    v_fma_f32 v114, v114, v50, v58
    v_fma_f32 v115, v115, v51, v59
    v_cvt_pk_bf16_f32 v161, v114, v115
    v_mfma_f32_32x32x16_bf16 a[224:239], a[88:91], v[144:147], a[224:239]
    ds_read_b64_tr_b16 a[84:85], v247 offset:20480
    ds_read_b64_tr_b16 a[86:87], v247 offset:21504
    ds_read_b128 v[64:67], v243 offset:51520
    ds_read_b128 v[72:75], v243 offset:49728
    ds_read_b128 v[68:71], v243 offset:51536
    ds_read_b128 v[76:79], v243 offset:49744
    v_lshlrev_b32 v116, 16, v162
    v_and_b32 v117, 0xffff0000, v162
    v_fma_f32 v116, v116, v14, v15
    v_mfma_f32_32x32x16_bf16 a[240:255], a[92:95], v[144:147], a[240:255]
    ds_read_b64_tr_b16 a[88:89], v248 offset:20480
    ds_read_b64_tr_b16 a[90:91], v248 offset:21504
    v_fma_f32 v117, v117, v14, v15
    v_fma_f32 v116, v116, v52, v60
    v_fma_f32 v117, v117, v53, v61
    v_cvt_pk_bf16_f32 v162, v116, v117
    s_waitcnt lgkmcnt(10)
    v_mfma_f32_32x32x16_bf16 a[128:143], a[64:67], v[148:151], a[128:143]
    ds_read_b64_tr_b16 a[92:93], v249 offset:20480
    ds_read_b64_tr_b16 a[94:95], v249 offset:21504
    v_lshlrev_b32 v118, 16, v163
    v_and_b32 v119, 0xffff0000, v163
    v_fma_f32 v118, v118, v14, v15
    v_fma_f32 v119, v119, v14, v15
    v_fma_f32 v118, v118, v54, v62
    v_mfma_f32_32x32x16_bf16 a[144:159], a[68:71], v[148:151], a[144:159]
    ds_read_b64_tr_b16 a[64:65], v246 offset:8192
    ds_read_b64_tr_b16 a[66:67], v246 offset:9216
    v_fma_f32 v119, v119, v55, v63
    v_cvt_pk_bf16_f32 v163, v118, v119
    s_waitcnt lgkmcnt(6)
    v_lshlrev_b32 v120, 16, v164
    v_and_b32 v121, 0xffff0000, v164
    v_fma_f32 v120, v120, v14, v15
    v_mfma_f32_32x32x16_bf16 a[160:175], a[72:75], v[148:151], a[160:175]
    ds_read_b64_tr_b16 a[68:69], v247 offset:8192
    ds_read_b64_tr_b16 a[70:71], v247 offset:9216
    v_fma_f32 v121, v121, v14, v15
    v_fma_f32 v120, v120, v64, v72
    v_fma_f32 v121, v121, v65, v73
    v_cvt_pk_bf16_f32 v164, v120, v121
    v_lshlrev_b32 v122, 16, v165
    v_mfma_f32_32x32x16_bf16 a[176:191], a[76:79], v[148:151], a[176:191]
    ds_read_b64_tr_b16 a[72:73], v248 offset:8192
    ds_read_b64_tr_b16 a[74:75], v248 offset:9216
    v_and_b32 v123, 0xffff0000, v165
    v_fma_f32 v122, v122, v14, v15
    v_fma_f32 v123, v123, v14, v15
    v_fma_f32 v122, v122, v66, v74
    s_waitcnt lgkmcnt(6)
    v_mfma_f32_32x32x16_bf16 a[192:207], a[80:83], v[148:151], a[192:207]
    ds_read_b64_tr_b16 a[76:77], v249 offset:8192
    ds_read_b64_tr_b16 a[78:79], v249 offset:9216
    ds_read_b128 v[80:83], v243 offset:51584
    ds_read_b128 v[88:91], v243 offset:49792
    ds_read_b128 v[84:87], v243 offset:51600
    ds_read_b128 v[92:95], v243 offset:49808
    s_barrier
    v_mfma_f32_32x32x16_bf16 a[208:223], a[84:87], v[148:151], a[208:223]
    ds_read_b64_tr_b16 a[80:81], v246 offset:24576
    ds_read_b64_tr_b16 a[82:83], v246 offset:25600
    s_add_u32 m0, s31, 16384
    s_add_u32 s33, s29, 2097152
    buffer_load_dwordx4 v245, s[8:11], s33 offen lds
    v_fma_f32 v123, v123, v67, v75
    v_cvt_pk_bf16_f32 v165, v122, v123
    v_mfma_f32_32x32x16_bf16 a[224:239], a[88:91], v[148:151], a[224:239]
    ds_read_b64_tr_b16 a[84:85], v247 offset:24576
    ds_read_b64_tr_b16 a[86:87], v247 offset:25600
    v_lshlrev_b32 v124, 16, v166
    v_and_b32 v125, 0xffff0000, v166
    v_fma_f32 v124, v124, v14, v15
    v_fma_f32 v125, v125, v14, v15
    v_fma_f32 v124, v124, v68, v76
    v_mfma_f32_32x32x16_bf16 a[240:255], a[92:95], v[148:151], a[240:255]
    ds_read_b64_tr_b16 a[88:89], v248 offset:24576
    ds_read_b64_tr_b16 a[90:91], v248 offset:25600
    v_fma_f32 v125, v125, v69, v77
    v_cvt_pk_bf16_f32 v166, v124, v125
    v_lshlrev_b32 v126, 16, v167
    v_and_b32 v127, 0xffff0000, v167
    s_waitcnt lgkmcnt(10)
    v_mfma_f32_32x32x16_bf16 a[128:143], a[64:67], v[152:155], a[128:143]
    ds_read_b64_tr_b16 a[92:93], v249 offset:24576
    ds_read_b64_tr_b16 a[94:95], v249 offset:25600
    s_add_u32 m0, s31, 17408
    s_add_u32 s33, s29, 2129920
    buffer_load_dwordx4 v245, s[8:11], s33 offen lds
    v_fma_f32 v126, v126, v14, v15
    v_fma_f32 v127, v127, v14, v15
    v_mfma_f32_32x32x16_bf16 a[144:159], a[68:71], v[152:155], a[144:159]
    ds_read_b64_tr_b16 a[64:65], v246 offset:12288
    ds_read_b64_tr_b16 a[66:67], v246 offset:13312
    v_fma_f32 v126, v126, v70, v78
    v_fma_f32 v127, v127, v71, v79
    v_cvt_pk_bf16_f32 v167, v126, v127
    s_waitcnt lgkmcnt(10)
    v_lshlrev_b32 v112, 16, v168
    v_and_b32 v113, 0xffff0000, v168
    v_mfma_f32_32x32x16_bf16 a[160:175], a[72:75], v[152:155], a[160:175]
    ds_read_b64_tr_b16 a[68:69], v247 offset:12288
    ds_read_b64_tr_b16 a[70:71], v247 offset:13312
    ds_read_b128 v[96:99], v243 offset:51648
    ds_read_b128 v[104:107], v243 offset:49856
    ds_read_b128 v[100:103], v243 offset:51664
    ds_read_b128 v[108:111], v243 offset:49872
    v_fma_f32 v112, v112, v14, v15
    v_fma_f32 v113, v113, v14, v15
    v_fma_f32 v112, v112, v80, v88
    v_mfma_f32_32x32x16_bf16 a[176:191], a[76:79], v[152:155], a[176:191]
    ds_read_b64_tr_b16 a[72:73], v248 offset:12288
    ds_read_b64_tr_b16 a[74:75], v248 offset:13312
    s_add_u32 m0, s31, 18432
    s_add_u32 s33, s29, 2162688
    buffer_load_dwordx4 v245, s[8:11], s33 offen lds
    v_fma_f32 v113, v113, v81, v89
    s_waitcnt lgkmcnt(10)
    v_mfma_f32_32x32x16_bf16 a[192:207], a[80:83], v[152:155], a[192:207]
    ds_read_b64_tr_b16 a[76:77], v249 offset:12288
    ds_read_b64_tr_b16 a[78:79], v249 offset:13312
    v_cvt_pk_bf16_f32 v168, v112, v113
    v_lshlrev_b32 v114, 16, v169
    v_and_b32 v115, 0xffff0000, v169
    v_fma_f32 v114, v114, v14, v15
    v_fma_f32 v115, v115, v14, v15
    v_mfma_f32_32x32x16_bf16 a[208:223], a[84:87], v[152:155], a[208:223]
    ds_read_b64_tr_b16 a[80:81], v246 offset:28672
    ds_read_b64_tr_b16 a[82:83], v246 offset:29696
    v_fma_f32 v114, v114, v82, v90
    v_fma_f32 v115, v115, v83, v91
    v_cvt_pk_bf16_f32 v169, v114, v115
    v_lshlrev_b32 v116, 16, v170
    v_and_b32 v117, 0xffff0000, v170
    v_mfma_f32_32x32x16_bf16 a[224:239], a[88:91], v[152:155], a[224:239]
    ds_read_b64_tr_b16 a[84:85], v247 offset:28672
    ds_read_b64_tr_b16 a[86:87], v247 offset:29696
    s_add_u32 m0, s31, 19456
    s_add_u32 s33, s29, 2195456
    buffer_load_dwordx4 v245, s[8:11], s33 offen lds
    v_fma_f32 v116, v116, v14, v15
    v_fma_f32 v117, v117, v14, v15
    v_mfma_f32_32x32x16_bf16 a[240:255], a[92:95], v[152:155], a[240:255]
    ds_read_b64_tr_b16 a[88:89], v248 offset:28672
    ds_read_b64_tr_b16 a[90:91], v248 offset:29696
    v_fma_f32 v116, v116, v84, v92
    v_fma_f32 v117, v117, v85, v93
    v_cvt_pk_bf16_f32 v170, v116, v117
    v_lshlrev_b32 v118, 16, v171
    s_waitcnt lgkmcnt(6)
    v_mfma_f32_32x32x16_bf16 a[128:143], a[64:67], v[156:159], a[128:143]
    ds_read_b64_tr_b16 a[92:93], v249 offset:28672
    ds_read_b64_tr_b16 a[94:95], v249 offset:29696
    v_and_b32 v119, 0xffff0000, v171
    v_fma_f32 v118, v118, v14, v15
    v_fma_f32 v119, v119, v14, v15
    v_fma_f32 v118, v118, v86, v94
    v_fma_f32 v119, v119, v87, v95
    v_mfma_f32_32x32x16_bf16 a[144:159], a[68:71], v[156:159], a[144:159]
    v_add_u32 v246, 0x8000, v246
    v_add_u32 v247, 0x8000, v247
    v_add_u32 v248, 0x8000, v248
    v_add_u32 v249, 0x8000, v249
    ds_read_b64_tr_b16 a[64:65], v246 offset:0
    ds_read_b64_tr_b16 a[66:67], v246 offset:1024
    s_add_u32 m0, s31, 20480
    s_add_u32 s33, s29, 2228224
    buffer_load_dwordx4 v245, s[8:11], s33 offen lds
    v_cvt_pk_bf16_f32 v171, v118, v119
    v_lshlrev_b32 v120, 16, v172
    v_mfma_f32_32x32x16_bf16 a[160:175], a[72:75], v[156:159], a[160:175]
    ds_read_b64_tr_b16 a[68:69], v247 offset:0
    ds_read_b64_tr_b16 a[70:71], v247 offset:1024
    v_and_b32 v121, 0xffff0000, v172
    v_fma_f32 v120, v120, v14, v15
    v_fma_f32 v121, v121, v14, v15
    v_fma_f32 v120, v120, v96, v104
    v_fma_f32 v121, v121, v97, v105
    v_mfma_f32_32x32x16_bf16 a[176:191], a[76:79], v[156:159], a[176:191]
    ds_read_b64_tr_b16 a[72:73], v248 offset:0
    ds_read_b64_tr_b16 a[74:75], v248 offset:1024
    v_cvt_pk_bf16_f32 v172, v120, v121
    v_lshlrev_b32 v122, 16, v173
    v_and_b32 v123, 0xffff0000, v173
    v_fma_f32 v122, v122, v14, v15
    s_waitcnt lgkmcnt(6)
    v_mfma_f32_32x32x16_bf16 a[192:207], a[80:83], v[156:159], a[192:207]
    ds_read_b64_tr_b16 a[76:77], v249 offset:0
    ds_read_b64_tr_b16 a[78:79], v249 offset:1024
    s_add_u32 m0, s31, 21504
    s_add_u32 s33, s29, 2260992
    buffer_load_dwordx4 v245, s[8:11], s33 offen lds
    v_fma_f32 v123, v123, v14, v15
    v_fma_f32 v122, v122, v98, v106
    v_mfma_f32_32x32x16_bf16 a[208:223], a[84:87], v[156:159], a[208:223]
    ds_read_b64_tr_b16 a[80:81], v246 offset:16384
    ds_read_b64_tr_b16 a[82:83], v246 offset:17408
    v_fma_f32 v123, v123, v99, v107
    v_cvt_pk_bf16_f32 v173, v122, v123
    v_lshlrev_b32 v124, 16, v174
    v_and_b32 v125, 0xffff0000, v174
    v_fma_f32 v124, v124, v14, v15
    v_mfma_f32_32x32x16_bf16 a[224:239], a[88:91], v[156:159], a[224:239]
    ds_read_b64_tr_b16 a[84:85], v247 offset:16384
    ds_read_b64_tr_b16 a[86:87], v247 offset:17408
    v_fma_f32 v125, v125, v14, v15
    v_fma_f32 v124, v124, v100, v108
    v_fma_f32 v125, v125, v101, v109
    v_cvt_pk_bf16_f32 v174, v124, v125
    v_lshlrev_b32 v126, 16, v175
    v_and_b32 v127, 0xffff0000, v175
    v_fma_f32 v126, v126, v14, v15
    v_fma_f32 v127, v127, v14, v15
    v_fma_f32 v126, v126, v102, v110
    v_fma_f32 v127, v127, v103, v111
    v_cvt_pk_bf16_f32 v175, v126, v127
    v_mfma_f32_32x32x16_bf16 a[240:255], a[92:95], v[156:159], a[240:255]
    ds_read_b64_tr_b16 a[88:89], v248 offset:16384
    ds_read_b64_tr_b16 a[90:91], v248 offset:17408
    s_add_u32 m0, s31, 22528
    s_add_u32 s33, s29, 2293760
    buffer_load_dwordx4 v245, s[8:11], s33 offen lds
    s_waitcnt lgkmcnt(6)
    v_mfma_f32_32x32x16_bf16 a[128:143], a[64:67], v[160:163], a[128:143]
    ds_read_b64_tr_b16 a[92:93], v249 offset:16384
    ds_read_b64_tr_b16 a[94:95], v249 offset:17408
    ds_read_b128 v[16:19], v243 offset:51712
    ds_read_b128 v[24:27], v243 offset:49920
    ds_read_b128 v[20:23], v243 offset:51728
    ds_read_b128 v[28:31], v243 offset:49936
    v_mfma_f32_32x32x16_bf16 a[144:159], a[68:71], v[160:163], a[144:159]
    ds_read_b64_tr_b16 a[64:65], v246 offset:4096
    ds_read_b64_tr_b16 a[66:67], v246 offset:5120
    v_mfma_f32_32x32x16_bf16 a[160:175], a[72:75], v[160:163], a[160:175]
    ds_read_b64_tr_b16 a[68:69], v247 offset:4096
    ds_read_b64_tr_b16 a[70:71], v247 offset:5120
    s_add_u32 m0, s31, 23552
    s_add_u32 s33, s29, 2326528
    buffer_load_dwordx4 v245, s[8:11], s33 offen lds
    v_mfma_f32_32x32x16_bf16 a[176:191], a[76:79], v[160:163], a[176:191]
    ds_read_b64_tr_b16 a[72:73], v248 offset:4096
    ds_read_b64_tr_b16 a[74:75], v248 offset:5120
    s_waitcnt lgkmcnt(6)
    v_lshlrev_b32 v112, 16, v176
    v_and_b32 v113, 0xffff0000, v176
    v_fma_f32 v112, v112, v14, v15
    v_fma_f32 v113, v113, v14, v15
    v_mfma_f32_32x32x16_bf16 a[192:207], a[80:83], v[160:163], a[192:207]
    ds_read_b64_tr_b16 a[76:77], v249 offset:4096
    ds_read_b64_tr_b16 a[78:79], v249 offset:5120
    v_fma_f32 v112, v112, v16, v24
    v_fma_f32 v113, v113, v17, v25
    v_cvt_pk_bf16_f32 v176, v112, v113
    v_lshlrev_b32 v114, 16, v177
    v_and_b32 v115, 0xffff0000, v177
    v_mfma_f32_32x32x16_bf16 a[208:223], a[84:87], v[160:163], a[208:223]
    ds_read_b64_tr_b16 a[80:81], v246 offset:20480
    ds_read_b64_tr_b16 a[82:83], v246 offset:21504
    v_fma_f32 v114, v114, v14, v15
    v_fma_f32 v115, v115, v14, v15
    v_fma_f32 v114, v114, v18, v26
    v_fma_f32 v115, v115, v19, v27
    v_cvt_pk_bf16_f32 v177, v114, v115
    v_mfma_f32_32x32x16_bf16 a[224:239], a[88:91], v[160:163], a[224:239]
    ds_read_b64_tr_b16 a[84:85], v247 offset:20480
    ds_read_b64_tr_b16 a[86:87], v247 offset:21504
    ds_read_b128 v[32:35], v243 offset:51776
    ds_read_b128 v[40:43], v243 offset:49984
    ds_read_b128 v[36:39], v243 offset:51792
    ds_read_b128 v[44:47], v243 offset:50000
    v_lshlrev_b32 v116, 16, v178
    v_and_b32 v117, 0xffff0000, v178
    v_fma_f32 v116, v116, v14, v15
    v_mfma_f32_32x32x16_bf16 a[240:255], a[92:95], v[160:163], a[240:255]
    ds_read_b64_tr_b16 a[88:89], v248 offset:20480
    ds_read_b64_tr_b16 a[90:91], v248 offset:21504
    v_fma_f32 v117, v117, v14, v15
    v_fma_f32 v116, v116, v20, v28
    v_fma_f32 v117, v117, v21, v29
    v_cvt_pk_bf16_f32 v178, v116, v117
    s_waitcnt lgkmcnt(10)
    v_mfma_f32_32x32x16_bf16 a[128:143], a[64:67], v[164:167], a[128:143]
    ds_read_b64_tr_b16 a[92:93], v249 offset:20480
    ds_read_b64_tr_b16 a[94:95], v249 offset:21504
    v_lshlrev_b32 v118, 16, v179
    v_and_b32 v119, 0xffff0000, v179
    v_fma_f32 v118, v118, v14, v15
    v_fma_f32 v119, v119, v14, v15
    v_fma_f32 v118, v118, v22, v30
    v_mfma_f32_32x32x16_bf16 a[144:159], a[68:71], v[164:167], a[144:159]
    ds_read_b64_tr_b16 a[64:65], v246 offset:8192
    ds_read_b64_tr_b16 a[66:67], v246 offset:9216
    v_fma_f32 v119, v119, v23, v31
    v_cvt_pk_bf16_f32 v179, v118, v119
    s_waitcnt lgkmcnt(6)
    v_lshlrev_b32 v120, 16, v180
    v_and_b32 v121, 0xffff0000, v180
    v_fma_f32 v120, v120, v14, v15
    v_mfma_f32_32x32x16_bf16 a[160:175], a[72:75], v[164:167], a[160:175]
    ds_read_b64_tr_b16 a[68:69], v247 offset:8192
    ds_read_b64_tr_b16 a[70:71], v247 offset:9216
    v_fma_f32 v121, v121, v14, v15
    v_fma_f32 v120, v120, v32, v40
    v_fma_f32 v121, v121, v33, v41
    v_cvt_pk_bf16_f32 v180, v120, v121
    v_lshlrev_b32 v122, 16, v181
    v_mfma_f32_32x32x16_bf16 a[176:191], a[76:79], v[164:167], a[176:191]
    ds_read_b64_tr_b16 a[72:73], v248 offset:8192
    ds_read_b64_tr_b16 a[74:75], v248 offset:9216
    v_and_b32 v123, 0xffff0000, v181
    v_fma_f32 v122, v122, v14, v15
    v_fma_f32 v123, v123, v14, v15
    v_fma_f32 v122, v122, v34, v42
    s_waitcnt lgkmcnt(6)
    v_mfma_f32_32x32x16_bf16 a[192:207], a[80:83], v[164:167], a[192:207]
    ds_read_b64_tr_b16 a[76:77], v249 offset:8192
    ds_read_b64_tr_b16 a[78:79], v249 offset:9216
    ds_read_b128 v[48:51], v243 offset:51840
    ds_read_b128 v[56:59], v243 offset:50048
    ds_read_b128 v[52:55], v243 offset:51856
    ds_read_b128 v[60:63], v243 offset:50064
    s_waitcnt vmcnt(9)
    s_barrier
    v_mfma_f32_32x32x16_bf16 a[208:223], a[84:87], v[164:167], a[208:223]
    ds_read_b64_tr_b16 a[80:81], v246 offset:24576
    ds_read_b64_tr_b16 a[82:83], v246 offset:25600
    s_add_u32 m0, s31, 98304
    s_add_u32 s33, s29, 2621440
    buffer_load_dwordx4 v245, s[8:11], s33 offen lds
    v_fma_f32 v123, v123, v35, v43
    v_cvt_pk_bf16_f32 v181, v122, v123
    v_mfma_f32_32x32x16_bf16 a[224:239], a[88:91], v[164:167], a[224:239]
    ds_read_b64_tr_b16 a[84:85], v247 offset:24576
    ds_read_b64_tr_b16 a[86:87], v247 offset:25600
    v_lshlrev_b32 v124, 16, v182
    v_and_b32 v125, 0xffff0000, v182
    v_fma_f32 v124, v124, v14, v15
    v_fma_f32 v125, v125, v14, v15
    v_fma_f32 v124, v124, v36, v44
    v_mfma_f32_32x32x16_bf16 a[240:255], a[92:95], v[164:167], a[240:255]
    ds_read_b64_tr_b16 a[88:89], v248 offset:24576
    ds_read_b64_tr_b16 a[90:91], v248 offset:25600
    v_fma_f32 v125, v125, v37, v45
    v_cvt_pk_bf16_f32 v182, v124, v125
    v_lshlrev_b32 v126, 16, v183
    v_and_b32 v127, 0xffff0000, v183
    s_waitcnt lgkmcnt(10)
    v_mfma_f32_32x32x16_bf16 a[128:143], a[64:67], v[168:171], a[128:143]
    ds_read_b64_tr_b16 a[92:93], v249 offset:24576
    ds_read_b64_tr_b16 a[94:95], v249 offset:25600
    s_add_u32 m0, s31, 99328
    s_add_u32 s33, s29, 2654208
    buffer_load_dwordx4 v245, s[8:11], s33 offen lds
    v_fma_f32 v126, v126, v14, v15
    v_fma_f32 v127, v127, v14, v15
    v_mfma_f32_32x32x16_bf16 a[144:159], a[68:71], v[168:171], a[144:159]
    ds_read_b64_tr_b16 a[64:65], v246 offset:12288
    ds_read_b64_tr_b16 a[66:67], v246 offset:13312
    v_fma_f32 v126, v126, v38, v46
    v_fma_f32 v127, v127, v39, v47
    v_cvt_pk_bf16_f32 v183, v126, v127
    s_waitcnt lgkmcnt(10)
    v_lshlrev_b32 v112, 16, v184
    v_and_b32 v113, 0xffff0000, v184
    v_mfma_f32_32x32x16_bf16 a[160:175], a[72:75], v[168:171], a[160:175]
    ds_read_b64_tr_b16 a[68:69], v247 offset:12288
    ds_read_b64_tr_b16 a[70:71], v247 offset:13312
    ds_read_b128 v[64:67], v243 offset:51904
    ds_read_b128 v[72:75], v243 offset:50112
    ds_read_b128 v[68:71], v243 offset:51920
    ds_read_b128 v[76:79], v243 offset:50128
    v_fma_f32 v112, v112, v14, v15
    v_fma_f32 v113, v113, v14, v15
    v_fma_f32 v112, v112, v48, v56
    v_mfma_f32_32x32x16_bf16 a[176:191], a[76:79], v[168:171], a[176:191]
    ds_read_b64_tr_b16 a[72:73], v248 offset:12288
    ds_read_b64_tr_b16 a[74:75], v248 offset:13312
    s_add_u32 m0, s31, 100352
    s_add_u32 s33, s29, 2686976
    buffer_load_dwordx4 v245, s[8:11], s33 offen lds
    v_fma_f32 v113, v113, v49, v57
    s_waitcnt lgkmcnt(10)
    v_mfma_f32_32x32x16_bf16 a[192:207], a[80:83], v[168:171], a[192:207]
    ds_read_b64_tr_b16 a[76:77], v249 offset:12288
    ds_read_b64_tr_b16 a[78:79], v249 offset:13312
    v_cvt_pk_bf16_f32 v184, v112, v113
    v_lshlrev_b32 v114, 16, v185
    v_and_b32 v115, 0xffff0000, v185
    v_fma_f32 v114, v114, v14, v15
    v_fma_f32 v115, v115, v14, v15
    v_mfma_f32_32x32x16_bf16 a[208:223], a[84:87], v[168:171], a[208:223]
    ds_read_b64_tr_b16 a[80:81], v246 offset:28672
    ds_read_b64_tr_b16 a[82:83], v246 offset:29696
    v_fma_f32 v114, v114, v50, v58
    v_fma_f32 v115, v115, v51, v59
    v_cvt_pk_bf16_f32 v185, v114, v115
    v_lshlrev_b32 v116, 16, v186
    v_and_b32 v117, 0xffff0000, v186
    v_mfma_f32_32x32x16_bf16 a[224:239], a[88:91], v[168:171], a[224:239]
    ds_read_b64_tr_b16 a[84:85], v247 offset:28672
    ds_read_b64_tr_b16 a[86:87], v247 offset:29696
    s_add_u32 m0, s31, 101376
    s_add_u32 s33, s29, 2719744
    buffer_load_dwordx4 v245, s[8:11], s33 offen lds
    v_fma_f32 v116, v116, v14, v15
    v_fma_f32 v117, v117, v14, v15
    v_mfma_f32_32x32x16_bf16 a[240:255], a[92:95], v[168:171], a[240:255]
    ds_read_b64_tr_b16 a[88:89], v248 offset:28672
    ds_read_b64_tr_b16 a[90:91], v248 offset:29696
    v_fma_f32 v116, v116, v52, v60
    v_fma_f32 v117, v117, v53, v61
    v_cvt_pk_bf16_f32 v186, v116, v117
    v_lshlrev_b32 v118, 16, v187
    s_waitcnt lgkmcnt(6)
    v_mfma_f32_32x32x16_bf16 a[128:143], a[64:67], v[172:175], a[128:143]
    ds_read_b64_tr_b16 a[92:93], v249 offset:28672
    ds_read_b64_tr_b16 a[94:95], v249 offset:29696
    v_and_b32 v119, 0xffff0000, v187
    v_fma_f32 v118, v118, v14, v15
    v_fma_f32 v119, v119, v14, v15
    v_fma_f32 v118, v118, v54, v62
    v_fma_f32 v119, v119, v55, v63
    v_mfma_f32_32x32x16_bf16 a[144:159], a[68:71], v[172:175], a[144:159]
    v_add_u32 v246, 0xffff0000, v246
    v_add_u32 v247, 0xffff0000, v247
    v_add_u32 v248, 0xffff0000, v248
    v_add_u32 v249, 0xffff0000, v249
    ds_read_b64_tr_b16 a[64:65], v246 offset:0
    ds_read_b64_tr_b16 a[66:67], v246 offset:1024
    s_add_u32 m0, s31, 102400
    s_add_u32 s33, s29, 2752512
    buffer_load_dwordx4 v245, s[8:11], s33 offen lds
    v_cvt_pk_bf16_f32 v187, v118, v119
    v_lshlrev_b32 v120, 16, v188
    v_mfma_f32_32x32x16_bf16 a[160:175], a[72:75], v[172:175], a[160:175]
    ds_read_b64_tr_b16 a[68:69], v247 offset:0
    ds_read_b64_tr_b16 a[70:71], v247 offset:1024
    v_and_b32 v121, 0xffff0000, v188
    v_fma_f32 v120, v120, v14, v15
    v_fma_f32 v121, v121, v14, v15
    v_fma_f32 v120, v120, v64, v72
    v_fma_f32 v121, v121, v65, v73
    v_mfma_f32_32x32x16_bf16 a[176:191], a[76:79], v[172:175], a[176:191]
    ds_read_b64_tr_b16 a[72:73], v248 offset:0
    ds_read_b64_tr_b16 a[74:75], v248 offset:1024
    v_cvt_pk_bf16_f32 v188, v120, v121
    v_lshlrev_b32 v122, 16, v189
    v_and_b32 v123, 0xffff0000, v189
    v_fma_f32 v122, v122, v14, v15
    s_waitcnt lgkmcnt(6)
    v_mfma_f32_32x32x16_bf16 a[192:207], a[80:83], v[172:175], a[192:207]
    ds_read_b64_tr_b16 a[76:77], v249 offset:0
    ds_read_b64_tr_b16 a[78:79], v249 offset:1024
    s_add_u32 m0, s31, 103424
    s_add_u32 s33, s29, 2785280
    buffer_load_dwordx4 v245, s[8:11], s33 offen lds
    v_fma_f32 v123, v123, v14, v15
    v_fma_f32 v122, v122, v66, v74
    v_mfma_f32_32x32x16_bf16 a[208:223], a[84:87], v[172:175], a[208:223]
    ds_read_b64_tr_b16 a[80:81], v246 offset:16384
    ds_read_b64_tr_b16 a[82:83], v246 offset:17408
    v_fma_f32 v123, v123, v67, v75
    v_cvt_pk_bf16_f32 v189, v122, v123
    v_lshlrev_b32 v124, 16, v190
    v_and_b32 v125, 0xffff0000, v190
    v_fma_f32 v124, v124, v14, v15
    v_mfma_f32_32x32x16_bf16 a[224:239], a[88:91], v[172:175], a[224:239]
    ds_read_b64_tr_b16 a[84:85], v247 offset:16384
    ds_read_b64_tr_b16 a[86:87], v247 offset:17408
    v_fma_f32 v125, v125, v14, v15
    v_fma_f32 v124, v124, v68, v76
    v_fma_f32 v125, v125, v69, v77
    v_cvt_pk_bf16_f32 v190, v124, v125
    v_lshlrev_b32 v126, 16, v191
    v_and_b32 v127, 0xffff0000, v191
    v_fma_f32 v126, v126, v14, v15
    v_fma_f32 v127, v127, v14, v15
    v_fma_f32 v126, v126, v70, v78
    v_fma_f32 v127, v127, v71, v79
    v_cvt_pk_bf16_f32 v191, v126, v127
    v_mfma_f32_32x32x16_bf16 a[240:255], a[92:95], v[172:175], a[240:255]
    ds_read_b64_tr_b16 a[88:89], v248 offset:16384
    ds_read_b64_tr_b16 a[90:91], v248 offset:17408
    s_add_u32 m0, s31, 104448
    s_add_u32 s33, s29, 2818048
    buffer_load_dwordx4 v245, s[8:11], s33 offen lds
    s_waitcnt lgkmcnt(6)
    v_mfma_f32_32x32x16_bf16 a[128:143], a[64:67], v[176:179], a[128:143]
    ds_read_b64_tr_b16 a[92:93], v249 offset:16384
    ds_read_b64_tr_b16 a[94:95], v249 offset:17408
    ds_read_b128 v[80:83], v243 offset:51968
    ds_read_b128 v[88:91], v243 offset:50176
    ds_read_b128 v[84:87], v243 offset:51984
    ds_read_b128 v[92:95], v243 offset:50192
    v_mfma_f32_32x32x16_bf16 a[144:159], a[68:71], v[176:179], a[144:159]
    ds_read_b64_tr_b16 a[64:65], v246 offset:4096
    ds_read_b64_tr_b16 a[66:67], v246 offset:5120
    v_mfma_f32_32x32x16_bf16 a[160:175], a[72:75], v[176:179], a[160:175]
    ds_read_b64_tr_b16 a[68:69], v247 offset:4096
    ds_read_b64_tr_b16 a[70:71], v247 offset:5120
    s_add_u32 m0, s31, 105472
    s_add_u32 s33, s29, 2850816
    buffer_load_dwordx4 v245, s[8:11], s33 offen lds
    v_mfma_f32_32x32x16_bf16 a[176:191], a[76:79], v[176:179], a[176:191]
    ds_read_b64_tr_b16 a[72:73], v248 offset:4096
    ds_read_b64_tr_b16 a[74:75], v248 offset:5120
    s_waitcnt lgkmcnt(6)
    v_lshlrev_b32 v112, 16, v192
    v_and_b32 v113, 0xffff0000, v192
    v_fma_f32 v112, v112, v14, v15
    v_fma_f32 v113, v113, v14, v15
    v_mfma_f32_32x32x16_bf16 a[192:207], a[80:83], v[176:179], a[192:207]
    ds_read_b64_tr_b16 a[76:77], v249 offset:4096
    ds_read_b64_tr_b16 a[78:79], v249 offset:5120
    v_fma_f32 v112, v112, v80, v88
    v_fma_f32 v113, v113, v81, v89
    v_cvt_pk_bf16_f32 v192, v112, v113
    v_lshlrev_b32 v114, 16, v193
    v_and_b32 v115, 0xffff0000, v193
    v_mfma_f32_32x32x16_bf16 a[208:223], a[84:87], v[176:179], a[208:223]
    ds_read_b64_tr_b16 a[80:81], v246 offset:20480
    ds_read_b64_tr_b16 a[82:83], v246 offset:21504
    v_fma_f32 v114, v114, v14, v15
    v_fma_f32 v115, v115, v14, v15
    v_fma_f32 v114, v114, v82, v90
    v_fma_f32 v115, v115, v83, v91
    v_cvt_pk_bf16_f32 v193, v114, v115
    v_mfma_f32_32x32x16_bf16 a[224:239], a[88:91], v[176:179], a[224:239]
    ds_read_b64_tr_b16 a[84:85], v247 offset:20480
    ds_read_b64_tr_b16 a[86:87], v247 offset:21504
    ds_read_b128 v[96:99], v243 offset:52032
    ds_read_b128 v[104:107], v243 offset:50240
    ds_read_b128 v[100:103], v243 offset:52048
    ds_read_b128 v[108:111], v243 offset:50256
    v_lshlrev_b32 v116, 16, v194
    v_and_b32 v117, 0xffff0000, v194
    v_fma_f32 v116, v116, v14, v15
    v_mfma_f32_32x32x16_bf16 a[240:255], a[92:95], v[176:179], a[240:255]
    ds_read_b64_tr_b16 a[88:89], v248 offset:20480
    ds_read_b64_tr_b16 a[90:91], v248 offset:21504
    v_fma_f32 v117, v117, v14, v15
    v_fma_f32 v116, v116, v84, v92
    v_fma_f32 v117, v117, v85, v93
    v_cvt_pk_bf16_f32 v194, v116, v117
    s_waitcnt lgkmcnt(10)
    v_mfma_f32_32x32x16_bf16 a[128:143], a[64:67], v[180:183], a[128:143]
    ds_read_b64_tr_b16 a[92:93], v249 offset:20480
    ds_read_b64_tr_b16 a[94:95], v249 offset:21504
    v_lshlrev_b32 v118, 16, v195
    v_and_b32 v119, 0xffff0000, v195
    v_fma_f32 v118, v118, v14, v15
    v_fma_f32 v119, v119, v14, v15
    v_fma_f32 v118, v118, v86, v94
    v_mfma_f32_32x32x16_bf16 a[144:159], a[68:71], v[180:183], a[144:159]
    ds_read_b64_tr_b16 a[64:65], v246 offset:8192
    ds_read_b64_tr_b16 a[66:67], v246 offset:9216
    v_fma_f32 v119, v119, v87, v95
    v_cvt_pk_bf16_f32 v195, v118, v119
    s_waitcnt lgkmcnt(6)
    v_lshlrev_b32 v120, 16, v196
    v_and_b32 v121, 0xffff0000, v196
    v_fma_f32 v120, v120, v14, v15
    v_mfma_f32_32x32x16_bf16 a[160:175], a[72:75], v[180:183], a[160:175]
    ds_read_b64_tr_b16 a[68:69], v247 offset:8192
    ds_read_b64_tr_b16 a[70:71], v247 offset:9216
    v_fma_f32 v121, v121, v14, v15
    v_fma_f32 v120, v120, v96, v104
    v_fma_f32 v121, v121, v97, v105
    v_cvt_pk_bf16_f32 v196, v120, v121
    v_lshlrev_b32 v122, 16, v197
    v_mfma_f32_32x32x16_bf16 a[176:191], a[76:79], v[180:183], a[176:191]
    ds_read_b64_tr_b16 a[72:73], v248 offset:8192
    ds_read_b64_tr_b16 a[74:75], v248 offset:9216
    v_and_b32 v123, 0xffff0000, v197
    v_fma_f32 v122, v122, v14, v15
    v_fma_f32 v123, v123, v14, v15
    v_fma_f32 v122, v122, v98, v106
    s_waitcnt lgkmcnt(6)
    v_mfma_f32_32x32x16_bf16 a[192:207], a[80:83], v[180:183], a[192:207]
    ds_read_b64_tr_b16 a[76:77], v249 offset:8192
    ds_read_b64_tr_b16 a[78:79], v249 offset:9216
    ds_read_b128 v[16:19], v243 offset:52096
    ds_read_b128 v[24:27], v243 offset:50304
    ds_read_b128 v[20:23], v243 offset:52112
    ds_read_b128 v[28:31], v243 offset:50320
    s_waitcnt vmcnt(8)
    s_barrier
    v_mfma_f32_32x32x16_bf16 a[208:223], a[84:87], v[180:183], a[208:223]
    ds_read_b64_tr_b16 a[80:81], v246 offset:24576
    ds_read_b64_tr_b16 a[82:83], v246 offset:25600
    s_add_u32 m0, s31, 131072
    s_add_u32 s33, s29, 3145728
    buffer_load_dwordx4 v245, s[8:11], s33 offen lds
    v_fma_f32 v123, v123, v99, v107
    v_cvt_pk_bf16_f32 v197, v122, v123
    v_mfma_f32_32x32x16_bf16 a[224:239], a[88:91], v[180:183], a[224:239]
    ds_read_b64_tr_b16 a[84:85], v247 offset:24576
    ds_read_b64_tr_b16 a[86:87], v247 offset:25600
    v_lshlrev_b32 v124, 16, v198
    v_and_b32 v125, 0xffff0000, v198
    v_fma_f32 v124, v124, v14, v15
    v_fma_f32 v125, v125, v14, v15
    v_fma_f32 v124, v124, v100, v108
    v_mfma_f32_32x32x16_bf16 a[240:255], a[92:95], v[180:183], a[240:255]
    ds_read_b64_tr_b16 a[88:89], v248 offset:24576
    ds_read_b64_tr_b16 a[90:91], v248 offset:25600
    v_fma_f32 v125, v125, v101, v109
    v_cvt_pk_bf16_f32 v198, v124, v125
    v_lshlrev_b32 v126, 16, v199
    v_and_b32 v127, 0xffff0000, v199
    s_waitcnt lgkmcnt(10)
    v_mfma_f32_32x32x16_bf16 a[128:143], a[64:67], v[184:187], a[128:143]
    ds_read_b64_tr_b16 a[92:93], v249 offset:24576
    ds_read_b64_tr_b16 a[94:95], v249 offset:25600
    s_add_u32 m0, s31, 132096
    s_add_u32 s33, s29, 3178496
    buffer_load_dwordx4 v245, s[8:11], s33 offen lds
    v_fma_f32 v126, v126, v14, v15
    v_fma_f32 v127, v127, v14, v15
    v_mfma_f32_32x32x16_bf16 a[144:159], a[68:71], v[184:187], a[144:159]
    ds_read_b64_tr_b16 a[64:65], v246 offset:12288
    ds_read_b64_tr_b16 a[66:67], v246 offset:13312
    v_fma_f32 v126, v126, v102, v110
    v_fma_f32 v127, v127, v103, v111
    v_cvt_pk_bf16_f32 v199, v126, v127
    s_waitcnt lgkmcnt(10)
    v_lshlrev_b32 v112, 16, v200
    v_and_b32 v113, 0xffff0000, v200
    v_mfma_f32_32x32x16_bf16 a[160:175], a[72:75], v[184:187], a[160:175]
    ds_read_b64_tr_b16 a[68:69], v247 offset:12288
    ds_read_b64_tr_b16 a[70:71], v247 offset:13312
    ds_read_b128 v[32:35], v243 offset:52160
    ds_read_b128 v[40:43], v243 offset:50368
    ds_read_b128 v[36:39], v243 offset:52176
    ds_read_b128 v[44:47], v243 offset:50384
    v_fma_f32 v112, v112, v14, v15
    v_fma_f32 v113, v113, v14, v15
    v_fma_f32 v112, v112, v16, v24
    v_mfma_f32_32x32x16_bf16 a[176:191], a[76:79], v[184:187], a[176:191]
    ds_read_b64_tr_b16 a[72:73], v248 offset:12288
    ds_read_b64_tr_b16 a[74:75], v248 offset:13312
    s_add_u32 m0, s31, 133120
    s_add_u32 s33, s29, 3211264
    buffer_load_dwordx4 v245, s[8:11], s33 offen lds
    v_fma_f32 v113, v113, v17, v25
    s_waitcnt lgkmcnt(10)
    v_mfma_f32_32x32x16_bf16 a[192:207], a[80:83], v[184:187], a[192:207]
    ds_read_b64_tr_b16 a[76:77], v249 offset:12288
    ds_read_b64_tr_b16 a[78:79], v249 offset:13312
    v_cvt_pk_bf16_f32 v200, v112, v113
    v_lshlrev_b32 v114, 16, v201
    v_and_b32 v115, 0xffff0000, v201
    v_fma_f32 v114, v114, v14, v15
    v_fma_f32 v115, v115, v14, v15
    v_mfma_f32_32x32x16_bf16 a[208:223], a[84:87], v[184:187], a[208:223]
    ds_read_b64_tr_b16 a[80:81], v246 offset:28672
    ds_read_b64_tr_b16 a[82:83], v246 offset:29696
    v_fma_f32 v114, v114, v18, v26
    v_fma_f32 v115, v115, v19, v27
    v_cvt_pk_bf16_f32 v201, v114, v115
    v_lshlrev_b32 v116, 16, v202
    v_and_b32 v117, 0xffff0000, v202
    v_mfma_f32_32x32x16_bf16 a[224:239], a[88:91], v[184:187], a[224:239]
    ds_read_b64_tr_b16 a[84:85], v247 offset:28672
    ds_read_b64_tr_b16 a[86:87], v247 offset:29696
    s_add_u32 m0, s31, 134144
    s_add_u32 s33, s29, 3244032
    buffer_load_dwordx4 v245, s[8:11], s33 offen lds
    v_fma_f32 v116, v116, v14, v15
    v_fma_f32 v117, v117, v14, v15
    v_mfma_f32_32x32x16_bf16 a[240:255], a[92:95], v[184:187], a[240:255]
    ds_read_b64_tr_b16 a[88:89], v248 offset:28672
    ds_read_b64_tr_b16 a[90:91], v248 offset:29696
    v_fma_f32 v116, v116, v20, v28
    v_fma_f32 v117, v117, v21, v29
    v_cvt_pk_bf16_f32 v202, v116, v117
    v_lshlrev_b32 v118, 16, v203
    s_waitcnt lgkmcnt(6)
    v_mfma_f32_32x32x16_bf16 a[128:143], a[64:67], v[188:191], a[128:143]
    ds_read_b64_tr_b16 a[92:93], v249 offset:28672
    ds_read_b64_tr_b16 a[94:95], v249 offset:29696
    v_and_b32 v119, 0xffff0000, v203
    v_fma_f32 v118, v118, v14, v15
    v_fma_f32 v119, v119, v14, v15
    v_fma_f32 v118, v118, v22, v30
    v_fma_f32 v119, v119, v23, v31
    v_mfma_f32_32x32x16_bf16 a[144:159], a[68:71], v[188:191], a[144:159]
    v_add_u32 v246, 0xffff4000, v246
    v_add_u32 v247, 0xffff4000, v247
    v_add_u32 v248, 0xffff4000, v248
    v_add_u32 v249, 0xffff4000, v249
    ds_read_b64_tr_b16 a[64:65], v246 offset:0
    ds_read_b64_tr_b16 a[66:67], v246 offset:1024
    s_add_u32 m0, s31, 135168
    s_add_u32 s33, s29, 3276800
    buffer_load_dwordx4 v245, s[8:11], s33 offen lds
    v_cvt_pk_bf16_f32 v203, v118, v119
    v_lshlrev_b32 v120, 16, v204
    v_mfma_f32_32x32x16_bf16 a[160:175], a[72:75], v[188:191], a[160:175]
    ds_read_b64_tr_b16 a[68:69], v247 offset:0
    ds_read_b64_tr_b16 a[70:71], v247 offset:1024
    v_and_b32 v121, 0xffff0000, v204
    v_fma_f32 v120, v120, v14, v15
    v_fma_f32 v121, v121, v14, v15
    v_fma_f32 v120, v120, v32, v40
    v_fma_f32 v121, v121, v33, v41
    v_mfma_f32_32x32x16_bf16 a[176:191], a[76:79], v[188:191], a[176:191]
    ds_read_b64_tr_b16 a[72:73], v248 offset:0
    ds_read_b64_tr_b16 a[74:75], v248 offset:1024
    v_cvt_pk_bf16_f32 v204, v120, v121
    v_lshlrev_b32 v122, 16, v205
    v_and_b32 v123, 0xffff0000, v205
    v_fma_f32 v122, v122, v14, v15
    s_waitcnt lgkmcnt(6)
    v_mfma_f32_32x32x16_bf16 a[192:207], a[80:83], v[188:191], a[192:207]
    ds_read_b64_tr_b16 a[76:77], v249 offset:0
    ds_read_b64_tr_b16 a[78:79], v249 offset:1024
    s_add_u32 m0, s31, 136192
    s_add_u32 s33, s29, 3309568
    buffer_load_dwordx4 v245, s[8:11], s33 offen lds
    v_fma_f32 v123, v123, v14, v15
    v_fma_f32 v122, v122, v34, v42
    v_mfma_f32_32x32x16_bf16 a[208:223], a[84:87], v[188:191], a[208:223]
    ds_read_b64_tr_b16 a[80:81], v246 offset:16384
    ds_read_b64_tr_b16 a[82:83], v246 offset:17408
    v_fma_f32 v123, v123, v35, v43
    v_cvt_pk_bf16_f32 v205, v122, v123
    v_lshlrev_b32 v124, 16, v206
    v_and_b32 v125, 0xffff0000, v206
    v_fma_f32 v124, v124, v14, v15
    v_mfma_f32_32x32x16_bf16 a[224:239], a[88:91], v[188:191], a[224:239]
    ds_read_b64_tr_b16 a[84:85], v247 offset:16384
    ds_read_b64_tr_b16 a[86:87], v247 offset:17408
    v_fma_f32 v125, v125, v14, v15
    v_fma_f32 v124, v124, v36, v44
    v_fma_f32 v125, v125, v37, v45
    v_cvt_pk_bf16_f32 v206, v124, v125
    v_lshlrev_b32 v126, 16, v207
    v_and_b32 v127, 0xffff0000, v207
    v_fma_f32 v126, v126, v14, v15
    v_fma_f32 v127, v127, v14, v15
    v_fma_f32 v126, v126, v38, v46
    v_fma_f32 v127, v127, v39, v47
    v_cvt_pk_bf16_f32 v207, v126, v127
    v_mfma_f32_32x32x16_bf16 a[240:255], a[92:95], v[188:191], a[240:255]
    ds_read_b64_tr_b16 a[88:89], v248 offset:16384
    ds_read_b64_tr_b16 a[90:91], v248 offset:17408
    s_add_u32 m0, s31, 137216
    s_add_u32 s33, s29, 3342336
    buffer_load_dwordx4 v245, s[8:11], s33 offen lds
    s_waitcnt lgkmcnt(6)
    v_mfma_f32_32x32x16_bf16 a[128:143], a[64:67], v[192:195], a[128:143]
    ds_read_b64_tr_b16 a[92:93], v249 offset:16384
    ds_read_b64_tr_b16 a[94:95], v249 offset:17408
    ds_read_b128 v[48:51], v243 offset:52224
    ds_read_b128 v[56:59], v243 offset:50432
    ds_read_b128 v[52:55], v243 offset:52240
    ds_read_b128 v[60:63], v243 offset:50448
    v_mfma_f32_32x32x16_bf16 a[144:159], a[68:71], v[192:195], a[144:159]
    ds_read_b64_tr_b16 a[64:65], v246 offset:4096
    ds_read_b64_tr_b16 a[66:67], v246 offset:5120
    v_mfma_f32_32x32x16_bf16 a[160:175], a[72:75], v[192:195], a[160:175]
    ds_read_b64_tr_b16 a[68:69], v247 offset:4096
    ds_read_b64_tr_b16 a[70:71], v247 offset:5120
    s_add_u32 m0, s31, 138240
    s_add_u32 s33, s29, 3375104
    buffer_load_dwordx4 v245, s[8:11], s33 offen lds
    v_mfma_f32_32x32x16_bf16 a[176:191], a[76:79], v[192:195], a[176:191]
    ds_read_b64_tr_b16 a[72:73], v248 offset:4096
    ds_read_b64_tr_b16 a[74:75], v248 offset:5120
    s_waitcnt lgkmcnt(6)
    v_lshlrev_b32 v112, 16, v208
    v_and_b32 v113, 0xffff0000, v208
    v_fma_f32 v112, v112, v14, v15
    v_fma_f32 v113, v113, v14, v15
    v_mfma_f32_32x32x16_bf16 a[192:207], a[80:83], v[192:195], a[192:207]
    ds_read_b64_tr_b16 a[76:77], v249 offset:4096
    ds_read_b64_tr_b16 a[78:79], v249 offset:5120
    v_fma_f32 v112, v112, v48, v56
    v_fma_f32 v113, v113, v49, v57
    v_cvt_pk_bf16_f32 v208, v112, v113
    v_lshlrev_b32 v114, 16, v209
    v_and_b32 v115, 0xffff0000, v209
    v_mfma_f32_32x32x16_bf16 a[208:223], a[84:87], v[192:195], a[208:223]
    ds_read_b64_tr_b16 a[80:81], v246 offset:20480
    ds_read_b64_tr_b16 a[82:83], v246 offset:21504
    v_fma_f32 v114, v114, v14, v15
    v_fma_f32 v115, v115, v14, v15
    v_fma_f32 v114, v114, v50, v58
    v_fma_f32 v115, v115, v51, v59
    v_cvt_pk_bf16_f32 v209, v114, v115
    v_mfma_f32_32x32x16_bf16 a[224:239], a[88:91], v[192:195], a[224:239]
    ds_read_b64_tr_b16 a[84:85], v247 offset:20480
    ds_read_b64_tr_b16 a[86:87], v247 offset:21504
    ds_read_b128 v[64:67], v243 offset:52288
    ds_read_b128 v[72:75], v243 offset:50496
    ds_read_b128 v[68:71], v243 offset:52304
    ds_read_b128 v[76:79], v243 offset:50512
    v_lshlrev_b32 v116, 16, v210
    v_and_b32 v117, 0xffff0000, v210
    v_fma_f32 v116, v116, v14, v15
    v_mfma_f32_32x32x16_bf16 a[240:255], a[92:95], v[192:195], a[240:255]
    ds_read_b64_tr_b16 a[88:89], v248 offset:20480
    ds_read_b64_tr_b16 a[90:91], v248 offset:21504
    v_fma_f32 v117, v117, v14, v15
    v_fma_f32 v116, v116, v52, v60
    v_fma_f32 v117, v117, v53, v61
    v_cvt_pk_bf16_f32 v210, v116, v117
    s_waitcnt lgkmcnt(10)
    v_mfma_f32_32x32x16_bf16 a[128:143], a[64:67], v[196:199], a[128:143]
    ds_read_b64_tr_b16 a[92:93], v249 offset:20480
    ds_read_b64_tr_b16 a[94:95], v249 offset:21504
    v_lshlrev_b32 v118, 16, v211
    v_and_b32 v119, 0xffff0000, v211
    v_fma_f32 v118, v118, v14, v15
    v_fma_f32 v119, v119, v14, v15
    v_fma_f32 v118, v118, v54, v62
    v_mfma_f32_32x32x16_bf16 a[144:159], a[68:71], v[196:199], a[144:159]
    ds_read_b64_tr_b16 a[64:65], v246 offset:8192
    ds_read_b64_tr_b16 a[66:67], v246 offset:9216
    v_fma_f32 v119, v119, v55, v63
    v_cvt_pk_bf16_f32 v211, v118, v119
    s_waitcnt lgkmcnt(6)
    v_lshlrev_b32 v120, 16, v212
    v_and_b32 v121, 0xffff0000, v212
    v_fma_f32 v120, v120, v14, v15
    v_mfma_f32_32x32x16_bf16 a[160:175], a[72:75], v[196:199], a[160:175]
    ds_read_b64_tr_b16 a[68:69], v247 offset:8192
    ds_read_b64_tr_b16 a[70:71], v247 offset:9216
    v_fma_f32 v121, v121, v14, v15
    v_fma_f32 v120, v120, v64, v72
    v_fma_f32 v121, v121, v65, v73
    v_cvt_pk_bf16_f32 v212, v120, v121
    v_lshlrev_b32 v122, 16, v213
    v_mfma_f32_32x32x16_bf16 a[176:191], a[76:79], v[196:199], a[176:191]
    ds_read_b64_tr_b16 a[72:73], v248 offset:8192
    ds_read_b64_tr_b16 a[74:75], v248 offset:9216
    v_and_b32 v123, 0xffff0000, v213
    v_fma_f32 v122, v122, v14, v15
    v_fma_f32 v123, v123, v14, v15
    v_fma_f32 v122, v122, v66, v74
    s_waitcnt lgkmcnt(6)
    v_mfma_f32_32x32x16_bf16 a[192:207], a[80:83], v[196:199], a[192:207]
    ds_read_b64_tr_b16 a[76:77], v249 offset:8192
    ds_read_b64_tr_b16 a[78:79], v249 offset:9216
    ds_read_b128 v[80:83], v243 offset:52352
    ds_read_b128 v[88:91], v243 offset:50560
    ds_read_b128 v[84:87], v243 offset:52368
    ds_read_b128 v[92:95], v243 offset:50576
    s_waitcnt vmcnt(8)
    s_barrier
    v_mfma_f32_32x32x16_bf16 a[208:223], a[84:87], v[196:199], a[208:223]
    ds_read_b64_tr_b16 a[80:81], v246 offset:24576
    ds_read_b64_tr_b16 a[82:83], v246 offset:25600
    s_add_u32 m0, s49, 65536
    s_nop 0
    buffer_load_dwordx4 v254, s[16:19], s48 offen offset:0 lds
    v_fma_f32 v123, v123, v67, v75
    v_cvt_pk_bf16_f32 v213, v122, v123
    v_mfma_f32_32x32x16_bf16 a[224:239], a[88:91], v[196:199], a[224:239]
    ds_read_b64_tr_b16 a[84:85], v247 offset:24576
    ds_read_b64_tr_b16 a[86:87], v247 offset:25600
    v_lshlrev_b32 v124, 16, v214
    v_and_b32 v125, 0xffff0000, v214
    v_fma_f32 v124, v124, v14, v15
    v_fma_f32 v125, v125, v14, v15
    v_fma_f32 v124, v124, v68, v76
    v_mfma_f32_32x32x16_bf16 a[240:255], a[92:95], v[196:199], a[240:255]
    ds_read_b64_tr_b16 a[88:89], v248 offset:24576
    ds_read_b64_tr_b16 a[90:91], v248 offset:25600
    s_add_u32 m0, s49, 65536
    s_nop 0
    buffer_load_dwordx4 v255, s[16:19], s48 offen offset:1024 lds
    v_fma_f32 v125, v125, v69, v77
    s_waitcnt lgkmcnt(10)
    v_mfma_f32_32x32x16_bf16 a[128:143], a[64:67], v[200:203], a[128:143]
    ds_read_b64_tr_b16 a[92:93], v249 offset:24576
    ds_read_b64_tr_b16 a[94:95], v249 offset:25600
    v_cvt_pk_bf16_f32 v214, v124, v125
    v_lshlrev_b32 v126, 16, v215
    v_and_b32 v127, 0xffff0000, v215
    v_fma_f32 v126, v126, v14, v15
    v_fma_f32 v127, v127, v14, v15
    v_mfma_f32_32x32x16_bf16 a[144:159], a[68:71], v[200:203], a[144:159]
    ds_read_b64_tr_b16 a[64:65], v246 offset:12288
    ds_read_b64_tr_b16 a[66:67], v246 offset:13312
    s_add_u32 m0, s49, 65536
    s_nop 0
    buffer_load_dwordx4 v254, s[16:19], s48 offen offset:2048 lds
    v_fma_f32 v126, v126, v70, v78
    v_fma_f32 v127, v127, v71, v79
    v_mfma_f32_32x32x16_bf16 a[160:175], a[72:75], v[200:203], a[160:175]
    ds_read_b64_tr_b16 a[68:69], v247 offset:12288
    ds_read_b64_tr_b16 a[70:71], v247 offset:13312
    ds_read_b128 v[96:99], v243 offset:52416
    ds_read_b128 v[104:107], v243 offset:50624
    ds_read_b128 v[100:103], v243 offset:52432
    ds_read_b128 v[108:111], v243 offset:50640
    v_cvt_pk_bf16_f32 v215, v126, v127
    s_waitcnt lgkmcnt(15)
    v_lshlrev_b32 v112, 16, v216
    v_and_b32 v113, 0xffff0000, v216
    v_mfma_f32_32x32x16_bf16 a[176:191], a[76:79], v[200:203], a[176:191]
    ds_read_b64_tr_b16 a[72:73], v248 offset:12288
    ds_read_b64_tr_b16 a[74:75], v248 offset:13312
    s_add_u32 m0, s49, 65536
    s_nop 0
    buffer_load_dwordx4 v255, s[16:19], s48 offen offset:3072 lds
    s_add_u32 s48, s48, 16384
    s_and_b32 s48, s48, 0xfffff
    v_fma_f32 v112, v112, v14, v15
    s_waitcnt lgkmcnt(10)
    v_mfma_f32_32x32x16_bf16 a[192:207], a[80:83], v[200:203], a[192:207]
    ds_read_b64_tr_b16 a[76:77], v249 offset:12288
    ds_read_b64_tr_b16 a[78:79], v249 offset:13312
    v_fma_f32 v113, v113, v14, v15
    v_fma_f32 v112, v112, v80, v88
    v_fma_f32 v113, v113, v81, v89
    v_cvt_pk_bf16_f32 v216, v112, v113
    v_lshlrev_b32 v114, 16, v217
    v_mfma_f32_32x32x16_bf16 a[208:223], a[84:87], v[200:203], a[208:223]
    ds_read_b64_tr_b16 a[80:81], v246 offset:28672
    ds_read_b64_tr_b16 a[82:83], v246 offset:29696
    v_and_b32 v115, 0xffff0000, v217
    v_fma_f32 v114, v114, v14, v15
    v_fma_f32 v115, v115, v14, v15
    v_fma_f32 v114, v114, v82, v90
    v_fma_f32 v115, v115, v83, v91
    v_mfma_f32_32x32x16_bf16 a[224:239], a[88:91], v[200:203], a[224:239]
    ds_read_b64_tr_b16 a[84:85], v247 offset:28672
    ds_read_b64_tr_b16 a[86:87], v247 offset:29696
    s_add_u32 m0, s49, 81920
    s_nop 0
    buffer_load_dwordx4 v254, s[16:19], s48 offen offset:0 lds
    v_cvt_pk_bf16_f32 v217, v114, v115
    v_lshlrev_b32 v116, 16, v218
    v_mfma_f32_32x32x16_bf16 a[240:255], a[92:95], v[200:203], a[240:255]
    ds_read_b64_tr_b16 a[88:89], v248 offset:28672
    ds_read_b64_tr_b16 a[90:91], v248 offset:29696
    v_and_b32 v117, 0xffff0000, v218
    v_fma_f32 v116, v116, v14, v15
    v_fma_f32 v117, v117, v14, v15
    v_fma_f32 v116, v116, v84, v92
    s_waitcnt lgkmcnt(6)
    v_mfma_f32_32x32x16_bf16 a[128:143], a[64:67], v[204:207], a[128:143]
    ds_read_b64_tr_b16 a[92:93], v249 offset:28672
    ds_read_b64_tr_b16 a[94:95], v249 offset:29696
    v_fma_f32 v117, v117, v85, v93
    v_cvt_pk_bf16_f32 v218, v116, v117
    v_lshlrev_b32 v118, 16, v219
    v_and_b32 v119, 0xffff0000, v219
    v_fma_f32 v118, v118, v14, v15
    v_mfma_f32_32x32x16_bf16 a[144:159], a[68:71], v[204:207], a[144:159]
    v_add_u32 v246, 0x14000, v246
    v_add_u32 v247, 0x14000, v247
    v_add_u32 v248, 0x14000, v248
    v_add_u32 v249, 0x14000, v249
    ds_read_b64_tr_b16 a[64:65], v246 offset:0
    ds_read_b64_tr_b16 a[66:67], v246 offset:1024
    s_add_u32 m0, s49, 81920
    s_nop 0
    buffer_load_dwordx4 v255, s[16:19], s48 offen offset:1024 lds
    v_fma_f32 v119, v119, v14, v15
    v_fma_f32 v118, v118, v86, v94
    v_mfma_f32_32x32x16_bf16 a[160:175], a[72:75], v[204:207], a[160:175]
    ds_read_b64_tr_b16 a[68:69], v247 offset:0
    ds_read_b64_tr_b16 a[70:71], v247 offset:1024
    v_fma_f32 v119, v119, v87, v95
    v_cvt_pk_bf16_f32 v219, v118, v119
    v_lshlrev_b32 v120, 16, v220
    v_and_b32 v121, 0xffff0000, v220
    v_fma_f32 v120, v120, v14, v15
    v_mfma_f32_32x32x16_bf16 a[176:191], a[76:79], v[204:207], a[176:191]
    ds_read_b64_tr_b16 a[72:73], v248 offset:0
    ds_read_b64_tr_b16 a[74:75], v248 offset:1024
    v_fma_f32 v121, v121, v14, v15
    v_fma_f32 v120, v120, v96, v104
    v_fma_f32 v121, v121, v97, v105
    v_cvt_pk_bf16_f32 v220, v120, v121
    s_waitcnt lgkmcnt(6)
    v_mfma_f32_32x32x16_bf16 a[192:207], a[80:83], v[204:207], a[192:207]
    ds_read_b64_tr_b16 a[76:77], v249 offset:0
    ds_read_b64_tr_b16 a[78:79], v249 offset:1024
    s_add_u32 m0, s49, 81920
    s_nop 0
    buffer_load_dwordx4 v254, s[16:19], s48 offen offset:2048 lds
    v_lshlrev_b32 v122, 16, v221
    v_and_b32 v123, 0xffff0000, v221
    v_mfma_f32_32x32x16_bf16 a[208:223], a[84:87], v[204:207], a[208:223]
    ds_read_b64_tr_b16 a[80:81], v246 offset:16384
    ds_read_b64_tr_b16 a[82:83], v246 offset:17408
    v_fma_f32 v122, v122, v14, v15
    v_fma_f32 v123, v123, v14, v15
    v_fma_f32 v122, v122, v98, v106
    v_fma_f32 v123, v123, v99, v107
    v_cvt_pk_bf16_f32 v221, v122, v123
    v_mfma_f32_32x32x16_bf16 a[224:239], a[88:91], v[204:207], a[224:239]
    ds_read_b64_tr_b16 a[84:85], v247 offset:16384
    ds_read_b64_tr_b16 a[86:87], v247 offset:17408
    v_lshlrev_b32 v124, 16, v222
    v_and_b32 v125, 0xffff0000, v222
    v_fma_f32 v124, v124, v14, v15
    v_fma_f32 v125, v125, v14, v15
    v_fma_f32 v124, v124, v100, v108
    v_fma_f32 v125, v125, v101, v109
    v_cvt_pk_bf16_f32 v222, v124, v125
    v_lshlrev_b32 v126, 16, v223
    v_and_b32 v127, 0xffff0000, v223
    v_fma_f32 v126, v126, v14, v15
    v_fma_f32 v127, v127, v14, v15
    v_fma_f32 v126, v126, v102, v110
    v_fma_f32 v127, v127, v103, v111
    v_cvt_pk_bf16_f32 v223, v126, v127
    v_mfma_f32_32x32x16_bf16 a[240:255], a[92:95], v[204:207], a[240:255]
    ds_read_b64_tr_b16 a[88:89], v248 offset:16384
    ds_read_b64_tr_b16 a[90:91], v248 offset:17408
    s_add_u32 m0, s49, 81920
    s_nop 0
    buffer_load_dwordx4 v255, s[16:19], s48 offen offset:3072 lds
    s_add_u32 s48, s48, 16384
    s_and_b32 s48, s48, 0xfffff
    s_waitcnt lgkmcnt(6)
    v_mfma_f32_32x32x16_bf16 a[128:143], a[64:67], v[208:211], a[128:143]
    ds_read_b64_tr_b16 a[92:93], v249 offset:16384
    ds_read_b64_tr_b16 a[94:95], v249 offset:17408
    ds_read_b128 v[16:19], v243 offset:52480
    ds_read_b128 v[24:27], v243 offset:50688
    ds_read_b128 v[20:23], v243 offset:52496
    ds_read_b128 v[28:31], v243 offset:50704
    v_mfma_f32_32x32x16_bf16 a[144:159], a[68:71], v[208:211], a[144:159]
    ds_read_b64_tr_b16 a[64:65], v246 offset:4096
    ds_read_b64_tr_b16 a[66:67], v246 offset:5120
    v_mfma_f32_32x32x16_bf16 a[160:175], a[72:75], v[208:211], a[160:175]
    ds_read_b64_tr_b16 a[68:69], v247 offset:4096
    ds_read_b64_tr_b16 a[70:71], v247 offset:5120
    v_mfma_f32_32x32x16_bf16 a[176:191], a[76:79], v[208:211], a[176:191]
    ds_read_b64_tr_b16 a[72:73], v248 offset:4096
    ds_read_b64_tr_b16 a[74:75], v248 offset:5120
    s_waitcnt lgkmcnt(6)
    v_lshlrev_b32 v112, 16, v224
    v_and_b32 v113, 0xffff0000, v224
    v_fma_f32 v112, v112, v14, v15
    v_fma_f32 v113, v113, v14, v15
    v_mfma_f32_32x32x16_bf16 a[192:207], a[80:83], v[208:211], a[192:207]
    ds_read_b64_tr_b16 a[76:77], v249 offset:4096
    ds_read_b64_tr_b16 a[78:79], v249 offset:5120
    v_fma_f32 v112, v112, v16, v24
    v_fma_f32 v113, v113, v17, v25
    v_cvt_pk_bf16_f32 v224, v112, v113
    v_lshlrev_b32 v114, 16, v225
    v_and_b32 v115, 0xffff0000, v225
    v_mfma_f32_32x32x16_bf16 a[208:223], a[84:87], v[208:211], a[208:223]
    ds_read_b64_tr_b16 a[80:81], v246 offset:20480
    ds_read_b64_tr_b16 a[82:83], v246 offset:21504
    v_fma_f32 v114, v114, v14, v15
    v_fma_f32 v115, v115, v14, v15
    v_fma_f32 v114, v114, v18, v26
    v_fma_f32 v115, v115, v19, v27
    v_cvt_pk_bf16_f32 v225, v114, v115
    v_mfma_f32_32x32x16_bf16 a[224:239], a[88:91], v[208:211], a[224:239]
    ds_read_b64_tr_b16 a[84:85], v247 offset:20480
    ds_read_b64_tr_b16 a[86:87], v247 offset:21504
    ds_read_b128 v[32:35], v243 offset:52544
    ds_read_b128 v[40:43], v243 offset:50752
    ds_read_b128 v[36:39], v243 offset:52560
    ds_read_b128 v[44:47], v243 offset:50768
    v_lshlrev_b32 v116, 16, v226
    v_and_b32 v117, 0xffff0000, v226
    v_fma_f32 v116, v116, v14, v15
    v_mfma_f32_32x32x16_bf16 a[240:255], a[92:95], v[208:211], a[240:255]
    ds_read_b64_tr_b16 a[88:89], v248 offset:20480
    ds_read_b64_tr_b16 a[90:91], v248 offset:21504
    v_fma_f32 v117, v117, v14, v15
    v_fma_f32 v116, v116, v20, v28
    v_fma_f32 v117, v117, v21, v29
    v_cvt_pk_bf16_f32 v226, v116, v117
    s_waitcnt lgkmcnt(10)
    v_mfma_f32_32x32x16_bf16 a[128:143], a[64:67], v[212:215], a[128:143]
    ds_read_b64_tr_b16 a[92:93], v249 offset:20480
    ds_read_b64_tr_b16 a[94:95], v249 offset:21504
    v_lshlrev_b32 v118, 16, v227
    v_and_b32 v119, 0xffff0000, v227
    v_fma_f32 v118, v118, v14, v15
    v_fma_f32 v119, v119, v14, v15
    v_fma_f32 v118, v118, v22, v30
    v_mfma_f32_32x32x16_bf16 a[144:159], a[68:71], v[212:215], a[144:159]
    ds_read_b64_tr_b16 a[64:65], v246 offset:8192
    ds_read_b64_tr_b16 a[66:67], v246 offset:9216
    v_fma_f32 v119, v119, v23, v31
    v_cvt_pk_bf16_f32 v227, v118, v119
    s_waitcnt lgkmcnt(6)
    v_lshlrev_b32 v120, 16, v228
    v_and_b32 v121, 0xffff0000, v228
    v_fma_f32 v120, v120, v14, v15
    v_mfma_f32_32x32x16_bf16 a[160:175], a[72:75], v[212:215], a[160:175]
    ds_read_b64_tr_b16 a[68:69], v247 offset:8192
    ds_read_b64_tr_b16 a[70:71], v247 offset:9216
    v_fma_f32 v121, v121, v14, v15
    v_fma_f32 v120, v120, v32, v40
    v_fma_f32 v121, v121, v33, v41
    v_cvt_pk_bf16_f32 v228, v120, v121
    v_lshlrev_b32 v122, 16, v229
    v_mfma_f32_32x32x16_bf16 a[176:191], a[76:79], v[212:215], a[176:191]
    ds_read_b64_tr_b16 a[72:73], v248 offset:8192
    ds_read_b64_tr_b16 a[74:75], v248 offset:9216
    v_and_b32 v123, 0xffff0000, v229
    v_fma_f32 v122, v122, v14, v15
    v_fma_f32 v123, v123, v14, v15
    v_fma_f32 v122, v122, v34, v42
    s_waitcnt lgkmcnt(6)
    v_mfma_f32_32x32x16_bf16 a[192:207], a[80:83], v[212:215], a[192:207]
    ds_read_b64_tr_b16 a[76:77], v249 offset:8192
    ds_read_b64_tr_b16 a[78:79], v249 offset:9216
    ds_read_b128 v[48:51], v243 offset:52608
    ds_read_b128 v[56:59], v243 offset:50816
    ds_read_b128 v[52:55], v243 offset:52624
    ds_read_b128 v[60:63], v243 offset:50832
    s_waitcnt vmcnt(8)
    s_barrier
    v_mfma_f32_32x32x16_bf16 a[208:223], a[84:87], v[212:215], a[208:223]
    ds_read_b64_tr_b16 a[80:81], v246 offset:24576
    ds_read_b64_tr_b16 a[82:83], v246 offset:25600
    s_add_u32 m0, s49, 16384
    s_nop 0
    buffer_load_dwordx4 v250, s[12:15], s47 offen offset:0 lds
    v_fma_f32 v123, v123, v35, v43
    v_cvt_pk_bf16_f32 v229, v122, v123
    v_mfma_f32_32x32x16_bf16 a[224:239], a[88:91], v[212:215], a[224:239]
    ds_read_b64_tr_b16 a[84:85], v247 offset:24576
    ds_read_b64_tr_b16 a[86:87], v247 offset:25600
    v_lshlrev_b32 v124, 16, v230
    v_and_b32 v125, 0xffff0000, v230
    v_fma_f32 v124, v124, v14, v15
    v_fma_f32 v125, v125, v14, v15
    v_fma_f32 v124, v124, v36, v44
    v_mfma_f32_32x32x16_bf16 a[240:255], a[92:95], v[212:215], a[240:255]
    ds_read_b64_tr_b16 a[88:89], v248 offset:24576
    ds_read_b64_tr_b16 a[90:91], v248 offset:25600
    s_add_u32 m0, s49, 16384
    s_nop 0
    buffer_load_dwordx4 v251, s[12:15], s47 offen offset:1024 lds
    v_fma_f32 v125, v125, v37, v45
    s_waitcnt lgkmcnt(10)
    v_mfma_f32_32x32x16_bf16 a[128:143], a[64:67], v[216:219], a[128:143]
    ds_read_b64_tr_b16 a[92:93], v249 offset:24576
    ds_read_b64_tr_b16 a[94:95], v249 offset:25600
    v_cvt_pk_bf16_f32 v230, v124, v125
    v_lshlrev_b32 v126, 16, v231
    v_and_b32 v127, 0xffff0000, v231
    v_fma_f32 v126, v126, v14, v15
    v_fma_f32 v127, v127, v14, v15
    v_mfma_f32_32x32x16_bf16 a[144:159], a[68:71], v[216:219], a[144:159]
    ds_read_b64_tr_b16 a[64:65], v246 offset:12288
    ds_read_b64_tr_b16 a[66:67], v246 offset:13312
    s_add_u32 m0, s49, 16384
    s_nop 0
    buffer_load_dwordx4 v252, s[12:15], s47 offen offset:2048 lds
    v_fma_f32 v126, v126, v38, v46
    v_fma_f32 v127, v127, v39, v47
    v_mfma_f32_32x32x16_bf16 a[160:175], a[72:75], v[216:219], a[160:175]
    ds_read_b64_tr_b16 a[68:69], v247 offset:12288
    ds_read_b64_tr_b16 a[70:71], v247 offset:13312
    ds_read_b128 v[64:67], v243 offset:52672
    ds_read_b128 v[72:75], v243 offset:50880
    ds_read_b128 v[68:71], v243 offset:52688
    ds_read_b128 v[76:79], v243 offset:50896
    v_cvt_pk_bf16_f32 v231, v126, v127
    s_waitcnt lgkmcnt(15)
    v_lshlrev_b32 v112, 16, v232
    v_and_b32 v113, 0xffff0000, v232
    v_mfma_f32_32x32x16_bf16 a[176:191], a[76:79], v[216:219], a[176:191]
    ds_read_b64_tr_b16 a[72:73], v248 offset:12288
    ds_read_b64_tr_b16 a[74:75], v248 offset:13312
    s_add_u32 m0, s49, 16384
    s_nop 0
    buffer_load_dwordx4 v253, s[12:15], s47 offen offset:3072 lds
    s_add_u32 s47, s47, 16384
    s_and_b32 s47, s47, 0xfffff
    v_fma_f32 v112, v112, v14, v15
    s_waitcnt lgkmcnt(10)
    v_mfma_f32_32x32x16_bf16 a[192:207], a[80:83], v[216:219], a[192:207]
    ds_read_b64_tr_b16 a[76:77], v249 offset:12288
    ds_read_b64_tr_b16 a[78:79], v249 offset:13312
    v_fma_f32 v113, v113, v14, v15
    v_fma_f32 v112, v112, v48, v56
    v_fma_f32 v113, v113, v49, v57
    v_cvt_pk_bf16_f32 v232, v112, v113
    v_lshlrev_b32 v114, 16, v233
    v_mfma_f32_32x32x16_bf16 a[208:223], a[84:87], v[216:219], a[208:223]
    ds_read_b64_tr_b16 a[80:81], v246 offset:28672
    ds_read_b64_tr_b16 a[82:83], v246 offset:29696
    v_and_b32 v115, 0xffff0000, v233
    v_fma_f32 v114, v114, v14, v15
    v_fma_f32 v115, v115, v14, v15
    v_fma_f32 v114, v114, v50, v58
    v_fma_f32 v115, v115, v51, v59
    v_mfma_f32_32x32x16_bf16 a[224:239], a[88:91], v[216:219], a[224:239]
    ds_read_b64_tr_b16 a[84:85], v247 offset:28672
    ds_read_b64_tr_b16 a[86:87], v247 offset:29696
    s_add_u32 m0, s49, 32768
    s_nop 0
    buffer_load_dwordx4 v250, s[12:15], s47 offen offset:0 lds
    v_cvt_pk_bf16_f32 v233, v114, v115
    v_lshlrev_b32 v116, 16, v234
    v_mfma_f32_32x32x16_bf16 a[240:255], a[92:95], v[216:219], a[240:255]
    ds_read_b64_tr_b16 a[88:89], v248 offset:28672
    ds_read_b64_tr_b16 a[90:91], v248 offset:29696
    v_and_b32 v117, 0xffff0000, v234
    v_fma_f32 v116, v116, v14, v15
    v_fma_f32 v117, v117, v14, v15
    v_fma_f32 v116, v116, v52, v60
    s_waitcnt lgkmcnt(6)
    v_mfma_f32_32x32x16_bf16 a[128:143], a[64:67], v[220:223], a[128:143]
    ds_read_b64_tr_b16 a[92:93], v249 offset:28672
    ds_read_b64_tr_b16 a[94:95], v249 offset:29696
    v_fma_f32 v117, v117, v53, v61
    v_cvt_pk_bf16_f32 v234, v116, v117
    v_lshlrev_b32 v118, 16, v235
    v_and_b32 v119, 0xffff0000, v235
    v_fma_f32 v118, v118, v14, v15
    v_mfma_f32_32x32x16_bf16 a[144:159], a[68:71], v[220:223], a[144:159]
    v_add_u32 v246, 0x8000, v246
    v_add_u32 v247, 0x8000, v247
    v_add_u32 v248, 0x8000, v248
    v_add_u32 v249, 0x8000, v249
    ds_read_b64_tr_b16 a[64:65], v246 offset:0
    ds_read_b64_tr_b16 a[66:67], v246 offset:1024
    s_add_u32 m0, s49, 32768
    s_nop 0
    buffer_load_dwordx4 v251, s[12:15], s47 offen offset:1024 lds
    v_fma_f32 v119, v119, v14, v15
    v_fma_f32 v118, v118, v54, v62
    v_mfma_f32_32x32x16_bf16 a[160:175], a[72:75], v[220:223], a[160:175]
    ds_read_b64_tr_b16 a[68:69], v246 offset:4096
    ds_read_b64_tr_b16 a[70:71], v246 offset:5120
    v_fma_f32 v119, v119, v55, v63
    v_cvt_pk_bf16_f32 v235, v118, v119
    v_lshlrev_b32 v120, 16, v236
    v_and_b32 v121, 0xffff0000, v236
    v_fma_f32 v120, v120, v14, v15
    v_mfma_f32_32x32x16_bf16 a[176:191], a[76:79], v[220:223], a[176:191]
    ds_read_b64_tr_b16 a[72:73], v246 offset:8192
    ds_read_b64_tr_b16 a[74:75], v246 offset:9216
    v_fma_f32 v121, v121, v14, v15
    v_fma_f32 v120, v120, v64, v72
    v_fma_f32 v121, v121, v65, v73
    v_cvt_pk_bf16_f32 v236, v120, v121
    s_waitcnt lgkmcnt(6)
    v_mfma_f32_32x32x16_bf16 a[192:207], a[80:83], v[220:223], a[192:207]
    ds_read_b64_tr_b16 a[76:77], v246 offset:12288
    ds_read_b64_tr_b16 a[78:79], v246 offset:13312
    s_add_u32 m0, s49, 32768
    s_nop 0
    buffer_load_dwordx4 v252, s[12:15], s47 offen offset:2048 lds
    v_lshlrev_b32 v122, 16, v237
    v_and_b32 v123, 0xffff0000, v237
    v_mfma_f32_32x32x16_bf16 a[208:223], a[84:87], v[220:223], a[208:223]
    ds_read_b64_tr_b16 a[80:81], v247 offset:0
    ds_read_b64_tr_b16 a[82:83], v247 offset:1024
    v_fma_f32 v122, v122, v14, v15
    v_fma_f32 v123, v123, v14, v15
    v_fma_f32 v122, v122, v66, v74
    v_fma_f32 v123, v123, v67, v75
    v_cvt_pk_bf16_f32 v237, v122, v123
    v_mfma_f32_32x32x16_bf16 a[224:239], a[88:91], v[220:223], a[224:239]
    ds_read_b64_tr_b16 a[84:85], v247 offset:4096
    ds_read_b64_tr_b16 a[86:87], v247 offset:5120
    v_lshlrev_b32 v124, 16, v238
    v_and_b32 v125, 0xffff0000, v238
    v_fma_f32 v124, v124, v14, v15
    v_fma_f32 v125, v125, v14, v15
    v_fma_f32 v124, v124, v68, v76
    v_fma_f32 v125, v125, v69, v77
    v_cvt_pk_bf16_f32 v238, v124, v125
    v_lshlrev_b32 v126, 16, v239
    v_and_b32 v127, 0xffff0000, v239
    v_fma_f32 v126, v126, v14, v15
    v_fma_f32 v127, v127, v14, v15
    v_fma_f32 v126, v126, v70, v78
    v_fma_f32 v127, v127, v71, v79
    v_cvt_pk_bf16_f32 v239, v126, v127
    v_mfma_f32_32x32x16_bf16 a[240:255], a[92:95], v[220:223], a[240:255]
    ds_read_b64_tr_b16 a[88:89], v247 offset:8192
    ds_read_b64_tr_b16 a[90:91], v247 offset:9216
    s_add_u32 m0, s49, 32768
    s_nop 0
    buffer_load_dwordx4 v253, s[12:15], s47 offen offset:3072 lds
    s_add_u32 s47, s47, 16384
    s_and_b32 s47, s47, 0xfffff
    s_waitcnt lgkmcnt(6)
    v_mfma_f32_32x32x16_bf16 a[128:143], a[64:67], v[224:227], a[128:143]
    ds_read_b64_tr_b16 a[92:93], v247 offset:12288
    ds_read_b64_tr_b16 a[94:95], v247 offset:13312
    v_and_b32 v192, 15, v241
    v_xor_b32 v192, v192, v242
    v_lshlrev_b32 v193, 9, v241
    v_xor_b32 v194, 0, v192
    v_lshl_add_u32 v196, v194, 4, v193
    v_xor_b32 v194, 2, v192
    v_lshl_add_u32 v197, v194, 4, v193
    v_xor_b32 v194, 4, v192
    v_lshl_add_u32 v198, v194, 4, v193
    v_mfma_f32_32x32x16_bf16 a[128:143], a[68:71], v[228:231], a[128:143]
    ds_read_b64_tr_b16 a[64:65], v248 offset:0
    ds_read_b64_tr_b16 a[66:67], v248 offset:1024
    v_xor_b32 v194, 6, v192
    v_lshl_add_u32 v199, v194, 4, v193
    v_xor_b32 v194, 8, v192
    v_lshl_add_u32 v200, v194, 4, v193
    v_xor_b32 v194, 10, v192
    v_lshl_add_u32 v201, v194, 4, v193
    v_xor_b32 v194, 12, v192
    v_lshl_add_u32 v202, v194, 4, v193
    v_xor_b32 v194, 14, v192
    v_mfma_f32_32x32x16_bf16 a[128:143], a[72:75], v[232:235], a[128:143]
    ds_read_b64_tr_b16 a[68:69], v248 offset:4096
    ds_read_b64_tr_b16 a[70:71], v248 offset:5120
    v_lshl_add_u32 v203, v194, 4, v193
    ds_read_b128 a[96:99], v196 offset:0
    ds_read_b128 a[100:103], v197 offset:0
    ds_read_b128 a[104:107], v198 offset:0
    ds_read_b128 a[108:111], v199 offset:0
    ds_read_b128 a[112:115], v200 offset:0
    ds_read_b128 a[116:119], v201 offset:0
    ds_read_b128 a[120:123], v202 offset:0
    ds_read_b128 a[124:127], v203 offset:0
    v_mfma_f32_32x32x16_bf16 a[128:143], a[76:79], v[236:239], a[128:143]
    ds_read_b64_tr_b16 a[72:73], v248 offset:8192
    ds_read_b64_tr_b16 a[74:75], v248 offset:9216
    s_waitcnt lgkmcnt(14)
    v_mfma_f32_32x32x16_bf16 a[144:159], a[80:83], v[224:227], a[144:159]
    ds_read_b64_tr_b16 a[76:77], v248 offset:12288
    ds_read_b64_tr_b16 a[78:79], v248 offset:13312
    v_mfma_f32_32x32x16_bf16 a[144:159], a[84:87], v[228:231], a[144:159]
    ds_read_b64_tr_b16 a[80:81], v249 offset:0
    ds_read_b64_tr_b16 a[82:83], v249 offset:1024
    v_mfma_f32_32x32x16_bf16 a[144:159], a[88:91], v[232:235], a[144:159]
    ds_read_b64_tr_b16 a[84:85], v249 offset:4096
    ds_read_b64_tr_b16 a[86:87], v249 offset:5120
    v_accvgpr_read_b32 v160, a128
    v_accvgpr_read_b32 v161, a129
    v_accvgpr_read_b32 v162, a130
    v_accvgpr_read_b32 v163, a131
    v_accvgpr_read_b32 v164, a132
    v_accvgpr_read_b32 v165, a133
    v_accvgpr_read_b32 v166, a134
    v_accvgpr_read_b32 v167, a135
    v_cvt_pk_bf16_f32 v144, v160, v161
    v_mfma_f32_32x32x16_bf16 a[144:159], a[92:95], v[236:239], a[144:159]
    ds_read_b64_tr_b16 a[88:89], v249 offset:8192
    ds_read_b64_tr_b16 a[90:91], v249 offset:9216
    v_cvt_pk_bf16_f32 v145, v162, v163
    v_cvt_pk_bf16_f32 v146, v164, v165
    v_cvt_pk_bf16_f32 v147, v166, v167
    v_accvgpr_write_b32 a0, v144
    v_accvgpr_write_b32 a1, v145
    v_accvgpr_write_b32 a2, v146
    v_accvgpr_write_b32 a3, v147
    v_accvgpr_read_b32 v168, a136
    s_waitcnt lgkmcnt(6)
    v_mfma_f32_32x32x16_bf16 a[160:175], a[64:67], v[224:227], a[160:175]
    ds_read_b64_tr_b16 a[92:93], v249 offset:12288
    ds_read_b64_tr_b16 a[94:95], v249 offset:13312
    v_accvgpr_read_b32 v169, a137
    v_accvgpr_read_b32 v170, a138
    v_accvgpr_read_b32 v171, a139
    v_accvgpr_read_b32 v172, a140
    v_accvgpr_read_b32 v173, a141
    v_accvgpr_read_b32 v174, a142
    v_accvgpr_read_b32 v175, a143
    v_cvt_pk_bf16_f32 v148, v168, v169
    v_cvt_pk_bf16_f32 v149, v170, v171
    v_mfma_f32_32x32x16_bf16 a[160:175], a[68:71], v[228:231], a[160:175]
    ds_read_b64_tr_b16 a[64:65], v246 offset:16384
    ds_read_b64_tr_b16 a[66:67], v246 offset:17408
    v_cvt_pk_bf16_f32 v150, v172, v173
    v_cvt_pk_bf16_f32 v151, v174, v175
    v_accvgpr_write_b32 a4, v148
    v_accvgpr_write_b32 a5, v149
    v_accvgpr_write_b32 a6, v150
    v_accvgpr_write_b32 a7, v151
    v_mfma_f32_32x32x16_bf16 a[160:175], a[72:75], v[232:235], a[160:175]
    ds_read_b64_tr_b16 a[68:69], v246 offset:20480
    ds_read_b64_tr_b16 a[70:71], v246 offset:21504
    v_accvgpr_read_b32 v176, a144
    v_accvgpr_read_b32 v177, a145
    v_accvgpr_read_b32 v178, a146
    v_accvgpr_read_b32 v179, a147
    v_accvgpr_read_b32 v180, a148
    v_accvgpr_read_b32 v181, a149
    v_accvgpr_read_b32 v182, a150
    v_accvgpr_read_b32 v183, a151
    v_mfma_f32_32x32x16_bf16 v[128:143], a[96:99], a[0:3], 0
    ds_read_b128 a[96:99], v196 offset:256
    v_mfma_f32_32x32x16_bf16 a[160:175], a[76:79], v[236:239], a[160:175]
    ds_read_b64_tr_b16 a[72:73], v246 offset:24576
    ds_read_b64_tr_b16 a[74:75], v246 offset:25600
    v_cvt_pk_bf16_f32 v152, v176, v177
    v_cvt_pk_bf16_f32 v153, v178, v179
    v_cvt_pk_bf16_f32 v154, v180, v181
    v_cvt_pk_bf16_f32 v155, v182, v183
    v_accvgpr_write_b32 a8, v152
    v_accvgpr_write_b32 a9, v153
    v_accvgpr_write_b32 a10, v154
    v_accvgpr_write_b32 a11, v155
    s_waitcnt lgkmcnt(7)
    v_mfma_f32_32x32x16_bf16 a[176:191], a[80:83], v[224:227], a[176:191]
    ds_read_b64_tr_b16 a[76:77], v246 offset:28672
    ds_read_b64_tr_b16 a[78:79], v246 offset:29696
    s_barrier
    v_accvgpr_read_b32 v184, a152
    v_accvgpr_read_b32 v185, a153
    v_accvgpr_read_b32 v186, a154
    v_accvgpr_read_b32 v187, a155
    v_mfma_f32_32x32x16_bf16 a[176:191], a[84:87], v[228:231], a[176:191]
    ds_read_b64_tr_b16 a[80:81], v247 offset:16384
    ds_read_b64_tr_b16 a[82:83], v247 offset:17408
    s_add_u32 m0, s49, 49152
    s_nop 0
    buffer_load_dwordx4 v250, s[12:15], s47 offen offset:0 lds
    v_accvgpr_read_b32 v188, a156
    v_accvgpr_read_b32 v189, a157
    v_accvgpr_read_b32 v190, a158
    v_accvgpr_read_b32 v191, a159
    v_mfma_f32_32x32x16_bf16 v[128:143], a[100:103], a[4:7], v[128:143]
    ds_read_b128 a[100:103], v197 offset:256
    v_cvt_pk_bf16_f32 v156, v184, v185
    v_mfma_f32_32x32x16_bf16 a[176:191], a[88:91], v[232:235], a[176:191]
    ds_read_b64_tr_b16 a[84:85], v247 offset:20480
    ds_read_b64_tr_b16 a[86:87], v247 offset:21504
    v_cvt_pk_bf16_f32 v157, v186, v187
    v_cvt_pk_bf16_f32 v158, v188, v189
    v_cvt_pk_bf16_f32 v159, v190, v191
    v_accvgpr_write_b32 a12, v156
    v_accvgpr_write_b32 a13, v157
    v_accvgpr_write_b32 a14, v158
    v_accvgpr_write_b32 a15, v159
    v_accvgpr_read_b32 v160, a160
    v_accvgpr_read_b32 v161, a161
    v_mfma_f32_32x32x16_bf16 a[176:191], a[92:95], v[236:239], a[176:191]
    ds_read_b64_tr_b16 a[88:89], v247 offset:24576
    ds_read_b64_tr_b16 a[90:91], v247 offset:25600
    s_add_u32 m0, s49, 49152
    s_nop 0
    buffer_load_dwordx4 v251, s[12:15], s47 offen offset:1024 lds
    v_accvgpr_read_b32 v162, a162
    v_accvgpr_read_b32 v163, a163
    v_accvgpr_read_b32 v164, a164
    v_accvgpr_read_b32 v165, a165
    v_accvgpr_read_b32 v166, a166
    s_waitcnt lgkmcnt(7)
    v_mfma_f32_32x32x16_bf16 a[192:207], a[64:67], v[224:227], a[192:207]
    ds_read_b64_tr_b16 a[92:93], v247 offset:28672
    ds_read_b64_tr_b16 a[94:95], v247 offset:29696
    v_accvgpr_read_b32 v167, a167
    v_mfma_f32_32x32x16_bf16 v[128:143], a[104:107], a[8:11], v[128:143]
    ds_read_b128 a[104:107], v198 offset:256
    v_cvt_pk_bf16_f32 v144, v160, v161
    v_cvt_pk_bf16_f32 v145, v162, v163
    v_cvt_pk_bf16_f32 v146, v164, v165
    v_cvt_pk_bf16_f32 v147, v166, v167
    v_accvgpr_write_b32 a16, v144
    v_accvgpr_write_b32 a17, v145
    v_accvgpr_write_b32 a18, v146
    v_mfma_f32_32x32x16_bf16 a[192:207], a[68:71], v[228:231], a[192:207]
    ds_read_b64_tr_b16 a[64:65], v248 offset:16384
    ds_read_b64_tr_b16 a[66:67], v248 offset:17408
    s_add_u32 m0, s49, 49152
    s_nop 0
    buffer_load_dwordx4 v252, s[12:15], s47 offen offset:2048 lds
    v_accvgpr_write_b32 a19, v147
    v_accvgpr_read_b32 v168, a168
    v_accvgpr_read_b32 v169, a169
    v_accvgpr_read_b32 v170, a170
    v_accvgpr_read_b32 v171, a171
    v_accvgpr_read_b32 v172, a172
    v_mfma_f32_32x32x16_bf16 a[192:207], a[72:75], v[232:235], a[192:207]
    ds_read_b64_tr_b16 a[68:69], v248 offset:20480
    ds_read_b64_tr_b16 a[70:71], v248 offset:21504
    v_accvgpr_read_b32 v173, a173
    v_accvgpr_read_b32 v174, a174
    v_accvgpr_read_b32 v175, a175
    v_mfma_f32_32x32x16_bf16 v[128:143], a[108:111], a[12:15], v[128:143]
    ds_read_b128 a[108:111], v199 offset:256
    v_cvt_pk_bf16_f32 v148, v168, v169
    v_cvt_pk_bf16_f32 v149, v170, v171
    v_cvt_pk_bf16_f32 v150, v172, v173
    v_cvt_pk_bf16_f32 v151, v174, v175
    v_accvgpr_write_b32 a20, v148
    v_mfma_f32_32x32x16_bf16 a[192:207], a[76:79], v[236:239], a[192:207]
    ds_read_b64_tr_b16 a[72:73], v248 offset:24576
    ds_read_b64_tr_b16 a[74:75], v248 offset:25600
    s_add_u32 m0, s49, 49152
    s_nop 0
    buffer_load_dwordx4 v253, s[12:15], s47 offen offset:3072 lds
    v_accvgpr_write_b32 a21, v149
    v_accvgpr_write_b32 a22, v150
    v_accvgpr_write_b32 a23, v151
    v_accvgpr_read_b32 v176, a176
    v_accvgpr_read_b32 v177, a177
    s_waitcnt lgkmcnt(8)
    v_mfma_f32_32x32x16_bf16 a[208:223], a[80:83], v[224:227], a[208:223]
    ds_read_b64_tr_b16 a[76:77], v248 offset:28672
    ds_read_b64_tr_b16 a[78:79], v248 offset:29696
    v_accvgpr_read_b32 v178, a178
    v_accvgpr_read_b32 v179, a179
    v_accvgpr_read_b32 v180, a180
    v_accvgpr_read_b32 v181, a181
    v_accvgpr_read_b32 v182, a182
    v_accvgpr_read_b32 v183, a183
    v_mfma_f32_32x32x16_bf16 v[128:143], a[112:115], a[16:19], v[128:143]
    ds_read_b128 a[112:115], v200 offset:256
    v_cvt_pk_bf16_f32 v152, v176, v177
    v_cvt_pk_bf16_f32 v153, v178, v179
    v_mfma_f32_32x32x16_bf16 a[208:223], a[84:87], v[228:231], a[208:223]
    ds_read_b64_tr_b16 a[80:81], v249 offset:16384
    ds_read_b64_tr_b16 a[82:83], v249 offset:17408
    s_add_u32 m0, s49, 98304
    s_nop 0
    buffer_load_dwordx4 v254, s[16:19], s48 offen offset:0 lds
    v_cvt_pk_bf16_f32 v154, v180, v181
    v_cvt_pk_bf16_f32 v155, v182, v183
    v_accvgpr_write_b32 a24, v152
    v_accvgpr_write_b32 a25, v153
    v_accvgpr_write_b32 a26, v154
    v_accvgpr_write_b32 a27, v155
    v_mfma_f32_32x32x16_bf16 a[208:223], a[88:91], v[232:235], a[208:223]
    ds_read_b64_tr_b16 a[84:85], v249 offset:20480
    ds_read_b64_tr_b16 a[86:87], v249 offset:21504
    v_accvgpr_read_b32 v184, a184
    v_accvgpr_read_b32 v185, a185
    v_accvgpr_read_b32 v186, a186
    v_accvgpr_read_b32 v187, a187
    v_accvgpr_read_b32 v188, a188
    v_accvgpr_read_b32 v189, a189
    v_accvgpr_read_b32 v190, a190
    v_accvgpr_read_b32 v191, a191
    v_mfma_f32_32x32x16_bf16 v[128:143], a[116:119], a[20:23], v[128:143]
    ds_read_b128 a[116:119], v201 offset:256
    v_mfma_f32_32x32x16_bf16 a[208:223], a[92:95], v[236:239], a[208:223]
    ds_read_b64_tr_b16 a[88:89], v249 offset:24576
    ds_read_b64_tr_b16 a[90:91], v249 offset:25600
    s_add_u32 m0, s49, 98304
    s_nop 0
    buffer_load_dwordx4 v255, s[16:19], s48 offen offset:1024 lds
    v_cvt_pk_bf16_f32 v156, v184, v185
    v_cvt_pk_bf16_f32 v157, v186, v187
    v_cvt_pk_bf16_f32 v158, v188, v189
    v_cvt_pk_bf16_f32 v159, v190, v191
    v_accvgpr_write_b32 a28, v156
    s_waitcnt lgkmcnt(8)
    v_mfma_f32_32x32x16_bf16 a[224:239], a[64:67], v[224:227], a[224:239]
    ds_read_b64_tr_b16 a[92:93], v249 offset:28672
    ds_read_b64_tr_b16 a[94:95], v249 offset:29696
    v_accvgpr_write_b32 a29, v157
    v_accvgpr_write_b32 a30, v158
    v_accvgpr_write_b32 a31, v159
    v_accvgpr_read_b32 v160, a192
    v_accvgpr_read_b32 v161, a193
    v_accvgpr_read_b32 v162, a194
    v_accvgpr_read_b32 v163, a195
    v_accvgpr_read_b32 v164, a196
    v_accvgpr_read_b32 v165, a197
    v_mfma_f32_32x32x16_bf16 a[224:239], a[68:71], v[228:231], a[224:239]
    v_accvgpr_read_b32 v166, a198
    v_accvgpr_read_b32 v167, a199
    v_mfma_f32_32x32x16_bf16 v[128:143], a[120:123], a[24:27], v[128:143]
    ds_read_b128 a[120:123], v202 offset:256
    v_cvt_pk_bf16_f32 v144, v160, v161
    v_cvt_pk_bf16_f32 v145, v162, v163
    v_cvt_pk_bf16_f32 v146, v164, v165
    v_cvt_pk_bf16_f32 v147, v166, v167
    v_accvgpr_write_b32 a32, v144
    v_accvgpr_write_b32 a33, v145
    v_accvgpr_write_b32 a34, v146
    v_mfma_f32_32x32x16_bf16 a[224:239], a[72:75], v[232:235], a[224:239]
    v_accvgpr_write_b32 a35, v147
    v_accvgpr_read_b32 v168, a200
    v_accvgpr_read_b32 v169, a201
    v_accvgpr_read_b32 v170, a202
    v_accvgpr_read_b32 v171, a203
    v_accvgpr_read_b32 v172, a204
    v_accvgpr_read_b32 v173, a205
    v_accvgpr_read_b32 v174, a206
    v_accvgpr_read_b32 v175, a207
    v_mfma_f32_32x32x16_bf16 v[128:143], a[124:127], a[28:31], v[128:143]
    ds_read_b128 a[124:127], v203 offset:256
    v_mfma_f32_32x32x16_bf16 a[224:239], a[76:79], v[236:239], a[224:239]
    v_cvt_pk_bf16_f32 v148, v168, v169
    v_cvt_pk_bf16_f32 v149, v170, v171
    v_cvt_pk_bf16_f32 v150, v172, v173
    v_cvt_pk_bf16_f32 v151, v174, v175
    v_accvgpr_write_b32 a36, v148
    v_accvgpr_write_b32 a37, v149
    v_accvgpr_write_b32 a38, v150
    v_accvgpr_write_b32 a39, v151
    v_accvgpr_read_b32 v176, a208
    s_waitcnt lgkmcnt(2)
    v_mfma_f32_32x32x16_bf16 a[240:255], a[80:83], v[224:227], a[240:255]
    v_accvgpr_read_b32 v177, a209
    v_accvgpr_read_b32 v178, a210
    v_accvgpr_read_b32 v179, a211
    v_accvgpr_read_b32 v180, a212
    v_accvgpr_read_b32 v181, a213
    v_accvgpr_read_b32 v182, a214
    v_accvgpr_read_b32 v183, a215
    v_mfma_f32_32x32x16_bf16 v[128:143], a[96:99], a[32:35], v[128:143]
    v_cvt_pk_bf16_f32 v152, v176, v177
    v_cvt_pk_bf16_f32 v153, v178, v179
    v_mfma_f32_32x32x16_bf16 a[240:255], a[84:87], v[228:231], a[240:255]
    v_cvt_pk_bf16_f32 v154, v180, v181
    v_cvt_pk_bf16_f32 v155, v182, v183
    v_accvgpr_write_b32 a40, v152
    v_accvgpr_write_b32 a41, v153
    v_accvgpr_write_b32 a42, v154
    v_accvgpr_write_b32 a43, v155
    v_accvgpr_read_b32 v184, a216
    v_accvgpr_read_b32 v185, a217
    v_accvgpr_read_b32 v186, a218
    v_accvgpr_read_b32 v187, a219
    v_mfma_f32_32x32x16_bf16 a[240:255], a[88:91], v[232:235], a[240:255]
    v_accvgpr_read_b32 v188, a220
    v_accvgpr_read_b32 v189, a221
    v_accvgpr_read_b32 v190, a222
    v_accvgpr_read_b32 v191, a223
    v_mfma_f32_32x32x16_bf16 v[128:143], a[100:103], a[36:39], v[128:143]
    v_cvt_pk_bf16_f32 v156, v184, v185
    v_cvt_pk_bf16_f32 v157, v186, v187
    v_cvt_pk_bf16_f32 v158, v188, v189
    v_cvt_pk_bf16_f32 v159, v190, v191
    v_accvgpr_write_b32 a44, v156
    v_mfma_f32_32x32x16_bf16 a[240:255], a[92:95], v[236:239], a[240:255]
    v_accvgpr_write_b32 a45, v157
    v_accvgpr_write_b32 a46, v158
    v_accvgpr_write_b32 a47, v159
    v_accvgpr_read_b32 v160, a224
    v_accvgpr_read_b32 v161, a225
    v_accvgpr_read_b32 v162, a226
    v_accvgpr_read_b32 v163, a227
    v_accvgpr_read_b32 v164, a228
    v_accvgpr_read_b32 v165, a229
    v_accvgpr_read_b32 v166, a230
    v_accvgpr_read_b32 v167, a231
    v_mfma_f32_32x32x16_bf16 v[128:143], a[104:107], a[40:43], v[128:143]
    v_cvt_pk_bf16_f32 v144, v160, v161
    v_cvt_pk_bf16_f32 v145, v162, v163
    v_cvt_pk_bf16_f32 v146, v164, v165
    v_cvt_pk_bf16_f32 v147, v166, v167
    v_accvgpr_write_b32 a48, v144
    v_accvgpr_write_b32 a49, v145
    v_accvgpr_write_b32 a50, v146
    v_accvgpr_write_b32 a51, v147
    v_accvgpr_read_b32 v168, a232
    v_accvgpr_read_b32 v169, a233
    v_accvgpr_read_b32 v170, a234
    v_accvgpr_read_b32 v171, a235
    v_accvgpr_read_b32 v172, a236
    v_accvgpr_read_b32 v173, a237
    v_accvgpr_read_b32 v174, a238
    v_accvgpr_read_b32 v175, a239
    v_mfma_f32_32x32x16_bf16 v[128:143], a[108:111], a[44:47], v[128:143]
    v_cvt_pk_bf16_f32 v148, v168, v169
    v_cvt_pk_bf16_f32 v149, v170, v171
    v_cvt_pk_bf16_f32 v150, v172, v173
    v_cvt_pk_bf16_f32 v151, v174, v175
    v_accvgpr_write_b32 a52, v148
    v_accvgpr_write_b32 a53, v149
    v_accvgpr_write_b32 a54, v150
    v_accvgpr_write_b32 a55, v151
    v_accvgpr_read_b32 v176, a240
    v_accvgpr_read_b32 v177, a241
    v_accvgpr_read_b32 v178, a242
    v_accvgpr_read_b32 v179, a243
    v_accvgpr_read_b32 v180, a244
    v_accvgpr_read_b32 v181, a245
    v_accvgpr_read_b32 v182, a246
    v_accvgpr_read_b32 v183, a247
    v_mfma_f32_32x32x16_bf16 v[128:143], a[112:115], a[48:51], v[128:143]
    v_cvt_pk_bf16_f32 v152, v176, v177
    v_cvt_pk_bf16_f32 v153, v178, v179
    v_cvt_pk_bf16_f32 v154, v180, v181
    v_cvt_pk_bf16_f32 v155, v182, v183
    v_accvgpr_write_b32 a56, v152
    v_accvgpr_write_b32 a57, v153
    v_accvgpr_write_b32 a58, v154
    v_accvgpr_write_b32 a59, v155
    v_accvgpr_read_b32 v184, a248
    v_accvgpr_read_b32 v185, a249
    v_accvgpr_read_b32 v186, a250
    v_accvgpr_read_b32 v187, a251
    v_accvgpr_read_b32 v188, a252
    v_accvgpr_read_b32 v189, a253
    v_accvgpr_read_b32 v190, a254
    v_accvgpr_read_b32 v191, a255
    v_mfma_f32_32x32x16_bf16 v[128:143], a[116:119], a[52:55], v[128:143]
    v_cvt_pk_bf16_f32 v156, v184, v185
    v_cvt_pk_bf16_f32 v157, v186, v187
    v_cvt_pk_bf16_f32 v158, v188, v189
    v_cvt_pk_bf16_f32 v159, v190, v191
    v_accvgpr_write_b32 a60, v156
    v_accvgpr_write_b32 a61, v157
    v_accvgpr_write_b32 a62, v158
    v_accvgpr_write_b32 a63, v159
    v_lshrrev_b32 v160, 4, v240
    v_and_b32 v161, 15, v240
    s_waitcnt lgkmcnt(1)
    v_mfma_f32_32x32x16_bf16 v[128:143], a[120:123], a[56:59], v[128:143]
    v_lshrrev_b32 v162, 2, v161
    v_lshrrev_b32 v163, 1, v160
    v_lshl_add_u32 v163, v163, 2, v162
    v_lshlrev_b32 v163, 9, v163
    s_waitcnt lgkmcnt(0)
    v_mfma_f32_32x32x16_bf16 v[128:143], a[124:127], a[60:63], v[128:143]
    v_and_b32 v164, 1, v160
    v_lshl_add_u32 v163, v164, 5, v163
    v_and_b32 v164, 1, v161
    v_lshl_add_u32 v163, v164, 4, v163
    v_and_b32 v164, 2, v161
    v_lshl_add_u32 v163, v164, 2, v163
    v_add_u32 v163, 0x10000, v163
    v_xor_b32 v164, 0, v162
    v_lshl_add_u32 v204, v164, 6, v163
    v_xor_b32 v164, 1, v162
    v_lshl_add_u32 v205, v164, 6, v163
    v_xor_b32 v164, 2, v162
    v_lshl_add_u32 v206, v164, 6, v163
    v_xor_b32 v164, 3, v162
    v_lshl_add_u32 v207, v164, 6, v163
    v_mov_b32 v186, 0
    v_mov_b32 v187, 0
    s_waitcnt vmcnt(10)
    s_barrier
    ds_read_b128 a[64:67], v196 offset:16384
    ds_read_b128 a[68:71], v197 offset:16384
    ds_read_b128 a[72:75], v198 offset:16384
    ds_read_b128 a[76:79], v199 offset:16384
    ds_read_b128 a[80:83], v200 offset:16384
    ds_read_b128 a[84:87], v201 offset:16384
    ds_read_b128 a[88:91], v202 offset:16384
    ds_read_b128 a[92:95], v203 offset:16384
    s_nop 7
    v_max3_f32 v191, v128, v129, v130
    v_max3_f32 v191, v191, v131, v132
    v_max3_f32 v191, v191, v133, v134
    v_max3_f32 v191, v191, v135, v136
    v_max3_f32 v191, v191, v137, v138
    v_max3_f32 v191, v191, v139, v140
    v_max3_f32 v191, v191, v141, v142
    v_max_f32 v189, v191, v143
    v_mov_b32 v190, v189
    s_nop 1
    v_permlane32_swap_b32 v189, v190
    v_max_f32 v184, v189, v190
    v_mul_f32 v185, s46, v184
    v_add_f32 v185, 0x42c80000, v185
    v_add_f32 v188, 0x445dce9e, v184
    s_mov_b32 s50, 0
    s_load_dwordx2 s[36:37], s[0:1], 32
    s_load_dwordx4 s[40:43], s[0:1], 48
    s_load_dwordx2 s[38:39], s[0:1], 64
    s_lshl_b32 s59, s52, 13
    v_lshlrev_b32 v237, 7, v240
    v_add_u32 v237, s59, v237
    s_mov_b32 s59, 0
    s_waitcnt lgkmcnt(0)
    s_mov_b32 s60, s36
    s_mov_b32 s61, s37
    s_mov_b32 s62, 3670016
    s_mov_b32 s63, 0x00020000
    s_cmp_eq_u32 s28, 1
    s_cselect_b32 s60, s40, s60
    s_cselect_b32 s61, s41, s61
    s_cselect_b32 s62, 1605632, s62
    s_cmp_eq_u32 s28, 2
    s_cselect_b32 s60, s42, s60
    s_cselect_b32 s61, s43, s61
    s_cselect_b32 s62, 1605632, s62
    s_cmp_eq_u32 s28, 3
    s_cselect_b32 s60, s38, s60
    s_cselect_b32 s61, s39, s61
    s_cselect_b32 s62, 1605632, s62
    s_mov_b32 s99, 0x40000
    s_cmp_eq_u32 s28, 0
    s_cselect_b32 s30, 4, 2
    s_lshl_b32 s99, s30, 15
    s_and_b32 s36, s2, 7
    s_lshl_b32 s36, s36, 5
    s_add_u32 s36, s36, s52
    s_mul_i32 s36, s36, s30
    v_add_u32 v237, s36, v240
    v_lshlrev_b32 v237, 7, v237
    v_mov_b32 v238, 0x7fff0000
    v_cmp_gt_u32 vcc, s30, v240
    v_cndmask_b32 v237, v238, v237, vcc
    s_mov_b32 s97, s62
    s_mov_b32 s98, s99
    s_mov_b32 s62, 0
    s_mov_b32 s99, 0
    s_cmp_ge_u32 s28, 2
    s_cselect_b32 s92, s16, s12
    s_cselect_b32 s93, s17, s13
    s_mov_b32 s94, s14
    s_mov_b32 s95, s15
    s_and_b32 s91, s52, 7
    s_lshl_b32 s91, s91, 3
    s_lshr_b32 s30, s52, 3
    s_add_u32 s91, s91, s30
    s_add_u32 s91, s91, 4
    s_lshl_b32 s91, s91, 1
    s_and_b32 s30, s28, 1
    s_add_u32 s91, s91, s30
    s_lshl_b32 s91, s91, 13
    v_lshlrev_b32 v234, 7, v240
    s_load_dwordx2 s[36:37], s[0:1], 32
    s_lshr_b32 s30, s2, 3
    s_mul_i32 s33, s30, 37
    s_lshr_b32 s33, s33, 8
    s_mul_i32 s33, s33, 7
    s_sub_u32 s30, s30, s33
    v_lshrrev_b32 v160, 3, v240
    v_and_b32 v161, 7, v240
    v_bfe_u32 v162, v240, 4, 1
    v_lshlrev_b32 v162, 2, v162
    v_xor_b32 v161, v161, v162
    v_lshlrev_b32 v161, 4, v161
    v_mul_u32_u24 v245, 896, v160
    v_add_u32 v245, v245, v161
    s_lshl_b32 s30, s30, 7
    s_mul_i32 s35, s28, 28672
    s_add_u32 s35, s35, s30
    s_waitcnt lgkmcnt(0)
    s_mov_b32 s8, s36
    s_mov_b32 s9, s37
    s_mov_b32 s10, 3670016
    s_mov_b32 s11, 0x00020000
    v_lshrrev_b32 v160, 4, v240
    v_and_b32 v161, 15, v240
    v_lshrrev_b32 v162, 2, v161
    v_lshrrev_b32 v163, 1, v160
    v_lshl_add_u32 v163, v163, 3, v162
    v_lshlrev_b32 v163, 7, v163
    v_and_b32 v164, 1, v160
    v_lshl_add_u32 v163, v164, 5, v163
    v_and_b32 v164, 3, v161
    v_lshl_add_u32 v163, v164, 3, v163
    v_add_u32 v163, s49, v163
    v_add_u32 v163, 0x20000, v163
    v_lshrrev_b32 v162, 3, v161
    s_lshr_b32 s30, s28, 1
    v_xor_b32 v162, s30, v162
    v_xor_b32 v164, 0, v162
    v_lshl_add_u32 v246, v164, 6, v163
    v_xor_b32 v164, 1, v162
    v_lshl_add_u32 v247, v164, 6, v163
    v_subrev_u32 v208, 0x20000, v246
    v_subrev_u32 v210, 0x10000, v246
    v_subrev_u32 v209, 0x20000, v247
    v_subrev_u32 v211, 0x10000, v247
    s_waitcnt lgkmcnt(4)
    v_mfma_f32_32x32x16_bf16 v[144:159], a[64:67], a[0:3], 0
    buffer_load_dwordx4 v254, s[16:19], s48 offen offset:2048 lds
    ds_read_b128 a[64:67], v196 offset:16640
    v_fma_f32 v168, v128, s46, -v185
    v_fma_f32 v169, v129, s46, -v185
    v_exp_f32 v168, v168
    v_mfma_f32_32x32x16_bf16 v[144:159], a[68:71], a[4:7], v[144:159]
    ds_read_b128 a[68:71], v197 offset:16640
    v_exp_f32 v169, v169
    v_fma_f32 v170, v130, s46, -v185
    v_fma_f32 v171, v131, s46, -v185
    v_mfma_f32_32x32x16_bf16 v[144:159], a[72:75], a[8:11], v[144:159]
    ds_read_b128 a[72:75], v198 offset:16640
    v_exp_f32 v170, v170
    v_add_f32 v186, v186, v168
    v_exp_f32 v171, v171
    v_mfma_f32_32x32x16_bf16 v[144:159], a[76:79], a[12:15], v[144:159]
    ds_read_b128 a[76:79], v199 offset:16640
    v_add_f32 v187, v187, v169
    v_cvt_pk_bf16_f32 v160, v168, v169
    v_fma_f32 v172, v132, s46, -v185
    v_fma_f32 v173, v133, s46, -v185
    s_waitcnt lgkmcnt(4)
    v_mfma_f32_32x32x16_bf16 v[144:159], a[80:83], a[16:19], v[144:159]
    buffer_load_dwordx4 v255, s[16:19], s48 offen offset:3072 lds
    ds_read_b128 a[80:83], v200 offset:16640
    v_exp_f32 v172, v172
    v_add_f32 v186, v186, v170
    v_mfma_f32_32x32x16_bf16 v[144:159], a[84:87], a[20:23], v[144:159]
    ds_read_b128 a[84:87], v201 offset:16640
    v_exp_f32 v173, v173
    v_add_f32 v187, v187, v171
    v_cvt_pk_bf16_f32 v161, v170, v171
    v_fma_f32 v174, v134, s46, -v185
    v_mfma_f32_32x32x16_bf16 v[144:159], a[88:91], a[24:27], v[144:159]
    ds_read_b128 a[88:91], v202 offset:16640
    v_fma_f32 v175, v135, s46, -v185
    v_exp_f32 v174, v174
    v_add_f32 v186, v186, v172
    v_mfma_f32_32x32x16_bf16 v[144:159], a[92:95], a[28:31], v[144:159]
    ds_read_b128 a[92:95], v203 offset:16640
    v_exp_f32 v175, v175
    v_add_f32 v187, v187, v173
    v_cvt_pk_bf16_f32 v162, v172, v173
    s_waitcnt lgkmcnt(4)
    v_mfma_f32_32x32x16_bf16 v[144:159], a[64:67], a[32:35], v[144:159]
    s_add_u32 m0, s49, 0
    s_add_u32 s47, s47, 16384
    s_and_b32 s47, s47, 0xfffff
    buffer_load_dwordx4 v250, s[12:15], s47 offen offset:0 lds
    ds_read_b64_tr_b16 a[96:97], v204 offset:0
    ds_read_b64_tr_b16 a[98:99], v204 offset:4096
    v_mfma_f32_32x32x16_bf16 v[144:159], a[68:71], a[36:39], v[144:159]
    ds_read_b64_tr_b16 a[100:101], v205 offset:0
    ds_read_b64_tr_b16 a[102:103], v205 offset:4096
    v_fma_f32 v176, v136, s46, -v185
    v_fma_f32 v177, v137, s46, -v185
    v_exp_f32 v176, v176
    v_mfma_f32_32x32x16_bf16 v[144:159], a[72:75], a[40:43], v[144:159]
    ds_read_b64_tr_b16 a[104:105], v206 offset:0
    ds_read_b64_tr_b16 a[106:107], v206 offset:4096
    v_add_f32 v186, v186, v174
    v_exp_f32 v177, v177
    v_add_f32 v187, v187, v175
    v_mfma_f32_32x32x16_bf16 v[144:159], a[76:79], a[44:47], v[144:159]
    ds_read_b64_tr_b16 a[108:109], v207 offset:0
    ds_read_b64_tr_b16 a[110:111], v207 offset:4096
    v_cvt_pk_bf16_f32 v163, v174, v175
    v_fma_f32 v178, v138, s46, -v185
    v_fma_f32 v179, v139, s46, -v185
    s_waitcnt lgkmcnt(8)
    v_mfma_f32_32x32x16_bf16 v[144:159], a[80:83], a[48:51], v[144:159]
    buffer_load_dwordx4 v251, s[12:15], s47 offen offset:1024 lds
    ds_read_b64_tr_b16 a[112:113], v204 offset:256
    ds_read_b64_tr_b16 a[114:115], v204 offset:4352
    v_exp_f32 v178, v178
    v_add_f32 v186, v186, v176
    v_mfma_f32_32x32x16_bf16 v[144:159], a[84:87], a[52:55], v[144:159]
    ds_read_b64_tr_b16 a[116:117], v205 offset:256
    ds_read_b64_tr_b16 a[118:119], v205 offset:4352
    v_exp_f32 v179, v179
    v_add_f32 v187, v187, v177
    v_cvt_pk_bf16_f32 v164, v176, v177
    v_mfma_f32_32x32x16_bf16 v[144:159], a[88:91], a[56:59], v[144:159]
    ds_read_b64_tr_b16 a[120:121], v206 offset:256
    ds_read_b64_tr_b16 a[122:123], v206 offset:4352
    v_fma_f32 v180, v140, s46, -v185
    v_fma_f32 v181, v141, s46, -v185
    v_exp_f32 v180, v180
    v_mfma_f32_32x32x16_bf16 v[144:159], a[92:95], a[60:63], v[144:159]
    ds_read_b64_tr_b16 a[124:125], v207 offset:256
    ds_read_b64_tr_b16 a[126:127], v207 offset:4352
    v_add_f32 v186, v186, v178
    v_exp_f32 v181, v181
    s_waitcnt lgkmcnt(8)
    v_mfma_f32_32x32x16_bf16 v[0:15], a[96:99], v[160:163], 0
    buffer_load_dwordx4 v252, s[12:15], s47 offen offset:2048 lds
    ds_read_b64_tr_b16 a[96:97], v204 offset:8192
    ds_read_b64_tr_b16 a[98:99], v204 offset:12288
    v_add_f32 v187, v187, v179
    v_cvt_pk_bf16_f32 v165, v178, v179
    v_fma_f32 v182, v142, s46, -v185
    v_mfma_f32_32x32x16_bf16 v[16:31], a[100:103], v[160:163], 0
    ds_read_b64_tr_b16 a[100:101], v205 offset:8192
    ds_read_b64_tr_b16 a[102:103], v205 offset:12288
    v_fma_f32 v183, v143, s46, -v185
    v_exp_f32 v182, v182
    v_add_f32 v186, v186, v180
    v_mfma_f32_32x32x16_bf16 v[32:47], a[104:107], v[160:163], 0
    ds_read_b64_tr_b16 a[104:105], v206 offset:8192
    ds_read_b64_tr_b16 a[106:107], v206 offset:12288
    v_exp_f32 v183, v183
    v_add_f32 v187, v187, v181
    v_cvt_pk_bf16_f32 v166, v180, v181
    v_mfma_f32_32x32x16_bf16 v[48:63], a[108:111], v[160:163], 0
    ds_read_b64_tr_b16 a[108:109], v207 offset:8192
    ds_read_b64_tr_b16 a[110:111], v207 offset:12288
    v_add_f32 v186, v186, v182
    v_add_f32 v187, v187, v183
    v_cvt_pk_bf16_f32 v167, v182, v183
    s_waitcnt lgkmcnt(8)
    v_mfma_f32_32x32x16_bf16 v[64:79], a[112:115], v[160:163], 0
    buffer_load_dwordx4 v253, s[12:15], s47 offen offset:3072 lds
    ds_read_b64_tr_b16 a[112:113], v204 offset:8448
    ds_read_b64_tr_b16 a[114:115], v204 offset:12544
    v_max3_f32 v191, v144, v145, v146
    v_max3_f32 v192, v147, v148, v149
    v_max3_f32 v193, v150, v151, v152
    v_mfma_f32_32x32x16_bf16 v[80:95], a[116:119], v[160:163], 0
    ds_read_b64_tr_b16 a[116:117], v205 offset:8448
    ds_read_b64_tr_b16 a[118:119], v205 offset:12544
    v_max3_f32 v194, v153, v154, v155
    v_max3_f32 v195, v156, v157, v158
    v_max3_f32 v191, v191, v192, v193
    v_max3_f32 v194, v194, v195, v159
    v_mfma_f32_32x32x16_bf16 v[96:111], a[120:123], v[160:163], 0
    ds_read_b64_tr_b16 a[120:121], v206 offset:8448
    ds_read_b64_tr_b16 a[122:123], v206 offset:12544
    v_max_f32 v189, v191, v194
    v_cmp_gt_f32 vcc, v189, v188
    v_mfma_f32_32x32x16_bf16 v[112:127], a[124:127], v[160:163], 0
    s_waitcnt vmcnt(12)
    s_barrier
    buffer_load_dword v238, v237, s[60:63], s59 offen
    s_add_u32 s59, s59, s99
    ds_read_b64_tr_b16 a[124:125], v207 offset:8448
    ds_read_b64_tr_b16 a[126:127], v207 offset:12544
    s_waitcnt lgkmcnt(8)
    v_mfma_f32_32x32x16_bf16 v[0:15], a[96:99], v[164:167], v[0:15]
    s_add_u32 m0, s49, 114688
    s_add_u32 s48, s48, 16384
    s_and_b32 s48, s48, 0xfffff
    buffer_load_dwordx4 v254, s[16:19], s48 offen offset:0 lds
    ds_read_b128 a[64:67], v196 offset:32768
    v_mfma_f32_32x32x16_bf16 v[16:31], a[100:103], v[164:167], v[16:31]
    ds_read_b128 a[68:71], v197 offset:32768
    v_mfma_f32_32x32x16_bf16 v[32:47], a[104:107], v[164:167], v[32:47]
    ds_read_b128 a[72:75], v198 offset:32768
    v_mfma_f32_32x32x16_bf16 v[48:63], a[108:111], v[164:167], v[48:63]
    ds_read_b128 a[76:79], v199 offset:32768
    s_waitcnt lgkmcnt(4)
    v_mfma_f32_32x32x16_bf16 v[64:79], a[112:115], v[164:167], v[64:79]
    buffer_load_dwordx4 v255, s[16:19], s48 offen offset:1024 lds
    ds_read_b128 a[80:83], v200 offset:32768
    v_mfma_f32_32x32x16_bf16 v[80:95], a[116:119], v[164:167], v[80:95]
    ds_read_b128 a[84:87], v201 offset:32768
    v_mfma_f32_32x32x16_bf16 v[96:111], a[120:123], v[164:167], v[96:111]
    ds_read_b128 a[88:91], v202 offset:32768
    v_mfma_f32_32x32x16_bf16 v[112:127], a[124:127], v[164:167], v[112:127]
    ds_read_b128 a[92:95], v203 offset:32768
    s_cbranch_vccnz ATT_RSh_0
ATT_BKh_0:
.p2align 6
ATT_LOOP0:
    s_waitcnt lgkmcnt(4)
    v_mfma_f32_32x32x16_bf16 v[128:143], a[64:67], a[0:3], 0
    buffer_load_dwordx4 v254, s[16:19], s48 offen offset:2048 lds
    ds_read_b128 a[64:67], v196 offset:33024
    v_fma_f32 v168, v144, s46, -v185
    v_fma_f32 v169, v145, s46, -v185
    v_exp_f32 v168, v168
    v_mfma_f32_32x32x16_bf16 v[128:143], a[68:71], a[4:7], v[128:143]
    ds_read_b128 a[68:71], v197 offset:33024
    v_exp_f32 v169, v169
    v_fma_f32 v170, v146, s46, -v185
    v_fma_f32 v171, v147, s46, -v185
    v_mfma_f32_32x32x16_bf16 v[128:143], a[72:75], a[8:11], v[128:143]
    ds_read_b128 a[72:75], v198 offset:33024
    v_exp_f32 v170, v170
    v_add_f32 v186, v186, v168
    v_exp_f32 v171, v171
    v_mfma_f32_32x32x16_bf16 v[128:143], a[76:79], a[12:15], v[128:143]
    ds_read_b128 a[76:79], v199 offset:33024
    v_add_f32 v187, v187, v169
    v_cvt_pk_bf16_f32 v160, v168, v169
    v_fma_f32 v172, v148, s46, -v185
    v_fma_f32 v173, v149, s46, -v185
    s_waitcnt lgkmcnt(4)
    v_mfma_f32_32x32x16_bf16 v[128:143], a[80:83], a[16:19], v[128:143]
    buffer_load_dwordx4 v255, s[16:19], s48 offen offset:3072 lds
    ds_read_b128 a[80:83], v200 offset:33024
    v_exp_f32 v172, v172
    v_add_f32 v186, v186, v170
    v_mfma_f32_32x32x16_bf16 v[128:143], a[84:87], a[20:23], v[128:143]
    ds_read_b128 a[84:87], v201 offset:33024
    v_exp_f32 v173, v173
    v_add_f32 v187, v187, v171
    v_cvt_pk_bf16_f32 v161, v170, v171
    v_fma_f32 v174, v150, s46, -v185
    v_mfma_f32_32x32x16_bf16 v[128:143], a[88:91], a[24:27], v[128:143]
    ds_read_b128 a[88:91], v202 offset:33024
    v_fma_f32 v175, v151, s46, -v185
    v_exp_f32 v174, v174
    v_add_f32 v186, v186, v172
    v_mfma_f32_32x32x16_bf16 v[128:143], a[92:95], a[28:31], v[128:143]
    ds_read_b128 a[92:95], v203 offset:33024
    v_exp_f32 v175, v175
    v_add_f32 v187, v187, v173
    v_cvt_pk_bf16_f32 v162, v172, v173
    s_waitcnt lgkmcnt(4)
    v_mfma_f32_32x32x16_bf16 v[128:143], a[64:67], a[32:35], v[128:143]
    s_add_u32 m0, s49, 16384
    s_add_u32 s47, s47, 16384
    s_and_b32 s47, s47, 0xfffff
    buffer_load_dwordx4 v250, s[12:15], s47 offen offset:0 lds
    ds_read_b64_tr_b16 a[96:97], v204 offset:16384
    ds_read_b64_tr_b16 a[98:99], v204 offset:20480
    v_mfma_f32_32x32x16_bf16 v[128:143], a[68:71], a[36:39], v[128:143]
    ds_read_b64_tr_b16 a[100:101], v205 offset:16384
    ds_read_b64_tr_b16 a[102:103], v205 offset:20480
    v_fma_f32 v176, v152, s46, -v185
    v_fma_f32 v177, v153, s46, -v185
    v_exp_f32 v176, v176
    v_mfma_f32_32x32x16_bf16 v[128:143], a[72:75], a[40:43], v[128:143]
    ds_read_b64_tr_b16 a[104:105], v206 offset:16384
    ds_read_b64_tr_b16 a[106:107], v206 offset:20480
    v_add_f32 v186, v186, v174
    v_exp_f32 v177, v177
    v_add_f32 v187, v187, v175
    v_mfma_f32_32x32x16_bf16 v[128:143], a[76:79], a[44:47], v[128:143]
    ds_read_b64_tr_b16 a[108:109], v207 offset:16384
    ds_read_b64_tr_b16 a[110:111], v207 offset:20480
    v_cvt_pk_bf16_f32 v163, v174, v175
    v_fma_f32 v178, v154, s46, -v185
    v_fma_f32 v179, v155, s46, -v185
    s_waitcnt lgkmcnt(8)
    v_mfma_f32_32x32x16_bf16 v[128:143], a[80:83], a[48:51], v[128:143]
    buffer_load_dwordx4 v251, s[12:15], s47 offen offset:1024 lds
    ds_read_b64_tr_b16 a[112:113], v204 offset:16640
    ds_read_b64_tr_b16 a[114:115], v204 offset:20736
    v_exp_f32 v178, v178
    v_add_f32 v186, v186, v176
    v_mfma_f32_32x32x16_bf16 v[128:143], a[84:87], a[52:55], v[128:143]
    ds_read_b64_tr_b16 a[116:117], v205 offset:16640
    ds_read_b64_tr_b16 a[118:119], v205 offset:20736
    v_exp_f32 v179, v179
    v_add_f32 v187, v187, v177
    v_cvt_pk_bf16_f32 v164, v176, v177
    v_mfma_f32_32x32x16_bf16 v[128:143], a[88:91], a[56:59], v[128:143]
    ds_read_b64_tr_b16 a[120:121], v206 offset:16640
    ds_read_b64_tr_b16 a[122:123], v206 offset:20736
    v_fma_f32 v180, v156, s46, -v185
    v_fma_f32 v181, v157, s46, -v185
    v_exp_f32 v180, v180
    v_mfma_f32_32x32x16_bf16 v[128:143], a[92:95], a[60:63], v[128:143]
    ds_read_b64_tr_b16 a[124:125], v207 offset:16640
    ds_read_b64_tr_b16 a[126:127], v207 offset:20736
    v_add_f32 v186, v186, v178
    v_exp_f32 v181, v181
    s_waitcnt lgkmcnt(8)
    v_mfma_f32_32x32x16_bf16 v[0:15], a[96:99], v[160:163], v[0:15]
    buffer_load_dwordx4 v252, s[12:15], s47 offen offset:2048 lds
    ds_read_b64_tr_b16 a[96:97], v204 offset:24576
    ds_read_b64_tr_b16 a[98:99], v204 offset:28672
    v_add_f32 v187, v187, v179
    v_cvt_pk_bf16_f32 v165, v178, v179
    v_fma_f32 v182, v158, s46, -v185
    v_mfma_f32_32x32x16_bf16 v[16:31], a[100:103], v[160:163], v[16:31]
    ds_read_b64_tr_b16 a[100:101], v205 offset:24576
    ds_read_b64_tr_b16 a[102:103], v205 offset:28672
    v_fma_f32 v183, v159, s46, -v185
    v_exp_f32 v182, v182
    v_add_f32 v186, v186, v180
    v_mfma_f32_32x32x16_bf16 v[32:47], a[104:107], v[160:163], v[32:47]
    ds_read_b64_tr_b16 a[104:105], v206 offset:24576
    ds_read_b64_tr_b16 a[106:107], v206 offset:28672
    v_exp_f32 v183, v183
    v_add_f32 v187, v187, v181
    v_cvt_pk_bf16_f32 v166, v180, v181
    v_mfma_f32_32x32x16_bf16 v[48:63], a[108:111], v[160:163], v[48:63]
    ds_read_b64_tr_b16 a[108:109], v207 offset:24576
    ds_read_b64_tr_b16 a[110:111], v207 offset:28672
    v_add_f32 v186, v186, v182
    v_add_f32 v187, v187, v183
    v_cvt_pk_bf16_f32 v167, v182, v183
    s_waitcnt lgkmcnt(8)
    v_mfma_f32_32x32x16_bf16 v[64:79], a[112:115], v[160:163], v[64:79]
    buffer_load_dwordx4 v253, s[12:15], s47 offen offset:3072 lds
    ds_read_b64_tr_b16 a[112:113], v204 offset:24832
    ds_read_b64_tr_b16 a[114:115], v204 offset:28928
    v_max3_f32 v191, v128, v129, v130
    v_max3_f32 v192, v131, v132, v133
    v_max3_f32 v193, v134, v135, v136
    v_mfma_f32_32x32x16_bf16 v[80:95], a[116:119], v[160:163], v[80:95]
    ds_read_b64_tr_b16 a[116:117], v205 offset:24832
    ds_read_b64_tr_b16 a[118:119], v205 offset:28928
    v_max3_f32 v194, v137, v138, v139
    v_max3_f32 v195, v140, v141, v142
    v_max3_f32 v191, v191, v192, v193
    v_max3_f32 v194, v194, v195, v143
    v_mfma_f32_32x32x16_bf16 v[96:111], a[120:123], v[160:163], v[96:111]
    ds_read_b64_tr_b16 a[120:121], v206 offset:24832
    ds_read_b64_tr_b16 a[122:123], v206 offset:28928
    v_max_f32 v189, v191, v194
    v_cmp_gt_f32 vcc, v189, v188
    v_mfma_f32_32x32x16_bf16 v[112:127], a[124:127], v[160:163], v[112:127]
    s_waitcnt vmcnt(13)
    s_barrier
    buffer_load_dword v238, v237, s[60:63], s59 offen
    s_add_u32 s59, s59, s99
    ds_read_b64_tr_b16 a[124:125], v207 offset:24832
    ds_read_b64_tr_b16 a[126:127], v207 offset:28928
    s_waitcnt lgkmcnt(8)
    v_mfma_f32_32x32x16_bf16 v[0:15], a[96:99], v[164:167], v[0:15]
    s_add_u32 m0, s49, 65536
    s_add_u32 s48, s48, 16384
    s_and_b32 s48, s48, 0xfffff
    buffer_load_dwordx4 v254, s[16:19], s48 offen offset:0 lds
    ds_read_b128 a[64:67], v196 offset:49152
    v_mfma_f32_32x32x16_bf16 v[16:31], a[100:103], v[164:167], v[16:31]
    ds_read_b128 a[68:71], v197 offset:49152
    v_mfma_f32_32x32x16_bf16 v[32:47], a[104:107], v[164:167], v[32:47]
    ds_read_b128 a[72:75], v198 offset:49152
    v_mfma_f32_32x32x16_bf16 v[48:63], a[108:111], v[164:167], v[48:63]
    ds_read_b128 a[76:79], v199 offset:49152
    s_waitcnt lgkmcnt(4)
    v_mfma_f32_32x32x16_bf16 v[64:79], a[112:115], v[164:167], v[64:79]
    buffer_load_dwordx4 v255, s[16:19], s48 offen offset:1024 lds
    ds_read_b128 a[80:83], v200 offset:49152
    v_mfma_f32_32x32x16_bf16 v[80:95], a[116:119], v[164:167], v[80:95]
    ds_read_b128 a[84:87], v201 offset:49152
    v_mfma_f32_32x32x16_bf16 v[96:111], a[120:123], v[164:167], v[96:111]
    ds_read_b128 a[88:91], v202 offset:49152
    v_mfma_f32_32x32x16_bf16 v[112:127], a[124:127], v[164:167], v[112:127]
    ds_read_b128 a[92:95], v203 offset:49152
    s_cbranch_vccnz ATT_RS0_1
ATT_BK0_1:
    s_waitcnt lgkmcnt(4)
    v_mfma_f32_32x32x16_bf16 v[144:159], a[64:67], a[0:3], 0
    buffer_load_dwordx4 v254, s[16:19], s48 offen offset:2048 lds
    ds_read_b128 a[64:67], v196 offset:49408
    v_fma_f32 v168, v128, s46, -v185
    v_fma_f32 v169, v129, s46, -v185
    v_exp_f32 v168, v168
    v_mfma_f32_32x32x16_bf16 v[144:159], a[68:71], a[4:7], v[144:159]
    ds_read_b128 a[68:71], v197 offset:49408
    v_exp_f32 v169, v169
    v_fma_f32 v170, v130, s46, -v185
    v_fma_f32 v171, v131, s46, -v185
    v_mfma_f32_32x32x16_bf16 v[144:159], a[72:75], a[8:11], v[144:159]
    ds_read_b128 a[72:75], v198 offset:49408
    v_exp_f32 v170, v170
    v_add_f32 v186, v186, v168
    v_exp_f32 v171, v171
    v_mfma_f32_32x32x16_bf16 v[144:159], a[76:79], a[12:15], v[144:159]
    ds_read_b128 a[76:79], v199 offset:49408
    v_add_f32 v187, v187, v169
    v_cvt_pk_bf16_f32 v160, v168, v169
    v_fma_f32 v172, v132, s46, -v185
    v_fma_f32 v173, v133, s46, -v185
    s_waitcnt lgkmcnt(4)
    v_mfma_f32_32x32x16_bf16 v[144:159], a[80:83], a[16:19], v[144:159]
    buffer_load_dwordx4 v255, s[16:19], s48 offen offset:3072 lds
    ds_read_b128 a[80:83], v200 offset:49408
    v_exp_f32 v172, v172
    v_add_f32 v186, v186, v170
    v_mfma_f32_32x32x16_bf16 v[144:159], a[84:87], a[20:23], v[144:159]
    ds_read_b128 a[84:87], v201 offset:49408
    v_exp_f32 v173, v173
    v_add_f32 v187, v187, v171
    v_cvt_pk_bf16_f32 v161, v170, v171
    v_fma_f32 v174, v134, s46, -v185
    v_mfma_f32_32x32x16_bf16 v[144:159], a[88:91], a[24:27], v[144:159]
    ds_read_b128 a[88:91], v202 offset:49408
    v_fma_f32 v175, v135, s46, -v185
    v_exp_f32 v174, v174
    v_add_f32 v186, v186, v172
    v_mfma_f32_32x32x16_bf16 v[144:159], a[92:95], a[28:31], v[144:159]
    ds_read_b128 a[92:95], v203 offset:49408
    v_exp_f32 v175, v175
    v_add_f32 v187, v187, v173
    v_cvt_pk_bf16_f32 v162, v172, v173
    s_waitcnt lgkmcnt(4)
    v_mfma_f32_32x32x16_bf16 v[144:159], a[64:67], a[32:35], v[144:159]
    s_add_u32 m0, s49, 32768
    s_add_u32 s47, s47, 16384
    s_and_b32 s47, s47, 0xfffff
    buffer_load_dwordx4 v250, s[12:15], s47 offen offset:0 lds
    ds_read_b64_tr_b16 a[96:97], v204 offset:32768
    ds_read_b64_tr_b16 a[98:99], v204 offset:36864
    v_mfma_f32_32x32x16_bf16 v[144:159], a[68:71], a[36:39], v[144:159]
    ds_read_b64_tr_b16 a[100:101], v205 offset:32768
    ds_read_b64_tr_b16 a[102:103], v205 offset:36864
    v_fma_f32 v176, v136, s46, -v185
    v_fma_f32 v177, v137, s46, -v185
    v_exp_f32 v176, v176
    v_mfma_f32_32x32x16_bf16 v[144:159], a[72:75], a[40:43], v[144:159]
    ds_read_b64_tr_b16 a[104:105], v206 offset:32768
    ds_read_b64_tr_b16 a[106:107], v206 offset:36864
    v_add_f32 v186, v186, v174
    v_exp_f32 v177, v177
    v_add_f32 v187, v187, v175
    v_mfma_f32_32x32x16_bf16 v[144:159], a[76:79], a[44:47], v[144:159]
    ds_read_b64_tr_b16 a[108:109], v207 offset:32768
    ds_read_b64_tr_b16 a[110:111], v207 offset:36864
    v_cvt_pk_bf16_f32 v163, v174, v175
    v_fma_f32 v178, v138, s46, -v185
    v_fma_f32 v179, v139, s46, -v185
    s_waitcnt lgkmcnt(8)
    v_mfma_f32_32x32x16_bf16 v[144:159], a[80:83], a[48:51], v[144:159]
    buffer_load_dwordx4 v251, s[12:15], s47 offen offset:1024 lds
    ds_read_b64_tr_b16 a[112:113], v204 offset:33024
    ds_read_b64_tr_b16 a[114:115], v204 offset:37120
    v_exp_f32 v178, v178
    v_add_f32 v186, v186, v176
    v_mfma_f32_32x32x16_bf16 v[144:159], a[84:87], a[52:55], v[144:159]
    ds_read_b64_tr_b16 a[116:117], v205 offset:33024
    ds_read_b64_tr_b16 a[118:119], v205 offset:37120
    v_exp_f32 v179, v179
    v_add_f32 v187, v187, v177
    v_cvt_pk_bf16_f32 v164, v176, v177
    v_mfma_f32_32x32x16_bf16 v[144:159], a[88:91], a[56:59], v[144:159]
    ds_read_b64_tr_b16 a[120:121], v206 offset:33024
    ds_read_b64_tr_b16 a[122:123], v206 offset:37120
    v_fma_f32 v180, v140, s46, -v185
    v_fma_f32 v181, v141, s46, -v185
    v_exp_f32 v180, v180
    v_mfma_f32_32x32x16_bf16 v[144:159], a[92:95], a[60:63], v[144:159]
    ds_read_b64_tr_b16 a[124:125], v207 offset:33024
    ds_read_b64_tr_b16 a[126:127], v207 offset:37120
    v_add_f32 v186, v186, v178
    v_exp_f32 v181, v181
    s_waitcnt lgkmcnt(8)
    v_mfma_f32_32x32x16_bf16 v[0:15], a[96:99], v[160:163], v[0:15]
    buffer_load_dwordx4 v252, s[12:15], s47 offen offset:2048 lds
    ds_read_b64_tr_b16 a[96:97], v204 offset:40960
    ds_read_b64_tr_b16 a[98:99], v204 offset:45056
    v_add_f32 v187, v187, v179
    v_cvt_pk_bf16_f32 v165, v178, v179
    v_fma_f32 v182, v142, s46, -v185
    v_mfma_f32_32x32x16_bf16 v[16:31], a[100:103], v[160:163], v[16:31]
    ds_read_b64_tr_b16 a[100:101], v205 offset:40960
    ds_read_b64_tr_b16 a[102:103], v205 offset:45056
    v_fma_f32 v183, v143, s46, -v185
    v_exp_f32 v182, v182
    v_add_f32 v186, v186, v180
    v_mfma_f32_32x32x16_bf16 v[32:47], a[104:107], v[160:163], v[32:47]
    ds_read_b64_tr_b16 a[104:105], v206 offset:40960
    ds_read_b64_tr_b16 a[106:107], v206 offset:45056
    v_exp_f32 v183, v183
    v_add_f32 v187, v187, v181
    v_cvt_pk_bf16_f32 v166, v180, v181
    v_mfma_f32_32x32x16_bf16 v[48:63], a[108:111], v[160:163], v[48:63]
    ds_read_b64_tr_b16 a[108:109], v207 offset:40960
    ds_read_b64_tr_b16 a[110:111], v207 offset:45056
    v_add_f32 v186, v186, v182
    v_add_f32 v187, v187, v183
    v_cvt_pk_bf16_f32 v167, v182, v183
    s_waitcnt lgkmcnt(8)
    v_mfma_f32_32x32x16_bf16 v[64:79], a[112:115], v[160:163], v[64:79]
    buffer_load_dwordx4 v253, s[12:15], s47 offen offset:3072 lds
    ds_read_b64_tr_b16 a[112:113], v204 offset:41216
    ds_read_b64_tr_b16 a[114:115], v204 offset:45312
    v_max3_f32 v191, v144, v145, v146
    v_max3_f32 v192, v147, v148, v149
    v_max3_f32 v193, v150, v151, v152
    v_mfma_f32_32x32x16_bf16 v[80:95], a[116:119], v[160:163], v[80:95]
    ds_read_b64_tr_b16 a[116:117], v205 offset:41216
    ds_read_b64_tr_b16 a[118:119], v205 offset:45312
    v_max3_f32 v194, v153, v154, v155
    v_max3_f32 v195, v156, v157, v158
    v_max3_f32 v191, v191, v192, v193
    v_max3_f32 v194, v194, v195, v159
    v_mfma_f32_32x32x16_bf16 v[96:111], a[120:123], v[160:163], v[96:111]
    ds_read_b64_tr_b16 a[120:121], v206 offset:41216
    ds_read_b64_tr_b16 a[122:123], v206 offset:45312
    v_max_f32 v189, v191, v194
    v_cmp_gt_f32 vcc, v189, v188
    v_mfma_f32_32x32x16_bf16 v[112:127], a[124:127], v[160:163], v[112:127]
    s_waitcnt vmcnt(13)
    s_barrier
    buffer_load_dword v238, v237, s[60:63], s59 offen
    s_add_u32 s59, s59, s99
    ds_read_b64_tr_b16 a[124:125], v207 offset:41216
    ds_read_b64_tr_b16 a[126:127], v207 offset:45312
    s_waitcnt lgkmcnt(8)
    v_mfma_f32_32x32x16_bf16 v[0:15], a[96:99], v[164:167], v[0:15]
    s_add_u32 m0, s49, 81920
    s_add_u32 s48, s48, 16384
    s_and_b32 s48, s48, 0xfffff
    buffer_load_dwordx4 v254, s[16:19], s48 offen offset:0 lds
    ds_read_b128 a[64:67], v196 offset:0
    v_mfma_f32_32x32x16_bf16 v[16:31], a[100:103], v[164:167], v[16:31]
    ds_read_b128 a[68:71], v197 offset:0
    v_mfma_f32_32x32x16_bf16 v[32:47], a[104:107], v[164:167], v[32:47]
    ds_read_b128 a[72:75], v198 offset:0
    v_mfma_f32_32x32x16_bf16 v[48:63], a[108:111], v[164:167], v[48:63]
    ds_read_b128 a[76:79], v199 offset:0
    s_waitcnt lgkmcnt(4)
    v_mfma_f32_32x32x16_bf16 v[64:79], a[112:115], v[164:167], v[64:79]
    buffer_load_dwordx4 v255, s[16:19], s48 offen offset:1024 lds
    ds_read_b128 a[80:83], v200 offset:0
    v_mfma_f32_32x32x16_bf16 v[80:95], a[116:119], v[164:167], v[80:95]
    ds_read_b128 a[84:87], v201 offset:0
    v_mfma_f32_32x32x16_bf16 v[96:111], a[120:123], v[164:167], v[96:111]
    ds_read_b128 a[88:91], v202 offset:0
    v_mfma_f32_32x32x16_bf16 v[112:127], a[124:127], v[164:167], v[112:127]
    ds_read_b128 a[92:95], v203 offset:0
    s_cbranch_vccnz ATT_RS0_2
ATT_BK0_2:
    s_waitcnt lgkmcnt(4)
    v_mfma_f32_32x32x16_bf16 v[128:143], a[64:67], a[0:3], 0
    buffer_load_dwordx4 v254, s[16:19], s48 offen offset:2048 lds
    ds_read_b128 a[64:67], v196 offset:256
    v_fma_f32 v168, v144, s46, -v185
    v_fma_f32 v169, v145, s46, -v185
    v_exp_f32 v168, v168
    v_mfma_f32_32x32x16_bf16 v[128:143], a[68:71], a[4:7], v[128:143]
    ds_read_b128 a[68:71], v197 offset:256
    v_exp_f32 v169, v169
    v_fma_f32 v170, v146, s46, -v185
    v_fma_f32 v171, v147, s46, -v185
    v_mfma_f32_32x32x16_bf16 v[128:143], a[72:75], a[8:11], v[128:143]
    ds_read_b128 a[72:75], v198 offset:256
    v_exp_f32 v170, v170
    v_add_f32 v186, v186, v168
    v_exp_f32 v171, v171
    v_mfma_f32_32x32x16_bf16 v[128:143], a[76:79], a[12:15], v[128:143]
    ds_read_b128 a[76:79], v199 offset:256
    v_add_f32 v187, v187, v169
    v_cvt_pk_bf16_f32 v160, v168, v169
    v_fma_f32 v172, v148, s46, -v185
    v_fma_f32 v173, v149, s46, -v185
    s_waitcnt lgkmcnt(4)
    v_mfma_f32_32x32x16_bf16 v[128:143], a[80:83], a[16:19], v[128:143]
    buffer_load_dwordx4 v255, s[16:19], s48 offen offset:3072 lds
    ds_read_b128 a[80:83], v200 offset:256
    v_exp_f32 v172, v172
    v_add_f32 v186, v186, v170
    v_mfma_f32_32x32x16_bf16 v[128:143], a[84:87], a[20:23], v[128:143]
    ds_read_b128 a[84:87], v201 offset:256
    v_exp_f32 v173, v173
    v_add_f32 v187, v187, v171
    v_cvt_pk_bf16_f32 v161, v170, v171
    v_fma_f32 v174, v150, s46, -v185
    v_mfma_f32_32x32x16_bf16 v[128:143], a[88:91], a[24:27], v[128:143]
    ds_read_b128 a[88:91], v202 offset:256
    v_fma_f32 v175, v151, s46, -v185
    v_exp_f32 v174, v174
    v_add_f32 v186, v186, v172
    v_mfma_f32_32x32x16_bf16 v[128:143], a[92:95], a[28:31], v[128:143]
    ds_read_b128 a[92:95], v203 offset:256
    v_exp_f32 v175, v175
    v_add_f32 v187, v187, v173
    v_cvt_pk_bf16_f32 v162, v172, v173
    s_waitcnt lgkmcnt(4)
    v_mfma_f32_32x32x16_bf16 v[128:143], a[64:67], a[32:35], v[128:143]
    s_add_u32 m0, s49, 49152
    s_add_u32 s47, s47, 16384
    s_and_b32 s47, s47, 0xfffff
    buffer_load_dwordx4 v250, s[12:15], s47 offen offset:0 lds
    ds_read_b64_tr_b16 a[96:97], v204 offset:49152
    ds_read_b64_tr_b16 a[98:99], v204 offset:53248
    v_mfma_f32_32x32x16_bf16 v[128:143], a[68:71], a[36:39], v[128:143]
    ds_read_b64_tr_b16 a[100:101], v205 offset:49152
    ds_read_b64_tr_b16 a[102:103], v205 offset:53248
    v_fma_f32 v176, v152, s46, -v185
    v_fma_f32 v177, v153, s46, -v185
    v_exp_f32 v176, v176
    v_mfma_f32_32x32x16_bf16 v[128:143], a[72:75], a[40:43], v[128:143]
    ds_read_b64_tr_b16 a[104:105], v206 offset:49152
    ds_read_b64_tr_b16 a[106:107], v206 offset:53248
    v_add_f32 v186, v186, v174
    v_exp_f32 v177, v177
    v_add_f32 v187, v187, v175
    v_mfma_f32_32x32x16_bf16 v[128:143], a[76:79], a[44:47], v[128:143]
    ds_read_b64_tr_b16 a[108:109], v207 offset:49152
    ds_read_b64_tr_b16 a[110:111], v207 offset:53248
    v_cvt_pk_bf16_f32 v163, v174, v175
    v_fma_f32 v178, v154, s46, -v185
    v_fma_f32 v179, v155, s46, -v185
    s_waitcnt lgkmcnt(8)
    v_mfma_f32_32x32x16_bf16 v[128:143], a[80:83], a[48:51], v[128:143]
    buffer_load_dwordx4 v251, s[12:15], s47 offen offset:1024 lds
    ds_read_b64_tr_b16 a[112:113], v204 offset:49408
    ds_read_b64_tr_b16 a[114:115], v204 offset:53504
    v_exp_f32 v178, v178
    v_add_f32 v186, v186, v176
    v_mfma_f32_32x32x16_bf16 v[128:143], a[84:87], a[52:55], v[128:143]
    ds_read_b64_tr_b16 a[116:117], v205 offset:49408
    ds_read_b64_tr_b16 a[118:119], v205 offset:53504
    v_exp_f32 v179, v179
    v_add_f32 v187, v187, v177
    v_cvt_pk_bf16_f32 v164, v176, v177
    v_mfma_f32_32x32x16_bf16 v[128:143], a[88:91], a[56:59], v[128:143]
    ds_read_b64_tr_b16 a[120:121], v206 offset:49408
    ds_read_b64_tr_b16 a[122:123], v206 offset:53504
    v_fma_f32 v180, v156, s46, -v185
    v_fma_f32 v181, v157, s46, -v185
    v_exp_f32 v180, v180
    v_mfma_f32_32x32x16_bf16 v[128:143], a[92:95], a[60:63], v[128:143]
    ds_read_b64_tr_b16 a[124:125], v207 offset:49408
    ds_read_b64_tr_b16 a[126:127], v207 offset:53504
    v_add_f32 v186, v186, v178
    v_exp_f32 v181, v181
    s_waitcnt lgkmcnt(8)
    v_mfma_f32_32x32x16_bf16 v[0:15], a[96:99], v[160:163], v[0:15]
    buffer_load_dwordx4 v252, s[12:15], s47 offen offset:2048 lds
    ds_read_b64_tr_b16 a[96:97], v204 offset:57344
    ds_read_b64_tr_b16 a[98:99], v204 offset:61440
    v_add_f32 v187, v187, v179
    v_cvt_pk_bf16_f32 v165, v178, v179
    v_fma_f32 v182, v158, s46, -v185
    v_mfma_f32_32x32x16_bf16 v[16:31], a[100:103], v[160:163], v[16:31]
    ds_read_b64_tr_b16 a[100:101], v205 offset:57344
    ds_read_b64_tr_b16 a[102:103], v205 offset:61440
    v_fma_f32 v183, v159, s46, -v185
    v_exp_f32 v182, v182
    v_add_f32 v186, v186, v180
    v_mfma_f32_32x32x16_bf16 v[32:47], a[104:107], v[160:163], v[32:47]
    ds_read_b64_tr_b16 a[104:105], v206 offset:57344
    ds_read_b64_tr_b16 a[106:107], v206 offset:61440
    v_exp_f32 v183, v183
    v_add_f32 v187, v187, v181
    v_cvt_pk_bf16_f32 v166, v180, v181
    v_mfma_f32_32x32x16_bf16 v[48:63], a[108:111], v[160:163], v[48:63]
    ds_read_b64_tr_b16 a[108:109], v207 offset:57344
    ds_read_b64_tr_b16 a[110:111], v207 offset:61440
    v_add_f32 v186, v186, v182
    v_add_f32 v187, v187, v183
    v_cvt_pk_bf16_f32 v167, v182, v183
    s_waitcnt lgkmcnt(8)
    v_mfma_f32_32x32x16_bf16 v[64:79], a[112:115], v[160:163], v[64:79]
    buffer_load_dwordx4 v253, s[12:15], s47 offen offset:3072 lds
    ds_read_b64_tr_b16 a[112:113], v204 offset:57600
    ds_read_b64_tr_b16 a[114:115], v204 offset:61696
    v_max3_f32 v191, v128, v129, v130
    v_max3_f32 v192, v131, v132, v133
    v_max3_f32 v193, v134, v135, v136
    v_mfma_f32_32x32x16_bf16 v[80:95], a[116:119], v[160:163], v[80:95]
    ds_read_b64_tr_b16 a[116:117], v205 offset:57600
    ds_read_b64_tr_b16 a[118:119], v205 offset:61696
    v_max3_f32 v194, v137, v138, v139
    v_max3_f32 v195, v140, v141, v142
    v_max3_f32 v191, v191, v192, v193
    v_max3_f32 v194, v194, v195, v143
    v_mfma_f32_32x32x16_bf16 v[96:111], a[120:123], v[160:163], v[96:111]
    ds_read_b64_tr_b16 a[120:121], v206 offset:57600
    ds_read_b64_tr_b16 a[122:123], v206 offset:61696
    v_max_f32 v189, v191, v194
    v_cmp_gt_f32 vcc, v189, v188
    v_mfma_f32_32x32x16_bf16 v[112:127], a[124:127], v[160:163], v[112:127]
    s_waitcnt vmcnt(13)
    s_barrier
    buffer_load_dword v238, v237, s[60:63], s59 offen
    s_add_u32 s59, s59, s99
    ds_read_b64_tr_b16 a[124:125], v207 offset:57600
    ds_read_b64_tr_b16 a[126:127], v207 offset:61696
    s_waitcnt lgkmcnt(8)
    v_mfma_f32_32x32x16_bf16 v[0:15], a[96:99], v[164:167], v[0:15]
    s_add_u32 m0, s49, 98304
    s_add_u32 s48, s48, 16384
    s_and_b32 s48, s48, 0xfffff
    buffer_load_dwordx4 v254, s[16:19], s48 offen offset:0 lds
    ds_read_b128 a[64:67], v196 offset:16384
    v_mfma_f32_32x32x16_bf16 v[16:31], a[100:103], v[164:167], v[16:31]
    ds_read_b128 a[68:71], v197 offset:16384
    v_mfma_f32_32x32x16_bf16 v[32:47], a[104:107], v[164:167], v[32:47]
    ds_read_b128 a[72:75], v198 offset:16384
    v_mfma_f32_32x32x16_bf16 v[48:63], a[108:111], v[164:167], v[48:63]
    ds_read_b128 a[76:79], v199 offset:16384
    s_waitcnt lgkmcnt(4)
    v_mfma_f32_32x32x16_bf16 v[64:79], a[112:115], v[164:167], v[64:79]
    buffer_load_dwordx4 v255, s[16:19], s48 offen offset:1024 lds
    ds_read_b128 a[80:83], v200 offset:16384
    v_mfma_f32_32x32x16_bf16 v[80:95], a[116:119], v[164:167], v[80:95]
    ds_read_b128 a[84:87], v201 offset:16384
    v_mfma_f32_32x32x16_bf16 v[96:111], a[120:123], v[164:167], v[96:111]
    ds_read_b128 a[88:91], v202 offset:16384
    v_mfma_f32_32x32x16_bf16 v[112:127], a[124:127], v[164:167], v[112:127]
    ds_read_b128 a[92:95], v203 offset:16384
    s_cbranch_vccnz ATT_RS0_3
ATT_BK0_3:
    s_waitcnt lgkmcnt(4)
    v_mfma_f32_32x32x16_bf16 v[144:159], a[64:67], a[0:3], 0
    buffer_load_dwordx4 v254, s[16:19], s48 offen offset:2048 lds
    ds_read_b128 a[64:67], v196 offset:16640
    v_fma_f32 v168, v128, s46, -v185
    v_fma_f32 v169, v129, s46, -v185
    v_exp_f32 v168, v168
    v_mfma_f32_32x32x16_bf16 v[144:159], a[68:71], a[4:7], v[144:159]
    ds_read_b128 a[68:71], v197 offset:16640
    v_exp_f32 v169, v169
    v_fma_f32 v170, v130, s46, -v185
    v_fma_f32 v171, v131, s46, -v185
    v_mfma_f32_32x32x16_bf16 v[144:159], a[72:75], a[8:11], v[144:159]
    ds_read_b128 a[72:75], v198 offset:16640
    v_exp_f32 v170, v170
    v_add_f32 v186, v186, v168
    v_exp_f32 v171, v171
    v_mfma_f32_32x32x16_bf16 v[144:159], a[76:79], a[12:15], v[144:159]
    ds_read_b128 a[76:79], v199 offset:16640
    v_add_f32 v187, v187, v169
    v_cvt_pk_bf16_f32 v160, v168, v169
    v_fma_f32 v172, v132, s46, -v185
    v_fma_f32 v173, v133, s46, -v185
    s_waitcnt lgkmcnt(4)
    v_mfma_f32_32x32x16_bf16 v[144:159], a[80:83], a[16:19], v[144:159]
    buffer_load_dwordx4 v255, s[16:19], s48 offen offset:3072 lds
    ds_read_b128 a[80:83], v200 offset:16640
    v_exp_f32 v172, v172
    v_add_f32 v186, v186, v170
    v_mfma_f32_32x32x16_bf16 v[144:159], a[84:87], a[20:23], v[144:159]
    ds_read_b128 a[84:87], v201 offset:16640
    v_exp_f32 v173, v173
    v_add_f32 v187, v187, v171
    v_cvt_pk_bf16_f32 v161, v170, v171
    v_fma_f32 v174, v134, s46, -v185
    v_mfma_f32_32x32x16_bf16 v[144:159], a[88:91], a[24:27], v[144:159]
    ds_read_b128 a[88:91], v202 offset:16640
    v_fma_f32 v175, v135, s46, -v185
    v_exp_f32 v174, v174
    v_add_f32 v186, v186, v172
    v_mfma_f32_32x32x16_bf16 v[144:159], a[92:95], a[28:31], v[144:159]
    ds_read_b128 a[92:95], v203 offset:16640
    v_exp_f32 v175, v175
    v_add_f32 v187, v187, v173
    v_cvt_pk_bf16_f32 v162, v172, v173
    s_waitcnt lgkmcnt(4)
    v_mfma_f32_32x32x16_bf16 v[144:159], a[64:67], a[32:35], v[144:159]
    s_add_u32 m0, s49, 0
    s_add_u32 s47, s47, 16384
    s_and_b32 s47, s47, 0xfffff
    buffer_load_dwordx4 v250, s[12:15], s47 offen offset:0 lds
    ds_read_b64_tr_b16 a[96:97], v204 offset:0
    ds_read_b64_tr_b16 a[98:99], v204 offset:4096
    v_mfma_f32_32x32x16_bf16 v[144:159], a[68:71], a[36:39], v[144:159]
    ds_read_b64_tr_b16 a[100:101], v205 offset:0
    ds_read_b64_tr_b16 a[102:103], v205 offset:4096
    v_fma_f32 v176, v136, s46, -v185
    v_fma_f32 v177, v137, s46, -v185
    v_exp_f32 v176, v176
    v_mfma_f32_32x32x16_bf16 v[144:159], a[72:75], a[40:43], v[144:159]
    ds_read_b64_tr_b16 a[104:105], v206 offset:0
    ds_read_b64_tr_b16 a[106:107], v206 offset:4096
    v_add_f32 v186, v186, v174
    v_exp_f32 v177, v177
    v_add_f32 v187, v187, v175
    v_mfma_f32_32x32x16_bf16 v[144:159], a[76:79], a[44:47], v[144:159]
    ds_read_b64_tr_b16 a[108:109], v207 offset:0
    ds_read_b64_tr_b16 a[110:111], v207 offset:4096
    v_cvt_pk_bf16_f32 v163, v174, v175
    v_fma_f32 v178, v138, s46, -v185
    v_fma_f32 v179, v139, s46, -v185
    s_waitcnt lgkmcnt(8)
    v_mfma_f32_32x32x16_bf16 v[144:159], a[80:83], a[48:51], v[144:159]
    buffer_load_dwordx4 v251, s[12:15], s47 offen offset:1024 lds
    ds_read_b64_tr_b16 a[112:113], v204 offset:256
    ds_read_b64_tr_b16 a[114:115], v204 offset:4352
    v_exp_f32 v178, v178
    v_add_f32 v186, v186, v176
    v_mfma_f32_32x32x16_bf16 v[144:159], a[84:87], a[52:55], v[144:159]
    ds_read_b64_tr_b16 a[116:117], v205 offset:256
    ds_read_b64_tr_b16 a[118:119], v205 offset:4352
    v_exp_f32 v179, v179
    v_add_f32 v187, v187, v177
    v_cvt_pk_bf16_f32 v164, v176, v177
    v_mfma_f32_32x32x16_bf16 v[144:159], a[88:91], a[56:59], v[144:159]
    ds_read_b64_tr_b16 a[120:121], v206 offset:256
    ds_read_b64_tr_b16 a[122:123], v206 offset:4352
    v_fma_f32 v180, v140, s46, -v185
    v_fma_f32 v181, v141, s46, -v185
    v_exp_f32 v180, v180
    v_mfma_f32_32x32x16_bf16 v[144:159], a[92:95], a[60:63], v[144:159]
    ds_read_b64_tr_b16 a[124:125], v207 offset:256
    ds_read_b64_tr_b16 a[126:127], v207 offset:4352
    v_add_f32 v186, v186, v178
    v_exp_f32 v181, v181
    s_waitcnt lgkmcnt(8)
    v_mfma_f32_32x32x16_bf16 v[0:15], a[96:99], v[160:163], v[0:15]
    buffer_load_dwordx4 v252, s[12:15], s47 offen offset:2048 lds
    ds_read_b64_tr_b16 a[96:97], v204 offset:8192
    ds_read_b64_tr_b16 a[98:99], v204 offset:12288
    v_add_f32 v187, v187, v179
    v_cvt_pk_bf16_f32 v165, v178, v179
    v_fma_f32 v182, v142, s46, -v185
    v_mfma_f32_32x32x16_bf16 v[16:31], a[100:103], v[160:163], v[16:31]
    ds_read_b64_tr_b16 a[100:101], v205 offset:8192
    ds_read_b64_tr_b16 a[102:103], v205 offset:12288
    v_fma_f32 v183, v143, s46, -v185
    v_exp_f32 v182, v182
    v_add_f32 v186, v186, v180
    v_mfma_f32_32x32x16_bf16 v[32:47], a[104:107], v[160:163], v[32:47]
    ds_read_b64_tr_b16 a[104:105], v206 offset:8192
    ds_read_b64_tr_b16 a[106:107], v206 offset:12288
    v_exp_f32 v183, v183
    v_add_f32 v187, v187, v181
    v_cvt_pk_bf16_f32 v166, v180, v181
    v_mfma_f32_32x32x16_bf16 v[48:63], a[108:111], v[160:163], v[48:63]
    ds_read_b64_tr_b16 a[108:109], v207 offset:8192
    ds_read_b64_tr_b16 a[110:111], v207 offset:12288
    v_add_f32 v186, v186, v182
    v_add_f32 v187, v187, v183
    v_cvt_pk_bf16_f32 v167, v182, v183
    s_waitcnt lgkmcnt(8)
    v_mfma_f32_32x32x16_bf16 v[64:79], a[112:115], v[160:163], v[64:79]
    buffer_load_dwordx4 v253, s[12:15], s47 offen offset:3072 lds
    ds_read_b64_tr_b16 a[112:113], v204 offset:8448
    ds_read_b64_tr_b16 a[114:115], v204 offset:12544
    v_max3_f32 v191, v144, v145, v146
    v_max3_f32 v192, v147, v148, v149
    v_max3_f32 v193, v150, v151, v152
    v_mfma_f32_32x32x16_bf16 v[80:95], a[116:119], v[160:163], v[80:95]
    ds_read_b64_tr_b16 a[116:117], v205 offset:8448
    ds_read_b64_tr_b16 a[118:119], v205 offset:12544
    v_max3_f32 v194, v153, v154, v155
    v_max3_f32 v195, v156, v157, v158
    v_max3_f32 v191, v191, v192, v193
    v_max3_f32 v194, v194, v195, v159
    v_mfma_f32_32x32x16_bf16 v[96:111], a[120:123], v[160:163], v[96:111]
    ds_read_b64_tr_b16 a[120:121], v206 offset:8448
    ds_read_b64_tr_b16 a[122:123], v206 offset:12544
    v_max_f32 v189, v191, v194
    v_cmp_gt_f32 vcc, v189, v188
    v_mfma_f32_32x32x16_bf16 v[112:127], a[124:127], v[160:163], v[112:127]
    s_waitcnt vmcnt(13)
    s_barrier
    buffer_load_dword v238, v237, s[60:63], s59 offen
    s_add_u32 s59, s59, s99
    ds_read_b64_tr_b16 a[124:125], v207 offset:8448
    ds_read_b64_tr_b16 a[126:127], v207 offset:12544
    s_waitcnt lgkmcnt(8)
    v_mfma_f32_32x32x16_bf16 v[0:15], a[96:99], v[164:167], v[0:15]
    s_add_u32 m0, s49, 114688
    s_add_u32 s48, s48, 16384
    s_and_b32 s48, s48, 0xfffff
    buffer_load_dwordx4 v254, s[16:19], s48 offen offset:0 lds
    ds_read_b128 a[64:67], v196 offset:32768
    v_mfma_f32_32x32x16_bf16 v[16:31], a[100:103], v[164:167], v[16:31]
    ds_read_b128 a[68:71], v197 offset:32768
    v_mfma_f32_32x32x16_bf16 v[32:47], a[104:107], v[164:167], v[32:47]
    ds_read_b128 a[72:75], v198 offset:32768
    v_mfma_f32_32x32x16_bf16 v[48:63], a[108:111], v[164:167], v[48:63]
    ds_read_b128 a[76:79], v199 offset:32768
    s_waitcnt lgkmcnt(4)
    v_mfma_f32_32x32x16_bf16 v[64:79], a[112:115], v[164:167], v[64:79]
    buffer_load_dwordx4 v255, s[16:19], s48 offen offset:1024 lds
    ds_read_b128 a[80:83], v200 offset:32768
    v_mfma_f32_32x32x16_bf16 v[80:95], a[116:119], v[164:167], v[80:95]
    ds_read_b128 a[84:87], v201 offset:32768
    v_mfma_f32_32x32x16_bf16 v[96:111], a[120:123], v[164:167], v[96:111]
    ds_read_b128 a[88:91], v202 offset:32768
    v_mfma_f32_32x32x16_bf16 v[112:127], a[124:127], v[164:167], v[112:127]
    ds_read_b128 a[92:95], v203 offset:32768
    s_cbranch_vccnz ATT_RS0_0
ATT_BK0_0:
    s_add_u32 s50, s50, 1
    s_cmp_ge_u32 s50, 3
    s_cselect_b32 s62, s97, s62
    s_cselect_b32 s99, s98, s99
    s_cmp_lg_u32 s50, 13
    s_cbranch_scc1 ATT_LOOP0
ATT_PEEL:
    s_waitcnt lgkmcnt(4)
    v_mfma_f32_32x32x16_bf16 v[128:143], a[64:67], a[0:3], 0
    buffer_load_dwordx4 v254, s[16:19], s48 offen offset:2048 lds
    ds_read_b128 a[64:67], v196 offset:33024
    v_fma_f32 v168, v144, s46, -v185
    v_fma_f32 v169, v145, s46, -v185
    v_exp_f32 v168, v168
    v_mfma_f32_32x32x16_bf16 v[128:143], a[68:71], a[4:7], v[128:143]
    ds_read_b128 a[68:71], v197 offset:33024
    v_exp_f32 v169, v169
    v_fma_f32 v170, v146, s46, -v185
    v_fma_f32 v171, v147, s46, -v185
    v_mfma_f32_32x32x16_bf16 v[128:143], a[72:75], a[8:11], v[128:143]
    ds_read_b128 a[72:75], v198 offset:33024
    v_exp_f32 v170, v170
    v_add_f32 v186, v186, v168
    v_exp_f32 v171, v171
    v_mfma_f32_32x32x16_bf16 v[128:143], a[76:79], a[12:15], v[128:143]
    ds_read_b128 a[76:79], v199 offset:33024
    v_add_f32 v187, v187, v169
    v_cvt_pk_bf16_f32 v160, v168, v169
    v_fma_f32 v172, v148, s46, -v185
    v_fma_f32 v173, v149, s46, -v185
    s_waitcnt lgkmcnt(4)
    v_mfma_f32_32x32x16_bf16 v[128:143], a[80:83], a[16:19], v[128:143]
    buffer_load_dwordx4 v255, s[16:19], s48 offen offset:3072 lds
    ds_read_b128 a[80:83], v200 offset:33024
    v_exp_f32 v172, v172
    v_add_f32 v186, v186, v170
    v_mfma_f32_32x32x16_bf16 v[128:143], a[84:87], a[20:23], v[128:143]
    ds_read_b128 a[84:87], v201 offset:33024
    v_exp_f32 v173, v173
    v_add_f32 v187, v187, v171
    v_cvt_pk_bf16_f32 v161, v170, v171
    v_fma_f32 v174, v150, s46, -v185
    v_mfma_f32_32x32x16_bf16 v[128:143], a[88:91], a[24:27], v[128:143]
    ds_read_b128 a[88:91], v202 offset:33024
    v_fma_f32 v175, v151, s46, -v185
    v_exp_f32 v174, v174
    v_add_f32 v186, v186, v172
    v_mfma_f32_32x32x16_bf16 v[128:143], a[92:95], a[28:31], v[128:143]
    ds_read_b128 a[92:95], v203 offset:33024
    v_exp_f32 v175, v175
    v_add_f32 v187, v187, v173
    v_cvt_pk_bf16_f32 v162, v172, v173
    s_waitcnt lgkmcnt(4)
    v_mfma_f32_32x32x16_bf16 v[128:143], a[64:67], a[32:35], v[128:143]
    s_add_u32 m0, s49, 16384
    s_add_u32 s47, s47, 16384
    s_and_b32 s47, s47, 0xfffff
    buffer_load_dwordx4 v250, s[12:15], s47 offen offset:0 lds
    ds_read_b64_tr_b16 a[96:97], v204 offset:16384
    ds_read_b64_tr_b16 a[98:99], v204 offset:20480
    v_mfma_f32_32x32x16_bf16 v[128:143], a[68:71], a[36:39], v[128:143]
    ds_read_b64_tr_b16 a[100:101], v205 offset:16384
    ds_read_b64_tr_b16 a[102:103], v205 offset:20480
    v_fma_f32 v176, v152, s46, -v185
    v_fma_f32 v177, v153, s46, -v185
    v_exp_f32 v176, v176
    v_mfma_f32_32x32x16_bf16 v[128:143], a[72:75], a[40:43], v[128:143]
    ds_read_b64_tr_b16 a[104:105], v206 offset:16384
    ds_read_b64_tr_b16 a[106:107], v206 offset:20480
    v_add_f32 v186, v186, v174
    v_exp_f32 v177, v177
    v_add_f32 v187, v187, v175
    v_mfma_f32_32x32x16_bf16 v[128:143], a[76:79], a[44:47], v[128:143]
    ds_read_b64_tr_b16 a[108:109], v207 offset:16384
    ds_read_b64_tr_b16 a[110:111], v207 offset:20480
    v_cvt_pk_bf16_f32 v163, v174, v175
    v_fma_f32 v178, v154, s46, -v185
    v_fma_f32 v179, v155, s46, -v185
    s_waitcnt lgkmcnt(8)
    v_mfma_f32_32x32x16_bf16 v[128:143], a[80:83], a[48:51], v[128:143]
    buffer_load_dwordx4 v251, s[12:15], s47 offen offset:1024 lds
    ds_read_b64_tr_b16 a[112:113], v204 offset:16640
    ds_read_b64_tr_b16 a[114:115], v204 offset:20736
    v_exp_f32 v178, v178
    v_add_f32 v186, v186, v176
    v_mfma_f32_32x32x16_bf16 v[128:143], a[84:87], a[52:55], v[128:143]
    ds_read_b64_tr_b16 a[116:117], v205 offset:16640
    ds_read_b64_tr_b16 a[118:119], v205 offset:20736
    v_exp_f32 v179, v179
    v_add_f32 v187, v187, v177
    v_cvt_pk_bf16_f32 v164, v176, v177
    v_mfma_f32_32x32x16_bf16 v[128:143], a[88:91], a[56:59], v[128:143]
    ds_read_b64_tr_b16 a[120:121], v206 offset:16640
    ds_read_b64_tr_b16 a[122:123], v206 offset:20736
    v_fma_f32 v180, v156, s46, -v185
    v_fma_f32 v181, v157, s46, -v185
    v_exp_f32 v180, v180
    v_mfma_f32_32x32x16_bf16 v[128:143], a[92:95], a[60:63], v[128:143]
    ds_read_b64_tr_b16 a[124:125], v207 offset:16640
    ds_read_b64_tr_b16 a[126:127], v207 offset:20736
    v_add_f32 v186, v186, v178
    v_exp_f32 v181, v181
    s_waitcnt lgkmcnt(8)
    v_mfma_f32_32x32x16_bf16 v[0:15], a[96:99], v[160:163], v[0:15]
    buffer_load_dwordx4 v252, s[12:15], s47 offen offset:2048 lds
    ds_read_b64_tr_b16 a[96:97], v204 offset:24576
    ds_read_b64_tr_b16 a[98:99], v204 offset:28672
    v_add_f32 v187, v187, v179
    v_cvt_pk_bf16_f32 v165, v178, v179
    v_fma_f32 v182, v158, s46, -v185
    v_mfma_f32_32x32x16_bf16 v[16:31], a[100:103], v[160:163], v[16:31]
    ds_read_b64_tr_b16 a[100:101], v205 offset:24576
    ds_read_b64_tr_b16 a[102:103], v205 offset:28672
    v_fma_f32 v183, v159, s46, -v185
    v_exp_f32 v182, v182
    v_add_f32 v186, v186, v180
    v_mfma_f32_32x32x16_bf16 v[32:47], a[104:107], v[160:163], v[32:47]
    ds_read_b64_tr_b16 a[104:105], v206 offset:24576
    ds_read_b64_tr_b16 a[106:107], v206 offset:28672
    v_exp_f32 v183, v183
    v_add_f32 v187, v187, v181
    v_cvt_pk_bf16_f32 v166, v180, v181
    v_mfma_f32_32x32x16_bf16 v[48:63], a[108:111], v[160:163], v[48:63]
    ds_read_b64_tr_b16 a[108:109], v207 offset:24576
    ds_read_b64_tr_b16 a[110:111], v207 offset:28672
    v_add_f32 v186, v186, v182
    v_add_f32 v187, v187, v183
    v_cvt_pk_bf16_f32 v167, v182, v183
    s_waitcnt lgkmcnt(8)
    v_mfma_f32_32x32x16_bf16 v[64:79], a[112:115], v[160:163], v[64:79]
    buffer_load_dwordx4 v253, s[12:15], s47 offen offset:3072 lds
    ds_read_b64_tr_b16 a[112:113], v204 offset:24832
    ds_read_b64_tr_b16 a[114:115], v204 offset:28928
    s_add_u32 m0, s49, 131072
    s_add_u32 s34, s35, 2752512
    buffer_load_dwordx4 v245, s[8:11], s34 offen lds
    v_max3_f32 v191, v128, v129, v130
    v_mfma_f32_32x32x16_bf16 v[80:95], a[116:119], v[160:163], v[80:95]
    ds_read_b64_tr_b16 a[116:117], v205 offset:24832
    ds_read_b64_tr_b16 a[118:119], v205 offset:28928
    s_add_u32 m0, s49, 132096
    s_add_u32 s34, s35, 2759680
    buffer_load_dwordx4 v245, s[8:11], s34 offen lds
    v_max3_f32 v192, v131, v132, v133
    v_max3_f32 v193, v134, v135, v136
    v_mfma_f32_32x32x16_bf16 v[96:111], a[120:123], v[160:163], v[96:111]
    ds_read_b64_tr_b16 a[120:121], v206 offset:24832
    ds_read_b64_tr_b16 a[122:123], v206 offset:28928
    s_add_u32 m0, s49, 133120
    s_add_u32 s34, s35, 2766848
    buffer_load_dwordx4 v245, s[8:11], s34 offen lds
    s_add_u32 m0, s49, 134144
    s_add_u32 s34, s35, 2774016
    buffer_load_dwordx4 v245, s[8:11], s34 offen lds
    v_mfma_f32_32x32x16_bf16 v[112:127], a[124:127], v[160:163], v[112:127]
    s_waitcnt vmcnt(16)
    s_barrier
    ds_read_b64_tr_b16 a[124:125], v207 offset:24832
    ds_read_b64_tr_b16 a[126:127], v207 offset:28928
    v_max3_f32 v194, v137, v138, v139
    s_waitcnt lgkmcnt(8)
    v_mfma_f32_32x32x16_bf16 v[0:15], a[96:99], v[164:167], v[0:15]
    s_add_u32 m0, s49, 65536
    s_add_u32 s48, s48, 16384
    s_and_b32 s48, s48, 0xfffff
    buffer_load_dwordx4 v254, s[16:19], s48 offen offset:0 lds
    ds_read_b128 a[64:67], v196 offset:49152
    v_max3_f32 v195, v140, v141, v142
    v_mfma_f32_32x32x16_bf16 v[16:31], a[100:103], v[164:167], v[16:31]
    ds_read_b128 a[68:71], v197 offset:49152
    v_max3_f32 v191, v191, v192, v193
    v_max3_f32 v194, v194, v195, v143
    v_max_f32 v189, v191, v194
    v_cmp_gt_f32 vcc, v189, v188
    v_mfma_f32_32x32x16_bf16 v[32:47], a[104:107], v[164:167], v[32:47]
    ds_read_b128 a[72:75], v198 offset:49152
    v_mfma_f32_32x32x16_bf16 v[48:63], a[108:111], v[164:167], v[48:63]
    ds_read_b128 a[76:79], v199 offset:49152
    s_waitcnt lgkmcnt(4)
    v_mfma_f32_32x32x16_bf16 v[64:79], a[112:115], v[164:167], v[64:79]
    buffer_load_dwordx4 v255, s[16:19], s48 offen offset:1024 lds
    ds_read_b128 a[80:83], v200 offset:49152
    v_mfma_f32_32x32x16_bf16 v[80:95], a[116:119], v[164:167], v[80:95]
    ds_read_b128 a[84:87], v201 offset:49152
    v_mfma_f32_32x32x16_bf16 v[96:111], a[120:123], v[164:167], v[96:111]
    ds_read_b128 a[88:91], v202 offset:49152
    v_mfma_f32_32x32x16_bf16 v[112:127], a[124:127], v[164:167], v[112:127]
    ds_read_b128 a[92:95], v203 offset:49152
    s_cbranch_vccnz ATT_RSp_0
ATT_BKp_0:
    s_waitcnt lgkmcnt(4)
    v_mfma_f32_32x32x16_bf16 v[144:159], a[64:67], a[0:3], 0
    buffer_load_dwordx4 v254, s[16:19], s48 offen offset:2048 lds
    ds_read_b128 a[64:67], v196 offset:49408
    v_fma_f32 v168, v128, s46, -v185
    v_fma_f32 v169, v129, s46, -v185
    v_exp_f32 v168, v168
    v_mfma_f32_32x32x16_bf16 v[144:159], a[68:71], a[4:7], v[144:159]
    ds_read_b128 a[68:71], v197 offset:49408
    v_exp_f32 v169, v169
    v_fma_f32 v170, v130, s46, -v185
    v_fma_f32 v171, v131, s46, -v185
    v_mfma_f32_32x32x16_bf16 v[144:159], a[72:75], a[8:11], v[144:159]
    ds_read_b128 a[72:75], v198 offset:49408
    v_exp_f32 v170, v170
    v_add_f32 v186, v186, v168
    v_exp_f32 v171, v171
    v_mfma_f32_32x32x16_bf16 v[144:159], a[76:79], a[12:15], v[144:159]
    ds_read_b128 a[76:79], v199 offset:49408
    v_add_f32 v187, v187, v169
    v_cvt_pk_bf16_f32 v160, v168, v169
    v_fma_f32 v172, v132, s46, -v185
    v_fma_f32 v173, v133, s46, -v185
    s_waitcnt lgkmcnt(4)
    v_mfma_f32_32x32x16_bf16 v[144:159], a[80:83], a[16:19], v[144:159]
    buffer_load_dwordx4 v255, s[16:19], s48 offen offset:3072 lds
    ds_read_b128 a[80:83], v200 offset:49408
    v_exp_f32 v172, v172
    v_add_f32 v186, v186, v170
    v_mfma_f32_32x32x16_bf16 v[144:159], a[84:87], a[20:23], v[144:159]
    ds_read_b128 a[84:87], v201 offset:49408
    v_exp_f32 v173, v173
    v_add_f32 v187, v187, v171
    v_cvt_pk_bf16_f32 v161, v170, v171
    v_fma_f32 v174, v134, s46, -v185
    v_mfma_f32_32x32x16_bf16 v[144:159], a[88:91], a[24:27], v[144:159]
    ds_read_b128 a[88:91], v202 offset:49408
    v_fma_f32 v175, v135, s46, -v185
    v_exp_f32 v174, v174
    v_add_f32 v186, v186, v172
    v_mfma_f32_32x32x16_bf16 v[144:159], a[92:95], a[28:31], v[144:159]
    ds_read_b128 a[92:95], v203 offset:49408
    v_exp_f32 v175, v175
    v_add_f32 v187, v187, v173
    v_cvt_pk_bf16_f32 v162, v172, v173
    s_waitcnt lgkmcnt(4)
    v_mfma_f32_32x32x16_bf16 v[144:159], a[64:67], a[32:35], v[144:159]
    s_add_u32 m0, s49, 32768
    s_add_u32 s47, s47, 16384
    s_and_b32 s47, s47, 0xfffff
    buffer_load_dwordx4 v250, s[12:15], s47 offen offset:0 lds
    ds_read_b64_tr_b16 a[96:97], v204 offset:32768
    ds_read_b64_tr_b16 a[98:99], v204 offset:36864
    v_mfma_f32_32x32x16_bf16 v[144:159], a[68:71], a[36:39], v[144:159]
    ds_read_b64_tr_b16 a[100:101], v205 offset:32768
    ds_read_b64_tr_b16 a[102:103], v205 offset:36864
    v_fma_f32 v176, v136, s46, -v185
    v_fma_f32 v177, v137, s46, -v185
    v_exp_f32 v176, v176
    v_mfma_f32_32x32x16_bf16 v[144:159], a[72:75], a[40:43], v[144:159]
    ds_read_b64_tr_b16 a[104:105], v206 offset:32768
    ds_read_b64_tr_b16 a[106:107], v206 offset:36864
    v_add_f32 v186, v186, v174
    v_exp_f32 v177, v177
    v_add_f32 v187, v187, v175
    v_mfma_f32_32x32x16_bf16 v[144:159], a[76:79], a[44:47], v[144:159]
    ds_read_b64_tr_b16 a[108:109], v207 offset:32768
    ds_read_b64_tr_b16 a[110:111], v207 offset:36864
    v_cvt_pk_bf16_f32 v163, v174, v175
    v_fma_f32 v178, v138, s46, -v185
    v_fma_f32 v179, v139, s46, -v185
    s_waitcnt lgkmcnt(8)
    v_mfma_f32_32x32x16_bf16 v[144:159], a[80:83], a[48:51], v[144:159]
    buffer_load_dwordx4 v251, s[12:15], s47 offen offset:1024 lds
    ds_read_b64_tr_b16 a[112:113], v204 offset:33024
    ds_read_b64_tr_b16 a[114:115], v204 offset:37120
    v_exp_f32 v178, v178
    v_add_f32 v186, v186, v176
    v_mfma_f32_32x32x16_bf16 v[144:159], a[84:87], a[52:55], v[144:159]
    ds_read_b64_tr_b16 a[116:117], v205 offset:33024
    ds_read_b64_tr_b16 a[118:119], v205 offset:37120
    v_exp_f32 v179, v179
    v_add_f32 v187, v187, v177
    v_cvt_pk_bf16_f32 v164, v176, v177
    v_mfma_f32_32x32x16_bf16 v[144:159], a[88:91], a[56:59], v[144:159]
    ds_read_b64_tr_b16 a[120:121], v206 offset:33024
    ds_read_b64_tr_b16 a[122:123], v206 offset:37120
    v_fma_f32 v180, v140, s46, -v185
    v_fma_f32 v181, v141, s46, -v185
    v_exp_f32 v180, v180
    v_mfma_f32_32x32x16_bf16 v[144:159], a[92:95], a[60:63], v[144:159]
    ds_read_b64_tr_b16 a[124:125], v207 offset:33024
    ds_read_b64_tr_b16 a[126:127], v207 offset:37120
    v_add_f32 v186, v186, v178
    v_exp_f32 v181, v181
    s_waitcnt lgkmcnt(8)
    v_mfma_f32_32x32x16_bf16 v[0:15], a[96:99], v[160:163], v[0:15]
    buffer_load_dwordx4 v252, s[12:15], s47 offen offset:2048 lds
    ds_read_b64_tr_b16 a[96:97], v204 offset:40960
    ds_read_b64_tr_b16 a[98:99], v204 offset:45056
    v_add_f32 v187, v187, v179
    v_cvt_pk_bf16_f32 v165, v178, v179
    v_fma_f32 v182, v142, s46, -v185
    v_mfma_f32_32x32x16_bf16 v[16:31], a[100:103], v[160:163], v[16:31]
    ds_read_b64_tr_b16 a[100:101], v205 offset:40960
    ds_read_b64_tr_b16 a[102:103], v205 offset:45056
    v_fma_f32 v183, v143, s46, -v185
    v_exp_f32 v182, v182
    v_add_f32 v186, v186, v180
    v_mfma_f32_32x32x16_bf16 v[32:47], a[104:107], v[160:163], v[32:47]
    ds_read_b64_tr_b16 a[104:105], v206 offset:40960
    ds_read_b64_tr_b16 a[106:107], v206 offset:45056
    v_exp_f32 v183, v183
    v_add_f32 v187, v187, v181
    v_cvt_pk_bf16_f32 v166, v180, v181
    v_mfma_f32_32x32x16_bf16 v[48:63], a[108:111], v[160:163], v[48:63]
    ds_read_b64_tr_b16 a[108:109], v207 offset:40960
    ds_read_b64_tr_b16 a[110:111], v207 offset:45056
    v_add_f32 v186, v186, v182
    v_add_f32 v187, v187, v183
    v_cvt_pk_bf16_f32 v167, v182, v183
    s_waitcnt lgkmcnt(8)
    v_mfma_f32_32x32x16_bf16 v[64:79], a[112:115], v[160:163], v[64:79]
    buffer_load_dwordx4 v253, s[12:15], s47 offen offset:3072 lds
    ds_read_b64_tr_b16 a[112:113], v204 offset:41216
    ds_read_b64_tr_b16 a[114:115], v204 offset:45312
    s_add_u32 m0, s49, 147456
    s_add_u32 s34, s35, 2867200
    buffer_load_dwordx4 v245, s[8:11], s34 offen lds
    v_max3_f32 v191, v144, v145, v146
    v_mfma_f32_32x32x16_bf16 v[80:95], a[116:119], v[160:163], v[80:95]
    ds_read_b64_tr_b16 a[116:117], v205 offset:41216
    ds_read_b64_tr_b16 a[118:119], v205 offset:45312
    s_add_u32 m0, s49, 148480
    s_add_u32 s34, s35, 2874368
    buffer_load_dwordx4 v245, s[8:11], s34 offen lds
    v_max3_f32 v192, v147, v148, v149
    v_max3_f32 v193, v150, v151, v152
    v_mfma_f32_32x32x16_bf16 v[96:111], a[120:123], v[160:163], v[96:111]
    ds_read_b64_tr_b16 a[120:121], v206 offset:41216
    ds_read_b64_tr_b16 a[122:123], v206 offset:45312
    s_add_u32 m0, s49, 149504
    s_add_u32 s34, s35, 2881536
    buffer_load_dwordx4 v245, s[8:11], s34 offen lds
    s_add_u32 m0, s49, 150528
    s_add_u32 s34, s35, 2888704
    buffer_load_dwordx4 v245, s[8:11], s34 offen lds
    v_mfma_f32_32x32x16_bf16 v[112:127], a[124:127], v[160:163], v[112:127]
    s_waitcnt vmcnt(12)
    s_barrier
    ds_read_b64_tr_b16 a[124:125], v207 offset:41216
    ds_read_b64_tr_b16 a[126:127], v207 offset:45312
    v_max3_f32 v194, v153, v154, v155
    s_waitcnt lgkmcnt(8)
    v_mfma_f32_32x32x16_bf16 v[0:15], a[96:99], v[164:167], v[0:15]
    s_add_u32 m0, s49, 81920
    s_add_u32 s48, s48, 16384
    s_and_b32 s48, s48, 0xfffff
    buffer_load_dwordx4 v254, s[16:19], s48 offen offset:0 lds
    ds_read_b128 a[64:67], v196 offset:0
    ds_read_b64_tr_b16 a[128:129], v246 offset:0
    v_mfma_f32_32x32x16_bf16 v[16:31], a[100:103], v[164:167], v[16:31]
    ds_read_b128 a[68:71], v197 offset:0
    ds_read_b64_tr_b16 a[130:131], v246 offset:512
    v_max3_f32 v195, v156, v157, v158
    v_max3_f32 v191, v191, v192, v193
    v_max3_f32 v194, v194, v195, v159
    v_max_f32 v189, v191, v194
    v_mfma_f32_32x32x16_bf16 v[32:47], a[104:107], v[164:167], v[32:47]
    ds_read_b128 a[72:75], v198 offset:0
    ds_read_b64_tr_b16 a[132:133], v247 offset:0
    v_cmp_gt_f32 vcc, v189, v188
    v_mfma_f32_32x32x16_bf16 v[48:63], a[108:111], v[164:167], v[48:63]
    ds_read_b128 a[76:79], v199 offset:0
    ds_read_b64_tr_b16 a[134:135], v247 offset:512
    s_waitcnt lgkmcnt(8)
    v_mfma_f32_32x32x16_bf16 v[64:79], a[112:115], v[164:167], v[64:79]
    buffer_load_dwordx4 v255, s[16:19], s48 offen offset:1024 lds
    ds_read_b128 a[80:83], v200 offset:0
    ds_read_b64_tr_b16 a[136:137], v246 offset:2048
    v_mfma_f32_32x32x16_bf16 v[80:95], a[116:119], v[164:167], v[80:95]
    ds_read_b128 a[84:87], v201 offset:0
    ds_read_b64_tr_b16 a[138:139], v246 offset:2560
    v_mfma_f32_32x32x16_bf16 v[96:111], a[120:123], v[164:167], v[96:111]
    ds_read_b128 a[88:91], v202 offset:0
    ds_read_b64_tr_b16 a[140:141], v247 offset:2048
    v_mfma_f32_32x32x16_bf16 v[112:127], a[124:127], v[164:167], v[112:127]
    ds_read_b128 a[92:95], v203 offset:0
    ds_read_b64_tr_b16 a[142:143], v247 offset:2560
    s_cbranch_vccnz ATT_RSp_1
ATT_BKp_1:
    s_waitcnt lgkmcnt(9)
    v_mfma_f32_32x32x16_bf16 v[128:143], a[64:67], a[0:3], 0
    buffer_load_dwordx4 v254, s[16:19], s48 offen offset:2048 lds
    ds_read_b128 a[64:67], v196 offset:256
    v_fma_f32 v168, v144, s46, -v185
    v_fma_f32 v169, v145, s46, -v185
    v_exp_f32 v168, v168
    v_mfma_f32_32x32x16_bf16 v[128:143], a[68:71], a[4:7], v[128:143]
    ds_read_b128 a[68:71], v197 offset:256
    v_exp_f32 v169, v169
    v_fma_f32 v170, v146, s46, -v185
    v_fma_f32 v171, v147, s46, -v185
    v_mfma_f32_32x32x16_bf16 v[128:143], a[72:75], a[8:11], v[128:143]
    ds_read_b128 a[72:75], v198 offset:256
    v_exp_f32 v170, v170
    v_add_f32 v186, v186, v168
    v_exp_f32 v171, v171
    v_mfma_f32_32x32x16_bf16 v[128:143], a[76:79], a[12:15], v[128:143]
    ds_read_b128 a[76:79], v199 offset:256
    v_add_f32 v187, v187, v169
    v_cvt_pk_bf16_f32 v160, v168, v169
    v_fma_f32 v172, v148, s46, -v185
    v_fma_f32 v173, v149, s46, -v185
    s_waitcnt lgkmcnt(5)
    v_mfma_f32_32x32x16_bf16 v[128:143], a[80:83], a[16:19], v[128:143]
    buffer_load_dwordx4 v255, s[16:19], s48 offen offset:3072 lds
    ds_read_b128 a[80:83], v200 offset:256
    v_exp_f32 v172, v172
    v_add_f32 v186, v186, v170
    v_mfma_f32_32x32x16_bf16 v[128:143], a[84:87], a[20:23], v[128:143]
    ds_read_b128 a[84:87], v201 offset:256
    v_exp_f32 v173, v173
    v_add_f32 v187, v187, v171
    v_cvt_pk_bf16_f32 v161, v170, v171
    v_fma_f32 v174, v150, s46, -v185
    v_mfma_f32_32x32x16_bf16 v[128:143], a[88:91], a[24:27], v[128:143]
    ds_read_b128 a[88:91], v202 offset:256
    v_fma_f32 v175, v151, s46, -v185
    v_exp_f32 v174, v174
    v_add_f32 v186, v186, v172
    v_mfma_f32_32x32x16_bf16 v[128:143], a[92:95], a[28:31], v[128:143]
    ds_read_b128 a[92:95], v203 offset:256
    v_exp_f32 v175, v175
    v_add_f32 v187, v187, v173
    v_cvt_pk_bf16_f32 v162, v172, v173
    s_waitcnt lgkmcnt(4)
    v_mfma_f32_32x32x16_bf16 v[128:143], a[64:67], a[32:35], v[128:143]
    s_add_u32 m0, s49, 49152
    s_add_u32 s47, s47, 16384
    s_and_b32 s47, s47, 0xfffff
    buffer_load_dwordx4 v250, s[12:15], s47 offen offset:0 lds
    ds_read_b64_tr_b16 a[96:97], v204 offset:49152
    ds_read_b64_tr_b16 a[98:99], v204 offset:53248
    v_mfma_f32_32x32x16_bf16 v[128:143], a[68:71], a[36:39], v[128:143]
    ds_read_b64_tr_b16 a[100:101], v205 offset:49152
    ds_read_b64_tr_b16 a[102:103], v205 offset:53248
    v_fma_f32 v176, v152, s46, -v185
    v_fma_f32 v177, v153, s46, -v185
    v_exp_f32 v176, v176
    v_mfma_f32_32x32x16_bf16 v[128:143], a[72:75], a[40:43], v[128:143]
    ds_read_b64_tr_b16 a[104:105], v206 offset:49152
    ds_read_b64_tr_b16 a[106:107], v206 offset:53248
    v_add_f32 v186, v186, v174
    v_exp_f32 v177, v177
    v_add_f32 v187, v187, v175
    v_mfma_f32_32x32x16_bf16 v[128:143], a[76:79], a[44:47], v[128:143]
    ds_read_b64_tr_b16 a[108:109], v207 offset:49152
    ds_read_b64_tr_b16 a[110:111], v207 offset:53248
    v_cvt_pk_bf16_f32 v163, v174, v175
    v_fma_f32 v178, v154, s46, -v185
    v_fma_f32 v179, v155, s46, -v185
    s_waitcnt lgkmcnt(8)
    v_mfma_f32_32x32x16_bf16 v[128:143], a[80:83], a[48:51], v[128:143]
    buffer_load_dwordx4 v251, s[12:15], s47 offen offset:1024 lds
    ds_read_b64_tr_b16 a[112:113], v204 offset:49408
    ds_read_b64_tr_b16 a[114:115], v204 offset:53504
    v_exp_f32 v178, v178
    v_add_f32 v186, v186, v176
    v_mfma_f32_32x32x16_bf16 v[128:143], a[84:87], a[52:55], v[128:143]
    ds_read_b64_tr_b16 a[116:117], v205 offset:49408
    ds_read_b64_tr_b16 a[118:119], v205 offset:53504
    v_exp_f32 v179, v179
    v_add_f32 v187, v187, v177
    v_cvt_pk_bf16_f32 v164, v176, v177
    v_mfma_f32_32x32x16_bf16 v[128:143], a[88:91], a[56:59], v[128:143]
    ds_read_b64_tr_b16 a[120:121], v206 offset:49408
    ds_read_b64_tr_b16 a[122:123], v206 offset:53504
    v_fma_f32 v180, v156, s46, -v185
    v_fma_f32 v181, v157, s46, -v185
    v_exp_f32 v180, v180
    v_mfma_f32_32x32x16_bf16 v[128:143], a[92:95], a[60:63], v[128:143]
    ds_read_b64_tr_b16 a[124:125], v207 offset:49408
    ds_read_b64_tr_b16 a[126:127], v207 offset:53504
    v_add_f32 v186, v186, v178
    v_exp_f32 v181, v181
    s_waitcnt lgkmcnt(8)
    v_mfma_f32_32x32x16_bf16 v[0:15], a[96:99], v[160:163], v[0:15]
    buffer_load_dwordx4 v252, s[12:15], s47 offen offset:2048 lds
    ds_read_b64_tr_b16 a[96:97], v204 offset:57344
    ds_read_b64_tr_b16 a[98:99], v204 offset:61440
    v_add_f32 v187, v187, v179
    v_cvt_pk_bf16_f32 v165, v178, v179
    v_fma_f32 v182, v158, s46, -v185
    v_mfma_f32_32x32x16_bf16 v[16:31], a[100:103], v[160:163], v[16:31]
    ds_read_b64_tr_b16 a[100:101], v205 offset:57344
    ds_read_b64_tr_b16 a[102:103], v205 offset:61440
    v_fma_f32 v183, v159, s46, -v185
    v_exp_f32 v182, v182
    v_add_f32 v186, v186, v180
    v_mfma_f32_32x32x16_bf16 v[32:47], a[104:107], v[160:163], v[32:47]
    ds_read_b64_tr_b16 a[104:105], v206 offset:57344
    ds_read_b64_tr_b16 a[106:107], v206 offset:61440
    v_exp_f32 v183, v183
    v_add_f32 v187, v187, v181
    v_cvt_pk_bf16_f32 v166, v180, v181
    v_mfma_f32_32x32x16_bf16 v[48:63], a[108:111], v[160:163], v[48:63]
    ds_read_b64_tr_b16 a[108:109], v207 offset:57344
    ds_read_b64_tr_b16 a[110:111], v207 offset:61440
    v_add_f32 v186, v186, v182
    v_add_f32 v187, v187, v183
    v_cvt_pk_bf16_f32 v167, v182, v183
    s_waitcnt lgkmcnt(8)
    v_mfma_f32_32x32x16_bf16 v[64:79], a[112:115], v[160:163], v[64:79]
    buffer_load_dwordx4 v253, s[12:15], s47 offen offset:3072 lds
    ds_read_b64_tr_b16 a[112:113], v204 offset:57600
    ds_read_b64_tr_b16 a[114:115], v204 offset:61696
    s_add_u32 m0, s49, 131072
    s_add_u32 s34, s35, 2981888
    buffer_load_dwordx4 v245, s[8:11], s34 offen lds
    v_max3_f32 v191, v128, v129, v130
    v_mfma_f32_32x32x16_bf16 v[80:95], a[116:119], v[160:163], v[80:95]
    ds_read_b64_tr_b16 a[116:117], v205 offset:57600
    ds_read_b64_tr_b16 a[118:119], v205 offset:61696
    s_add_u32 m0, s49, 132096
    s_add_u32 s34, s35, 2989056
    buffer_load_dwordx4 v245, s[8:11], s34 offen lds
    v_max3_f32 v192, v131, v132, v133
    v_max3_f32 v193, v134, v135, v136
    v_mfma_f32_32x32x16_bf16 v[96:111], a[120:123], v[160:163], v[96:111]
    ds_read_b64_tr_b16 a[120:121], v206 offset:57600
    ds_read_b64_tr_b16 a[122:123], v206 offset:61696
    s_add_u32 m0, s49, 133120
    s_add_u32 s34, s35, 2996224
    buffer_load_dwordx4 v245, s[8:11], s34 offen lds
    s_add_u32 m0, s49, 134144
    s_add_u32 s34, s35, 3003392
    buffer_load_dwordx4 v245, s[8:11], s34 offen lds
    v_mfma_f32_32x32x16_bf16 v[112:127], a[124:127], v[160:163], v[112:127]
    s_waitcnt vmcnt(12)
    s_barrier
    ds_read_b64_tr_b16 a[124:125], v207 offset:57600
    ds_read_b64_tr_b16 a[126:127], v207 offset:61696
    v_max3_f32 v194, v137, v138, v139
    s_waitcnt lgkmcnt(8)
    v_mfma_f32_32x32x16_bf16 v[0:15], a[96:99], v[164:167], v[0:15]
    s_add_u32 m0, s49, 98304
    s_add_u32 s48, s48, 16384
    s_and_b32 s48, s48, 0xfffff
    buffer_load_dwordx4 v254, s[16:19], s48 offen offset:0 lds
    ds_read_b128 a[64:67], v196 offset:16384
    ds_read_b64_tr_b16 a[144:145], v246 offset:16384
    v_mfma_f32_32x32x16_bf16 v[16:31], a[100:103], v[164:167], v[16:31]
    ds_read_b128 a[68:71], v197 offset:16384
    ds_read_b64_tr_b16 a[146:147], v246 offset:16896
    v_max3_f32 v195, v140, v141, v142
    v_max3_f32 v191, v191, v192, v193
    v_max3_f32 v194, v194, v195, v143
    v_max_f32 v189, v191, v194
    v_mfma_f32_32x32x16_bf16 v[32:47], a[104:107], v[164:167], v[32:47]
    ds_read_b128 a[72:75], v198 offset:16384
    ds_read_b64_tr_b16 a[148:149], v247 offset:16384
    v_cmp_gt_f32 vcc, v189, v188
    v_mfma_f32_32x32x16_bf16 v[48:63], a[108:111], v[164:167], v[48:63]
    ds_read_b128 a[76:79], v199 offset:16384
    ds_read_b64_tr_b16 a[150:151], v247 offset:16896
    s_waitcnt lgkmcnt(8)
    v_mfma_f32_32x32x16_bf16 v[64:79], a[112:115], v[164:167], v[64:79]
    buffer_load_dwordx4 v255, s[16:19], s48 offen offset:1024 lds
    ds_read_b128 a[80:83], v200 offset:16384
    ds_read_b64_tr_b16 a[152:153], v246 offset:18432
    v_mfma_f32_32x32x16_bf16 v[80:95], a[116:119], v[164:167], v[80:95]
    ds_read_b128 a[84:87], v201 offset:16384
    ds_read_b64_tr_b16 a[154:155], v246 offset:18944
    v_mfma_f32_32x32x16_bf16 v[96:111], a[120:123], v[164:167], v[96:111]
    ds_read_b128 a[88:91], v202 offset:16384
    ds_read_b64_tr_b16 a[156:157], v247 offset:18432
    v_mfma_f32_32x32x16_bf16 v[112:127], a[124:127], v[164:167], v[112:127]
    ds_read_b128 a[92:95], v203 offset:16384
    ds_read_b64_tr_b16 a[158:159], v247 offset:18944
    s_cbranch_vccnz ATT_RSp_2
ATT_BKp_2:
    s_waitcnt lgkmcnt(9)
    v_mfma_f32_32x32x16_bf16 v[144:159], a[64:67], a[0:3], 0
    buffer_load_dwordx4 v254, s[16:19], s48 offen offset:2048 lds
    ds_read_b128 a[64:67], v196 offset:16640
    v_fma_f32 v168, v128, s46, -v185
    v_fma_f32 v169, v129, s46, -v185
    v_exp_f32 v168, v168
    v_mfma_f32_32x32x16_bf16 v[144:159], a[68:71], a[4:7], v[144:159]
    ds_read_b128 a[68:71], v197 offset:16640
    v_exp_f32 v169, v169
    v_fma_f32 v170, v130, s46, -v185
    v_fma_f32 v171, v131, s46, -v185
    v_mfma_f32_32x32x16_bf16 v[144:159], a[72:75], a[8:11], v[144:159]
    ds_read_b128 a[72:75], v198 offset:16640
    v_exp_f32 v170, v170
    v_add_f32 v186, v186, v168
    v_exp_f32 v171, v171
    v_mfma_f32_32x32x16_bf16 v[144:159], a[76:79], a[12:15], v[144:159]
    ds_read_b128 a[76:79], v199 offset:16640
    v_add_f32 v187, v187, v169
    v_cvt_pk_bf16_f32 v160, v168, v169
    v_fma_f32 v172, v132, s46, -v185
    v_fma_f32 v173, v133, s46, -v185
    s_waitcnt lgkmcnt(5)
    v_mfma_f32_32x32x16_bf16 v[144:159], a[80:83], a[16:19], v[144:159]
    buffer_load_dwordx4 v255, s[16:19], s48 offen offset:3072 lds
    ds_read_b128 a[80:83], v200 offset:16640
    v_exp_f32 v172, v172
    v_add_f32 v186, v186, v170
    v_mfma_f32_32x32x16_bf16 v[144:159], a[84:87], a[20:23], v[144:159]
    ds_read_b128 a[84:87], v201 offset:16640
    v_exp_f32 v173, v173
    v_add_f32 v187, v187, v171
    v_cvt_pk_bf16_f32 v161, v170, v171
    v_fma_f32 v174, v134, s46, -v185
    v_mfma_f32_32x32x16_bf16 v[144:159], a[88:91], a[24:27], v[144:159]
    ds_read_b128 a[88:91], v202 offset:16640
    v_fma_f32 v175, v135, s46, -v185
    v_exp_f32 v174, v174
    v_add_f32 v186, v186, v172
    v_mfma_f32_32x32x16_bf16 v[144:159], a[92:95], a[28:31], v[144:159]
    ds_read_b128 a[92:95], v203 offset:16640
    v_exp_f32 v175, v175
    v_add_f32 v187, v187, v173
    v_cvt_pk_bf16_f32 v162, v172, v173
    s_waitcnt lgkmcnt(4)
    v_mfma_f32_32x32x16_bf16 v[144:159], a[64:67], a[32:35], v[144:159]
    s_add_u32 m0, s49, 0
    s_add_u32 s47, s47, 16384
    s_and_b32 s47, s47, 0xfffff
    buffer_load_dwordx4 v250, s[12:15], s47 offen offset:0 lds
    ds_read_b64_tr_b16 a[96:97], v204 offset:0
    ds_read_b64_tr_b16 a[98:99], v204 offset:4096
    v_mfma_f32_32x32x16_bf16 v[144:159], a[68:71], a[36:39], v[144:159]
    ds_read_b64_tr_b16 a[100:101], v205 offset:0
    ds_read_b64_tr_b16 a[102:103], v205 offset:4096
    v_fma_f32 v176, v136, s46, -v185
    v_fma_f32 v177, v137, s46, -v185
    v_exp_f32 v176, v176
    v_mfma_f32_32x32x16_bf16 v[144:159], a[72:75], a[40:43], v[144:159]
    ds_read_b64_tr_b16 a[104:105], v206 offset:0
    ds_read_b64_tr_b16 a[106:107], v206 offset:4096
    v_add_f32 v186, v186, v174
    v_exp_f32 v177, v177
    v_add_f32 v187, v187, v175
    v_mfma_f32_32x32x16_bf16 v[144:159], a[76:79], a[44:47], v[144:159]
    ds_read_b64_tr_b16 a[108:109], v207 offset:0
    ds_read_b64_tr_b16 a[110:111], v207 offset:4096
    v_cvt_pk_bf16_f32 v163, v174, v175
    v_fma_f32 v178, v138, s46, -v185
    v_fma_f32 v179, v139, s46, -v185
    s_waitcnt lgkmcnt(8)
    v_mfma_f32_32x32x16_bf16 v[144:159], a[80:83], a[48:51], v[144:159]
    buffer_load_dwordx4 v251, s[12:15], s47 offen offset:1024 lds
    ds_read_b64_tr_b16 a[112:113], v204 offset:256
    ds_read_b64_tr_b16 a[114:115], v204 offset:4352
    v_exp_f32 v178, v178
    v_add_f32 v186, v186, v176
    v_mfma_f32_32x32x16_bf16 v[144:159], a[84:87], a[52:55], v[144:159]
    ds_read_b64_tr_b16 a[116:117], v205 offset:256
    ds_read_b64_tr_b16 a[118:119], v205 offset:4352
    v_exp_f32 v179, v179
    v_add_f32 v187, v187, v177
    v_cvt_pk_bf16_f32 v164, v176, v177
    v_mfma_f32_32x32x16_bf16 v[144:159], a[88:91], a[56:59], v[144:159]
    ds_read_b64_tr_b16 a[120:121], v206 offset:256
    ds_read_b64_tr_b16 a[122:123], v206 offset:4352
    v_fma_f32 v180, v140, s46, -v185
    v_fma_f32 v181, v141, s46, -v185
    v_exp_f32 v180, v180
    v_mfma_f32_32x32x16_bf16 v[144:159], a[92:95], a[60:63], v[144:159]
    ds_read_b64_tr_b16 a[124:125], v207 offset:256
    ds_read_b64_tr_b16 a[126:127], v207 offset:4352
    v_add_f32 v186, v186, v178
    v_exp_f32 v181, v181
    s_waitcnt lgkmcnt(8)
    v_mfma_f32_32x32x16_bf16 v[0:15], a[96:99], v[160:163], v[0:15]
    buffer_load_dwordx4 v252, s[12:15], s47 offen offset:2048 lds
    ds_read_b64_tr_b16 a[96:97], v204 offset:8192
    ds_read_b64_tr_b16 a[98:99], v204 offset:12288
    v_add_f32 v187, v187, v179
    v_cvt_pk_bf16_f32 v165, v178, v179
    v_fma_f32 v182, v142, s46, -v185
    v_mfma_f32_32x32x16_bf16 v[16:31], a[100:103], v[160:163], v[16:31]
    ds_read_b64_tr_b16 a[100:101], v205 offset:8192
    ds_read_b64_tr_b16 a[102:103], v205 offset:12288
    v_fma_f32 v183, v143, s46, -v185
    v_exp_f32 v182, v182
    v_add_f32 v186, v186, v180
    v_mfma_f32_32x32x16_bf16 v[32:47], a[104:107], v[160:163], v[32:47]
    ds_read_b64_tr_b16 a[104:105], v206 offset:8192
    ds_read_b64_tr_b16 a[106:107], v206 offset:12288
    v_exp_f32 v183, v183
    v_add_f32 v187, v187, v181
    v_cvt_pk_bf16_f32 v166, v180, v181
    v_mfma_f32_32x32x16_bf16 v[48:63], a[108:111], v[160:163], v[48:63]
    ds_read_b64_tr_b16 a[108:109], v207 offset:8192
    ds_read_b64_tr_b16 a[110:111], v207 offset:12288
    v_add_f32 v186, v186, v182
    v_add_f32 v187, v187, v183
    v_cvt_pk_bf16_f32 v167, v182, v183
    s_waitcnt lgkmcnt(8)
    v_mfma_f32_32x32x16_bf16 v[64:79], a[112:115], v[160:163], v[64:79]
    buffer_load_dwordx4 v253, s[12:15], s47 offen offset:3072 lds
    ds_read_b64_tr_b16 a[112:113], v204 offset:8448
    ds_read_b64_tr_b16 a[114:115], v204 offset:12544
    s_add_u32 m0, s49, 147456
    s_add_u32 s34, s35, 3096576
    buffer_load_dwordx4 v245, s[8:11], s34 offen lds
    v_max3_f32 v191, v144, v145, v146
    v_mfma_f32_32x32x16_bf16 v[80:95], a[116:119], v[160:163], v[80:95]
    ds_read_b64_tr_b16 a[116:117], v205 offset:8448
    ds_read_b64_tr_b16 a[118:119], v205 offset:12544
    s_add_u32 m0, s49, 148480
    s_add_u32 s34, s35, 3103744
    buffer_load_dwordx4 v245, s[8:11], s34 offen lds
    v_max3_f32 v192, v147, v148, v149
    v_max3_f32 v193, v150, v151, v152
    v_mfma_f32_32x32x16_bf16 v[96:111], a[120:123], v[160:163], v[96:111]
    ds_read_b64_tr_b16 a[120:121], v206 offset:8448
    ds_read_b64_tr_b16 a[122:123], v206 offset:12544
    s_add_u32 m0, s49, 149504
    s_add_u32 s34, s35, 3110912
    buffer_load_dwordx4 v245, s[8:11], s34 offen lds
    s_add_u32 m0, s49, 150528
    s_add_u32 s34, s35, 3118080
    buffer_load_dwordx4 v245, s[8:11], s34 offen lds
    v_mfma_f32_32x32x16_bf16 v[112:127], a[124:127], v[160:163], v[112:127]
    s_waitcnt vmcnt(12)
    s_barrier
    ds_read_b64_tr_b16 a[124:125], v207 offset:8448
    ds_read_b64_tr_b16 a[126:127], v207 offset:12544
    v_max3_f32 v194, v153, v154, v155
    s_waitcnt lgkmcnt(8)
    v_mfma_f32_32x32x16_bf16 v[0:15], a[96:99], v[164:167], v[0:15]
    s_add_u32 m0, s49, 114688
    s_add_u32 s48, s48, 16384
    s_and_b32 s48, s48, 0xfffff
    buffer_load_dwordx4 v254, s[16:19], s48 offen offset:0 lds
    ds_read_b128 a[64:67], v196 offset:32768
    ds_read_b64_tr_b16 a[160:161], v246 offset:0
    v_mfma_f32_32x32x16_bf16 v[16:31], a[100:103], v[164:167], v[16:31]
    ds_read_b128 a[68:71], v197 offset:32768
    ds_read_b64_tr_b16 a[162:163], v246 offset:512
    v_max3_f32 v195, v156, v157, v158
    v_max3_f32 v191, v191, v192, v193
    v_max3_f32 v194, v194, v195, v159
    v_max_f32 v189, v191, v194
    v_mfma_f32_32x32x16_bf16 v[32:47], a[104:107], v[164:167], v[32:47]
    ds_read_b128 a[72:75], v198 offset:32768
    ds_read_b64_tr_b16 a[164:165], v247 offset:0
    v_cmp_gt_f32 vcc, v189, v188
    v_mfma_f32_32x32x16_bf16 v[48:63], a[108:111], v[164:167], v[48:63]
    ds_read_b128 a[76:79], v199 offset:32768
    ds_read_b64_tr_b16 a[166:167], v247 offset:512
    s_waitcnt lgkmcnt(8)
    v_mfma_f32_32x32x16_bf16 v[64:79], a[112:115], v[164:167], v[64:79]
    buffer_load_dwordx4 v255, s[16:19], s48 offen offset:1024 lds
    ds_read_b128 a[80:83], v200 offset:32768
    ds_read_b64_tr_b16 a[168:169], v246 offset:2048
    v_mfma_f32_32x32x16_bf16 v[80:95], a[116:119], v[164:167], v[80:95]
    ds_read_b128 a[84:87], v201 offset:32768
    ds_read_b64_tr_b16 a[170:171], v246 offset:2560
    v_mfma_f32_32x32x16_bf16 v[96:111], a[120:123], v[164:167], v[96:111]
    ds_read_b128 a[88:91], v202 offset:32768
    ds_read_b64_tr_b16 a[172:173], v247 offset:2048
    v_mfma_f32_32x32x16_bf16 v[112:127], a[124:127], v[164:167], v[112:127]
    ds_read_b128 a[92:95], v203 offset:32768
    ds_read_b64_tr_b16 a[174:175], v247 offset:2560
    s_cbranch_vccnz ATT_RSp_3
ATT_BKp_3:
    s_waitcnt lgkmcnt(9)
    v_mfma_f32_32x32x16_bf16 v[128:143], a[64:67], a[0:3], 0
    buffer_load_dwordx4 v254, s[16:19], s48 offen offset:2048 lds
    ds_read_b128 a[64:67], v196 offset:33024
    v_fma_f32 v168, v144, s46, -v185
    v_fma_f32 v169, v145, s46, -v185
    v_exp_f32 v168, v168
    v_mfma_f32_32x32x16_bf16 v[128:143], a[68:71], a[4:7], v[128:143]
    ds_read_b128 a[68:71], v197 offset:33024
    v_exp_f32 v169, v169
    v_fma_f32 v170, v146, s46, -v185
    v_fma_f32 v171, v147, s46, -v185
    v_mfma_f32_32x32x16_bf16 v[128:143], a[72:75], a[8:11], v[128:143]
    ds_read_b128 a[72:75], v198 offset:33024
    v_exp_f32 v170, v170
    v_add_f32 v186, v186, v168
    v_exp_f32 v171, v171
    v_mfma_f32_32x32x16_bf16 v[128:143], a[76:79], a[12:15], v[128:143]
    ds_read_b128 a[76:79], v199 offset:33024
    v_add_f32 v187, v187, v169
    v_cvt_pk_bf16_f32 v160, v168, v169
    v_fma_f32 v172, v148, s46, -v185
    v_fma_f32 v173, v149, s46, -v185
    s_waitcnt lgkmcnt(5)
    v_mfma_f32_32x32x16_bf16 v[128:143], a[80:83], a[16:19], v[128:143]
    buffer_load_dwordx4 v255, s[16:19], s48 offen offset:3072 lds
    ds_read_b128 a[80:83], v200 offset:33024
    v_exp_f32 v172, v172
    v_add_f32 v186, v186, v170
    v_mfma_f32_32x32x16_bf16 v[128:143], a[84:87], a[20:23], v[128:143]
    ds_read_b128 a[84:87], v201 offset:33024
    v_exp_f32 v173, v173
    v_add_f32 v187, v187, v171
    v_cvt_pk_bf16_f32 v161, v170, v171
    v_fma_f32 v174, v150, s46, -v185
    v_mfma_f32_32x32x16_bf16 v[128:143], a[88:91], a[24:27], v[128:143]
    ds_read_b128 a[88:91], v202 offset:33024
    v_fma_f32 v175, v151, s46, -v185
    v_exp_f32 v174, v174
    v_add_f32 v186, v186, v172
    v_mfma_f32_32x32x16_bf16 v[128:143], a[92:95], a[28:31], v[128:143]
    ds_read_b128 a[92:95], v203 offset:33024
    v_exp_f32 v175, v175
    v_add_f32 v187, v187, v173
    v_cvt_pk_bf16_f32 v162, v172, v173
    s_waitcnt lgkmcnt(4)
    v_mfma_f32_32x32x16_bf16 v[128:143], a[64:67], a[32:35], v[128:143]
    s_add_u32 m0, s49, 16384
    s_add_u32 s47, s47, 16384
    s_and_b32 s47, s47, 0xfffff
    buffer_load_dwordx4 v250, s[12:15], s47 offen offset:0 lds
    ds_read_b64_tr_b16 a[96:97], v204 offset:16384
    ds_read_b64_tr_b16 a[98:99], v204 offset:20480
    v_mfma_f32_32x32x16_bf16 v[128:143], a[68:71], a[36:39], v[128:143]
    ds_read_b64_tr_b16 a[100:101], v205 offset:16384
    ds_read_b64_tr_b16 a[102:103], v205 offset:20480
    v_fma_f32 v176, v152, s46, -v185
    v_fma_f32 v177, v153, s46, -v185
    v_exp_f32 v176, v176
    v_mfma_f32_32x32x16_bf16 v[128:143], a[72:75], a[40:43], v[128:143]
    ds_read_b64_tr_b16 a[104:105], v206 offset:16384
    ds_read_b64_tr_b16 a[106:107], v206 offset:20480
    v_add_f32 v186, v186, v174
    v_exp_f32 v177, v177
    v_add_f32 v187, v187, v175
    v_mfma_f32_32x32x16_bf16 v[128:143], a[76:79], a[44:47], v[128:143]
    ds_read_b64_tr_b16 a[108:109], v207 offset:16384
    ds_read_b64_tr_b16 a[110:111], v207 offset:20480
    v_cvt_pk_bf16_f32 v163, v174, v175
    v_fma_f32 v178, v154, s46, -v185
    v_fma_f32 v179, v155, s46, -v185
    s_waitcnt lgkmcnt(8)
    v_mfma_f32_32x32x16_bf16 v[128:143], a[80:83], a[48:51], v[128:143]
    buffer_load_dwordx4 v251, s[12:15], s47 offen offset:1024 lds
    ds_read_b64_tr_b16 a[112:113], v204 offset:16640
    ds_read_b64_tr_b16 a[114:115], v204 offset:20736
    v_exp_f32 v178, v178
    v_add_f32 v186, v186, v176
    v_mfma_f32_32x32x16_bf16 v[128:143], a[84:87], a[52:55], v[128:143]
    ds_read_b64_tr_b16 a[116:117], v205 offset:16640
    ds_read_b64_tr_b16 a[118:119], v205 offset:20736
    v_exp_f32 v179, v179
    v_add_f32 v187, v187, v177
    v_cvt_pk_bf16_f32 v164, v176, v177
    v_mfma_f32_32x32x16_bf16 v[128:143], a[88:91], a[56:59], v[128:143]
    ds_read_b64_tr_b16 a[120:121], v206 offset:16640
    ds_read_b64_tr_b16 a[122:123], v206 offset:20736
    v_fma_f32 v180, v156, s46, -v185
    v_fma_f32 v181, v157, s46, -v185
    v_exp_f32 v180, v180
    v_mfma_f32_32x32x16_bf16 v[128:143], a[92:95], a[60:63], v[128:143]
    ds_read_b64_tr_b16 a[124:125], v207 offset:16640
    ds_read_b64_tr_b16 a[126:127], v207 offset:20736
    v_add_f32 v186, v186, v178
    v_exp_f32 v181, v181
    s_waitcnt lgkmcnt(8)
    v_mfma_f32_32x32x16_bf16 v[0:15], a[96:99], v[160:163], v[0:15]
    buffer_load_dwordx4 v252, s[12:15], s47 offen offset:2048 lds
    ds_read_b64_tr_b16 a[96:97], v204 offset:24576
    ds_read_b64_tr_b16 a[98:99], v204 offset:28672
    v_add_f32 v187, v187, v179
    v_cvt_pk_bf16_f32 v165, v178, v179
    v_fma_f32 v182, v158, s46, -v185
    v_mfma_f32_32x32x16_bf16 v[16:31], a[100:103], v[160:163], v[16:31]
    ds_read_b64_tr_b16 a[100:101], v205 offset:24576
    ds_read_b64_tr_b16 a[102:103], v205 offset:28672
    v_fma_f32 v183, v159, s46, -v185
    v_exp_f32 v182, v182
    v_add_f32 v186, v186, v180
    v_mfma_f32_32x32x16_bf16 v[32:47], a[104:107], v[160:163], v[32:47]
    ds_read_b64_tr_b16 a[104:105], v206 offset:24576
    ds_read_b64_tr_b16 a[106:107], v206 offset:28672
    v_exp_f32 v183, v183
    v_add_f32 v187, v187, v181
    v_cvt_pk_bf16_f32 v166, v180, v181
    v_mfma_f32_32x32x16_bf16 v[48:63], a[108:111], v[160:163], v[48:63]
    ds_read_b64_tr_b16 a[108:109], v207 offset:24576
    ds_read_b64_tr_b16 a[110:111], v207 offset:28672
    v_add_f32 v186, v186, v182
    v_add_f32 v187, v187, v183
    v_cvt_pk_bf16_f32 v167, v182, v183
    s_waitcnt lgkmcnt(8)
    v_mfma_f32_32x32x16_bf16 v[64:79], a[112:115], v[160:163], v[64:79]
    buffer_load_dwordx4 v253, s[12:15], s47 offen offset:3072 lds
    ds_read_b64_tr_b16 a[112:113], v204 offset:24832
    ds_read_b64_tr_b16 a[114:115], v204 offset:28928
    s_add_u32 m0, s49, 131072
    s_add_u32 s34, s35, 3211264
    buffer_load_dwordx4 v245, s[8:11], s34 offen lds
    v_max3_f32 v191, v128, v129, v130
    v_mfma_f32_32x32x16_bf16 v[80:95], a[116:119], v[160:163], v[80:95]
    ds_read_b64_tr_b16 a[116:117], v205 offset:24832
    ds_read_b64_tr_b16 a[118:119], v205 offset:28928
    s_add_u32 m0, s49, 132096
    s_add_u32 s34, s35, 3218432
    buffer_load_dwordx4 v245, s[8:11], s34 offen lds
    v_max3_f32 v192, v131, v132, v133
    v_max3_f32 v193, v134, v135, v136
    v_mfma_f32_32x32x16_bf16 v[96:111], a[120:123], v[160:163], v[96:111]
    ds_read_b64_tr_b16 a[120:121], v206 offset:24832
    ds_read_b64_tr_b16 a[122:123], v206 offset:28928
    s_add_u32 m0, s49, 133120
    s_add_u32 s34, s35, 3225600
    buffer_load_dwordx4 v245, s[8:11], s34 offen lds
    s_add_u32 m0, s49, 134144
    s_add_u32 s34, s35, 3232768
    buffer_load_dwordx4 v245, s[8:11], s34 offen lds
    v_mfma_f32_32x32x16_bf16 v[112:127], a[124:127], v[160:163], v[112:127]
    s_waitcnt vmcnt(12)
    s_barrier
    ds_read_b64_tr_b16 a[124:125], v207 offset:24832
    ds_read_b64_tr_b16 a[126:127], v207 offset:28928
    v_max3_f32 v194, v137, v138, v139
    s_waitcnt lgkmcnt(8)
    v_mfma_f32_32x32x16_bf16 v[0:15], a[96:99], v[164:167], v[0:15]
    s_add_u32 m0, s49, 65536
    s_add_u32 s48, s48, 16384
    s_and_b32 s48, s48, 0xfffff
    buffer_load_dwordx4 v254, s[16:19], s48 offen offset:0 lds
    ds_read_b128 a[64:67], v196 offset:49152
    ds_read_b64_tr_b16 a[176:177], v246 offset:16384
    v_mfma_f32_32x32x16_bf16 v[16:31], a[100:103], v[164:167], v[16:31]
    ds_read_b128 a[68:71], v197 offset:49152
    ds_read_b64_tr_b16 a[178:179], v246 offset:16896
    v_max3_f32 v195, v140, v141, v142
    v_max3_f32 v191, v191, v192, v193
    v_max3_f32 v194, v194, v195, v143
    v_max_f32 v189, v191, v194
    v_mfma_f32_32x32x16_bf16 v[32:47], a[104:107], v[164:167], v[32:47]
    ds_read_b128 a[72:75], v198 offset:49152
    ds_read_b64_tr_b16 a[180:181], v247 offset:16384
    v_cmp_gt_f32 vcc, v189, v188
    v_mfma_f32_32x32x16_bf16 v[48:63], a[108:111], v[164:167], v[48:63]
    ds_read_b128 a[76:79], v199 offset:49152
    ds_read_b64_tr_b16 a[182:183], v247 offset:16896
    s_waitcnt lgkmcnt(8)
    v_mfma_f32_32x32x16_bf16 v[64:79], a[112:115], v[164:167], v[64:79]
    buffer_load_dwordx4 v255, s[16:19], s48 offen offset:1024 lds
    ds_read_b128 a[80:83], v200 offset:49152
    ds_read_b64_tr_b16 a[184:185], v246 offset:18432
    v_mfma_f32_32x32x16_bf16 v[80:95], a[116:119], v[164:167], v[80:95]
    ds_read_b128 a[84:87], v201 offset:49152
    ds_read_b64_tr_b16 a[186:187], v246 offset:18944
    v_mfma_f32_32x32x16_bf16 v[96:111], a[120:123], v[164:167], v[96:111]
    ds_read_b128 a[88:91], v202 offset:49152
    ds_read_b64_tr_b16 a[188:189], v247 offset:18432
    v_mfma_f32_32x32x16_bf16 v[112:127], a[124:127], v[164:167], v[112:127]
    ds_read_b128 a[92:95], v203 offset:49152
    ds_read_b64_tr_b16 a[190:191], v247 offset:18944
    s_cbranch_vccnz ATT_RSp_4
ATT_BKp_4:
    s_waitcnt lgkmcnt(9)
    v_mfma_f32_32x32x16_bf16 v[144:159], a[64:67], a[0:3], 0
    buffer_load_dwordx4 v254, s[16:19], s48 offen offset:2048 lds
    ds_read_b128 a[64:67], v196 offset:49408
    v_fma_f32 v168, v128, s46, -v185
    v_fma_f32 v169, v129, s46, -v185
    v_exp_f32 v168, v168
    v_mfma_f32_32x32x16_bf16 v[144:159], a[68:71], a[4:7], v[144:159]
    ds_read_b128 a[68:71], v197 offset:49408
    v_exp_f32 v169, v169
    v_fma_f32 v170, v130, s46, -v185
    v_fma_f32 v171, v131, s46, -v185
    v_mfma_f32_32x32x16_bf16 v[144:159], a[72:75], a[8:11], v[144:159]
    ds_read_b128 a[72:75], v198 offset:49408
    v_exp_f32 v170, v170
    v_add_f32 v186, v186, v168
    v_exp_f32 v171, v171
    v_mfma_f32_32x32x16_bf16 v[144:159], a[76:79], a[12:15], v[144:159]
    ds_read_b128 a[76:79], v199 offset:49408
    v_add_f32 v187, v187, v169
    v_cvt_pk_bf16_f32 v160, v168, v169
    v_fma_f32 v172, v132, s46, -v185
    v_fma_f32 v173, v133, s46, -v185
    s_waitcnt lgkmcnt(5)
    v_mfma_f32_32x32x16_bf16 v[144:159], a[80:83], a[16:19], v[144:159]
    buffer_load_dwordx4 v255, s[16:19], s48 offen offset:3072 lds
    ds_read_b128 a[80:83], v200 offset:49408
    v_exp_f32 v172, v172
    v_add_f32 v186, v186, v170
    v_mfma_f32_32x32x16_bf16 v[144:159], a[84:87], a[20:23], v[144:159]
    ds_read_b128 a[84:87], v201 offset:49408
    v_exp_f32 v173, v173
    v_add_f32 v187, v187, v171
    v_cvt_pk_bf16_f32 v161, v170, v171
    v_fma_f32 v174, v134, s46, -v185
    v_mfma_f32_32x32x16_bf16 v[144:159], a[88:91], a[24:27], v[144:159]
    ds_read_b128 a[88:91], v202 offset:49408
    v_fma_f32 v175, v135, s46, -v185
    v_exp_f32 v174, v174
    v_add_f32 v186, v186, v172
    v_mfma_f32_32x32x16_bf16 v[144:159], a[92:95], a[28:31], v[144:159]
    ds_read_b128 a[92:95], v203 offset:49408
    v_exp_f32 v175, v175
    v_add_f32 v187, v187, v173
    v_cvt_pk_bf16_f32 v162, v172, v173
    s_waitcnt lgkmcnt(4)
    v_mfma_f32_32x32x16_bf16 v[144:159], a[64:67], a[32:35], v[144:159]
    s_add_u32 m0, s49, 32768
    s_add_u32 s47, s47, 16384
    s_and_b32 s47, s47, 0xfffff
    buffer_load_dwordx4 v250, s[12:15], s47 offen offset:0 lds
    ds_read_b64_tr_b16 a[96:97], v204 offset:32768
    ds_read_b64_tr_b16 a[98:99], v204 offset:36864
    v_mfma_f32_32x32x16_bf16 v[144:159], a[68:71], a[36:39], v[144:159]
    ds_read_b64_tr_b16 a[100:101], v205 offset:32768
    ds_read_b64_tr_b16 a[102:103], v205 offset:36864
    v_fma_f32 v176, v136, s46, -v185
    v_fma_f32 v177, v137, s46, -v185
    v_exp_f32 v176, v176
    v_mfma_f32_32x32x16_bf16 v[144:159], a[72:75], a[40:43], v[144:159]
    ds_read_b64_tr_b16 a[104:105], v206 offset:32768
    ds_read_b64_tr_b16 a[106:107], v206 offset:36864
    v_add_f32 v186, v186, v174
    v_exp_f32 v177, v177
    v_add_f32 v187, v187, v175
    v_mfma_f32_32x32x16_bf16 v[144:159], a[76:79], a[44:47], v[144:159]
    ds_read_b64_tr_b16 a[108:109], v207 offset:32768
    ds_read_b64_tr_b16 a[110:111], v207 offset:36864
    v_cvt_pk_bf16_f32 v163, v174, v175
    v_fma_f32 v178, v138, s46, -v185
    v_fma_f32 v179, v139, s46, -v185
    s_waitcnt lgkmcnt(8)
    v_mfma_f32_32x32x16_bf16 v[144:159], a[80:83], a[48:51], v[144:159]
    buffer_load_dwordx4 v251, s[12:15], s47 offen offset:1024 lds
    ds_read_b64_tr_b16 a[112:113], v204 offset:33024
    ds_read_b64_tr_b16 a[114:115], v204 offset:37120
    v_exp_f32 v178, v178
    v_add_f32 v186, v186, v176
    v_mfma_f32_32x32x16_bf16 v[144:159], a[84:87], a[52:55], v[144:159]
    ds_read_b64_tr_b16 a[116:117], v205 offset:33024
    ds_read_b64_tr_b16 a[118:119], v205 offset:37120
    v_exp_f32 v179, v179
    v_add_f32 v187, v187, v177
    v_cvt_pk_bf16_f32 v164, v176, v177
    v_mfma_f32_32x32x16_bf16 v[144:159], a[88:91], a[56:59], v[144:159]
    ds_read_b64_tr_b16 a[120:121], v206 offset:33024
    ds_read_b64_tr_b16 a[122:123], v206 offset:37120
    v_fma_f32 v180, v140, s46, -v185
    v_fma_f32 v181, v141, s46, -v185
    v_exp_f32 v180, v180
    v_mfma_f32_32x32x16_bf16 v[144:159], a[92:95], a[60:63], v[144:159]
    ds_read_b64_tr_b16 a[124:125], v207 offset:33024
    ds_read_b64_tr_b16 a[126:127], v207 offset:37120
    v_add_f32 v186, v186, v178
    v_exp_f32 v181, v181
    s_waitcnt lgkmcnt(8)
    v_mfma_f32_32x32x16_bf16 v[0:15], a[96:99], v[160:163], v[0:15]
    buffer_load_dwordx4 v252, s[12:15], s47 offen offset:2048 lds
    ds_read_b64_tr_b16 a[96:97], v204 offset:40960
    ds_read_b64_tr_b16 a[98:99], v204 offset:45056
    v_add_f32 v187, v187, v179
    v_cvt_pk_bf16_f32 v165, v178, v179
    v_fma_f32 v182, v142, s46, -v185
    v_mfma_f32_32x32x16_bf16 v[16:31], a[100:103], v[160:163], v[16:31]
    ds_read_b64_tr_b16 a[100:101], v205 offset:40960
    ds_read_b64_tr_b16 a[102:103], v205 offset:45056
    v_fma_f32 v183, v143, s46, -v185
    v_exp_f32 v182, v182
    v_add_f32 v186, v186, v180
    v_mfma_f32_32x32x16_bf16 v[32:47], a[104:107], v[160:163], v[32:47]
    ds_read_b64_tr_b16 a[104:105], v206 offset:40960
    ds_read_b64_tr_b16 a[106:107], v206 offset:45056
    v_exp_f32 v183, v183
    v_add_f32 v187, v187, v181
    v_cvt_pk_bf16_f32 v166, v180, v181
    v_mfma_f32_32x32x16_bf16 v[48:63], a[108:111], v[160:163], v[48:63]
    ds_read_b64_tr_b16 a[108:109], v207 offset:40960
    ds_read_b64_tr_b16 a[110:111], v207 offset:45056
    v_add_f32 v186, v186, v182
    v_add_f32 v187, v187, v183
    v_cvt_pk_bf16_f32 v167, v182, v183
    s_waitcnt lgkmcnt(8)
    v_mfma_f32_32x32x16_bf16 v[64:79], a[112:115], v[160:163], v[64:79]
    buffer_load_dwordx4 v253, s[12:15], s47 offen offset:3072 lds
    ds_read_b64_tr_b16 a[112:113], v204 offset:41216
    ds_read_b64_tr_b16 a[114:115], v204 offset:45312
    s_add_u32 m0, s49, 147456
    s_add_u32 s34, s35, 3325952
    buffer_load_dwordx4 v245, s[8:11], s34 offen lds
    v_max3_f32 v191, v144, v145, v146
    v_mfma_f32_32x32x16_bf16 v[80:95], a[116:119], v[160:163], v[80:95]
    ds_read_b64_tr_b16 a[116:117], v205 offset:41216
    ds_read_b64_tr_b16 a[118:119], v205 offset:45312
    s_add_u32 m0, s49, 148480
    s_add_u32 s34, s35, 3333120
    buffer_load_dwordx4 v245, s[8:11], s34 offen lds
    v_max3_f32 v192, v147, v148, v149
    v_max3_f32 v193, v150, v151, v152
    v_mfma_f32_32x32x16_bf16 v[96:111], a[120:123], v[160:163], v[96:111]
    ds_read_b64_tr_b16 a[120:121], v206 offset:41216
    ds_read_b64_tr_b16 a[122:123], v206 offset:45312
    s_add_u32 m0, s49, 149504
    s_add_u32 s34, s35, 3340288
    buffer_load_dwordx4 v245, s[8:11], s34 offen lds
    s_add_u32 m0, s49, 150528
    s_add_u32 s34, s35, 3347456
    buffer_load_dwordx4 v245, s[8:11], s34 offen lds
    v_mfma_f32_32x32x16_bf16 v[112:127], a[124:127], v[160:163], v[112:127]
    s_waitcnt vmcnt(12)
    s_barrier
    ds_read_b64_tr_b16 a[124:125], v207 offset:41216
    ds_read_b64_tr_b16 a[126:127], v207 offset:45312
    v_max3_f32 v194, v153, v154, v155
    s_waitcnt lgkmcnt(8)
    v_mfma_f32_32x32x16_bf16 v[0:15], a[96:99], v[164:167], v[0:15]
    s_add_u32 m0, s49, 81920
    s_add_u32 s48, s48, 16384
    s_and_b32 s48, s48, 0xfffff
    buffer_load_dwordx4 v254, s[16:19], s48 offen offset:0 lds
    ds_read_b128 a[64:67], v196 offset:0
    ds_read_b64_tr_b16 a[192:193], v246 offset:0
    v_mfma_f32_32x32x16_bf16 v[16:31], a[100:103], v[164:167], v[16:31]
    ds_read_b128 a[68:71], v197 offset:0
    ds_read_b64_tr_b16 a[194:195], v246 offset:512
    v_max3_f32 v195, v156, v157, v158
    v_max3_f32 v191, v191, v192, v193
    v_max3_f32 v194, v194, v195, v159
    v_max_f32 v189, v191, v194
    v_mfma_f32_32x32x16_bf16 v[32:47], a[104:107], v[164:167], v[32:47]
    ds_read_b128 a[72:75], v198 offset:0
    ds_read_b64_tr_b16 a[196:197], v247 offset:0
    v_cmp_gt_f32 vcc, v189, v188
    v_mfma_f32_32x32x16_bf16 v[48:63], a[108:111], v[164:167], v[48:63]
    ds_read_b128 a[76:79], v199 offset:0
    ds_read_b64_tr_b16 a[198:199], v247 offset:512
    s_waitcnt lgkmcnt(8)
    v_mfma_f32_32x32x16_bf16 v[64:79], a[112:115], v[164:167], v[64:79]
    buffer_load_dwordx4 v255, s[16:19], s48 offen offset:1024 lds
    ds_read_b128 a[80:83], v200 offset:0
    ds_read_b64_tr_b16 a[200:201], v246 offset:2048
    v_mfma_f32_32x32x16_bf16 v[80:95], a[116:119], v[164:167], v[80:95]
    ds_read_b128 a[84:87], v201 offset:0
    ds_read_b64_tr_b16 a[202:203], v246 offset:2560
    v_mfma_f32_32x32x16_bf16 v[96:111], a[120:123], v[164:167], v[96:111]
    ds_read_b128 a[88:91], v202 offset:0
    ds_read_b64_tr_b16 a[204:205], v247 offset:2048
    v_mfma_f32_32x32x16_bf16 v[112:127], a[124:127], v[164:167], v[112:127]
    ds_read_b128 a[92:95], v203 offset:0
    ds_read_b64_tr_b16 a[206:207], v247 offset:2560
    s_cbranch_vccnz ATT_RSp_5
ATT_BKp_5:
    s_waitcnt lgkmcnt(9)
    v_mfma_f32_32x32x16_bf16 v[128:143], a[64:67], a[0:3], 0
    buffer_load_dwordx4 v254, s[16:19], s48 offen offset:2048 lds
    ds_read_b128 a[64:67], v196 offset:256
    v_fma_f32 v168, v144, s46, -v185
    v_fma_f32 v169, v145, s46, -v185
    v_exp_f32 v168, v168
    v_mfma_f32_32x32x16_bf16 v[128:143], a[68:71], a[4:7], v[128:143]
    ds_read_b128 a[68:71], v197 offset:256
    v_exp_f32 v169, v169
    v_fma_f32 v170, v146, s46, -v185
    v_fma_f32 v171, v147, s46, -v185
    v_mfma_f32_32x32x16_bf16 v[128:143], a[72:75], a[8:11], v[128:143]
    ds_read_b128 a[72:75], v198 offset:256
    v_exp_f32 v170, v170
    v_add_f32 v186, v186, v168
    v_exp_f32 v171, v171
    v_mfma_f32_32x32x16_bf16 v[128:143], a[76:79], a[12:15], v[128:143]
    ds_read_b128 a[76:79], v199 offset:256
    v_add_f32 v187, v187, v169
    v_cvt_pk_bf16_f32 v160, v168, v169
    v_fma_f32 v172, v148, s46, -v185
    v_fma_f32 v173, v149, s46, -v185
    s_waitcnt lgkmcnt(5)
    v_mfma_f32_32x32x16_bf16 v[128:143], a[80:83], a[16:19], v[128:143]
    buffer_load_dwordx4 v255, s[16:19], s48 offen offset:3072 lds
    ds_read_b128 a[80:83], v200 offset:256
    v_exp_f32 v172, v172
    v_add_f32 v186, v186, v170
    v_mfma_f32_32x32x16_bf16 v[128:143], a[84:87], a[20:23], v[128:143]
    ds_read_b128 a[84:87], v201 offset:256
    v_exp_f32 v173, v173
    v_add_f32 v187, v187, v171
    v_cvt_pk_bf16_f32 v161, v170, v171
    v_fma_f32 v174, v150, s46, -v185
    v_mfma_f32_32x32x16_bf16 v[128:143], a[88:91], a[24:27], v[128:143]
    ds_read_b128 a[88:91], v202 offset:256
    v_fma_f32 v175, v151, s46, -v185
    v_exp_f32 v174, v174
    v_add_f32 v186, v186, v172
    v_mfma_f32_32x32x16_bf16 v[128:143], a[92:95], a[28:31], v[128:143]
    ds_read_b128 a[92:95], v203 offset:256
    v_exp_f32 v175, v175
    v_add_f32 v187, v187, v173
    v_cvt_pk_bf16_f32 v162, v172, v173
    s_waitcnt lgkmcnt(4)
    v_mfma_f32_32x32x16_bf16 v[128:143], a[64:67], a[32:35], v[128:143]
    s_add_u32 m0, s49, 49152
    s_add_u32 s47, s47, 16384
    s_and_b32 s47, s47, 0xfffff
    buffer_load_dwordx4 v250, s[12:15], s47 offen offset:0 lds
    ds_read_b64_tr_b16 a[96:97], v204 offset:49152
    ds_read_b64_tr_b16 a[98:99], v204 offset:53248
    v_mfma_f32_32x32x16_bf16 v[128:143], a[68:71], a[36:39], v[128:143]
    ds_read_b64_tr_b16 a[100:101], v205 offset:49152
    ds_read_b64_tr_b16 a[102:103], v205 offset:53248
    v_fma_f32 v176, v152, s46, -v185
    v_fma_f32 v177, v153, s46, -v185
    v_exp_f32 v176, v176
    v_mfma_f32_32x32x16_bf16 v[128:143], a[72:75], a[40:43], v[128:143]
    ds_read_b64_tr_b16 a[104:105], v206 offset:49152
    ds_read_b64_tr_b16 a[106:107], v206 offset:53248
    v_add_f32 v186, v186, v174
    v_exp_f32 v177, v177
    v_add_f32 v187, v187, v175
    v_mfma_f32_32x32x16_bf16 v[128:143], a[76:79], a[44:47], v[128:143]
    ds_read_b64_tr_b16 a[108:109], v207 offset:49152
    ds_read_b64_tr_b16 a[110:111], v207 offset:53248
    v_cvt_pk_bf16_f32 v163, v174, v175
    v_fma_f32 v178, v154, s46, -v185
    v_fma_f32 v179, v155, s46, -v185
    s_waitcnt lgkmcnt(8)
    v_mfma_f32_32x32x16_bf16 v[128:143], a[80:83], a[48:51], v[128:143]
    buffer_load_dwordx4 v251, s[12:15], s47 offen offset:1024 lds
    ds_read_b64_tr_b16 a[112:113], v204 offset:49408
    ds_read_b64_tr_b16 a[114:115], v204 offset:53504
    v_exp_f32 v178, v178
    v_add_f32 v186, v186, v176
    v_mfma_f32_32x32x16_bf16 v[128:143], a[84:87], a[52:55], v[128:143]
    ds_read_b64_tr_b16 a[116:117], v205 offset:49408
    ds_read_b64_tr_b16 a[118:119], v205 offset:53504
    v_exp_f32 v179, v179
    v_add_f32 v187, v187, v177
    v_cvt_pk_bf16_f32 v164, v176, v177
    v_mfma_f32_32x32x16_bf16 v[128:143], a[88:91], a[56:59], v[128:143]
    ds_read_b64_tr_b16 a[120:121], v206 offset:49408
    ds_read_b64_tr_b16 a[122:123], v206 offset:53504
    v_fma_f32 v180, v156, s46, -v185
    v_fma_f32 v181, v157, s46, -v185
    v_exp_f32 v180, v180
    v_mfma_f32_32x32x16_bf16 v[128:143], a[92:95], a[60:63], v[128:143]
    ds_read_b64_tr_b16 a[124:125], v207 offset:49408
    ds_read_b64_tr_b16 a[126:127], v207 offset:53504
    v_add_f32 v186, v186, v178
    v_exp_f32 v181, v181
    s_waitcnt lgkmcnt(8)
    v_mfma_f32_32x32x16_bf16 v[0:15], a[96:99], v[160:163], v[0:15]
    buffer_load_dwordx4 v252, s[12:15], s47 offen offset:2048 lds
    ds_read_b64_tr_b16 a[96:97], v204 offset:57344
    ds_read_b64_tr_b16 a[98:99], v204 offset:61440
    v_add_f32 v187, v187, v179
    v_cvt_pk_bf16_f32 v165, v178, v179
    v_fma_f32 v182, v158, s46, -v185
    v_mfma_f32_32x32x16_bf16 v[16:31], a[100:103], v[160:163], v[16:31]
    ds_read_b64_tr_b16 a[100:101], v205 offset:57344
    ds_read_b64_tr_b16 a[102:103], v205 offset:61440
    v_fma_f32 v183, v159, s46, -v185
    v_exp_f32 v182, v182
    v_add_f32 v186, v186, v180
    v_mfma_f32_32x32x16_bf16 v[32:47], a[104:107], v[160:163], v[32:47]
    ds_read_b64_tr_b16 a[104:105], v206 offset:57344
    ds_read_b64_tr_b16 a[106:107], v206 offset:61440
    v_exp_f32 v183, v183
    v_add_f32 v187, v187, v181
    v_cvt_pk_bf16_f32 v166, v180, v181
    v_mfma_f32_32x32x16_bf16 v[48:63], a[108:111], v[160:163], v[48:63]
    ds_read_b64_tr_b16 a[108:109], v207 offset:57344
    ds_read_b64_tr_b16 a[110:111], v207 offset:61440
    v_add_f32 v186, v186, v182
    v_add_f32 v187, v187, v183
    v_cvt_pk_bf16_f32 v167, v182, v183
    s_waitcnt lgkmcnt(8)
    v_mfma_f32_32x32x16_bf16 v[64:79], a[112:115], v[160:163], v[64:79]
    buffer_load_dwordx4 v253, s[12:15], s47 offen offset:3072 lds
    ds_read_b64_tr_b16 a[112:113], v204 offset:57600
    ds_read_b64_tr_b16 a[114:115], v204 offset:61696
    s_add_u32 m0, s49, 131072
    s_add_u32 s34, s35, 3440640
    buffer_load_dwordx4 v245, s[8:11], s34 offen lds
    v_max3_f32 v191, v128, v129, v130
    v_mfma_f32_32x32x16_bf16 v[80:95], a[116:119], v[160:163], v[80:95]
    ds_read_b64_tr_b16 a[116:117], v205 offset:57600
    ds_read_b64_tr_b16 a[118:119], v205 offset:61696
    s_add_u32 m0, s49, 132096
    s_add_u32 s34, s35, 3447808
    buffer_load_dwordx4 v245, s[8:11], s34 offen lds
    v_max3_f32 v192, v131, v132, v133
    v_max3_f32 v193, v134, v135, v136
    v_mfma_f32_32x32x16_bf16 v[96:111], a[120:123], v[160:163], v[96:111]
    ds_read_b64_tr_b16 a[120:121], v206 offset:57600
    ds_read_b64_tr_b16 a[122:123], v206 offset:61696
    s_add_u32 m0, s49, 133120
    s_add_u32 s34, s35, 3454976
    buffer_load_dwordx4 v245, s[8:11], s34 offen lds
    s_add_u32 m0, s49, 134144
    s_add_u32 s34, s35, 3462144
    buffer_load_dwordx4 v245, s[8:11], s34 offen lds
    v_mfma_f32_32x32x16_bf16 v[112:127], a[124:127], v[160:163], v[112:127]
    s_waitcnt vmcnt(12)
    s_barrier
    ds_read_b64_tr_b16 a[124:125], v207 offset:57600
    ds_read_b64_tr_b16 a[126:127], v207 offset:61696
    v_max3_f32 v194, v137, v138, v139
    s_waitcnt lgkmcnt(8)
    v_mfma_f32_32x32x16_bf16 v[0:15], a[96:99], v[164:167], v[0:15]
    s_add_u32 m0, s49, 98304
    s_add_u32 s48, s48, 16384
    s_and_b32 s48, s48, 0xfffff
    buffer_load_dwordx4 v254, s[16:19], s48 offen offset:0 lds
    ds_read_b128 a[64:67], v196 offset:16384
    ds_read_b64_tr_b16 a[208:209], v246 offset:16384
    v_mfma_f32_32x32x16_bf16 v[16:31], a[100:103], v[164:167], v[16:31]
    ds_read_b128 a[68:71], v197 offset:16384
    ds_read_b64_tr_b16 a[210:211], v246 offset:16896
    s_add_u32 m0, s49, 0
    s_add_u32 s34, s35, 1835008
    buffer_load_dwordx4 v245, s[8:11], s34 offen lds
    v_max3_f32 v195, v140, v141, v142
    v_max3_f32 v191, v191, v192, v193
    v_mfma_f32_32x32x16_bf16 v[32:47], a[104:107], v[164:167], v[32:47]
    ds_read_b128 a[72:75], v198 offset:16384
    ds_read_b64_tr_b16 a[212:213], v247 offset:16384
    v_max3_f32 v194, v194, v195, v143
    v_max_f32 v189, v191, v194
    v_cmp_gt_f32 vcc, v189, v188
    v_mfma_f32_32x32x16_bf16 v[48:63], a[108:111], v[164:167], v[48:63]
    ds_read_b128 a[76:79], v199 offset:16384
    ds_read_b64_tr_b16 a[214:215], v247 offset:16896
    s_add_u32 m0, s49, 1024
    s_add_u32 s34, s35, 1842176
    buffer_load_dwordx4 v245, s[8:11], s34 offen lds
    s_waitcnt lgkmcnt(8)
    v_mfma_f32_32x32x16_bf16 v[64:79], a[112:115], v[164:167], v[64:79]
    s_add_u32 m0, s49, 98304
    s_nop 0
    buffer_load_dwordx4 v255, s[16:19], s48 offen offset:1024 lds
    ds_read_b128 a[80:83], v200 offset:16384
    ds_read_b64_tr_b16 a[216:217], v246 offset:18432
    v_mfma_f32_32x32x16_bf16 v[80:95], a[116:119], v[164:167], v[80:95]
    ds_read_b128 a[84:87], v201 offset:16384
    ds_read_b64_tr_b16 a[218:219], v246 offset:18944
    s_add_u32 m0, s49, 2048
    s_add_u32 s34, s35, 1849344
    buffer_load_dwordx4 v245, s[8:11], s34 offen lds
    v_mfma_f32_32x32x16_bf16 v[96:111], a[120:123], v[164:167], v[96:111]
    ds_read_b128 a[88:91], v202 offset:16384
    ds_read_b64_tr_b16 a[220:221], v247 offset:18432
    v_mfma_f32_32x32x16_bf16 v[112:127], a[124:127], v[164:167], v[112:127]
    ds_read_b128 a[92:95], v203 offset:16384
    ds_read_b64_tr_b16 a[222:223], v247 offset:18944
    s_add_u32 m0, s49, 3072
    s_add_u32 s34, s35, 1856512
    buffer_load_dwordx4 v245, s[8:11], s34 offen lds
    s_cbranch_vccnz ATT_RSp_6
ATT_BKp_6:
    s_waitcnt lgkmcnt(9)
    v_mfma_f32_32x32x16_bf16 v[144:159], a[64:67], a[0:3], 0
    s_add_u32 m0, s49, 98304
    s_nop 0
    buffer_load_dwordx4 v254, s[16:19], s48 offen offset:2048 lds
    ds_read_b128 a[64:67], v196 offset:16640
    v_fma_f32 v168, v128, s46, -v185
    v_fma_f32 v169, v129, s46, -v185
    v_exp_f32 v168, v168
    v_mfma_f32_32x32x16_bf16 v[144:159], a[68:71], a[4:7], v[144:159]
    ds_read_b128 a[68:71], v197 offset:16640
    v_exp_f32 v169, v169
    v_fma_f32 v170, v130, s46, -v185
    v_fma_f32 v171, v131, s46, -v185
    v_mfma_f32_32x32x16_bf16 v[144:159], a[72:75], a[8:11], v[144:159]
    ds_read_b128 a[72:75], v198 offset:16640
    v_exp_f32 v170, v170
    v_add_f32 v186, v186, v168
    v_exp_f32 v171, v171
    v_mfma_f32_32x32x16_bf16 v[144:159], a[76:79], a[12:15], v[144:159]
    ds_read_b128 a[76:79], v199 offset:16640
    v_add_f32 v187, v187, v169
    v_cvt_pk_bf16_f32 v160, v168, v169
    v_fma_f32 v172, v132, s46, -v185
    v_fma_f32 v173, v133, s46, -v185
    s_waitcnt lgkmcnt(5)
    v_mfma_f32_32x32x16_bf16 v[144:159], a[80:83], a[16:19], v[144:159]
    buffer_load_dwordx4 v255, s[16:19], s48 offen offset:3072 lds
    ds_read_b128 a[80:83], v200 offset:16640
    v_exp_f32 v172, v172
    v_add_f32 v186, v186, v170
    v_mfma_f32_32x32x16_bf16 v[144:159], a[84:87], a[20:23], v[144:159]
    ds_read_b128 a[84:87], v201 offset:16640
    v_exp_f32 v173, v173
    v_add_f32 v187, v187, v171
    v_cvt_pk_bf16_f32 v161, v170, v171
    v_fma_f32 v174, v134, s46, -v185
    v_mfma_f32_32x32x16_bf16 v[144:159], a[88:91], a[24:27], v[144:159]
    ds_read_b128 a[88:91], v202 offset:16640
    v_fma_f32 v175, v135, s46, -v185
    v_exp_f32 v174, v174
    v_add_f32 v186, v186, v172
    v_mfma_f32_32x32x16_bf16 v[144:159], a[92:95], a[28:31], v[144:159]
    ds_read_b128 a[92:95], v203 offset:16640
    v_exp_f32 v175, v175
    v_add_f32 v187, v187, v173
    v_cvt_pk_bf16_f32 v162, v172, v173
    s_waitcnt lgkmcnt(4)
    v_mfma_f32_32x32x16_bf16 v[144:159], a[64:67], a[32:35], v[144:159]
    ds_read_b64_tr_b16 a[96:97], v204 offset:0
    ds_read_b64_tr_b16 a[98:99], v204 offset:4096
    v_fma_f32 v176, v136, s46, -v185
    v_fma_f32 v177, v137, s46, -v185
    v_exp_f32 v176, v176
    v_mfma_f32_32x32x16_bf16 v[144:159], a[68:71], a[36:39], v[144:159]
    ds_read_b64_tr_b16 a[100:101], v205 offset:0
    ds_read_b64_tr_b16 a[102:103], v205 offset:4096
    v_add_f32 v186, v186, v174
    v_exp_f32 v177, v177
    v_add_f32 v187, v187, v175
    v_mfma_f32_32x32x16_bf16 v[144:159], a[72:75], a[40:43], v[144:159]
    ds_read_b64_tr_b16 a[104:105], v206 offset:0
    ds_read_b64_tr_b16 a[106:107], v206 offset:4096
    v_cvt_pk_bf16_f32 v163, v174, v175
    v_fma_f32 v178, v138, s46, -v185
    v_fma_f32 v179, v139, s46, -v185
    v_mfma_f32_32x32x16_bf16 v[144:159], a[76:79], a[44:47], v[144:159]
    ds_read_b64_tr_b16 a[108:109], v207 offset:0
    ds_read_b64_tr_b16 a[110:111], v207 offset:4096
    v_exp_f32 v178, v178
    v_add_f32 v186, v186, v176
    s_waitcnt lgkmcnt(8)
    v_mfma_f32_32x32x16_bf16 v[144:159], a[80:83], a[48:51], v[144:159]
    ds_read_b64_tr_b16 a[112:113], v204 offset:256
    ds_read_b64_tr_b16 a[114:115], v204 offset:4352
    v_exp_f32 v179, v179
    v_add_f32 v187, v187, v177
    v_cvt_pk_bf16_f32 v164, v176, v177
    v_mfma_f32_32x32x16_bf16 v[144:159], a[84:87], a[52:55], v[144:159]
    ds_read_b64_tr_b16 a[116:117], v205 offset:256
    ds_read_b64_tr_b16 a[118:119], v205 offset:4352
    v_fma_f32 v180, v140, s46, -v185
    v_fma_f32 v181, v141, s46, -v185
    v_exp_f32 v180, v180
    v_mfma_f32_32x32x16_bf16 v[144:159], a[88:91], a[56:59], v[144:159]
    ds_read_b64_tr_b16 a[120:121], v206 offset:256
    ds_read_b64_tr_b16 a[122:123], v206 offset:4352
    v_add_f32 v186, v186, v178
    v_exp_f32 v181, v181
    v_add_f32 v187, v187, v179
    v_mfma_f32_32x32x16_bf16 v[144:159], a[92:95], a[60:63], v[144:159]
    ds_read_b64_tr_b16 a[124:125], v207 offset:256
    ds_read_b64_tr_b16 a[126:127], v207 offset:4352
    v_cvt_pk_bf16_f32 v165, v178, v179
    v_fma_f32 v182, v142, s46, -v185
    v_fma_f32 v183, v143, s46, -v185
    s_waitcnt lgkmcnt(8)
    v_mfma_f32_32x32x16_bf16 v[0:15], a[96:99], v[160:163], v[0:15]
    ds_read_b64_tr_b16 a[96:97], v204 offset:8192
    ds_read_b64_tr_b16 a[98:99], v204 offset:12288
    v_exp_f32 v182, v182
    v_add_f32 v186, v186, v180
    v_mfma_f32_32x32x16_bf16 v[16:31], a[100:103], v[160:163], v[16:31]
    ds_read_b64_tr_b16 a[100:101], v205 offset:8192
    ds_read_b64_tr_b16 a[102:103], v205 offset:12288
    v_exp_f32 v183, v183
    v_add_f32 v187, v187, v181
    v_cvt_pk_bf16_f32 v166, v180, v181
    v_mfma_f32_32x32x16_bf16 v[32:47], a[104:107], v[160:163], v[32:47]
    ds_read_b64_tr_b16 a[104:105], v206 offset:8192
    ds_read_b64_tr_b16 a[106:107], v206 offset:12288
    v_add_f32 v186, v186, v182
    v_add_f32 v187, v187, v183
    v_cvt_pk_bf16_f32 v167, v182, v183
    v_mfma_f32_32x32x16_bf16 v[48:63], a[108:111], v[160:163], v[48:63]
    ds_read_b64_tr_b16 a[108:109], v207 offset:8192
    ds_read_b64_tr_b16 a[110:111], v207 offset:12288
    v_max3_f32 v191, v144, v145, v146
    v_max3_f32 v192, v147, v148, v149
    v_max3_f32 v193, v150, v151, v152
    s_waitcnt lgkmcnt(8)
    v_mfma_f32_32x32x16_bf16 v[64:79], a[112:115], v[160:163], v[64:79]
    ds_read_b64_tr_b16 a[112:113], v204 offset:8448
    ds_read_b64_tr_b16 a[114:115], v204 offset:12544
    s_add_u32 m0, s49, 147456
    s_add_u32 s34, s35, 3555328
    buffer_load_dwordx4 v245, s[8:11], s34 offen lds
    v_max3_f32 v194, v153, v154, v155
    v_max3_f32 v195, v156, v157, v158
    v_mfma_f32_32x32x16_bf16 v[80:95], a[116:119], v[160:163], v[80:95]
    ds_read_b64_tr_b16 a[116:117], v205 offset:8448
    ds_read_b64_tr_b16 a[118:119], v205 offset:12544
    s_add_u32 m0, s49, 148480
    s_add_u32 s34, s35, 3562496
    buffer_load_dwordx4 v245, s[8:11], s34 offen lds
    v_max3_f32 v191, v191, v192, v193
    v_max3_f32 v194, v194, v195, v159
    v_mfma_f32_32x32x16_bf16 v[96:111], a[120:123], v[160:163], v[96:111]
    ds_read_b64_tr_b16 a[120:121], v206 offset:8448
    ds_read_b64_tr_b16 a[122:123], v206 offset:12544
    s_add_u32 m0, s49, 149504
    s_add_u32 s34, s35, 3569664
    buffer_load_dwordx4 v245, s[8:11], s34 offen lds
    s_add_u32 m0, s49, 150528
    s_add_u32 s34, s35, 3576832
    buffer_load_dwordx4 v245, s[8:11], s34 offen lds
    v_mfma_f32_32x32x16_bf16 v[112:127], a[124:127], v[160:163], v[112:127]
    s_waitcnt vmcnt(12)
    s_barrier
    ds_read_b64_tr_b16 a[124:125], v207 offset:8448
    ds_read_b64_tr_b16 a[126:127], v207 offset:12544
    v_max_f32 v189, v191, v194
    s_waitcnt lgkmcnt(8)
    v_mfma_f32_32x32x16_bf16 v[0:15], a[96:99], v[164:167], v[0:15]
    s_add_u32 m0, s49, 114688
    s_add_u32 s48, s48, 16384
    s_and_b32 s48, s48, 0xfffff
    buffer_load_dwordx4 v254, s[16:19], s48 offen offset:0 lds
    ds_read_b128 a[64:67], v196 offset:32768
    ds_read_b64_tr_b16 a[224:225], v246 offset:0
    v_mfma_f32_32x32x16_bf16 v[16:31], a[100:103], v[164:167], v[16:31]
    ds_read_b128 a[68:71], v197 offset:32768
    ds_read_b64_tr_b16 a[226:227], v246 offset:512
    s_add_u32 m0, s49, 16384
    s_add_u32 s34, s35, 1949696
    buffer_load_dwordx4 v245, s[8:11], s34 offen lds
    v_cmp_gt_f32 vcc, v189, v188
    v_mfma_f32_32x32x16_bf16 v[32:47], a[104:107], v[164:167], v[32:47]
    ds_read_b128 a[72:75], v198 offset:32768
    ds_read_b64_tr_b16 a[228:229], v247 offset:0
    v_mfma_f32_32x32x16_bf16 v[48:63], a[108:111], v[164:167], v[48:63]
    ds_read_b128 a[76:79], v199 offset:32768
    ds_read_b64_tr_b16 a[230:231], v247 offset:512
    s_add_u32 m0, s49, 17408
    s_add_u32 s34, s35, 1956864
    buffer_load_dwordx4 v245, s[8:11], s34 offen lds
    s_waitcnt lgkmcnt(8)
    v_mfma_f32_32x32x16_bf16 v[64:79], a[112:115], v[164:167], v[64:79]
    s_add_u32 m0, s49, 114688
    s_nop 0
    buffer_load_dwordx4 v255, s[16:19], s48 offen offset:1024 lds
    ds_read_b128 a[80:83], v200 offset:32768
    ds_read_b64_tr_b16 a[232:233], v246 offset:2048
    v_mfma_f32_32x32x16_bf16 v[80:95], a[116:119], v[164:167], v[80:95]
    ds_read_b128 a[84:87], v201 offset:32768
    ds_read_b64_tr_b16 a[234:235], v246 offset:2560
    s_add_u32 m0, s49, 18432
    s_add_u32 s34, s35, 1964032
    buffer_load_dwordx4 v245, s[8:11], s34 offen lds
    v_mfma_f32_32x32x16_bf16 v[96:111], a[120:123], v[164:167], v[96:111]
    ds_read_b128 a[88:91], v202 offset:32768
    ds_read_b64_tr_b16 a[236:237], v247 offset:2048
    v_mfma_f32_32x32x16_bf16 v[112:127], a[124:127], v[164:167], v[112:127]
    ds_read_b128 a[92:95], v203 offset:32768
    ds_read_b64_tr_b16 a[238:239], v247 offset:2560
    s_add_u32 m0, s49, 19456
    s_add_u32 s34, s35, 1971200
    buffer_load_dwordx4 v245, s[8:11], s34 offen lds
    s_cbranch_vccnz ATT_RSp_7
ATT_BKp_7:
    s_waitcnt lgkmcnt(9)
    v_mfma_f32_32x32x16_bf16 v[128:143], a[64:67], a[0:3], 0
    s_add_u32 m0, s49, 114688
    s_nop 0
    buffer_load_dwordx4 v254, s[16:19], s48 offen offset:2048 lds
    ds_read_b128 a[64:67], v196 offset:33024
    v_fma_f32 v168, v144, s46, -v185
    v_fma_f32 v169, v145, s46, -v185
    v_exp_f32 v168, v168
    v_mfma_f32_32x32x16_bf16 v[128:143], a[68:71], a[4:7], v[128:143]
    ds_read_b128 a[68:71], v197 offset:33024
    v_exp_f32 v169, v169
    v_fma_f32 v170, v146, s46, -v185
    v_fma_f32 v171, v147, s46, -v185
    v_mfma_f32_32x32x16_bf16 v[128:143], a[72:75], a[8:11], v[128:143]
    ds_read_b128 a[72:75], v198 offset:33024
    v_exp_f32 v170, v170
    v_add_f32 v186, v186, v168
    v_exp_f32 v171, v171
    v_mfma_f32_32x32x16_bf16 v[128:143], a[76:79], a[12:15], v[128:143]
    ds_read_b128 a[76:79], v199 offset:33024
    v_add_f32 v187, v187, v169
    v_cvt_pk_bf16_f32 v160, v168, v169
    v_fma_f32 v172, v148, s46, -v185
    v_fma_f32 v173, v149, s46, -v185
    s_waitcnt lgkmcnt(5)
    v_mfma_f32_32x32x16_bf16 v[128:143], a[80:83], a[16:19], v[128:143]
    buffer_load_dwordx4 v255, s[16:19], s48 offen offset:3072 lds
    ds_read_b128 a[80:83], v200 offset:33024
    v_exp_f32 v172, v172
    v_add_f32 v186, v186, v170
    v_mfma_f32_32x32x16_bf16 v[128:143], a[84:87], a[20:23], v[128:143]
    ds_read_b128 a[84:87], v201 offset:33024
    v_exp_f32 v173, v173
    v_add_f32 v187, v187, v171
    v_cvt_pk_bf16_f32 v161, v170, v171
    v_fma_f32 v174, v150, s46, -v185
    v_mfma_f32_32x32x16_bf16 v[128:143], a[88:91], a[24:27], v[128:143]
    ds_read_b128 a[88:91], v202 offset:33024
    v_fma_f32 v175, v151, s46, -v185
    v_exp_f32 v174, v174
    v_add_f32 v186, v186, v172
    v_mfma_f32_32x32x16_bf16 v[128:143], a[92:95], a[28:31], v[128:143]
    ds_read_b128 a[92:95], v203 offset:33024
    v_exp_f32 v175, v175
    v_add_f32 v187, v187, v173
    v_cvt_pk_bf16_f32 v162, v172, v173
    s_waitcnt lgkmcnt(4)
    v_mfma_f32_32x32x16_bf16 v[128:143], a[64:67], a[32:35], v[128:143]
    ds_read_b64_tr_b16 a[96:97], v204 offset:16384
    ds_read_b64_tr_b16 a[98:99], v204 offset:20480
    v_fma_f32 v176, v152, s46, -v185
    v_fma_f32 v177, v153, s46, -v185
    v_exp_f32 v176, v176
    v_mfma_f32_32x32x16_bf16 v[128:143], a[68:71], a[36:39], v[128:143]
    ds_read_b64_tr_b16 a[100:101], v205 offset:16384
    ds_read_b64_tr_b16 a[102:103], v205 offset:20480
    v_add_f32 v186, v186, v174
    v_exp_f32 v177, v177
    v_add_f32 v187, v187, v175
    v_mfma_f32_32x32x16_bf16 v[128:143], a[72:75], a[40:43], v[128:143]
    ds_read_b64_tr_b16 a[104:105], v206 offset:16384
    ds_read_b64_tr_b16 a[106:107], v206 offset:20480
    v_cvt_pk_bf16_f32 v163, v174, v175
    v_fma_f32 v178, v154, s46, -v185
    v_fma_f32 v179, v155, s46, -v185
    v_mfma_f32_32x32x16_bf16 v[128:143], a[76:79], a[44:47], v[128:143]
    ds_read_b64_tr_b16 a[108:109], v207 offset:16384
    ds_read_b64_tr_b16 a[110:111], v207 offset:20480
    v_exp_f32 v178, v178
    v_add_f32 v186, v186, v176
    s_waitcnt lgkmcnt(8)
    v_mfma_f32_32x32x16_bf16 v[128:143], a[80:83], a[48:51], v[128:143]
    ds_read_b64_tr_b16 a[112:113], v204 offset:16640
    ds_read_b64_tr_b16 a[114:115], v204 offset:20736
    v_exp_f32 v179, v179
    v_add_f32 v187, v187, v177
    v_cvt_pk_bf16_f32 v164, v176, v177
    v_mfma_f32_32x32x16_bf16 v[128:143], a[84:87], a[52:55], v[128:143]
    ds_read_b64_tr_b16 a[116:117], v205 offset:16640
    ds_read_b64_tr_b16 a[118:119], v205 offset:20736
    v_fma_f32 v180, v156, s46, -v185
    v_fma_f32 v181, v157, s46, -v185
    v_exp_f32 v180, v180
    v_mfma_f32_32x32x16_bf16 v[128:143], a[88:91], a[56:59], v[128:143]
    ds_read_b64_tr_b16 a[120:121], v206 offset:16640
    ds_read_b64_tr_b16 a[122:123], v206 offset:20736
    v_add_f32 v186, v186, v178
    v_exp_f32 v181, v181
    v_add_f32 v187, v187, v179
    v_mfma_f32_32x32x16_bf16 v[128:143], a[92:95], a[60:63], v[128:143]
    ds_read_b64_tr_b16 a[124:125], v207 offset:16640
    ds_read_b64_tr_b16 a[126:127], v207 offset:20736
    v_cvt_pk_bf16_f32 v165, v178, v179
    v_fma_f32 v182, v158, s46, -v185
    v_fma_f32 v183, v159, s46, -v185
    s_waitcnt lgkmcnt(8)
    v_mfma_f32_32x32x16_bf16 v[0:15], a[96:99], v[160:163], v[0:15]
    ds_read_b64_tr_b16 a[96:97], v204 offset:24576
    ds_read_b64_tr_b16 a[98:99], v204 offset:28672
    v_exp_f32 v182, v182
    v_add_f32 v186, v186, v180
    v_mfma_f32_32x32x16_bf16 v[16:31], a[100:103], v[160:163], v[16:31]
    ds_read_b64_tr_b16 a[100:101], v205 offset:24576
    ds_read_b64_tr_b16 a[102:103], v205 offset:28672
    v_exp_f32 v183, v183
    v_add_f32 v187, v187, v181
    v_cvt_pk_bf16_f32 v166, v180, v181
    v_mfma_f32_32x32x16_bf16 v[32:47], a[104:107], v[160:163], v[32:47]
    ds_read_b64_tr_b16 a[104:105], v206 offset:24576
    ds_read_b64_tr_b16 a[106:107], v206 offset:28672
    v_add_f32 v186, v186, v182
    v_add_f32 v187, v187, v183
    v_cvt_pk_bf16_f32 v167, v182, v183
    v_mfma_f32_32x32x16_bf16 v[48:63], a[108:111], v[160:163], v[48:63]
    ds_read_b64_tr_b16 a[108:109], v207 offset:24576
    ds_read_b64_tr_b16 a[110:111], v207 offset:28672
    v_max3_f32 v191, v128, v129, v130
    v_max3_f32 v192, v131, v132, v133
    v_max3_f32 v193, v134, v135, v136
    s_waitcnt lgkmcnt(8)
    v_mfma_f32_32x32x16_bf16 v[64:79], a[112:115], v[160:163], v[64:79]
    ds_read_b64_tr_b16 a[112:113], v204 offset:24832
    ds_read_b64_tr_b16 a[114:115], v204 offset:28928
    s_add_u32 m0, s49, 131072
    s_add_u32 s34, s35, 2523136
    buffer_load_dwordx4 v245, s[8:11], s34 offen lds
    v_max3_f32 v194, v137, v138, v139
    v_max3_f32 v195, v140, v141, v142
    v_mfma_f32_32x32x16_bf16 v[80:95], a[116:119], v[160:163], v[80:95]
    ds_read_b64_tr_b16 a[116:117], v205 offset:24832
    ds_read_b64_tr_b16 a[118:119], v205 offset:28928
    s_add_u32 m0, s49, 132096
    s_add_u32 s34, s35, 2530304
    buffer_load_dwordx4 v245, s[8:11], s34 offen lds
    v_max3_f32 v191, v191, v192, v193
    v_max3_f32 v194, v194, v195, v143
    v_mfma_f32_32x32x16_bf16 v[96:111], a[120:123], v[160:163], v[96:111]
    ds_read_b64_tr_b16 a[120:121], v206 offset:24832
    ds_read_b64_tr_b16 a[122:123], v206 offset:28928
    s_add_u32 m0, s49, 133120
    s_add_u32 s34, s35, 2537472
    buffer_load_dwordx4 v245, s[8:11], s34 offen lds
    s_add_u32 m0, s49, 134144
    s_add_u32 s34, s35, 2544640
    buffer_load_dwordx4 v245, s[8:11], s34 offen lds
    v_mfma_f32_32x32x16_bf16 v[112:127], a[124:127], v[160:163], v[112:127]
    s_waitcnt vmcnt(12)
    s_barrier
    ds_read_b64_tr_b16 a[124:125], v207 offset:24832
    ds_read_b64_tr_b16 a[126:127], v207 offset:28928
    v_max_f32 v189, v191, v194
    s_waitcnt lgkmcnt(8)
    v_mfma_f32_32x32x16_bf16 v[0:15], a[96:99], v[164:167], v[0:15]
    ds_read_b128 a[64:67], v196 offset:49152
    ds_read_b64_tr_b16 a[240:241], v246 offset:16384
    s_add_u32 m0, s49, 32768
    s_add_u32 s34, s35, 2064384
    buffer_load_dwordx4 v245, s[8:11], s34 offen lds
    v_cmp_gt_f32 vcc, v189, v188
    v_mfma_f32_32x32x16_bf16 v[16:31], a[100:103], v[164:167], v[16:31]
    ds_read_b128 a[68:71], v197 offset:49152
    ds_read_b64_tr_b16 a[242:243], v246 offset:16896
    s_add_u32 m0, s49, 33792
    s_add_u32 s34, s35, 2071552
    buffer_load_dwordx4 v245, s[8:11], s34 offen lds
    v_mfma_f32_32x32x16_bf16 v[32:47], a[104:107], v[164:167], v[32:47]
    ds_read_b128 a[72:75], v198 offset:49152
    ds_read_b64_tr_b16 a[244:245], v247 offset:16384
    s_add_u32 m0, s49, 34816
    s_add_u32 s34, s35, 2078720
    buffer_load_dwordx4 v245, s[8:11], s34 offen lds
    v_mfma_f32_32x32x16_bf16 v[48:63], a[108:111], v[164:167], v[48:63]
    ds_read_b128 a[76:79], v199 offset:49152
    ds_read_b64_tr_b16 a[246:247], v247 offset:16896
    s_add_u32 m0, s49, 35840
    s_add_u32 s34, s35, 2085888
    buffer_load_dwordx4 v245, s[8:11], s34 offen lds
    s_waitcnt lgkmcnt(8)
    v_mfma_f32_32x32x16_bf16 v[64:79], a[112:115], v[164:167], v[64:79]
    ds_read_b128 a[80:83], v200 offset:49152
    ds_read_b64_tr_b16 a[248:249], v246 offset:18432
    s_add_u32 m0, s49, 65536
    s_add_u32 s34, s35, 2179072
    buffer_load_dwordx4 v245, s[8:11], s34 offen lds
    v_mfma_f32_32x32x16_bf16 v[80:95], a[116:119], v[164:167], v[80:95]
    ds_read_b128 a[84:87], v201 offset:49152
    ds_read_b64_tr_b16 a[250:251], v246 offset:18944
    s_add_u32 m0, s49, 66560
    s_add_u32 s34, s35, 2186240
    buffer_load_dwordx4 v245, s[8:11], s34 offen lds
    v_mfma_f32_32x32x16_bf16 v[96:111], a[120:123], v[164:167], v[96:111]
    ds_read_b128 a[88:91], v202 offset:49152
    ds_read_b64_tr_b16 a[252:253], v247 offset:18432
    s_add_u32 m0, s49, 67584
    s_add_u32 s34, s35, 2193408
    buffer_load_dwordx4 v245, s[8:11], s34 offen lds
    v_mfma_f32_32x32x16_bf16 v[112:127], a[124:127], v[164:167], v[112:127]
    ds_read_b128 a[92:95], v203 offset:49152
    ds_read_b64_tr_b16 a[254:255], v247 offset:18944
    s_add_u32 m0, s49, 68608
    s_add_u32 s34, s35, 2200576
    buffer_load_dwordx4 v245, s[8:11], s34 offen lds
    s_cbranch_vccnz ATT_RSp_8
ATT_BKp_8:
    s_waitcnt lgkmcnt(9)
    v_mfma_f32_32x32x16_bf16 v[144:159], a[64:67], a[0:3], 0
    ds_read_b128 a[64:67], v196 offset:49408
    v_fma_f32 v168, v128, s46, -v185
    v_fma_f32 v169, v129, s46, -v185
    v_exp_f32 v168, v168
    v_mfma_f32_32x32x16_bf16 v[144:159], a[68:71], a[4:7], v[144:159]
    ds_read_b128 a[68:71], v197 offset:49408
    v_exp_f32 v169, v169
    v_fma_f32 v170, v130, s46, -v185
    v_fma_f32 v171, v131, s46, -v185
    v_mfma_f32_32x32x16_bf16 v[144:159], a[72:75], a[8:11], v[144:159]
    ds_read_b128 a[72:75], v198 offset:49408
    v_exp_f32 v170, v170
    v_add_f32 v186, v186, v168
    v_exp_f32 v171, v171
    v_mfma_f32_32x32x16_bf16 v[144:159], a[76:79], a[12:15], v[144:159]
    ds_read_b128 a[76:79], v199 offset:49408
    v_add_f32 v187, v187, v169
    v_cvt_pk_bf16_f32 v160, v168, v169
    v_fma_f32 v172, v132, s46, -v185
    v_fma_f32 v173, v133, s46, -v185
    s_waitcnt lgkmcnt(5)
    v_mfma_f32_32x32x16_bf16 v[144:159], a[80:83], a[16:19], v[144:159]
    ds_read_b128 a[80:83], v200 offset:49408
    v_exp_f32 v172, v172
    v_add_f32 v186, v186, v170
    v_exp_f32 v173, v173
    v_mfma_f32_32x32x16_bf16 v[144:159], a[84:87], a[20:23], v[144:159]
    ds_read_b128 a[84:87], v201 offset:49408
    v_add_f32 v187, v187, v171
    v_cvt_pk_bf16_f32 v161, v170, v171
    v_fma_f32 v174, v134, s46, -v185
    v_fma_f32 v175, v135, s46, -v185
    v_mfma_f32_32x32x16_bf16 v[144:159], a[88:91], a[24:27], v[144:159]
    ds_read_b128 a[88:91], v202 offset:49408
    v_exp_f32 v174, v174
    v_add_f32 v186, v186, v172
    v_exp_f32 v175, v175
    v_mfma_f32_32x32x16_bf16 v[144:159], a[92:95], a[28:31], v[144:159]
    ds_read_b128 a[92:95], v203 offset:49408
    v_add_f32 v187, v187, v173
    v_cvt_pk_bf16_f32 v162, v172, v173
    v_fma_f32 v176, v136, s46, -v185
    v_fma_f32 v177, v137, s46, -v185
    s_waitcnt lgkmcnt(4)
    v_mfma_f32_32x32x16_bf16 v[144:159], a[64:67], a[32:35], v[144:159]
    ds_read_b64_tr_b16 a[96:97], v204 offset:32768
    ds_read_b64_tr_b16 a[98:99], v204 offset:36864
    v_exp_f32 v176, v176
    v_add_f32 v186, v186, v174
    v_mfma_f32_32x32x16_bf16 v[144:159], a[68:71], a[36:39], v[144:159]
    ds_read_b64_tr_b16 a[100:101], v205 offset:32768
    ds_read_b64_tr_b16 a[102:103], v205 offset:36864
    v_exp_f32 v177, v177
    v_add_f32 v187, v187, v175
    v_cvt_pk_bf16_f32 v163, v174, v175
    v_mfma_f32_32x32x16_bf16 v[144:159], a[72:75], a[40:43], v[144:159]
    ds_read_b64_tr_b16 a[104:105], v206 offset:32768
    ds_read_b64_tr_b16 a[106:107], v206 offset:36864
    v_fma_f32 v178, v138, s46, -v185
    v_fma_f32 v179, v139, s46, -v185
    v_exp_f32 v178, v178
    v_mfma_f32_32x32x16_bf16 v[144:159], a[76:79], a[44:47], v[144:159]
    ds_read_b64_tr_b16 a[108:109], v207 offset:32768
    ds_read_b64_tr_b16 a[110:111], v207 offset:36864
    v_add_f32 v186, v186, v176
    v_exp_f32 v179, v179
    s_waitcnt lgkmcnt(8)
    v_mfma_f32_32x32x16_bf16 v[144:159], a[80:83], a[48:51], v[144:159]
    ds_read_b64_tr_b16 a[112:113], v204 offset:33024
    ds_read_b64_tr_b16 a[114:115], v204 offset:37120
    v_add_f32 v187, v187, v177
    v_cvt_pk_bf16_f32 v164, v176, v177
    v_fma_f32 v180, v140, s46, -v185
    v_fma_f32 v181, v141, s46, -v185
    v_mfma_f32_32x32x16_bf16 v[144:159], a[84:87], a[52:55], v[144:159]
    ds_read_b64_tr_b16 a[116:117], v205 offset:33024
    ds_read_b64_tr_b16 a[118:119], v205 offset:37120
    v_exp_f32 v180, v180
    v_add_f32 v186, v186, v178
    v_mfma_f32_32x32x16_bf16 v[144:159], a[88:91], a[56:59], v[144:159]
    ds_read_b64_tr_b16 a[120:121], v206 offset:33024
    ds_read_b64_tr_b16 a[122:123], v206 offset:37120
    v_exp_f32 v181, v181
    v_add_f32 v187, v187, v179
    v_cvt_pk_bf16_f32 v165, v178, v179
    v_mfma_f32_32x32x16_bf16 v[144:159], a[92:95], a[60:63], v[144:159]
    ds_read_b64_tr_b16 a[124:125], v207 offset:33024
    ds_read_b64_tr_b16 a[126:127], v207 offset:37120
    v_fma_f32 v182, v142, s46, -v185
    v_fma_f32 v183, v143, s46, -v185
    s_waitcnt lgkmcnt(8)
    v_mfma_f32_32x32x16_bf16 v[0:15], a[96:99], v[160:163], v[0:15]
    ds_read_b64_tr_b16 a[96:97], v204 offset:40960
    ds_read_b64_tr_b16 a[98:99], v204 offset:45056
    v_exp_f32 v182, v182
    v_add_f32 v186, v186, v180
    v_mfma_f32_32x32x16_bf16 v[16:31], a[100:103], v[160:163], v[16:31]
    ds_read_b64_tr_b16 a[100:101], v205 offset:40960
    ds_read_b64_tr_b16 a[102:103], v205 offset:45056
    v_exp_f32 v183, v183
    v_add_f32 v187, v187, v181
    v_cvt_pk_bf16_f32 v166, v180, v181
    v_mfma_f32_32x32x16_bf16 v[32:47], a[104:107], v[160:163], v[32:47]
    ds_read_b64_tr_b16 a[104:105], v206 offset:40960
    ds_read_b64_tr_b16 a[106:107], v206 offset:45056
    v_add_f32 v186, v186, v182
    v_add_f32 v187, v187, v183
    v_cvt_pk_bf16_f32 v167, v182, v183
    v_mfma_f32_32x32x16_bf16 v[48:63], a[108:111], v[160:163], v[48:63]
    ds_read_b64_tr_b16 a[108:109], v207 offset:40960
    ds_read_b64_tr_b16 a[110:111], v207 offset:45056
    v_max3_f32 v191, v144, v145, v146
    v_max3_f32 v192, v147, v148, v149
    v_max3_f32 v193, v150, v151, v152
    s_waitcnt lgkmcnt(8)
    v_mfma_f32_32x32x16_bf16 v[64:79], a[112:115], v[160:163], v[64:79]
    ds_read_b64_tr_b16 a[112:113], v204 offset:41216
    ds_read_b64_tr_b16 a[114:115], v204 offset:45312
    s_add_u32 m0, s49, 147456
    s_add_u32 s34, s35, 2637824
    buffer_load_dwordx4 v245, s[8:11], s34 offen lds
    v_max3_f32 v194, v153, v154, v155
    v_max3_f32 v195, v156, v157, v158
    v_mfma_f32_32x32x16_bf16 v[80:95], a[116:119], v[160:163], v[80:95]
    ds_read_b64_tr_b16 a[116:117], v205 offset:41216
    ds_read_b64_tr_b16 a[118:119], v205 offset:45312
    s_add_u32 m0, s49, 148480
    s_add_u32 s34, s35, 2644992
    buffer_load_dwordx4 v245, s[8:11], s34 offen lds
    v_max3_f32 v191, v191, v192, v193
    v_max3_f32 v194, v194, v195, v159
    v_mfma_f32_32x32x16_bf16 v[96:111], a[120:123], v[160:163], v[96:111]
    ds_read_b64_tr_b16 a[120:121], v206 offset:41216
    ds_read_b64_tr_b16 a[122:123], v206 offset:45312
    s_add_u32 m0, s49, 149504
    s_add_u32 s34, s35, 2652160
    buffer_load_dwordx4 v245, s[8:11], s34 offen lds
    s_add_u32 m0, s49, 150528
    s_add_u32 s34, s35, 2659328
    buffer_load_dwordx4 v245, s[8:11], s34 offen lds
    v_mfma_f32_32x32x16_bf16 v[112:127], a[124:127], v[160:163], v[112:127]
    s_waitcnt vmcnt(16)
    s_barrier
    ds_read_b64_tr_b16 a[124:125], v207 offset:41216
    ds_read_b64_tr_b16 a[126:127], v207 offset:45312
    v_max_f32 v189, v191, v194
    s_waitcnt lgkmcnt(8)
    v_mfma_f32_32x32x16_bf16 v[0:15], a[96:99], v[164:167], v[0:15]
    s_add_u32 m0, s49, 49152
    s_add_u32 s34, s35, 2293760
    buffer_load_dwordx4 v245, s[8:11], s34 offen lds
    ds_read_b64_tr_b16 a[0:1], v208 offset:0
    ds_read_b64_tr_b16 a[2:3], v208 offset:512
    v_cmp_gt_f32 vcc, v189, v188
    v_mfma_f32_32x32x16_bf16 v[16:31], a[100:103], v[164:167], v[16:31]
    s_add_u32 m0, s49, 50176
    s_add_u32 s34, s35, 2300928
    buffer_load_dwordx4 v245, s[8:11], s34 offen lds
    ds_read_b64_tr_b16 a[4:5], v209 offset:0
    ds_read_b64_tr_b16 a[6:7], v209 offset:512
    v_mfma_f32_32x32x16_bf16 v[32:47], a[104:107], v[164:167], v[32:47]
    s_add_u32 m0, s49, 51200
    s_add_u32 s34, s35, 2308096
    buffer_load_dwordx4 v245, s[8:11], s34 offen lds
    ds_read_b64_tr_b16 a[8:9], v208 offset:2048
    ds_read_b64_tr_b16 a[10:11], v208 offset:2560
    v_mfma_f32_32x32x16_bf16 v[48:63], a[108:111], v[164:167], v[48:63]
    s_add_u32 m0, s49, 52224
    s_add_u32 s34, s35, 2315264
    buffer_load_dwordx4 v245, s[8:11], s34 offen lds
    ds_read_b64_tr_b16 a[12:13], v209 offset:2048
    ds_read_b64_tr_b16 a[14:15], v209 offset:2560
    s_waitcnt lgkmcnt(8)
    v_mfma_f32_32x32x16_bf16 v[64:79], a[112:115], v[164:167], v[64:79]
    s_add_u32 m0, s49, 81920
    s_add_u32 s34, s35, 2408448
    buffer_load_dwordx4 v245, s[8:11], s34 offen lds
    ds_read_b64_tr_b16 a[16:17], v208 offset:16384
    ds_read_b64_tr_b16 a[18:19], v208 offset:16896
    v_mfma_f32_32x32x16_bf16 v[80:95], a[116:119], v[164:167], v[80:95]
    s_add_u32 m0, s49, 82944
    s_add_u32 s34, s35, 2415616
    buffer_load_dwordx4 v245, s[8:11], s34 offen lds
    ds_read_b64_tr_b16 a[20:21], v209 offset:16384
    ds_read_b64_tr_b16 a[22:23], v209 offset:16896
    v_mfma_f32_32x32x16_bf16 v[96:111], a[120:123], v[164:167], v[96:111]
    s_add_u32 m0, s49, 83968
    s_add_u32 s34, s35, 2422784
    buffer_load_dwordx4 v245, s[8:11], s34 offen lds
    ds_read_b64_tr_b16 a[24:25], v208 offset:18432
    ds_read_b64_tr_b16 a[26:27], v208 offset:18944
    v_mfma_f32_32x32x16_bf16 v[112:127], a[124:127], v[164:167], v[112:127]
    s_add_u32 m0, s49, 84992
    s_add_u32 s34, s35, 2429952
    buffer_load_dwordx4 v245, s[8:11], s34 offen lds
    ds_read_b64_tr_b16 a[28:29], v209 offset:18432
    ds_read_b64_tr_b16 a[30:31], v209 offset:18944
    s_cbranch_vccnz ATT_RSp_9
ATT_BKp_9:
    v_fma_f32 v168, v144, s46, -v185
    v_fma_f32 v169, v145, s46, -v185
    v_exp_f32 v168, v168
    v_exp_f32 v169, v169
    v_fma_f32 v170, v146, s46, -v185
    v_fma_f32 v171, v147, s46, -v185
    v_exp_f32 v170, v170
    v_add_f32 v186, v186, v168
    v_exp_f32 v171, v171
    v_add_f32 v187, v187, v169
    v_cvt_pk_bf16_f32 v160, v168, v169
    v_fma_f32 v172, v148, s46, -v185
    v_fma_f32 v173, v149, s46, -v185
    v_exp_f32 v172, v172
    v_add_f32 v186, v186, v170
    v_exp_f32 v173, v173
    v_add_f32 v187, v187, v171
    v_cvt_pk_bf16_f32 v161, v170, v171
    v_fma_f32 v174, v150, s46, -v185
    v_fma_f32 v175, v151, s46, -v185
    v_exp_f32 v174, v174
    v_add_f32 v186, v186, v172
    v_exp_f32 v175, v175
    v_add_f32 v187, v187, v173
    v_cvt_pk_bf16_f32 v162, v172, v173
    v_fma_f32 v176, v152, s46, -v185
    v_fma_f32 v177, v153, s46, -v185
    v_exp_f32 v176, v176
    v_add_f32 v186, v186, v174
    v_exp_f32 v177, v177
    v_add_f32 v187, v187, v175
    v_cvt_pk_bf16_f32 v163, v174, v175
    v_fma_f32 v178, v154, s46, -v185
    v_fma_f32 v179, v155, s46, -v185
    v_exp_f32 v178, v178
    v_add_f32 v186, v186, v176
    v_exp_f32 v179, v179
    v_add_f32 v187, v187, v177
    v_cvt_pk_bf16_f32 v164, v176, v177
    v_fma_f32 v180, v156, s46, -v185
    v_fma_f32 v181, v157, s46, -v185
    v_exp_f32 v180, v180
    v_add_f32 v186, v186, v178
    v_exp_f32 v181, v181
    v_add_f32 v187, v187, v179
    v_cvt_pk_bf16_f32 v165, v178, v179
    v_fma_f32 v182, v158, s46, -v185
    v_fma_f32 v183, v159, s46, -v185
    v_exp_f32 v182, v182
    v_add_f32 v186, v186, v180
    v_exp_f32 v183, v183
    v_add_f32 v187, v187, v181
    v_cvt_pk_bf16_f32 v166, v180, v181
    v_add_f32 v186, v186, v182
    v_add_f32 v187, v187, v183
    v_cvt_pk_bf16_f32 v167, v182, v183
    v_add_f32 v186, v186, v187
    v_mov_b32 v187, v186
    s_lshl_b32 s58, s56, 18
    s_lshl_b32 s59, s55, 14
    v_permlane32_swap_b32 v186, v187
    v_add_f32 v186, v186, v187
    v_rcp_f32 v186, v186
    v_lshlrev_b32 v239, 4, v240
    s_add_u32 s58, s58, s59
    s_lshl_b32 s73, s54, 8
    ds_read_b64_tr_b16 a[96:97], v204 offset:49152
    ds_read_b64_tr_b16 a[98:99], v204 offset:53248
    ds_read_b64_tr_b16 a[100:101], v204 offset:57344
    ds_read_b64_tr_b16 a[102:103], v204 offset:61440
    ds_read_b64_tr_b16 a[104:105], v205 offset:49152
    ds_read_b64_tr_b16 a[106:107], v205 offset:53248
    ds_read_b64_tr_b16 a[108:109], v205 offset:57344
    ds_read_b64_tr_b16 a[110:111], v205 offset:61440
    ds_read_b64_tr_b16 a[112:113], v206 offset:49152
    ds_read_b64_tr_b16 a[114:115], v206 offset:53248
    ds_read_b64_tr_b16 a[116:117], v206 offset:57344
    ds_read_b64_tr_b16 a[118:119], v206 offset:61440
    ds_read_b64_tr_b16 a[120:121], v207 offset:49152
    ds_read_b64_tr_b16 a[122:123], v207 offset:53248
    ds_read_b64_tr_b16 a[124:125], v207 offset:57344
    ds_read_b64_tr_b16 a[126:127], v207 offset:61440
    s_waitcnt lgkmcnt(8)
    v_mfma_f32_32x32x16_bf16 v[0:15], a[96:99], v[160:163], v[0:15]
    ds_read_b64_tr_b16 a[96:97], v204 offset:49408
    ds_read_b64_tr_b16 a[98:99], v204 offset:53504
    v_mfma_f32_32x32x16_bf16 v[0:15], a[100:103], v[164:167], v[0:15]
    ds_read_b64_tr_b16 a[100:101], v204 offset:57600
    ds_read_b64_tr_b16 a[102:103], v204 offset:61696
    v_mfma_f32_32x32x16_bf16 v[16:31], a[104:107], v[160:163], v[16:31]
    ds_read_b64_tr_b16 a[104:105], v205 offset:49408
    ds_read_b64_tr_b16 a[106:107], v205 offset:53504
    v_mfma_f32_32x32x16_bf16 v[16:31], a[108:111], v[164:167], v[16:31]
    ds_read_b64_tr_b16 a[108:109], v205 offset:57600
    ds_read_b64_tr_b16 a[110:111], v205 offset:61696
    s_waitcnt lgkmcnt(8)
    v_mfma_f32_32x32x16_bf16 v[32:47], a[112:115], v[160:163], v[32:47]
    ds_read_b64_tr_b16 a[112:113], v206 offset:49408
    ds_read_b64_tr_b16 a[114:115], v206 offset:53504
    v_mul_f32 v0, v0, v186
    v_mul_f32 v1, v1, v186
    v_mul_f32 v2, v2, v186
    v_mul_f32 v3, v3, v186
    v_mul_f32 v4, v4, v186
    v_mul_f32 v5, v5, v186
    v_mul_f32 v6, v6, v186
    v_mul_f32 v7, v7, v186
    v_cvt_pk_bf16_f32 v128, v0, v1
    v_cvt_pk_bf16_f32 v129, v2, v3
    v_mfma_f32_32x32x16_bf16 v[32:47], a[116:119], v[164:167], v[32:47]
    ds_read_b64_tr_b16 a[116:117], v206 offset:57600
    ds_read_b64_tr_b16 a[118:119], v206 offset:61696
    v_cvt_pk_bf16_f32 v130, v4, v5
    v_cvt_pk_bf16_f32 v131, v6, v7
    buffer_store_dwordx4 v[128:131], v239, s[24:27], s58 offen offset:0 sc1
    v_mul_f32 v8, v8, v186
    v_mul_f32 v9, v9, v186
    v_mul_f32 v10, v10, v186
    v_mul_f32 v11, v11, v186
    v_mul_f32 v12, v12, v186
    v_mul_f32 v13, v13, v186
    v_mul_f32 v14, v14, v186
    v_mfma_f32_32x32x16_bf16 v[48:63], a[120:123], v[160:163], v[48:63]
    ds_read_b64_tr_b16 a[120:121], v207 offset:49408
    ds_read_b64_tr_b16 a[122:123], v207 offset:53504
    v_mul_f32 v15, v15, v186
    v_cvt_pk_bf16_f32 v132, v8, v9
    v_cvt_pk_bf16_f32 v133, v10, v11
    v_cvt_pk_bf16_f32 v134, v12, v13
    v_cvt_pk_bf16_f32 v135, v14, v15
    buffer_store_dwordx4 v[132:135], v239, s[24:27], s58 offen offset:1024 sc1
    v_mul_f32 v16, v16, v186
    v_mul_f32 v17, v17, v186
    v_mul_f32 v18, v18, v186
    v_mul_f32 v19, v19, v186
    v_mfma_f32_32x32x16_bf16 v[48:63], a[124:127], v[164:167], v[48:63]
    s_barrier
    ds_read_b64_tr_b16 a[124:125], v207 offset:57600
    ds_read_b64_tr_b16 a[126:127], v207 offset:61696
    v_mul_f32 v20, v20, v186
    v_mul_f32 v21, v21, v186
    v_mul_f32 v22, v22, v186
    v_mul_f32 v23, v23, v186
    v_cvt_pk_bf16_f32 v136, v16, v17
    v_cvt_pk_bf16_f32 v137, v18, v19
    v_cvt_pk_bf16_f32 v138, v20, v21
    s_waitcnt lgkmcnt(8)
    v_mfma_f32_32x32x16_bf16 v[64:79], a[96:99], v[160:163], v[64:79]
    v_cvt_pk_bf16_f32 v139, v22, v23
    buffer_store_dwordx4 v[136:139], v239, s[24:27], s58 offen offset:2048 sc1
    v_mul_f32 v24, v24, v186
    v_mul_f32 v25, v25, v186
    v_mul_f32 v26, v26, v186
    v_mul_f32 v27, v27, v186
    v_mul_f32 v28, v28, v186
    v_mul_f32 v29, v29, v186
    v_mul_f32 v30, v30, v186
    v_mul_f32 v31, v31, v186
    v_cvt_pk_bf16_f32 v140, v24, v25
    v_mfma_f32_32x32x16_bf16 v[64:79], a[100:103], v[164:167], v[64:79]
    v_cvt_pk_bf16_f32 v141, v26, v27
    v_cvt_pk_bf16_f32 v142, v28, v29
    v_cvt_pk_bf16_f32 v143, v30, v31
    buffer_store_dwordx4 v[140:143], v239, s[24:27], s58 offen offset:3072 sc1
    v_mul_f32 v32, v32, v186
    v_mul_f32 v33, v33, v186
    v_mul_f32 v34, v34, v186
    v_mul_f32 v35, v35, v186
    v_mul_f32 v36, v36, v186
    v_mul_f32 v37, v37, v186
    v_mul_f32 v38, v38, v186
    v_mfma_f32_32x32x16_bf16 v[80:95], a[104:107], v[160:163], v[80:95]
    v_mul_f32 v39, v39, v186
    v_cvt_pk_bf16_f32 v144, v32, v33
    v_cvt_pk_bf16_f32 v145, v34, v35
    v_cvt_pk_bf16_f32 v146, v36, v37
    v_cvt_pk_bf16_f32 v147, v38, v39
    s_add_u32 s58, s58, 4096
    buffer_store_dwordx4 v[144:147], v239, s[24:27], s58 offen offset:0 sc1
    v_mul_f32 v40, v40, v186
    v_mul_f32 v41, v41, v186
    v_mul_f32 v42, v42, v186
    v_mul_f32 v43, v43, v186
    v_mfma_f32_32x32x16_bf16 v[80:95], a[108:111], v[164:167], v[80:95]
    v_mul_f32 v44, v44, v186
    v_mul_f32 v45, v45, v186
    v_mul_f32 v46, v46, v186
    v_mul_f32 v47, v47, v186
    v_cvt_pk_bf16_f32 v148, v40, v41
    v_cvt_pk_bf16_f32 v149, v42, v43
    v_cvt_pk_bf16_f32 v150, v44, v45
    v_cvt_pk_bf16_f32 v151, v46, v47
    buffer_store_dwordx4 v[148:151], v239, s[24:27], s58 offen offset:1024 sc1
    v_mul_f32 v48, v48, v186
    s_waitcnt lgkmcnt(0)
    v_mfma_f32_32x32x16_bf16 v[96:111], a[112:115], v[160:163], v[96:111]
    v_mul_f32 v49, v49, v186
    v_mul_f32 v50, v50, v186
    v_mul_f32 v51, v51, v186
    v_mul_f32 v52, v52, v186
    v_mul_f32 v53, v53, v186
    v_mul_f32 v54, v54, v186
    v_mul_f32 v55, v55, v186
    v_cvt_pk_bf16_f32 v152, v48, v49
    v_cvt_pk_bf16_f32 v153, v50, v51
    v_cvt_pk_bf16_f32 v154, v52, v53
    v_cvt_pk_bf16_f32 v155, v54, v55
    v_mfma_f32_32x32x16_bf16 v[96:111], a[116:119], v[164:167], v[96:111]
    buffer_store_dwordx4 v[152:155], v239, s[24:27], s58 offen offset:2048 sc1
    v_mul_f32 v56, v56, v186
    v_mul_f32 v57, v57, v186
    v_mul_f32 v58, v58, v186
    v_mul_f32 v59, v59, v186
    v_mul_f32 v60, v60, v186
    v_mul_f32 v61, v61, v186
    v_mul_f32 v62, v62, v186
    v_mul_f32 v63, v63, v186
    v_cvt_pk_bf16_f32 v156, v56, v57
    v_cvt_pk_bf16_f32 v157, v58, v59
    v_mfma_f32_32x32x16_bf16 v[112:127], a[120:123], v[160:163], v[112:127]
    v_cvt_pk_bf16_f32 v158, v60, v61
    v_cvt_pk_bf16_f32 v159, v62, v63
    buffer_store_dwordx4 v[156:159], v239, s[24:27], s58 offen offset:3072 sc1
    v_mul_f32 v64, v64, v186
    v_mul_f32 v65, v65, v186
    v_mul_f32 v66, v66, v186
    v_mul_f32 v67, v67, v186
    v_mul_f32 v68, v68, v186
    v_mul_f32 v69, v69, v186
    v_mul_f32 v70, v70, v186
    v_mul_f32 v71, v71, v186
    v_mfma_f32_32x32x16_bf16 v[112:127], a[124:127], v[164:167], v[112:127]
    v_cvt_pk_bf16_f32 v128, v64, v65
    v_cvt_pk_bf16_f32 v129, v66, v67
    v_cvt_pk_bf16_f32 v130, v68, v69
    v_cvt_pk_bf16_f32 v131, v70, v71
    s_add_u32 s58, s58, 4096
    buffer_store_dwordx4 v[128:131], v239, s[24:27], s58 offen offset:0 sc1
    v_mul_f32 v72, v72, v186
    v_mul_f32 v73, v73, v186
    v_mul_f32 v74, v74, v186
    v_mul_f32 v75, v75, v186
ATT_EPI:
    v_mul_f32 v76, v76, v186
    v_mul_f32 v77, v77, v186
    v_mul_f32 v78, v78, v186
    v_mul_f32 v79, v79, v186
    v_cvt_pk_bf16_f32 v132, v72, v73
    v_cvt_pk_bf16_f32 v133, v74, v75
    v_cvt_pk_bf16_f32 v134, v76, v77
    v_cvt_pk_bf16_f32 v135, v78, v79
    buffer_store_dwordx4 v[132:135], v239, s[24:27], s58 offen offset:1024 sc1
    v_mul_f32 v80, v80, v186
    v_mul_f32 v81, v81, v186
    v_mul_f32 v82, v82, v186
    v_mul_f32 v83, v83, v186
    v_mul_f32 v84, v84, v186
    v_mul_f32 v85, v85, v186
    v_mul_f32 v86, v86, v186
    v_mul_f32 v87, v87, v186
    v_cvt_pk_bf16_f32 v136, v80, v81
    v_cvt_pk_bf16_f32 v137, v82, v83
    v_cvt_pk_bf16_f32 v138, v84, v85
    v_cvt_pk_bf16_f32 v139, v86, v87
    buffer_store_dwordx4 v[136:139], v239, s[24:27], s58 offen offset:2048 sc1
    v_mul_f32 v88, v88, v186
    v_mul_f32 v89, v89, v186
    v_mul_f32 v90, v90, v186
    v_mul_f32 v91, v91, v186
    v_mul_f32 v92, v92, v186
    v_mul_f32 v93, v93, v186
    v_mul_f32 v94, v94, v186
    v_mul_f32 v95, v95, v186
    v_cvt_pk_bf16_f32 v140, v88, v89
    v_cvt_pk_bf16_f32 v141, v90, v91
    v_cvt_pk_bf16_f32 v142, v92, v93
    v_cvt_pk_bf16_f32 v143, v94, v95
    buffer_store_dwordx4 v[140:143], v239, s[24:27], s58 offen offset:3072 sc1
    v_mul_f32 v96, v96, v186
    v_mul_f32 v97, v97, v186
    v_mul_f32 v98, v98, v186
    v_mul_f32 v99, v99, v186
    v_mul_f32 v100, v100, v186
    v_mul_f32 v101, v101, v186
    v_mul_f32 v102, v102, v186
    v_mul_f32 v103, v103, v186
    v_cvt_pk_bf16_f32 v144, v96, v97
    v_cvt_pk_bf16_f32 v145, v98, v99
    v_cvt_pk_bf16_f32 v146, v100, v101
    v_cvt_pk_bf16_f32 v147, v102, v103
    s_add_u32 s58, s58, 4096
    buffer_store_dwordx4 v[144:147], v239, s[24:27], s58 offen offset:0 sc1
    v_mul_f32 v104, v104, v186
    v_mul_f32 v105, v105, v186
    v_mul_f32 v106, v106, v186
    v_mul_f32 v107, v107, v186
    v_mul_f32 v108, v108, v186
    v_mul_f32 v109, v109, v186
    v_mul_f32 v110, v110, v186
    v_mul_f32 v111, v111, v186
    v_cvt_pk_bf16_f32 v148, v104, v105
    v_cvt_pk_bf16_f32 v149, v106, v107
    v_cvt_pk_bf16_f32 v150, v108, v109
    v_cvt_pk_bf16_f32 v151, v110, v111
    buffer_store_dwordx4 v[148:151], v239, s[24:27], s58 offen offset:1024 sc1
    v_mul_f32 v112, v112, v186
    v_mul_f32 v113, v113, v186
    v_mul_f32 v114, v114, v186
    v_mul_f32 v115, v115, v186
    v_mul_f32 v116, v116, v186
    v_mul_f32 v117, v117, v186
    v_mul_f32 v118, v118, v186
    v_mul_f32 v119, v119, v186
    v_cvt_pk_bf16_f32 v152, v112, v113
    v_cvt_pk_bf16_f32 v153, v114, v115
    v_cvt_pk_bf16_f32 v154, v116, v117
    v_cvt_pk_bf16_f32 v155, v118, v119
    buffer_store_dwordx4 v[152:155], v239, s[24:27], s58 offen offset:2048 sc1
    v_mul_f32 v120, v120, v186
    v_mul_f32 v121, v121, v186
    v_mul_f32 v122, v122, v186
    v_mul_f32 v123, v123, v186
    v_mul_f32 v124, v124, v186
    v_mul_f32 v125, v125, v186
    v_mul_f32 v126, v126, v186
    v_mul_f32 v127, v127, v186
    v_cvt_pk_bf16_f32 v156, v120, v121
    v_cvt_pk_bf16_f32 v157, v122, v123
    v_cvt_pk_bf16_f32 v158, v124, v125
    v_cvt_pk_bf16_f32 v159, v126, v127
    buffer_store_dwordx4 v[156:159], v239, s[24:27], s58 offen offset:3072 sc1
    s_add_u32 m0, s49, 0
    s_add_u32 s34, s35, 0
    buffer_load_dwordx4 v245, s[8:11], s34 offen lds
    s_waitcnt vmcnt(33)
    ds_read_b64_tr_b16 a[32:33], v208 offset:32768
    ds_read_b64_tr_b16 a[34:35], v208 offset:33280
    ds_read_b64_tr_b16 a[36:37], v209 offset:32768
    ds_read_b64_tr_b16 a[38:39], v209 offset:33280
    s_add_u32 m0, s49, 1024
    s_add_u32 s34, s35, 7168
    buffer_load_dwordx4 v245, s[8:11], s34 offen lds
    ds_read_b64_tr_b16 a[40:41], v208 offset:34816
    ds_read_b64_tr_b16 a[42:43], v208 offset:35328
    ds_read_b64_tr_b16 a[44:45], v209 offset:34816
    ds_read_b64_tr_b16 a[46:47], v209 offset:35328
    s_add_u32 m0, s49, 2048
    s_add_u32 s34, s35, 14336
    buffer_load_dwordx4 v245, s[8:11], s34 offen lds
    s_waitcnt vmcnt(31)
    ds_read_b64_tr_b16 a[48:49], v210 offset:0
    ds_read_b64_tr_b16 a[50:51], v210 offset:512
    ds_read_b64_tr_b16 a[52:53], v211 offset:0
    ds_read_b64_tr_b16 a[54:55], v211 offset:512
    s_add_u32 m0, s49, 3072
    s_add_u32 s34, s35, 21504
    buffer_load_dwordx4 v245, s[8:11], s34 offen lds
    ds_read_b64_tr_b16 a[56:57], v210 offset:2048
    ds_read_b64_tr_b16 a[58:59], v210 offset:2560
    ds_read_b64_tr_b16 a[60:61], v211 offset:2048
    ds_read_b64_tr_b16 a[62:63], v211 offset:2560
    s_add_u32 m0, s49, 16384
    s_add_u32 s34, s35, 114688
    buffer_load_dwordx4 v245, s[8:11], s34 offen lds
    s_waitcnt vmcnt(25)
    ds_read_b64_tr_b16 a[64:65], v208 offset:49152
    ds_read_b64_tr_b16 a[66:67], v208 offset:49664
    ds_read_b64_tr_b16 a[68:69], v209 offset:49152
    ds_read_b64_tr_b16 a[70:71], v209 offset:49664
    s_add_u32 m0, s49, 17408
    s_add_u32 s34, s35, 121856
    buffer_load_dwordx4 v245, s[8:11], s34 offen lds
    ds_read_b64_tr_b16 a[72:73], v208 offset:51200
    ds_read_b64_tr_b16 a[74:75], v208 offset:51712
    ds_read_b64_tr_b16 a[76:77], v209 offset:51200
    ds_read_b64_tr_b16 a[78:79], v209 offset:51712
    s_add_u32 m0, s49, 18432
    s_add_u32 s34, s35, 129024
    buffer_load_dwordx4 v245, s[8:11], s34 offen lds
    s_waitcnt vmcnt(23)
    ds_read_b64_tr_b16 a[80:81], v210 offset:16384
    ds_read_b64_tr_b16 a[82:83], v210 offset:16896
    ds_read_b64_tr_b16 a[84:85], v211 offset:16384
    ds_read_b64_tr_b16 a[86:87], v211 offset:16896
    s_add_u32 m0, s49, 19456
    s_add_u32 s34, s35, 136192
    buffer_load_dwordx4 v245, s[8:11], s34 offen lds
    ds_read_b64_tr_b16 a[88:89], v210 offset:18432
    ds_read_b64_tr_b16 a[90:91], v210 offset:18944
    ds_read_b64_tr_b16 a[92:93], v211 offset:18432
    ds_read_b64_tr_b16 a[94:95], v211 offset:18944
    s_add_u32 m0, s49, 98304
    s_add_u32 s34, s35, 229376
    buffer_load_dwordx4 v245, s[8:11], s34 offen lds
    ds_read_b64_tr_b16 a[96:97], v246 offset:0
    ds_read_b64_tr_b16 a[98:99], v246 offset:512
    ds_read_b64_tr_b16 a[100:101], v247 offset:0
    ds_read_b64_tr_b16 a[102:103], v247 offset:512
    s_add_u32 m0, s49, 99328
    s_add_u32 s34, s35, 236544
    buffer_load_dwordx4 v245, s[8:11], s34 offen lds
    ds_read_b64_tr_b16 a[104:105], v246 offset:2048
    ds_read_b64_tr_b16 a[106:107], v246 offset:2560
    ds_read_b64_tr_b16 a[108:109], v247 offset:2048
    ds_read_b64_tr_b16 a[110:111], v247 offset:2560
    s_add_u32 m0, s49, 100352
    s_add_u32 s34, s35, 243712
    buffer_load_dwordx4 v245, s[8:11], s34 offen lds
    ds_read_b64_tr_b16 a[112:113], v246 offset:16384
    ds_read_b64_tr_b16 a[114:115], v246 offset:16896
    ds_read_b64_tr_b16 a[116:117], v247 offset:16384
    ds_read_b64_tr_b16 a[118:119], v247 offset:16896
    s_add_u32 m0, s49, 101376
    s_add_u32 s34, s35, 250880
    buffer_load_dwordx4 v245, s[8:11], s34 offen lds
    ds_read_b64_tr_b16 a[120:121], v246 offset:18432
    ds_read_b64_tr_b16 a[122:123], v246 offset:18944
    ds_read_b64_tr_b16 a[124:125], v247 offset:18432
    ds_read_b64_tr_b16 a[126:127], v247 offset:18944
    s_waitcnt lgkmcnt(0)
    s_load_dwordx2 s[38:39], s[0:1], 0
    s_load_dwordx2 s[40:41], s[0:1], 88
    s_load_dwordx2 s[44:45], s[0:1], 104
    s_load_dwordx4 s[92:95], s[0:1], 48
    v_mov_b32 v160, v240
    v_mov_b32 v161, v241
    v_mov_b32 v162, v242
    s_and_b32 s51, s2, 7
    s_lshr_b32 s52, s2, 3
    s_mul_i32 s53, s52, 37
    s_lshr_b32 s53, s53, 8
    s_mul_i32 s54, s53, 7
    s_sub_u32 s54, s52, s54
    s_lshl_b32 s53, s53, 3
    s_add_u32 s53, s53, s51
    v_lshlrev_b32 v163, 4, v160
    s_and_b32 s30, s28, 1
    s_mul_i32 s30, s30, 262144
    v_add_u32 v164, s30, v163
    s_sub_u32 s30, 262144, s30
    v_add_u32 v165, s30, v163
    s_mul_i32 s29, s53, 524288
    s_lshl_b32 s30, s28, 11
    s_add_u32 s29, s29, s30
    v_lshrrev_b32 v168, 4, v160
    v_and_b32 v169, 15, v160
    v_lshrrev_b32 v170, 2, v169
    v_lshrrev_b32 v171, 1, v168
    v_lshl_add_u32 v171, v171, 3, v170
    v_lshlrev_b32 v171, 7, v171
    v_and_b32 v172, 1, v168
    v_lshl_add_u32 v171, v172, 5, v171
    v_and_b32 v172, 3, v169
    v_lshl_add_u32 v171, v172, 3, v171
    v_add_u32 v171, s49, v171
    v_lshrrev_b32 v170, 3, v169
    s_lshr_b32 s30, s28, 1
    v_xor_b32 v170, s30, v170
    v_xor_b32 v172, 0, v170
    v_lshl_add_u32 v166, v172, 6, v171
    v_xor_b32 v172, 1, v170
    v_lshl_add_u32 v167, v172, 6, v171
    v_add_u32 v172, 0x10000, v166
    v_add_u32 v174, 0x20000, v166
    v_add_u32 v173, 0x10000, v167
    v_add_u32 v175, 0x20000, v167
    s_waitcnt lgkmcnt(0)
    s_add_u32 s4, s44, 1048576
    s_addc_u32 s5, s45, 0
    s_mov_b32 s6, 16777216
    s_mov_b32 s7, 0x00020000
    s_mov_b32 s12, s38
    s_mov_b32 s13, s39
    s_mov_b32 s14, 1835008
    s_mov_b32 s15, 0x00020000
    s_add_u32 s16, s44, 18874368
    s_addc_u32 s17, s45, 0
    s_mov_b32 s18, 14417920
    s_mov_b32 s19, 0x00020000
    s_mov_b32 s20, s44
    s_mov_b32 s21, s45
    s_mov_b32 s22, 10752
    s_mov_b32 s23, 0x00020000
    s_waitcnt vmcnt(12)
    s_barrier
    s_cmp_lg_u32 s28, 0
    s_cbranch_scc1 SIG1
    s_mov_b64 exec, 1
    v_mov_b32 v0, 0
    v_mov_b32 v1, 1
    buffer_atomic_add v1, v0, s[68:71], s73 offen sc1
    s_mov_b64 exec, -1
SIG1:
    s_cmp_ge_u32 s2, 224
    s_cbranch_scc1 UV_GO
    s_add_u32 m0, s49, 32768
    s_add_u32 s34, s35, 344064
    buffer_load_dwordx4 v245, s[8:11], s34 offen lds
    s_add_u32 m0, s49, 33792
    s_add_u32 s34, s35, 351232
    buffer_load_dwordx4 v245, s[8:11], s34 offen lds
    s_add_u32 m0, s49, 34816
    s_add_u32 s34, s35, 358400
    buffer_load_dwordx4 v245, s[8:11], s34 offen lds
    s_add_u32 m0, s49, 35840
    s_add_u32 s34, s35, 365568
    buffer_load_dwordx4 v245, s[8:11], s34 offen lds
    s_add_u32 m0, s49, 65536
    s_add_u32 s34, s35, 458752
    buffer_load_dwordx4 v245, s[8:11], s34 offen lds
    s_add_u32 m0, s49, 66560
    s_add_u32 s34, s35, 465920
    buffer_load_dwordx4 v245, s[8:11], s34 offen lds
    s_add_u32 m0, s49, 67584
    s_add_u32 s34, s35, 473088
    buffer_load_dwordx4 v245, s[8:11], s34 offen lds
    s_add_u32 m0, s49, 68608
    s_add_u32 s34, s35, 480256
    buffer_load_dwordx4 v245, s[8:11], s34 offen lds
    s_add_u32 m0, s49, 49152
    s_add_u32 s34, s35, 573440
    buffer_load_dwordx4 v245, s[8:11], s34 offen lds
    s_add_u32 m0, s49, 50176
    s_add_u32 s34, s35, 580608
    buffer_load_dwordx4 v245, s[8:11], s34 offen lds
    s_add_u32 m0, s49, 51200
    s_add_u32 s34, s35, 587776
    buffer_load_dwordx4 v245, s[8:11], s34 offen lds
    s_add_u32 m0, s49, 52224
    s_add_u32 s34, s35, 594944
    buffer_load_dwordx4 v245, s[8:11], s34 offen lds
    s_add_u32 m0, s49, 81920
    s_add_u32 s34, s35, 688128
    buffer_load_dwordx4 v245, s[8:11], s34 offen lds
    s_add_u32 m0, s49, 82944
    s_add_u32 s34, s35, 695296
    buffer_load_dwordx4 v245, s[8:11], s34 offen lds
    s_add_u32 m0, s49, 83968
    s_add_u32 s34, s35, 702464
    buffer_load_dwordx4 v245, s[8:11], s34 offen lds
    s_add_u32 m0, s49, 84992
    s_add_u32 s34, s35, 709632
    buffer_load_dwordx4 v245, s[8:11], s34 offen lds
    s_add_u32 m0, s49, 131072
    s_add_u32 s34, s35, 802816
    buffer_load_dwordx4 v245, s[8:11], s34 offen lds
    s_add_u32 m0, s49, 132096
    s_add_u32 s34, s35, 809984
    buffer_load_dwordx4 v245, s[8:11], s34 offen lds
    s_add_u32 m0, s49, 133120
    s_add_u32 s34, s35, 817152
    buffer_load_dwordx4 v245, s[8:11], s34 offen lds
    s_add_u32 m0, s49, 134144
    s_add_u32 s34, s35, 824320
    buffer_load_dwordx4 v245, s[8:11], s34 offen lds
    s_add_u32 m0, s49, 147456
    s_add_u32 s34, s35, 917504
    buffer_load_dwordx4 v245, s[8:11], s34 offen lds
    s_add_u32 m0, s49, 148480
    s_add_u32 s34, s35, 924672
    buffer_load_dwordx4 v245, s[8:11], s34 offen lds
    s_add_u32 m0, s49, 149504
    s_add_u32 s34, s35, 931840
    buffer_load_dwordx4 v245, s[8:11], s34 offen lds
    s_add_u32 m0, s49, 150528
    s_add_u32 s34, s35, 939008
    buffer_load_dwordx4 v245, s[8:11], s34 offen lds
    s_add_u32 m0, s49, 114688
    s_add_u32 s34, s35, 1032192
    buffer_load_dwordx4 v245, s[8:11], s34 offen lds
    s_add_u32 m0, s49, 115712
    s_add_u32 s34, s35, 1039360
    buffer_load_dwordx4 v245, s[8:11], s34 offen lds
    s_add_u32 m0, s49, 116736
    s_add_u32 s34, s35, 1046528
    buffer_load_dwordx4 v245, s[8:11], s34 offen lds
    s_add_u32 m0, s49, 117760
    s_add_u32 s34, s35, 1053696
    buffer_load_dwordx4 v245, s[8:11], s34 offen lds
    s_lshr_b32 s55, s28, 1
    s_and_b32 s56, s28, 1
    s_lshl_b32 s57, s53, 6
    s_lshl_b32 s58, s56, 5
    s_add_u32 s57, s57, s58
    v_add_u32 v168, s57, v161
    v_mul_u32_u24 v168, 896, v168
    v_lshl_add_u32 v168, v162, 3, v168
    s_lshl_b32 s58, s54, 7
    s_lshl_b32 s59, s55, 6
    s_add_u32 s58, s58, s59
    s_lshr_b32 s61, s57, 5
    s_mul_i32 s61, s61, 28
    s_lshl_b32 s62, s54, 2
    s_add_u32 s61, s61, s62
    s_lshl_b32 s62, s55, 1
    s_add_u32 s61, s61, s62
    s_lshl_b32 s61, s61, 10
    buffer_load_dwordx2 v[176:177], v168, s[12:15], s58 offen offset:0
    buffer_load_dwordx2 v[178:179], v168, s[12:15], s58 offen offset:16
    buffer_load_dwordx2 v[180:181], v168, s[12:15], s58 offen offset:32
    buffer_load_dwordx2 v[182:183], v168, s[12:15], s58 offen offset:48
    v_lshlrev_b32 v169, 4, v162
    s_lshl_b32 s59, s58, 1
    s_add_u32 s59, s59, 3584
    s_lshr_b32 s74, s53, 1
    s_lshl_b32 s74, s74, 8
    s_add_u32 s74, s74, 0
    s_cmp_lg_u32 s28, 0
    s_cbranch_scc1 WF2_D
    v_mbcnt_lo_u32_b32 v0, -1, 0
    v_and_b32 v0, 0, v0
    v_lshlrev_b32 v0, 6, v0
    s_mov_b32 s72, 0
WF2_P:
    buffer_load_dword v1, v0, s[68:71], s74 offen sc1
    s_waitcnt vmcnt(0)
    v_cmp_gt_u32 vcc, 16, v1
    s_cmp_eq_u64 vcc, 0
    s_cbranch_scc1 WF2_D
    s_sleep 1
    s_add_u32 s72, s72, 1
    s_cmp_lt_u32 s72, 0x400000
    s_cbranch_scc1 WF2_P
WF2_D:
    s_barrier
    s_add_u32 s33, s29, 131072
    buffer_load_dwordx4 v[64:67], v164, s[4:7], s33 offen offset:0 sc1
    buffer_load_dwordx4 v[68:71], v165, s[4:7], s33 offen offset:0 sc1
    buffer_load_dwordx4 v[72:75], v164, s[4:7], s33 offen offset:1024 sc1
    buffer_load_dwordx4 v[76:79], v165, s[4:7], s33 offen offset:1024 sc1
    s_add_u32 s33, s29, 0
    buffer_load_dwordx4 v[80:83], v164, s[4:7], s33 offen offset:0 sc1
    buffer_load_dwordx4 v[84:87], v165, s[4:7], s33 offen offset:0 sc1
    buffer_load_dwordx4 v[88:91], v164, s[4:7], s33 offen offset:1024 sc1
    buffer_load_dwordx4 v[92:95], v165, s[4:7], s33 offen offset:1024 sc1
    s_add_u32 s33, s29, 139264
    buffer_load_dwordx4 v[96:99], v164, s[4:7], s33 offen offset:0 sc1
    buffer_load_dwordx4 v[100:103], v165, s[4:7], s33 offen offset:0 sc1
    buffer_load_dwordx4 v[104:107], v164, s[4:7], s33 offen offset:1024 sc1
    buffer_load_dwordx4 v[108:111], v165, s[4:7], s33 offen offset:1024 sc1
    s_add_u32 s33, s29, 8192
    buffer_load_dwordx4 v[112:115], v164, s[4:7], s33 offen offset:0 sc1
    buffer_load_dwordx4 v[116:119], v165, s[4:7], s33 offen offset:0 sc1
    buffer_load_dwordx4 v[120:123], v164, s[4:7], s33 offen offset:1024 sc1
    buffer_load_dwordx4 v[124:127], v165, s[4:7], s33 offen offset:1024 sc1
    s_add_u32 s33, s29, 147456
    buffer_load_dwordx4 v[200:203], v164, s[4:7], s33 offen offset:0 sc1
    buffer_load_dwordx4 v[204:207], v165, s[4:7], s33 offen offset:0 sc1
    buffer_load_dwordx4 v[208:211], v164, s[4:7], s33 offen offset:1024 sc1
    buffer_load_dwordx4 v[212:215], v165, s[4:7], s33 offen offset:1024 sc1
    s_waitcnt vmcnt(16)
    v_mfma_f32_32x32x16_bf16 v[0:15], a[0:3], v[64:67], 0
    ds_read_b64_tr_b16 v[144:145], v166 offset:0
    ds_read_b64_tr_b16 v[146:147], v166 offset:512
    v_mfma_f32_32x32x16_bf16 v[16:31], a[0:3], v[68:71], 0
    ds_read_b64_tr_b16 v[148:149], v167 offset:0
    ds_read_b64_tr_b16 v[150:151], v167 offset:512
    s_add_u32 s33, s29, 16384
    buffer_load_dwordx4 v[216:219], v164, s[4:7], s33 offen offset:0 sc1
    buffer_load_dwordx4 v[220:223], v165, s[4:7], s33 offen offset:0 sc1
    buffer_load_dwordx4 v[224:227], v164, s[4:7], s33 offen offset:1024 sc1
    buffer_load_dwordx4 v[228:231], v165, s[4:7], s33 offen offset:1024 sc1
    v_mfma_f32_32x32x16_bf16 v[32:47], a[4:7], v[64:67], 0
    ds_read_b64_tr_b16 v[152:153], v166 offset:2048
    ds_read_b64_tr_b16 v[154:155], v166 offset:2560
    v_mfma_f32_32x32x16_bf16 v[48:63], a[4:7], v[68:71], 0
    ds_read_b64_tr_b16 v[156:157], v167 offset:2048
    ds_read_b64_tr_b16 v[158:159], v167 offset:2560
    v_mfma_f32_32x32x16_bf16 v[0:15], a[8:11], v[72:75], v[0:15]
    v_mfma_f32_32x32x16_bf16 v[16:31], a[8:11], v[76:79], v[16:31]
    v_mfma_f32_32x32x16_bf16 v[32:47], a[12:15], v[72:75], v[32:47]
    v_mfma_f32_32x32x16_bf16 v[48:63], a[12:15], v[76:79], v[48:63]
    s_waitcnt vmcnt(16)
    s_waitcnt lgkmcnt(0)
    v_mfma_f32_32x32x16_bf16 v[0:15], v[144:147], v[80:83], v[0:15]
    v_mfma_f32_32x32x16_bf16 v[16:31], v[144:147], v[84:87], v[16:31]
    s_add_u32 s33, s29, 155648
    buffer_load_dwordx4 v[64:67], v164, s[4:7], s33 offen offset:0 sc1
    buffer_load_dwordx4 v[68:71], v165, s[4:7], s33 offen offset:0 sc1
    buffer_load_dwordx4 v[72:75], v164, s[4:7], s33 offen offset:1024 sc1
    buffer_load_dwordx4 v[76:79], v165, s[4:7], s33 offen offset:1024 sc1
    v_mfma_f32_32x32x16_bf16 v[32:47], v[148:151], v[80:83], v[32:47]
    v_mfma_f32_32x32x16_bf16 v[48:63], v[148:151], v[84:87], v[48:63]
    v_mfma_f32_32x32x16_bf16 v[0:15], v[152:155], v[88:91], v[0:15]
    s_add_u32 m0, s49, 0
    s_add_u32 s34, s35, 1146880
    buffer_load_dwordx4 v245, s[8:11], s34 offen lds
    s_add_u32 m0, s49, 1024
    s_add_u32 s34, s35, 1154048
    buffer_load_dwordx4 v245, s[8:11], s34 offen lds
    s_add_u32 m0, s49, 2048
    s_add_u32 s34, s35, 1161216
    buffer_load_dwordx4 v245, s[8:11], s34 offen lds
    s_add_u32 m0, s49, 3072
    s_add_u32 s34, s35, 1168384
    buffer_load_dwordx4 v245, s[8:11], s34 offen lds
    v_mfma_f32_32x32x16_bf16 v[16:31], v[152:155], v[92:95], v[16:31]
    v_mfma_f32_32x32x16_bf16 v[32:47], v[156:159], v[88:91], v[32:47]
    v_mfma_f32_32x32x16_bf16 v[48:63], v[156:159], v[92:95], v[48:63]
    s_waitcnt vmcnt(20)
    v_mfma_f32_32x32x16_bf16 v[0:15], a[16:19], v[96:99], v[0:15]
    ds_read_b64_tr_b16 v[144:145], v166 offset:16384
    ds_read_b64_tr_b16 v[146:147], v166 offset:16896
    v_mfma_f32_32x32x16_bf16 v[16:31], a[16:19], v[100:103], v[16:31]
    ds_read_b64_tr_b16 v[148:149], v167 offset:16384
    ds_read_b64_tr_b16 v[150:151], v167 offset:16896
    s_add_u32 s33, s29, 24576
    buffer_load_dwordx4 v[80:83], v164, s[4:7], s33 offen offset:0 sc1
    buffer_load_dwordx4 v[84:87], v165, s[4:7], s33 offen offset:0 sc1
    buffer_load_dwordx4 v[88:91], v164, s[4:7], s33 offen offset:1024 sc1
    buffer_load_dwordx4 v[92:95], v165, s[4:7], s33 offen offset:1024 sc1
    v_mfma_f32_32x32x16_bf16 v[32:47], a[20:23], v[96:99], v[32:47]
    ds_read_b64_tr_b16 v[152:153], v166 offset:18432
    ds_read_b64_tr_b16 v[154:155], v166 offset:18944
    v_mfma_f32_32x32x16_bf16 v[48:63], a[20:23], v[100:103], v[48:63]
    ds_read_b64_tr_b16 v[156:157], v167 offset:18432
    ds_read_b64_tr_b16 v[158:159], v167 offset:18944
    v_mfma_f32_32x32x16_bf16 v[0:15], a[24:27], v[104:107], v[0:15]
    v_mfma_f32_32x32x16_bf16 v[16:31], a[24:27], v[108:111], v[16:31]
    v_mfma_f32_32x32x16_bf16 v[32:47], a[28:31], v[104:107], v[32:47]
    v_mfma_f32_32x32x16_bf16 v[48:63], a[28:31], v[108:111], v[48:63]
    s_waitcnt vmcnt(20)
    s_waitcnt lgkmcnt(0)
    v_mfma_f32_32x32x16_bf16 v[0:15], v[144:147], v[112:115], v[0:15]
    v_mfma_f32_32x32x16_bf16 v[16:31], v[144:147], v[116:119], v[16:31]
    s_add_u32 s33, s29, 163840
    buffer_load_dwordx4 v[96:99], v164, s[4:7], s33 offen offset:0 sc1
    buffer_load_dwordx4 v[100:103], v165, s[4:7], s33 offen offset:0 sc1
    buffer_load_dwordx4 v[104:107], v164, s[4:7], s33 offen offset:1024 sc1
    buffer_load_dwordx4 v[108:111], v165, s[4:7], s33 offen offset:1024 sc1
    v_mfma_f32_32x32x16_bf16 v[32:47], v[148:151], v[112:115], v[32:47]
    v_mfma_f32_32x32x16_bf16 v[48:63], v[148:151], v[116:119], v[48:63]
    v_mfma_f32_32x32x16_bf16 v[0:15], v[152:155], v[120:123], v[0:15]
    s_add_u32 m0, s49, 16384
    s_add_u32 s34, s35, 1261568
    buffer_load_dwordx4 v245, s[8:11], s34 offen lds
    s_add_u32 m0, s49, 17408
    s_add_u32 s34, s35, 1268736
    buffer_load_dwordx4 v245, s[8:11], s34 offen lds
    s_add_u32 m0, s49, 18432
    s_add_u32 s34, s35, 1275904
    buffer_load_dwordx4 v245, s[8:11], s34 offen lds
    s_add_u32 m0, s49, 19456
    s_add_u32 s34, s35, 1283072
    buffer_load_dwordx4 v245, s[8:11], s34 offen lds
    v_mfma_f32_32x32x16_bf16 v[16:31], v[152:155], v[124:127], v[16:31]
    v_mfma_f32_32x32x16_bf16 v[32:47], v[156:159], v[120:123], v[32:47]
    v_mfma_f32_32x32x16_bf16 v[48:63], v[156:159], v[124:127], v[48:63]
    s_waitcnt vmcnt(24)
    v_mfma_f32_32x32x16_bf16 v[0:15], a[32:35], v[200:203], v[0:15]
    ds_read_b64_tr_b16 v[144:145], v172 offset:32768
    ds_read_b64_tr_b16 v[146:147], v172 offset:33280
    v_mfma_f32_32x32x16_bf16 v[16:31], a[32:35], v[204:207], v[16:31]
    ds_read_b64_tr_b16 v[148:149], v173 offset:32768
    ds_read_b64_tr_b16 v[150:151], v173 offset:33280
    s_add_u32 s33, s29, 32768
    buffer_load_dwordx4 v[112:115], v164, s[4:7], s33 offen offset:0 sc1
    buffer_load_dwordx4 v[116:119], v165, s[4:7], s33 offen offset:0 sc1
    buffer_load_dwordx4 v[120:123], v164, s[4:7], s33 offen offset:1024 sc1
    buffer_load_dwordx4 v[124:127], v165, s[4:7], s33 offen offset:1024 sc1
    v_mfma_f32_32x32x16_bf16 v[32:47], a[36:39], v[200:203], v[32:47]
    ds_read_b64_tr_b16 v[152:153], v172 offset:34816
    ds_read_b64_tr_b16 v[154:155], v172 offset:35328
    v_mfma_f32_32x32x16_bf16 v[48:63], a[36:39], v[204:207], v[48:63]
    ds_read_b64_tr_b16 v[156:157], v173 offset:34816
    ds_read_b64_tr_b16 v[158:159], v173 offset:35328
    v_mfma_f32_32x32x16_bf16 v[0:15], a[40:43], v[208:211], v[0:15]
    v_mfma_f32_32x32x16_bf16 v[16:31], a[40:43], v[212:215], v[16:31]
    v_mfma_f32_32x32x16_bf16 v[32:47], a[44:47], v[208:211], v[32:47]
    v_mfma_f32_32x32x16_bf16 v[48:63], a[44:47], v[212:215], v[48:63]
    s_waitcnt vmcnt(24)
    s_waitcnt lgkmcnt(0)
    v_mfma_f32_32x32x16_bf16 v[0:15], v[144:147], v[216:219], v[0:15]
    v_mfma_f32_32x32x16_bf16 v[16:31], v[144:147], v[220:223], v[16:31]
    s_add_u32 s33, s29, 172032
    buffer_load_dwordx4 v[200:203], v164, s[4:7], s33 offen offset:0 sc1
    buffer_load_dwordx4 v[204:207], v165, s[4:7], s33 offen offset:0 sc1
    buffer_load_dwordx4 v[208:211], v164, s[4:7], s33 offen offset:1024 sc1
    buffer_load_dwordx4 v[212:215], v165, s[4:7], s33 offen offset:1024 sc1
    v_mfma_f32_32x32x16_bf16 v[32:47], v[148:151], v[216:219], v[32:47]
    v_mfma_f32_32x32x16_bf16 v[48:63], v[148:151], v[220:223], v[48:63]
    v_mfma_f32_32x32x16_bf16 v[0:15], v[152:155], v[224:227], v[0:15]
    s_add_u32 m0, s49, 98304
    s_add_u32 s34, s35, 1376256
    buffer_load_dwordx4 v245, s[8:11], s34 offen lds
    s_add_u32 m0, s49, 99328
    s_add_u32 s34, s35, 1383424
    buffer_load_dwordx4 v245, s[8:11], s34 offen lds
    s_add_u32 m0, s49, 100352
    s_add_u32 s34, s35, 1390592
    buffer_load_dwordx4 v245, s[8:11], s34 offen lds
    s_add_u32 m0, s49, 101376
    s_add_u32 s34, s35, 1397760
    buffer_load_dwordx4 v245, s[8:11], s34 offen lds
    v_mfma_f32_32x32x16_bf16 v[16:31], v[152:155], v[228:231], v[16:31]
    v_mfma_f32_32x32x16_bf16 v[32:47], v[156:159], v[224:227], v[32:47]
    v_mfma_f32_32x32x16_bf16 v[48:63], v[156:159], v[228:231], v[48:63]
    s_waitcnt vmcnt(28)
    v_mfma_f32_32x32x16_bf16 v[0:15], a[48:51], v[64:67], v[0:15]
    ds_read_b64_tr_b16 v[144:145], v166 offset:32768
    ds_read_b64_tr_b16 v[146:147], v166 offset:33280
    v_mfma_f32_32x32x16_bf16 v[16:31], a[48:51], v[68:71], v[16:31]
    ds_read_b64_tr_b16 v[148:149], v167 offset:32768
    ds_read_b64_tr_b16 v[150:151], v167 offset:33280
    s_add_u32 s33, s29, 40960
    buffer_load_dwordx4 v[216:219], v164, s[4:7], s33 offen offset:0 sc1
    buffer_load_dwordx4 v[220:223], v165, s[4:7], s33 offen offset:0 sc1
    buffer_load_dwordx4 v[224:227], v164, s[4:7], s33 offen offset:1024 sc1
    buffer_load_dwordx4 v[228:231], v165, s[4:7], s33 offen offset:1024 sc1
    v_mfma_f32_32x32x16_bf16 v[32:47], a[52:55], v[64:67], v[32:47]
    ds_read_b64_tr_b16 v[152:153], v166 offset:34816
    ds_read_b64_tr_b16 v[154:155], v166 offset:35328
    v_mfma_f32_32x32x16_bf16 v[48:63], a[52:55], v[68:71], v[48:63]
    ds_read_b64_tr_b16 v[156:157], v167 offset:34816
    ds_read_b64_tr_b16 v[158:159], v167 offset:35328
    v_mfma_f32_32x32x16_bf16 v[0:15], a[56:59], v[72:75], v[0:15]
    v_mfma_f32_32x32x16_bf16 v[16:31], a[56:59], v[76:79], v[16:31]
    v_mfma_f32_32x32x16_bf16 v[32:47], a[60:63], v[72:75], v[32:47]
    v_mfma_f32_32x32x16_bf16 v[48:63], a[60:63], v[76:79], v[48:63]
    s_waitcnt vmcnt(24)
    s_waitcnt lgkmcnt(0)
    v_mfma_f32_32x32x16_bf16 v[0:15], v[144:147], v[80:83], v[0:15]
    v_mfma_f32_32x32x16_bf16 v[16:31], v[144:147], v[84:87], v[16:31]
    s_add_u32 s33, s29, 180224
    buffer_load_dwordx4 v[64:67], v164, s[4:7], s33 offen offset:0 sc1
    buffer_load_dwordx4 v[68:71], v165, s[4:7], s33 offen offset:0 sc1
    buffer_load_dwordx4 v[72:75], v164, s[4:7], s33 offen offset:1024 sc1
    buffer_load_dwordx4 v[76:79], v165, s[4:7], s33 offen offset:1024 sc1
    v_mfma_f32_32x32x16_bf16 v[32:47], v[148:151], v[80:83], v[32:47]
    v_mfma_f32_32x32x16_bf16 v[48:63], v[148:151], v[84:87], v[48:63]
    v_mfma_f32_32x32x16_bf16 v[0:15], v[152:155], v[88:91], v[0:15]
    s_add_u32 m0, s49, 32768
    s_add_u32 s34, s35, 1490944
    buffer_load_dwordx4 v245, s[8:11], s34 offen lds
    s_add_u32 m0, s49, 33792
    s_add_u32 s34, s35, 1498112
    buffer_load_dwordx4 v245, s[8:11], s34 offen lds
    s_add_u32 m0, s49, 34816
    s_add_u32 s34, s35, 1505280
    buffer_load_dwordx4 v245, s[8:11], s34 offen lds
    s_add_u32 m0, s49, 35840
    s_add_u32 s34, s35, 1512448
    buffer_load_dwordx4 v245, s[8:11], s34 offen lds
    v_mfma_f32_32x32x16_bf16 v[16:31], v[152:155], v[92:95], v[16:31]
    v_mfma_f32_32x32x16_bf16 v[32:47], v[156:159], v[88:91], v[32:47]
    v_mfma_f32_32x32x16_bf16 v[48:63], v[156:159], v[92:95], v[48:63]
    s_waitcnt vmcnt(28)
    v_mfma_f32_32x32x16_bf16 v[0:15], a[64:67], v[96:99], v[0:15]
    ds_read_b64_tr_b16 v[144:145], v172 offset:0
    ds_read_b64_tr_b16 v[146:147], v172 offset:512
    v_mfma_f32_32x32x16_bf16 v[16:31], a[64:67], v[100:103], v[16:31]
    ds_read_b64_tr_b16 v[148:149], v173 offset:0
    ds_read_b64_tr_b16 v[150:151], v173 offset:512
    s_add_u32 s33, s29, 49152
    buffer_load_dwordx4 v[80:83], v164, s[4:7], s33 offen offset:0 sc1
    buffer_load_dwordx4 v[84:87], v165, s[4:7], s33 offen offset:0 sc1
    buffer_load_dwordx4 v[88:91], v164, s[4:7], s33 offen offset:1024 sc1
    buffer_load_dwordx4 v[92:95], v165, s[4:7], s33 offen offset:1024 sc1
    v_mfma_f32_32x32x16_bf16 v[32:47], a[68:71], v[96:99], v[32:47]
    ds_read_b64_tr_b16 v[152:153], v172 offset:2048
    ds_read_b64_tr_b16 v[154:155], v172 offset:2560
    v_mfma_f32_32x32x16_bf16 v[48:63], a[68:71], v[100:103], v[48:63]
    ds_read_b64_tr_b16 v[156:157], v173 offset:2048
    ds_read_b64_tr_b16 v[158:159], v173 offset:2560
    v_mfma_f32_32x32x16_bf16 v[0:15], a[72:75], v[104:107], v[0:15]
    v_mfma_f32_32x32x16_bf16 v[16:31], a[72:75], v[108:111], v[16:31]
    v_mfma_f32_32x32x16_bf16 v[32:47], a[76:79], v[104:107], v[32:47]
    v_mfma_f32_32x32x16_bf16 v[48:63], a[76:79], v[108:111], v[48:63]
    s_waitcnt vmcnt(24)
    s_waitcnt lgkmcnt(0)
    v_mfma_f32_32x32x16_bf16 v[0:15], v[144:147], v[112:115], v[0:15]
    v_mfma_f32_32x32x16_bf16 v[16:31], v[144:147], v[116:119], v[16:31]
    s_add_u32 s33, s29, 188416
    buffer_load_dwordx4 v[96:99], v164, s[4:7], s33 offen offset:0 sc1
    buffer_load_dwordx4 v[100:103], v165, s[4:7], s33 offen offset:0 sc1
    buffer_load_dwordx4 v[104:107], v164, s[4:7], s33 offen offset:1024 sc1
    buffer_load_dwordx4 v[108:111], v165, s[4:7], s33 offen offset:1024 sc1
    v_mfma_f32_32x32x16_bf16 v[32:47], v[148:151], v[112:115], v[32:47]
    v_mfma_f32_32x32x16_bf16 v[48:63], v[148:151], v[116:119], v[48:63]
    v_mfma_f32_32x32x16_bf16 v[0:15], v[152:155], v[120:123], v[0:15]
    s_add_u32 m0, s49, 65536
    s_add_u32 s34, s35, 1605632
    buffer_load_dwordx4 v245, s[8:11], s34 offen lds
    s_add_u32 m0, s49, 66560
    s_add_u32 s34, s35, 1612800
    buffer_load_dwordx4 v245, s[8:11], s34 offen lds
    s_add_u32 m0, s49, 67584
    s_add_u32 s34, s35, 1619968
    buffer_load_dwordx4 v245, s[8:11], s34 offen lds
    s_add_u32 m0, s49, 68608
    s_add_u32 s34, s35, 1627136
    buffer_load_dwordx4 v245, s[8:11], s34 offen lds
    v_mfma_f32_32x32x16_bf16 v[16:31], v[152:155], v[124:127], v[16:31]
    v_mfma_f32_32x32x16_bf16 v[32:47], v[156:159], v[120:123], v[32:47]
    v_mfma_f32_32x32x16_bf16 v[48:63], v[156:159], v[124:127], v[48:63]
    s_waitcnt vmcnt(28)
    v_mfma_f32_32x32x16_bf16 v[0:15], a[80:83], v[200:203], v[0:15]
    ds_read_b64_tr_b16 v[144:145], v166 offset:49152
    ds_read_b64_tr_b16 v[146:147], v166 offset:49664
    v_mfma_f32_32x32x16_bf16 v[16:31], a[80:83], v[204:207], v[16:31]
    ds_read_b64_tr_b16 v[148:149], v167 offset:49152
    ds_read_b64_tr_b16 v[150:151], v167 offset:49664
    s_add_u32 s33, s29, 57344
    buffer_load_dwordx4 v[112:115], v164, s[4:7], s33 offen offset:0 sc1
    buffer_load_dwordx4 v[116:119], v165, s[4:7], s33 offen offset:0 sc1
    buffer_load_dwordx4 v[120:123], v164, s[4:7], s33 offen offset:1024 sc1
    buffer_load_dwordx4 v[124:127], v165, s[4:7], s33 offen offset:1024 sc1
    v_mfma_f32_32x32x16_bf16 v[32:47], a[84:87], v[200:203], v[32:47]
    ds_read_b64_tr_b16 v[152:153], v166 offset:51200
    ds_read_b64_tr_b16 v[154:155], v166 offset:51712
    v_mfma_f32_32x32x16_bf16 v[48:63], a[84:87], v[204:207], v[48:63]
    ds_read_b64_tr_b16 v[156:157], v167 offset:51200
    ds_read_b64_tr_b16 v[158:159], v167 offset:51712
    v_mfma_f32_32x32x16_bf16 v[0:15], a[88:91], v[208:211], v[0:15]
    v_mfma_f32_32x32x16_bf16 v[16:31], a[88:91], v[212:215], v[16:31]
    v_mfma_f32_32x32x16_bf16 v[32:47], a[92:95], v[208:211], v[32:47]
    v_mfma_f32_32x32x16_bf16 v[48:63], a[92:95], v[212:215], v[48:63]
    s_waitcnt vmcnt(24)
    s_waitcnt lgkmcnt(0)
    v_mfma_f32_32x32x16_bf16 v[0:15], v[144:147], v[216:219], v[0:15]
    v_mfma_f32_32x32x16_bf16 v[16:31], v[144:147], v[220:223], v[16:31]
    s_add_u32 s33, s29, 196608
    buffer_load_dwordx4 v[200:203], v164, s[4:7], s33 offen offset:0 sc1
    buffer_load_dwordx4 v[204:207], v165, s[4:7], s33 offen offset:0 sc1
    buffer_load_dwordx4 v[208:211], v164, s[4:7], s33 offen offset:1024 sc1
    buffer_load_dwordx4 v[212:215], v165, s[4:7], s33 offen offset:1024 sc1
    v_mfma_f32_32x32x16_bf16 v[32:47], v[148:151], v[216:219], v[32:47]
    v_mfma_f32_32x32x16_bf16 v[48:63], v[148:151], v[220:223], v[48:63]
    v_mfma_f32_32x32x16_bf16 v[0:15], v[152:155], v[224:227], v[0:15]
    s_add_u32 m0, s49, 49152
    s_add_u32 s34, s35, 1720320
    buffer_load_dwordx4 v245, s[8:11], s34 offen lds
    s_add_u32 m0, s49, 50176
    s_add_u32 s34, s35, 1727488
    buffer_load_dwordx4 v245, s[8:11], s34 offen lds
    s_add_u32 m0, s49, 51200
    s_add_u32 s34, s35, 1734656
    buffer_load_dwordx4 v245, s[8:11], s34 offen lds
    s_add_u32 m0, s49, 52224
    s_add_u32 s34, s35, 1741824
    buffer_load_dwordx4 v245, s[8:11], s34 offen lds
    v_mfma_f32_32x32x16_bf16 v[16:31], v[152:155], v[228:231], v[16:31]
    v_mfma_f32_32x32x16_bf16 v[32:47], v[156:159], v[224:227], v[32:47]
    v_mfma_f32_32x32x16_bf16 v[48:63], v[156:159], v[228:231], v[48:63]
    s_waitcnt vmcnt(28)
    v_mfma_f32_32x32x16_bf16 v[0:15], a[96:99], v[64:67], v[0:15]
    ds_read_b64_tr_b16 v[144:145], v172 offset:16384
    ds_read_b64_tr_b16 v[146:147], v172 offset:16896
    v_mfma_f32_32x32x16_bf16 v[16:31], a[96:99], v[68:71], v[16:31]
    ds_read_b64_tr_b16 v[148:149], v173 offset:16384
    ds_read_b64_tr_b16 v[150:151], v173 offset:16896
    s_add_u32 s33, s29, 65536
    buffer_load_dwordx4 v[216:219], v164, s[4:7], s33 offen offset:0 sc1
    buffer_load_dwordx4 v[220:223], v165, s[4:7], s33 offen offset:0 sc1
    buffer_load_dwordx4 v[224:227], v164, s[4:7], s33 offen offset:1024 sc1
    buffer_load_dwordx4 v[228:231], v165, s[4:7], s33 offen offset:1024 sc1
    v_mfma_f32_32x32x16_bf16 v[32:47], a[100:103], v[64:67], v[32:47]
    ds_read_b64_tr_b16 v[152:153], v172 offset:18432
    ds_read_b64_tr_b16 v[154:155], v172 offset:18944
    v_mfma_f32_32x32x16_bf16 v[48:63], a[100:103], v[68:71], v[48:63]
    ds_read_b64_tr_b16 v[156:157], v173 offset:18432
    ds_read_b64_tr_b16 v[158:159], v173 offset:18944
    v_mfma_f32_32x32x16_bf16 v[0:15], a[104:107], v[72:75], v[0:15]
    v_mfma_f32_32x32x16_bf16 v[16:31], a[104:107], v[76:79], v[16:31]
    v_mfma_f32_32x32x16_bf16 v[32:47], a[108:111], v[72:75], v[32:47]
    v_mfma_f32_32x32x16_bf16 v[48:63], a[108:111], v[76:79], v[48:63]
    s_waitcnt vmcnt(24)
    s_waitcnt lgkmcnt(0)
    v_mfma_f32_32x32x16_bf16 v[0:15], v[144:147], v[80:83], v[0:15]
    v_mfma_f32_32x32x16_bf16 v[16:31], v[144:147], v[84:87], v[16:31]
    s_add_u32 s33, s29, 204800
    buffer_load_dwordx4 v[64:67], v164, s[4:7], s33 offen offset:0 sc1
    buffer_load_dwordx4 v[68:71], v165, s[4:7], s33 offen offset:0 sc1
    buffer_load_dwordx4 v[72:75], v164, s[4:7], s33 offen offset:1024 sc1
    buffer_load_dwordx4 v[76:79], v165, s[4:7], s33 offen offset:1024 sc1
    v_mfma_f32_32x32x16_bf16 v[32:47], v[148:151], v[80:83], v[32:47]
    v_mfma_f32_32x32x16_bf16 v[48:63], v[148:151], v[84:87], v[48:63]
    v_mfma_f32_32x32x16_bf16 v[0:15], v[152:155], v[88:91], v[0:15]
    v_mfma_f32_32x32x16_bf16 v[16:31], v[152:155], v[92:95], v[16:31]
    v_mfma_f32_32x32x16_bf16 v[32:47], v[156:159], v[88:91], v[32:47]
    v_mfma_f32_32x32x16_bf16 v[48:63], v[156:159], v[92:95], v[48:63]
    s_waitcnt vmcnt(24)
    v_mfma_f32_32x32x16_bf16 v[0:15], a[112:115], v[96:99], v[0:15]
    ds_read_b64_tr_b16 v[144:145], v174 offset:0
    ds_read_b64_tr_b16 v[146:147], v174 offset:512
    v_mfma_f32_32x32x16_bf16 v[16:31], a[112:115], v[100:103], v[16:31]
    ds_read_b64_tr_b16 v[148:149], v175 offset:0
    ds_read_b64_tr_b16 v[150:151], v175 offset:512
    s_add_u32 s33, s29, 73728
    buffer_load_dwordx4 v[80:83], v164, s[4:7], s33 offen offset:0 sc1
    buffer_load_dwordx4 v[84:87], v165, s[4:7], s33 offen offset:0 sc1
    buffer_load_dwordx4 v[88:91], v164, s[4:7], s33 offen offset:1024 sc1
    buffer_load_dwordx4 v[92:95], v165, s[4:7], s33 offen offset:1024 sc1
    v_mfma_f32_32x32x16_bf16 v[32:47], a[116:119], v[96:99], v[32:47]
    ds_read_b64_tr_b16 v[152:153], v174 offset:2048
    ds_read_b64_tr_b16 v[154:155], v174 offset:2560
    v_mfma_f32_32x32x16_bf16 v[48:63], a[116:119], v[100:103], v[48:63]
    ds_read_b64_tr_b16 v[156:157], v175 offset:2048
    ds_read_b64_tr_b16 v[158:159], v175 offset:2560
    v_mfma_f32_32x32x16_bf16 v[0:15], a[120:123], v[104:107], v[0:15]
    v_mfma_f32_32x32x16_bf16 v[16:31], a[120:123], v[108:111], v[16:31]
    v_mfma_f32_32x32x16_bf16 v[32:47], a[124:127], v[104:107], v[32:47]
    v_mfma_f32_32x32x16_bf16 v[48:63], a[124:127], v[108:111], v[48:63]
    s_waitcnt vmcnt(20)
    s_waitcnt lgkmcnt(0)
    v_mfma_f32_32x32x16_bf16 v[0:15], v[144:147], v[112:115], v[0:15]
    v_mfma_f32_32x32x16_bf16 v[16:31], v[144:147], v[116:119], v[16:31]
    s_add_u32 s33, s29, 212992
    buffer_load_dwordx4 v[96:99], v164, s[4:7], s33 offen offset:0 sc1
    buffer_load_dwordx4 v[100:103], v165, s[4:7], s33 offen offset:0 sc1
    buffer_load_dwordx4 v[104:107], v164, s[4:7], s33 offen offset:1024 sc1
    buffer_load_dwordx4 v[108:111], v165, s[4:7], s33 offen offset:1024 sc1
    v_mfma_f32_32x32x16_bf16 v[32:47], v[148:151], v[112:115], v[32:47]
    v_mfma_f32_32x32x16_bf16 v[48:63], v[148:151], v[116:119], v[48:63]
    v_mfma_f32_32x32x16_bf16 v[0:15], v[152:155], v[120:123], v[0:15]
    v_mfma_f32_32x32x16_bf16 v[16:31], v[152:155], v[124:127], v[16:31]
    v_mfma_f32_32x32x16_bf16 v[32:47], v[156:159], v[120:123], v[32:47]
    v_mfma_f32_32x32x16_bf16 v[48:63], v[156:159], v[124:127], v[48:63]
    s_waitcnt vmcnt(20)
    v_mfma_f32_32x32x16_bf16 v[0:15], a[128:131], v[200:203], v[0:15]
    ds_read_b64_tr_b16 v[144:145], v174 offset:16384
    ds_read_b64_tr_b16 v[146:147], v174 offset:16896
    v_mfma_f32_32x32x16_bf16 v[16:31], a[128:131], v[204:207], v[16:31]
    ds_read_b64_tr_b16 v[148:149], v175 offset:16384
    ds_read_b64_tr_b16 v[150:151], v175 offset:16896
    s_add_u32 s33, s29, 81920
    buffer_load_dwordx4 v[112:115], v164, s[4:7], s33 offen offset:0 sc1
    buffer_load_dwordx4 v[116:119], v165, s[4:7], s33 offen offset:0 sc1
    buffer_load_dwordx4 v[120:123], v164, s[4:7], s33 offen offset:1024 sc1
    buffer_load_dwordx4 v[124:127], v165, s[4:7], s33 offen offset:1024 sc1
    v_mfma_f32_32x32x16_bf16 v[32:47], a[132:135], v[200:203], v[32:47]
    ds_read_b64_tr_b16 v[152:153], v174 offset:18432
    ds_read_b64_tr_b16 v[154:155], v174 offset:18944
    v_mfma_f32_32x32x16_bf16 v[48:63], a[132:135], v[204:207], v[48:63]
    ds_read_b64_tr_b16 v[156:157], v175 offset:18432
    ds_read_b64_tr_b16 v[158:159], v175 offset:18944
    v_mfma_f32_32x32x16_bf16 v[0:15], a[136:139], v[208:211], v[0:15]
    v_mfma_f32_32x32x16_bf16 v[16:31], a[136:139], v[212:215], v[16:31]
    v_mfma_f32_32x32x16_bf16 v[32:47], a[140:143], v[208:211], v[32:47]
    v_mfma_f32_32x32x16_bf16 v[48:63], a[140:143], v[212:215], v[48:63]
    s_waitcnt vmcnt(16)
    s_waitcnt lgkmcnt(0)
    v_mfma_f32_32x32x16_bf16 v[0:15], v[144:147], v[216:219], v[0:15]
    v_mfma_f32_32x32x16_bf16 v[16:31], v[144:147], v[220:223], v[16:31]
    s_add_u32 s33, s29, 221184
    buffer_load_dwordx4 v[200:203], v164, s[4:7], s33 offen offset:0 sc1
    buffer_load_dwordx4 v[204:207], v165, s[4:7], s33 offen offset:0 sc1
    buffer_load_dwordx4 v[208:211], v164, s[4:7], s33 offen offset:1024 sc1
    buffer_load_dwordx4 v[212:215], v165, s[4:7], s33 offen offset:1024 sc1
    v_mfma_f32_32x32x16_bf16 v[32:47], v[148:151], v[216:219], v[32:47]
    v_mfma_f32_32x32x16_bf16 v[48:63], v[148:151], v[220:223], v[48:63]
    v_mfma_f32_32x32x16_bf16 v[0:15], v[152:155], v[224:227], v[0:15]
    v_mfma_f32_32x32x16_bf16 v[16:31], v[152:155], v[228:231], v[16:31]
    v_mfma_f32_32x32x16_bf16 v[32:47], v[156:159], v[224:227], v[32:47]
    v_mfma_f32_32x32x16_bf16 v[48:63], v[156:159], v[228:231], v[48:63]
    s_waitcnt vmcnt(16)
    v_mfma_f32_32x32x16_bf16 v[0:15], a[144:147], v[64:67], v[0:15]
    ds_read_b64_tr_b16 v[144:145], v172 offset:49152
    ds_read_b64_tr_b16 v[146:147], v172 offset:49664
    v_mfma_f32_32x32x16_bf16 v[16:31], a[144:147], v[68:71], v[16:31]
    ds_read_b64_tr_b16 v[148:149], v173 offset:49152
    ds_read_b64_tr_b16 v[150:151], v173 offset:49664
    s_add_u32 s33, s29, 90112
    buffer_load_dwordx4 v[216:219], v164, s[4:7], s33 offen offset:0 sc1
    buffer_load_dwordx4 v[220:223], v165, s[4:7], s33 offen offset:0 sc1
    buffer_load_dwordx4 v[224:227], v164, s[4:7], s33 offen offset:1024 sc1
    buffer_load_dwordx4 v[228:231], v165, s[4:7], s33 offen offset:1024 sc1
    v_mfma_f32_32x32x16_bf16 v[32:47], a[148:151], v[64:67], v[32:47]
    ds_read_b64_tr_b16 v[152:153], v172 offset:51200
    ds_read_b64_tr_b16 v[154:155], v172 offset:51712
    v_mfma_f32_32x32x16_bf16 v[48:63], a[148:151], v[68:71], v[48:63]
    ds_read_b64_tr_b16 v[156:157], v173 offset:51200
    ds_read_b64_tr_b16 v[158:159], v173 offset:51712
    v_mfma_f32_32x32x16_bf16 v[0:15], a[152:155], v[72:75], v[0:15]
    v_mfma_f32_32x32x16_bf16 v[16:31], a[152:155], v[76:79], v[16:31]
    v_mfma_f32_32x32x16_bf16 v[32:47], a[156:159], v[72:75], v[32:47]
    v_mfma_f32_32x32x16_bf16 v[48:63], a[156:159], v[76:79], v[48:63]
    s_waitcnt vmcnt(16)
    s_waitcnt lgkmcnt(0)
    v_mfma_f32_32x32x16_bf16 v[0:15], v[144:147], v[80:83], v[0:15]
    v_mfma_f32_32x32x16_bf16 v[16:31], v[144:147], v[84:87], v[16:31]
    s_add_u32 s33, s29, 229376
    buffer_load_dwordx4 v[64:67], v164, s[4:7], s33 offen offset:0 sc1
    buffer_load_dwordx4 v[68:71], v165, s[4:7], s33 offen offset:0 sc1
    buffer_load_dwordx4 v[72:75], v164, s[4:7], s33 offen offset:1024 sc1
    buffer_load_dwordx4 v[76:79], v165, s[4:7], s33 offen offset:1024 sc1
    v_mfma_f32_32x32x16_bf16 v[32:47], v[148:151], v[80:83], v[32:47]
    v_mfma_f32_32x32x16_bf16 v[48:63], v[148:151], v[84:87], v[48:63]
    v_mfma_f32_32x32x16_bf16 v[0:15], v[152:155], v[88:91], v[0:15]
    v_mfma_f32_32x32x16_bf16 v[16:31], v[152:155], v[92:95], v[16:31]
    v_mfma_f32_32x32x16_bf16 v[32:47], v[156:159], v[88:91], v[32:47]
    v_mfma_f32_32x32x16_bf16 v[48:63], v[156:159], v[92:95], v[48:63]
    s_waitcnt vmcnt(16)
    v_mfma_f32_32x32x16_bf16 v[0:15], a[160:163], v[96:99], v[0:15]
    ds_read_b64_tr_b16 v[144:145], v166 offset:0
    ds_read_b64_tr_b16 v[146:147], v166 offset:512
    v_mfma_f32_32x32x16_bf16 v[16:31], a[160:163], v[100:103], v[16:31]
    ds_read_b64_tr_b16 v[148:149], v167 offset:0
    ds_read_b64_tr_b16 v[150:151], v167 offset:512
    s_add_u32 s33, s29, 98304
    buffer_load_dwordx4 v[80:83], v164, s[4:7], s33 offen offset:0 sc1
    buffer_load_dwordx4 v[84:87], v165, s[4:7], s33 offen offset:0 sc1
    buffer_load_dwordx4 v[88:91], v164, s[4:7], s33 offen offset:1024 sc1
    buffer_load_dwordx4 v[92:95], v165, s[4:7], s33 offen offset:1024 sc1
    v_mfma_f32_32x32x16_bf16 v[32:47], a[164:167], v[96:99], v[32:47]
    ds_read_b64_tr_b16 v[152:153], v166 offset:2048
    ds_read_b64_tr_b16 v[154:155], v166 offset:2560
    v_mfma_f32_32x32x16_bf16 v[48:63], a[164:167], v[100:103], v[48:63]
    ds_read_b64_tr_b16 v[156:157], v167 offset:2048
    ds_read_b64_tr_b16 v[158:159], v167 offset:2560
    v_mfma_f32_32x32x16_bf16 v[0:15], a[168:171], v[104:107], v[0:15]
    v_mfma_f32_32x32x16_bf16 v[16:31], a[168:171], v[108:111], v[16:31]
    v_mfma_f32_32x32x16_bf16 v[32:47], a[172:175], v[104:107], v[32:47]
    v_mfma_f32_32x32x16_bf16 v[48:63], a[172:175], v[108:111], v[48:63]
    s_waitcnt vmcnt(16)
    s_waitcnt lgkmcnt(0)
    v_mfma_f32_32x32x16_bf16 v[0:15], v[144:147], v[112:115], v[0:15]
    v_mfma_f32_32x32x16_bf16 v[16:31], v[144:147], v[116:119], v[16:31]
    s_add_u32 s33, s29, 237568
    buffer_load_dwordx4 v[96:99], v164, s[4:7], s33 offen offset:0 sc1
    buffer_load_dwordx4 v[100:103], v165, s[4:7], s33 offen offset:0 sc1
    buffer_load_dwordx4 v[104:107], v164, s[4:7], s33 offen offset:1024 sc1
    buffer_load_dwordx4 v[108:111], v165, s[4:7], s33 offen offset:1024 sc1
    v_mfma_f32_32x32x16_bf16 v[32:47], v[148:151], v[112:115], v[32:47]
    v_mfma_f32_32x32x16_bf16 v[48:63], v[148:151], v[116:119], v[48:63]
    v_mfma_f32_32x32x16_bf16 v[0:15], v[152:155], v[120:123], v[0:15]
    v_mfma_f32_32x32x16_bf16 v[16:31], v[152:155], v[124:127], v[16:31]
    v_mfma_f32_32x32x16_bf16 v[32:47], v[156:159], v[120:123], v[32:47]
    v_mfma_f32_32x32x16_bf16 v[48:63], v[156:159], v[124:127], v[48:63]
    s_waitcnt vmcnt(16)
    v_mfma_f32_32x32x16_bf16 v[0:15], a[176:179], v[200:203], v[0:15]
    ds_read_b64_tr_b16 v[144:145], v166 offset:16384
    ds_read_b64_tr_b16 v[146:147], v166 offset:16896
    v_mfma_f32_32x32x16_bf16 v[16:31], a[176:179], v[204:207], v[16:31]
    ds_read_b64_tr_b16 v[148:149], v167 offset:16384
    ds_read_b64_tr_b16 v[150:151], v167 offset:16896
    s_add_u32 s33, s29, 106496
    buffer_load_dwordx4 v[112:115], v164, s[4:7], s33 offen offset:0 sc1
    buffer_load_dwordx4 v[116:119], v165, s[4:7], s33 offen offset:0 sc1
    buffer_load_dwordx4 v[120:123], v164, s[4:7], s33 offen offset:1024 sc1
    buffer_load_dwordx4 v[124:127], v165, s[4:7], s33 offen offset:1024 sc1
    v_mfma_f32_32x32x16_bf16 v[32:47], a[180:183], v[200:203], v[32:47]
    ds_read_b64_tr_b16 v[152:153], v166 offset:18432
    ds_read_b64_tr_b16 v[154:155], v166 offset:18944
    v_mfma_f32_32x32x16_bf16 v[48:63], a[180:183], v[204:207], v[48:63]
    ds_read_b64_tr_b16 v[156:157], v167 offset:18432
    ds_read_b64_tr_b16 v[158:159], v167 offset:18944
    v_mfma_f32_32x32x16_bf16 v[0:15], a[184:187], v[208:211], v[0:15]
    v_mfma_f32_32x32x16_bf16 v[16:31], a[184:187], v[212:215], v[16:31]
    v_mfma_f32_32x32x16_bf16 v[32:47], a[188:191], v[208:211], v[32:47]
    v_mfma_f32_32x32x16_bf16 v[48:63], a[188:191], v[212:215], v[48:63]
    s_waitcnt vmcnt(16)
    s_waitcnt lgkmcnt(0)
    v_mfma_f32_32x32x16_bf16 v[0:15], v[144:147], v[216:219], v[0:15]
    v_mfma_f32_32x32x16_bf16 v[16:31], v[144:147], v[220:223], v[16:31]
    s_add_u32 s33, s29, 245760
    buffer_load_dwordx4 v[200:203], v164, s[4:7], s33 offen offset:0 sc1
    buffer_load_dwordx4 v[204:207], v165, s[4:7], s33 offen offset:0 sc1
    buffer_load_dwordx4 v[208:211], v164, s[4:7], s33 offen offset:1024 sc1
    buffer_load_dwordx4 v[212:215], v165, s[4:7], s33 offen offset:1024 sc1
    v_mfma_f32_32x32x16_bf16 v[32:47], v[148:151], v[216:219], v[32:47]
    v_mfma_f32_32x32x16_bf16 v[48:63], v[148:151], v[220:223], v[48:63]
    v_mfma_f32_32x32x16_bf16 v[0:15], v[152:155], v[224:227], v[0:15]
    v_mfma_f32_32x32x16_bf16 v[16:31], v[152:155], v[228:231], v[16:31]
    v_mfma_f32_32x32x16_bf16 v[32:47], v[156:159], v[224:227], v[32:47]
    v_mfma_f32_32x32x16_bf16 v[48:63], v[156:159], v[228:231], v[48:63]
    s_waitcnt vmcnt(16)
    v_mfma_f32_32x32x16_bf16 v[0:15], a[192:195], v[64:67], v[0:15]
    ds_read_b64_tr_b16 v[144:145], v172 offset:32768
    ds_read_b64_tr_b16 v[146:147], v172 offset:33280
    v_mfma_f32_32x32x16_bf16 v[16:31], a[192:195], v[68:71], v[16:31]
    ds_read_b64_tr_b16 v[148:149], v173 offset:32768
    ds_read_b64_tr_b16 v[150:151], v173 offset:33280
    s_add_u32 s33, s29, 114688
    buffer_load_dwordx4 v[216:219], v164, s[4:7], s33 offen offset:0 sc1
    buffer_load_dwordx4 v[220:223], v165, s[4:7], s33 offen offset:0 sc1
    buffer_load_dwordx4 v[224:227], v164, s[4:7], s33 offen offset:1024 sc1
    buffer_load_dwordx4 v[228:231], v165, s[4:7], s33 offen offset:1024 sc1
    v_mfma_f32_32x32x16_bf16 v[32:47], a[196:199], v[64:67], v[32:47]
    ds_read_b64_tr_b16 v[152:153], v172 offset:34816
    ds_read_b64_tr_b16 v[154:155], v172 offset:35328
    v_mfma_f32_32x32x16_bf16 v[48:63], a[196:199], v[68:71], v[48:63]
    ds_read_b64_tr_b16 v[156:157], v173 offset:34816
    ds_read_b64_tr_b16 v[158:159], v173 offset:35328
    v_mfma_f32_32x32x16_bf16 v[0:15], a[200:203], v[72:75], v[0:15]
    v_mfma_f32_32x32x16_bf16 v[16:31], a[200:203], v[76:79], v[16:31]
    v_mfma_f32_32x32x16_bf16 v[32:47], a[204:207], v[72:75], v[32:47]
    v_mfma_f32_32x32x16_bf16 v[48:63], a[204:207], v[76:79], v[48:63]
    s_waitcnt vmcnt(16)
    s_waitcnt lgkmcnt(0)
    v_mfma_f32_32x32x16_bf16 v[0:15], v[144:147], v[80:83], v[0:15]
    v_mfma_f32_32x32x16_bf16 v[16:31], v[144:147], v[84:87], v[16:31]
    s_add_u32 s33, s29, 253952
    buffer_load_dwordx4 v[64:67], v164, s[4:7], s33 offen offset:0 sc1
    buffer_load_dwordx4 v[68:71], v165, s[4:7], s33 offen offset:0 sc1
    buffer_load_dwordx4 v[72:75], v164, s[4:7], s33 offen offset:1024 sc1
    buffer_load_dwordx4 v[76:79], v165, s[4:7], s33 offen offset:1024 sc1
    v_mfma_f32_32x32x16_bf16 v[32:47], v[148:151], v[80:83], v[32:47]
    v_mfma_f32_32x32x16_bf16 v[48:63], v[148:151], v[84:87], v[48:63]
    v_mfma_f32_32x32x16_bf16 v[0:15], v[152:155], v[88:91], v[0:15]
    v_mfma_f32_32x32x16_bf16 v[16:31], v[152:155], v[92:95], v[16:31]
    v_mfma_f32_32x32x16_bf16 v[32:47], v[156:159], v[88:91], v[32:47]
    v_mfma_f32_32x32x16_bf16 v[48:63], v[156:159], v[92:95], v[48:63]
    s_waitcnt vmcnt(16)
    v_mfma_f32_32x32x16_bf16 v[0:15], a[208:211], v[96:99], v[0:15]
    ds_read_b64_tr_b16 v[144:145], v166 offset:32768
    ds_read_b64_tr_b16 v[146:147], v166 offset:33280
    v_mfma_f32_32x32x16_bf16 v[16:31], a[208:211], v[100:103], v[16:31]
    ds_read_b64_tr_b16 v[148:149], v167 offset:32768
    ds_read_b64_tr_b16 v[150:151], v167 offset:33280
    s_add_u32 s33, s29, 122880
    buffer_load_dwordx4 v[80:83], v164, s[4:7], s33 offen offset:0 sc1
    buffer_load_dwordx4 v[84:87], v165, s[4:7], s33 offen offset:0 sc1
    buffer_load_dwordx4 v[88:91], v164, s[4:7], s33 offen offset:1024 sc1
    buffer_load_dwordx4 v[92:95], v165, s[4:7], s33 offen offset:1024 sc1
    v_mfma_f32_32x32x16_bf16 v[32:47], a[212:215], v[96:99], v[32:47]
    ds_read_b64_tr_b16 v[152:153], v166 offset:34816
    ds_read_b64_tr_b16 v[154:155], v166 offset:35328
    v_mfma_f32_32x32x16_bf16 v[48:63], a[212:215], v[100:103], v[48:63]
    ds_read_b64_tr_b16 v[156:157], v167 offset:34816
    ds_read_b64_tr_b16 v[158:159], v167 offset:35328
    v_mfma_f32_32x32x16_bf16 v[0:15], a[216:219], v[104:107], v[0:15]
    v_mfma_f32_32x32x16_bf16 v[16:31], a[216:219], v[108:111], v[16:31]
    v_mfma_f32_32x32x16_bf16 v[32:47], a[220:223], v[104:107], v[32:47]
    v_mfma_f32_32x32x16_bf16 v[48:63], a[220:223], v[108:111], v[48:63]
    s_waitcnt vmcnt(16)
    s_waitcnt lgkmcnt(0)
    v_mfma_f32_32x32x16_bf16 v[0:15], v[144:147], v[112:115], v[0:15]
    v_mfma_f32_32x32x16_bf16 v[16:31], v[144:147], v[116:119], v[16:31]
    v_mfma_f32_32x32x16_bf16 v[32:47], v[148:151], v[112:115], v[32:47]
    v_mfma_f32_32x32x16_bf16 v[48:63], v[148:151], v[116:119], v[48:63]
    v_mfma_f32_32x32x16_bf16 v[0:15], v[152:155], v[120:123], v[0:15]
    v_mfma_f32_32x32x16_bf16 v[16:31], v[152:155], v[124:127], v[16:31]
    s_and_b32 s75, s2, 31
    s_lshl_b32 s75, s75, 8
    s_add_u32 s75, s75, 12288
    v_mov_b32 v233, 0
    buffer_load_dword v232, v233, s[68:71], s75 offen sc1
    v_mfma_f32_32x32x16_bf16 v[32:47], v[156:159], v[120:123], v[32:47]
    v_mfma_f32_32x32x16_bf16 v[48:63], v[156:159], v[124:127], v[48:63]
    s_waitcnt vmcnt(13)
    v_mfma_f32_32x32x16_bf16 v[0:15], a[224:227], v[200:203], v[0:15]
    ds_read_b64_tr_b16 v[144:145], v172 offset:0
    ds_read_b64_tr_b16 v[146:147], v172 offset:512
    v_mfma_f32_32x32x16_bf16 v[16:31], a[224:227], v[204:207], v[16:31]
    ds_read_b64_tr_b16 v[148:149], v173 offset:0
    ds_read_b64_tr_b16 v[150:151], v173 offset:512
    v_mfma_f32_32x32x16_bf16 v[32:47], a[228:231], v[200:203], v[32:47]
    ds_read_b64_tr_b16 v[152:153], v172 offset:2048
    ds_read_b64_tr_b16 v[154:155], v172 offset:2560
    v_mfma_f32_32x32x16_bf16 v[48:63], a[228:231], v[204:207], v[48:63]
    ds_read_b64_tr_b16 v[156:157], v173 offset:2048
    ds_read_b64_tr_b16 v[158:159], v173 offset:2560
    v_mfma_f32_32x32x16_bf16 v[0:15], a[232:235], v[208:211], v[0:15]
    v_mfma_f32_32x32x16_bf16 v[16:31], a[232:235], v[212:215], v[16:31]
    v_mfma_f32_32x32x16_bf16 v[32:47], a[236:239], v[208:211], v[32:47]
    v_mfma_f32_32x32x16_bf16 v[48:63], a[236:239], v[212:215], v[48:63]
    s_waitcnt vmcnt(9)
    s_waitcnt lgkmcnt(0)
    v_mfma_f32_32x32x16_bf16 v[0:15], v[144:147], v[216:219], v[0:15]
    v_mfma_f32_32x32x16_bf16 v[16:31], v[144:147], v[220:223], v[16:31]
    v_mfma_f32_32x32x16_bf16 v[32:47], v[148:151], v[216:219], v[32:47]
    v_mfma_f32_32x32x16_bf16 v[48:63], v[148:151], v[220:223], v[48:63]
    v_mfma_f32_32x32x16_bf16 v[0:15], v[152:155], v[224:227], v[0:15]
    v_mfma_f32_32x32x16_bf16 v[16:31], v[152:155], v[228:231], v[16:31]
    v_mfma_f32_32x32x16_bf16 v[32:47], v[156:159], v[224:227], v[32:47]
    v_mfma_f32_32x32x16_bf16 v[48:63], v[156:159], v[228:231], v[48:63]
    s_waitcnt vmcnt(5)
    v_mfma_f32_32x32x16_bf16 v[0:15], a[240:243], v[64:67], v[0:15]
    ds_read_b64_tr_b16 v[144:145], v166 offset:49152
    ds_read_b64_tr_b16 v[146:147], v166 offset:49664
    v_mfma_f32_32x32x16_bf16 v[16:31], a[240:243], v[68:71], v[16:31]
    ds_read_b64_tr_b16 v[148:149], v167 offset:49152
    ds_read_b64_tr_b16 v[150:151], v167 offset:49664
    v_mfma_f32_32x32x16_bf16 v[32:47], a[244:247], v[64:67], v[32:47]
    ds_read_b64_tr_b16 v[152:153], v166 offset:51200
    ds_read_b64_tr_b16 v[154:155], v166 offset:51712
    v_mfma_f32_32x32x16_bf16 v[48:63], a[244:247], v[68:71], v[48:63]
    ds_read_b64_tr_b16 v[156:157], v167 offset:51200
    ds_read_b64_tr_b16 v[158:159], v167 offset:51712
    v_mfma_f32_32x32x16_bf16 v[0:15], a[248:251], v[72:75], v[0:15]
    v_mfma_f32_32x32x16_bf16 v[16:31], a[248:251], v[76:79], v[16:31]
    v_mfma_f32_32x32x16_bf16 v[32:47], a[252:255], v[72:75], v[32:47]
    v_mfma_f32_32x32x16_bf16 v[48:63], a[252:255], v[76:79], v[48:63]
    s_waitcnt vmcnt(1)
    s_waitcnt lgkmcnt(0)
    v_mfma_f32_32x32x16_bf16 v[0:15], v[144:147], v[80:83], v[0:15]
    v_mfma_f32_32x32x16_bf16 v[16:31], v[144:147], v[84:87], v[16:31]
    v_mfma_f32_32x32x16_bf16 v[32:47], v[148:151], v[80:83], v[32:47]
    v_mfma_f32_32x32x16_bf16 v[48:63], v[148:151], v[84:87], v[48:63]
    v_mfma_f32_32x32x16_bf16 v[0:15], v[152:155], v[88:91], v[0:15]
    v_mfma_f32_32x32x16_bf16 v[16:31], v[152:155], v[92:95], v[16:31]
    v_mfma_f32_32x32x16_bf16 v[32:47], v[156:159], v[88:91], v[32:47]
    v_mfma_f32_32x32x16_bf16 v[48:63], v[156:159], v[92:95], v[48:63]
    s_nop 15
    s_waitcnt vmcnt(0)
    s_mov_b32 s72, 0
P2L_P:
    v_readfirstlane_b32 s60, v232
    s_cmp_ge_u32 s60, 60
    s_cbranch_scc1 P2L_D
    s_sleep 1
    buffer_load_dword v232, v233, s[68:71], s75 offen sc1
    s_waitcnt vmcnt(0)
    s_add_u32 s72, s72, 1
    s_cmp_lt_u32 s72, 0x400000
    s_cbranch_scc1 P2L_P
P2L_D:
    buffer_load_dwordx4 v[184:187], v169, s[20:23], s59 offen offset:0 sc1
    buffer_load_dwordx4 v[188:191], v169, s[20:23], s59 offen offset:32 sc1
    buffer_load_dwordx4 v[192:195], v169, s[20:23], s59 offen offset:64 sc1
    buffer_load_dwordx4 v[196:199], v169, s[20:23], s59 offen offset:96 sc1
    s_add_u32 s60, s59, 3584
    buffer_load_dwordx4 v[128:131], v169, s[20:23], s60 offen offset:0 sc1
    buffer_load_dwordx4 v[132:135], v169, s[20:23], s60 offen offset:32 sc1
    buffer_load_dwordx4 v[136:139], v169, s[20:23], s60 offen offset:64 sc1
    buffer_load_dwordx4 v[140:143], v169, s[20:23], s60 offen offset:96 sc1
    s_lshr_b32 s30, s2, 3
    s_cmp_ge_u32 s30, 14
    s_cselect_b32 s33, 14, 0
    s_sub_u32 s30, s30, s33
    s_lshl_b32 s29, s30, 8
    s_and_b32 s30, s28, 1
    s_lshl_b32 s33, s30, 10
    s_mul_i32 s30, s30, 57344
    s_add_u32 s29, s29, s30
    s_lshr_b32 s31, s28, 1
    s_mul_i32 s31, s31, 28672
    s_add_u32 s31, s31, s33
    s_cmp_ge_u32 s28, 2
    s_cselect_b32 s88, s94, s92
    s_cselect_b32 s89, s95, s93
    s_mov_b32 s90, 1605632
    s_mov_b32 s91, 0x00020000
    v_lshrrev_b32 v232, 2, v240
    v_and_b32 v233, 3, v240
    v_lshlrev_b32 v233, 4, v233
    v_mul_u32_u24 v245, 3584, v232
    v_add_u32 v245, v245, v233
    s_barrier
    s_add_u32 m0, s31, 49152
    s_add_u32 s33, s29, 0
    buffer_load_dwordx4 v245, s[88:91], s33 offen lds
    s_add_u32 m0, s31, 51200
    s_add_u32 s33, s29, 114688
    buffer_load_dwordx4 v245, s[88:91], s33 offen lds
    s_add_u32 m0, s31, 53248
    s_add_u32 s33, s29, 229376
    buffer_load_dwordx4 v245, s[88:91], s33 offen lds
    s_xor_b32 s60, s28, 1
    s_mul_i32 s60, s60, 12288
    v_add_u32 v170, s60, v163
    ds_write_b128 v170, v[16:19] offset:0
    ds_write_b128 v170, v[20:23] offset:1024
    ds_write_b128 v170, v[24:27] offset:2048
    ds_write_b128 v170, v[28:31] offset:3072
    s_add_u32 m0, s31, 55296
    s_add_u32 s33, s29, 344064
    buffer_load_dwordx4 v245, s[88:91], s33 offen lds
    s_add_u32 m0, s31, 57344
    s_add_u32 s33, s29, 458752
    buffer_load_dwordx4 v245, s[88:91], s33 offen lds
    s_add_u32 m0, s31, 59392
    s_add_u32 s33, s29, 573440
    buffer_load_dwordx4 v245, s[88:91], s33 offen lds
    s_xor_b32 s60, s28, 2
    s_mul_i32 s60, s60, 12288
    v_add_u32 v170, s60, v163
    ds_write_b128 v170, v[32:35] offset:4096
    ds_write_b128 v170, v[36:39] offset:5120
    ds_write_b128 v170, v[40:43] offset:6144
    ds_write_b128 v170, v[44:47] offset:7168
    s_add_u32 m0, s31, 61440
    s_add_u32 s33, s29, 688128
    buffer_load_dwordx4 v245, s[88:91], s33 offen lds
    s_add_u32 m0, s31, 63488
    s_add_u32 s33, s29, 802816
    buffer_load_dwordx4 v245, s[88:91], s33 offen lds
    s_add_u32 m0, s31, 65536
    s_add_u32 s33, s29, 917504
    buffer_load_dwordx4 v245, s[88:91], s33 offen lds
    s_xor_b32 s60, s28, 3
    s_mul_i32 s60, s60, 12288
    v_add_u32 v170, s60, v163
    ds_write_b128 v170, v[48:51] offset:8192
    ds_write_b128 v170, v[52:55] offset:9216
    ds_write_b128 v170, v[56:59] offset:10240
    ds_write_b128 v170, v[60:63] offset:11264
    s_add_u32 m0, s31, 67584
    s_add_u32 s33, s29, 1032192
    buffer_load_dwordx4 v245, s[88:91], s33 offen lds
    s_add_u32 m0, s31, 69632
    s_add_u32 s33, s29, 1146880
    buffer_load_dwordx4 v245, s[88:91], s33 offen lds
    s_add_u32 m0, s31, 71680
    s_add_u32 s33, s29, 1261568
    buffer_load_dwordx4 v245, s[88:91], s33 offen lds
    s_add_u32 m0, s31, 73728
    s_add_u32 s33, s29, 1376256
    buffer_load_dwordx4 v245, s[88:91], s33 offen lds
    s_waitcnt lgkmcnt(0)
    s_barrier
    s_mul_i32 s60, s28, 12288
    v_add_u32 v170, s60, v163
    ds_read_b128 v[64:67], v170 offset:0
    ds_read_b128 v[68:71], v170 offset:1024
    ds_read_b128 v[72:75], v170 offset:2048
    ds_read_b128 v[76:79], v170 offset:3072
    ds_read_b128 v[80:83], v170 offset:4096
    ds_read_b128 v[84:87], v170 offset:5120
    ds_read_b128 v[88:91], v170 offset:6144
    ds_read_b128 v[92:95], v170 offset:7168
    ds_read_b128 v[96:99], v170 offset:8192
    ds_read_b128 v[100:103], v170 offset:9216
    ds_read_b128 v[104:107], v170 offset:10240
    ds_read_b128 v[108:111], v170 offset:11264
    s_add_u32 m0, s31, 75776
    s_add_u32 s33, s29, 1490944
    buffer_load_dwordx4 v245, s[88:91], s33 offen lds
    s_add_u32 m0, s31, 106496
    s_add_u32 s33, s29, 64
    buffer_load_dwordx4 v245, s[88:91], s33 offen lds
    s_add_u32 m0, s31, 108544
    s_add_u32 s33, s29, 114752
    buffer_load_dwordx4 v245, s[88:91], s33 offen lds
    s_waitcnt lgkmcnt(0)
    v_add_f32 v112, v0, v64
    v_add_f32 v113, v1, v65
    v_add_f32 v114, v2, v66
    v_add_f32 v115, v3, v67
    v_add_f32 v116, v4, v68
    v_add_f32 v117, v5, v69
    v_add_f32 v118, v6, v70
    v_add_f32 v119, v7, v71
    v_add_f32 v120, v8, v72
    v_add_f32 v121, v9, v73
    v_add_f32 v122, v10, v74
    v_add_f32 v123, v11, v75
    v_add_f32 v124, v12, v76
    v_add_f32 v125, v13, v77
    v_add_f32 v126, v14, v78
    v_add_f32 v127, v15, v79
    v_add_f32 v112, v112, v80
    v_add_f32 v113, v113, v81
    v_add_f32 v114, v114, v82
    v_add_f32 v115, v115, v83
    v_add_f32 v116, v116, v84
    v_add_f32 v117, v117, v85
    v_add_f32 v118, v118, v86
    v_add_f32 v119, v119, v87
    v_add_f32 v120, v120, v88
    v_add_f32 v121, v121, v89
    v_add_f32 v122, v122, v90
    v_add_f32 v123, v123, v91
    v_add_f32 v124, v124, v92
    v_add_f32 v125, v125, v93
    v_add_f32 v126, v126, v94
    v_add_f32 v127, v127, v95
    v_add_f32 v112, v112, v96
    v_add_f32 v113, v113, v97
    v_add_f32 v114, v114, v98
    v_add_f32 v115, v115, v99
    v_add_f32 v116, v116, v100
    v_add_f32 v117, v117, v101
    v_add_f32 v118, v118, v102
    v_add_f32 v119, v119, v103
    v_add_f32 v120, v120, v104
    v_add_f32 v121, v121, v105
    v_add_f32 v122, v122, v106
    v_add_f32 v123, v123, v107
    v_add_f32 v124, v124, v108
    v_add_f32 v125, v125, v109
    v_add_f32 v126, v126, v110
    v_add_f32 v127, v127, v111
    s_waitcnt vmcnt(16)
    s_add_u32 s63, s61, 12582912
    v_cvt_pk_bf16_f32 v112, 0, v112
    v_mul_f32 v112, v112, v184
    v_cvt_pk_bf16_f32 v112, 0, v112
    v_lshlrev_b32 v152, 16, v176
    v_add_f32 v112, v112, v152
    v_cvt_pk_bf16_f32 v113, 0, v113
    v_mul_f32 v113, v113, v185
    v_cvt_pk_bf16_f32 v113, 0, v113
    v_and_b32 v152, 0xffff0000, v176
    v_add_f32 v113, v113, v152
    v_cvt_pk_bf16_f32 v114, 0, v114
    v_mul_f32 v114, v114, v186
    v_cvt_pk_bf16_f32 v114, 0, v114
    v_lshlrev_b32 v152, 16, v177
    v_add_f32 v114, v114, v152
    v_cvt_pk_bf16_f32 v115, 0, v115
    v_mul_f32 v115, v115, v187
    v_cvt_pk_bf16_f32 v115, 0, v115
    v_and_b32 v152, 0xffff0000, v177
    v_add_f32 v115, v115, v152
    v_cvt_pk_bf16_f32 v116, 0, v116
    v_mul_f32 v116, v116, v188
    v_cvt_pk_bf16_f32 v116, 0, v116
    v_lshlrev_b32 v152, 16, v178
    v_add_f32 v116, v116, v152
    v_cvt_pk_bf16_f32 v117, 0, v117
    v_mul_f32 v117, v117, v189
    v_cvt_pk_bf16_f32 v117, 0, v117
    v_and_b32 v152, 0xffff0000, v178
    v_add_f32 v117, v117, v152
    v_cvt_pk_bf16_f32 v118, 0, v118
    v_mul_f32 v118, v118, v190
    v_cvt_pk_bf16_f32 v118, 0, v118
    v_lshlrev_b32 v152, 16, v179
    v_add_f32 v118, v118, v152
    v_cvt_pk_bf16_f32 v119, 0, v119
    v_mul_f32 v119, v119, v191
    v_cvt_pk_bf16_f32 v119, 0, v119
    v_and_b32 v152, 0xffff0000, v179
    v_add_f32 v119, v119, v152
    v_cvt_pk_bf16_f32 v64, v112, v113
    v_cvt_pk_bf16_f32 v65, v114, v115
    v_cvt_pk_bf16_f32 v66, v116, v117
    v_cvt_pk_bf16_f32 v67, v118, v119
    s_nop 1
    v_permlane32_swap_b32 v64, v66
    v_permlane32_swap_b32 v65, v67
    buffer_store_dwordx4 v[64:67], v163, s[16:19], s61 offen offset:0 sc1
    v_cvt_pk_bf16_f32 v112, 0, v112
    v_mul_f32 v112, v112, v128
    v_cvt_pk_bf16_f32 v113, 0, v113
    v_mul_f32 v113, v113, v129
    v_cvt_pk_bf16_f32 v114, 0, v114
    v_mul_f32 v114, v114, v130
    v_cvt_pk_bf16_f32 v115, 0, v115
    v_mul_f32 v115, v115, v131
    v_cvt_pk_bf16_f32 v116, 0, v116
    v_mul_f32 v116, v116, v132
    v_cvt_pk_bf16_f32 v117, 0, v117
    v_mul_f32 v117, v117, v133
    v_cvt_pk_bf16_f32 v118, 0, v118
    v_mul_f32 v118, v118, v134
    v_cvt_pk_bf16_f32 v119, 0, v119
    v_mul_f32 v119, v119, v135
    v_cvt_pk_bf16_f32 v88, v112, v113
    v_cvt_pk_bf16_f32 v89, v114, v115
    v_cvt_pk_bf16_f32 v90, v116, v117
    v_cvt_pk_bf16_f32 v91, v118, v119
    s_nop 1
    v_permlane32_swap_b32 v88, v90
    v_permlane32_swap_b32 v89, v91
    buffer_store_dwordx4 v[88:91], v163, s[16:19], s63 offen offset:0 sc1
    v_cvt_pk_bf16_f32 v120, 0, v120
    v_mul_f32 v120, v120, v192
    v_cvt_pk_bf16_f32 v120, 0, v120
    v_lshlrev_b32 v152, 16, v180
    v_add_f32 v120, v120, v152
    v_cvt_pk_bf16_f32 v121, 0, v121
    v_mul_f32 v121, v121, v193
    v_cvt_pk_bf16_f32 v121, 0, v121
    v_and_b32 v152, 0xffff0000, v180
    v_add_f32 v121, v121, v152
    v_cvt_pk_bf16_f32 v122, 0, v122
    v_mul_f32 v122, v122, v194
    v_cvt_pk_bf16_f32 v122, 0, v122
    v_lshlrev_b32 v152, 16, v181
    v_add_f32 v122, v122, v152
    v_cvt_pk_bf16_f32 v123, 0, v123
    v_mul_f32 v123, v123, v195
    v_cvt_pk_bf16_f32 v123, 0, v123
    v_and_b32 v152, 0xffff0000, v181
    v_add_f32 v123, v123, v152
    v_cvt_pk_bf16_f32 v124, 0, v124
    v_mul_f32 v124, v124, v196
    v_cvt_pk_bf16_f32 v124, 0, v124
    v_lshlrev_b32 v152, 16, v182
    v_add_f32 v124, v124, v152
    v_cvt_pk_bf16_f32 v125, 0, v125
    v_mul_f32 v125, v125, v197
    v_cvt_pk_bf16_f32 v125, 0, v125
    v_and_b32 v152, 0xffff0000, v182
    v_add_f32 v125, v125, v152
    v_cvt_pk_bf16_f32 v126, 0, v126
    v_mul_f32 v126, v126, v198
    v_cvt_pk_bf16_f32 v126, 0, v126
    v_lshlrev_b32 v152, 16, v183
    v_add_f32 v126, v126, v152
    v_cvt_pk_bf16_f32 v127, 0, v127
    v_mul_f32 v127, v127, v199
    v_cvt_pk_bf16_f32 v127, 0, v127
    v_and_b32 v152, 0xffff0000, v183
    v_add_f32 v127, v127, v152
    v_cvt_pk_bf16_f32 v68, v120, v121
    v_cvt_pk_bf16_f32 v69, v122, v123
    v_cvt_pk_bf16_f32 v70, v124, v125
    v_cvt_pk_bf16_f32 v71, v126, v127
    s_nop 1
    v_permlane32_swap_b32 v68, v70
    v_permlane32_swap_b32 v69, v71
    buffer_store_dwordx4 v[68:71], v163, s[16:19], s61 offen offset:1024 sc1
    v_cvt_pk_bf16_f32 v120, 0, v120
    v_mul_f32 v120, v120, v136
    v_cvt_pk_bf16_f32 v121, 0, v121
    v_mul_f32 v121, v121, v137
    v_cvt_pk_bf16_f32 v122, 0, v122
    v_mul_f32 v122, v122, v138
    v_cvt_pk_bf16_f32 v123, 0, v123
    v_mul_f32 v123, v123, v139
    v_cvt_pk_bf16_f32 v124, 0, v124
    v_mul_f32 v124, v124, v140
    v_cvt_pk_bf16_f32 v125, 0, v125
    v_mul_f32 v125, v125, v141
    v_cvt_pk_bf16_f32 v126, 0, v126
    v_mul_f32 v126, v126, v142
    v_cvt_pk_bf16_f32 v127, 0, v127
    v_mul_f32 v127, v127, v143
    v_cvt_pk_bf16_f32 v92, v120, v121
    v_cvt_pk_bf16_f32 v93, v122, v123
    v_cvt_pk_bf16_f32 v94, v124, v125
    v_cvt_pk_bf16_f32 v95, v126, v127
    s_nop 1
    v_permlane32_swap_b32 v92, v94
    v_permlane32_swap_b32 v93, v95
    buffer_store_dwordx4 v[92:95], v163, s[16:19], s63 offen offset:1024 sc1
    s_mov_b32 s60, 0x3f803f80
    v_mov_b32 v80, s60
    v_mov_b32 v72, 0
    v_mov_b32 v73, 0
    v_mov_b32 v74, 0
    v_mov_b32 v75, 0
    v_dot2_f32_bf16 v72, v64, v80, v72
    v_dot2_f32_bf16 v73, v64, v64, v73
    v_dot2_f32_bf16 v74, v65, v80, v74
    v_dot2_f32_bf16 v75, v65, v65, v75
    v_dot2_f32_bf16 v72, v66, v80, v72
    v_dot2_f32_bf16 v73, v66, v66, v73
    v_dot2_f32_bf16 v74, v67, v80, v74
    v_dot2_f32_bf16 v75, v67, v67, v75
    v_dot2_f32_bf16 v72, v68, v80, v72
    v_dot2_f32_bf16 v73, v68, v68, v73
    v_dot2_f32_bf16 v74, v69, v80, v74
    v_dot2_f32_bf16 v75, v69, v69, v75
    v_dot2_f32_bf16 v72, v70, v80, v72
    v_dot2_f32_bf16 v73, v70, v70, v73
    v_dot2_f32_bf16 v74, v71, v80, v74
    v_dot2_f32_bf16 v75, v71, v71, v75
    s_add_u32 s40, s44, 29360128
    s_addc_u32 s41, s45, 0
    s_mov_b32 s42, 229376
    s_mov_b32 s43, 0x00020000
    v_add_f32 v72, v72, v74
    v_add_f32 v73, v73, v75
    v_mov_b32 v74, v72
    v_mov_b32 v75, v73
    s_lshr_b32 s60, s57, 5
    s_mul_i32 s60, s60, 14
    v_permlane32_swap_b32 v72, v74
    v_permlane32_swap_b32 v73, v75
    v_add_f32 v72, v72, v74
    v_add_f32 v73, v73, v75
    s_lshl_b32 s62, s54, 1
    s_add_u32 s60, s60, s62
    s_add_u32 s60, s60, s55
    s_lshl_b32 s60, s60, 8
    v_lshlrev_b32 v76, 3, v161
    s_mov_b32 exec_hi, 0
    buffer_store_dwordx2 v[72:73], v76, s[40:43], s60 offen sc1
    s_mov_b32 exec_hi, -1
    s_lshr_b32 s73, s53, 1
    s_lshl_b32 s73, s73, 8
    s_add_u32 s73, s73, 4096
    s_load_dwordx2 s[36:37], s[0:1], 64
    s_lshr_b32 s30, s2, 3
    s_mul_i32 s33, s30, 37
    s_lshr_b32 s33, s33, 8
    s_mul_i32 s33, s33, 7
    s_sub_u32 s30, s30, s33
    v_lshrrev_b32 v0, 3, v240
    v_and_b32 v1, 7, v240
    v_bfe_u32 v2, v240, 4, 1
    v_lshlrev_b32 v2, 2, v2
    v_xor_b32 v1, v1, v2
    v_lshlrev_b32 v1, 4, v1
    v_mul_u32_u24 v250, 896, v0
    v_add_u32 v250, v250, v1
    s_lshl_b32 s30, s30, 7
    s_mul_i32 s35, s28, 28672
    s_add_u32 s35, s35, s30
    s_waitcnt lgkmcnt(0)
    s_mov_b32 s12, s36
    s_mov_b32 s13, s37
    s_mov_b32 s14, 1605632
    s_mov_b32 s15, 0x00020000
    s_and_b32 s51, s2, 7
    s_lshr_b32 s52, s2, 3
    s_cmp_ge_u32 s52, 14
    s_cselect_b32 s53, 8, 0
    s_cselect_b32 s54, 14, 0
    s_add_u32 s53, s53, s51
    s_sub_u32 s54, s52, s54
    s_lshl_b32 s56, s53, 2
    s_add_u32 s56, s56, s28
    v_lshlrev_b32 v244, 4, v240
    s_add_u32 s4, s44, 31457280
    s_addc_u32 s5, s45, 0
    s_mov_b32 s6, 1835008
    s_mov_b32 s7, 0x00020000
    s_add_u32 s20, s44, 30408704
    s_addc_u32 s21, s45, 0
    s_mov_b32 s22, 114688
    s_mov_b32 s23, 0x00020000
    s_add_u32 s24, s44, 20971520
    s_addc_u32 s25, s45, 0
    s_mov_b32 s26, 7340032
    s_mov_b32 s27, 0x00020000
    s_add_u32 s16, s44, 29360128
    s_addc_u32 s17, s45, 0
    s_mov_b32 s18, 229376
    s_mov_b32 s19, 0x00020000
    s_lshl_b32 s74, s53, 8
    s_add_u32 s74, s74, 4096
    s_mov_b32 s75, 0xbfb8aa3b
    s_mul_i32 s58, s56, 114688
    s_lshl_b32 s59, s54, 13
    s_add_u32 s58, s58, s59
    s_add_u32 s59, s58, 4096
    s_lshl_b32 s57, s53, 8
    s_add_u32 s57, s57, 8192
    v_lshrrev_b32 v0, 4, v240
    v_and_b32 v1, 15, v240
    v_lshlrev_b32 v2, 2, v0
    v_xor_b32 v2, v1, v2
    v_lshlrev_b32 v2, 4, v2
    v_mul_u32_u24 v248, 3584, v0
    v_add_u32 v248, v248, v2
    v_lshrrev_b32 v2, 2, v1
    v_lshrrev_b32 v3, 1, v0
    v_lshl_add_u32 v3, v3, 3, v2
    v_and_b32 v4, 1, v0
    v_lshlrev_b32 v4, 5, v4
    v_and_b32 v5, 1, v1
    v_lshl_add_u32 v4, v5, 4, v4
    v_and_b32 v5, 2, v1
    v_lshl_add_u32 v4, v5, 2, v4
    v_lshl_add_u32 v5, v3, 6, v4
    v_add_u32 v246, 49152, v5
    v_add_u32 v247, 106496, v5
    v_lshl_add_u32 v3, v3, 8, v4
    v_add_u32 v3, 40960, v3
    v_xor_b32 v4, 0, v2
    v_lshl_add_u32 v8, v4, 6, v3
    v_xor_b32 v4, 1, v2
    v_lshl_add_u32 v9, v4, 6, v3
    v_xor_b32 v4, 2, v2
    v_lshl_add_u32 v10, v4, 6, v3
    v_xor_b32 v4, 3, v2
    v_lshl_add_u32 v11, v4, 6, v3
    s_waitcnt vmcnt(0)
    s_barrier
    s_cmp_lg_u32 s28, 0
    s_cbranch_scc1 SIG3
    s_mov_b64 exec, 1
    v_mov_b32 v0, 0
    v_mov_b32 v1, 1
    buffer_atomic_add v1, v0, s[68:71], s73 offen sc1
    s_mov_b64 exec, -1
SIG3:
    s_add_u32 m0, s31, 110592
    s_add_u32 s33, s29, 229440
    buffer_load_dwordx4 v245, s[88:91], s33 offen lds
    s_add_u32 m0, s31, 112640
    s_add_u32 s33, s29, 344128
    buffer_load_dwordx4 v245, s[88:91], s33 offen lds
    s_add_u32 m0, s31, 114688
    s_add_u32 s33, s29, 458816
    buffer_load_dwordx4 v245, s[88:91], s33 offen lds
    s_add_u32 m0, s31, 116736
    s_add_u32 s33, s29, 573504
    buffer_load_dwordx4 v245, s[88:91], s33 offen lds
    s_add_u32 m0, s31, 118784
    s_add_u32 s33, s29, 688192
    buffer_load_dwordx4 v245, s[88:91], s33 offen lds
    s_add_u32 m0, s31, 120832
    s_add_u32 s33, s29, 802880
    buffer_load_dwordx4 v245, s[88:91], s33 offen lds
    s_add_u32 m0, s31, 122880
    s_add_u32 s33, s29, 917568
    buffer_load_dwordx4 v245, s[88:91], s33 offen lds
    s_add_u32 m0, s31, 124928
    s_add_u32 s33, s29, 1032256
    buffer_load_dwordx4 v245, s[88:91], s33 offen lds
    s_add_u32 m0, s31, 126976
    s_add_u32 s33, s29, 1146944
    buffer_load_dwordx4 v245, s[88:91], s33 offen lds
    s_add_u32 m0, s31, 129024
    s_add_u32 s33, s29, 1261632
    buffer_load_dwordx4 v245, s[88:91], s33 offen lds
    s_add_u32 m0, s31, 131072
    s_add_u32 s33, s29, 1376320
    buffer_load_dwordx4 v245, s[88:91], s33 offen lds
    s_add_u32 m0, s31, 133120
    s_add_u32 s33, s29, 1491008
    buffer_load_dwordx4 v245, s[88:91], s33 offen lds
    s_waitcnt vmcnt(0)
    s_cmp_lg_u32 s28, 0
    s_cbranch_scc1 WF4_D
    v_mbcnt_lo_u32_b32 v0, -1, 0
    v_and_b32 v0, 0, v0
    v_lshlrev_b32 v0, 6, v0
    s_mov_b32 s72, 0
WF4_P:
    buffer_load_dword v1, v0, s[68:71], s74 offen sc1
    s_waitcnt vmcnt(0)
    v_cmp_gt_u32 vcc, 46, v1
    s_cmp_eq_u64 vcc, 0
    s_cbranch_scc1 WF4_D
    s_sleep 1
    s_add_u32 s72, s72, 1
    s_cmp_lt_u32 s72, 0x400000
    s_cbranch_scc1 WF4_P
WF4_D:
    s_barrier
    v_lshlrev_b32 v0, 3, v241
    v_mul_u32_u24 v1, 1792, v242
    v_add_u32 v0, v0, v1
    s_mul_i32 s30, s56, 3584
    s_mul_i32 s33, s56, 28672
    buffer_load_dwordx4 v[128:131], v244, s[4:7], s33 offen offset:0 sc1
    buffer_load_dwordx4 v[132:135], v244, s[4:7], s33 offen offset:1024 sc1
    buffer_load_dwordx4 v[136:139], v244, s[4:7], s33 offen offset:2048 sc1
    buffer_load_dwordx4 v[140:143], v244, s[4:7], s33 offen offset:3072 sc1
    buffer_load_dwordx2 v[112:113], v0, s[16:19], s30 offen offset:0 sc1
    buffer_load_dwordx2 v[114:115], v0, s[16:19], s30 offen offset:256 sc1
    buffer_load_dwordx2 v[116:117], v0, s[16:19], s30 offen offset:512 sc1
    buffer_load_dwordx2 v[118:119], v0, s[16:19], s30 offen offset:768 sc1
    buffer_load_dwordx2 v[120:121], v0, s[16:19], s30 offen offset:1024 sc1
    buffer_load_dwordx2 v[122:123], v0, s[16:19], s30 offen offset:1280 sc1
    buffer_load_dwordx2 v[124:125], v0, s[16:19], s30 offen offset:1536 sc1
    s_lshr_b32 s30, s28, 1
    s_mul_i32 s32, s30, 57344
    s_lshl_b32 s30, s30, 12
    s_and_b32 s34, s28, 1
    s_mul_i32 s36, s34, 28672
    s_add_u32 s32, s32, s36
    s_lshl_b32 s36, s54, 8
    s_add_u32 s32, s32, s36
    s_lshl_b32 s34, s34, 11
    s_add_u32 s30, s30, s34
    s_add_u32 m0, s30, 40960
    s_add_u32 s34, s32, 0
    buffer_load_dwordx4 v248, s[20:23], s34 offen sc1 lds
    s_add_u32 m0, s30, 41984
    s_add_u32 s34, s32, 14336
    buffer_load_dwordx4 v248, s[20:23], s34 offen sc1 lds
    s_add_u32 s33, s33, 4096
    buffer_load_dwordx4 v[144:147], v244, s[4:7], s33 offen offset:0 sc1
    buffer_load_dwordx4 v[148:151], v244, s[4:7], s33 offen offset:1024 sc1
    buffer_load_dwordx4 v[152:155], v244, s[4:7], s33 offen offset:2048 sc1
    buffer_load_dwordx4 v[156:159], v244, s[4:7], s33 offen offset:3072 sc1
    s_add_u32 s33, s33, 4096
    buffer_load_dwordx4 v[160:163], v244, s[4:7], s33 offen offset:0 sc1
    buffer_load_dwordx4 v[164:167], v244, s[4:7], s33 offen offset:1024 sc1
    buffer_load_dwordx4 v[168:171], v244, s[4:7], s33 offen offset:2048 sc1
    buffer_load_dwordx4 v[172:175], v244, s[4:7], s33 offen offset:3072 sc1
    s_add_u32 s33, s33, 4096
    buffer_load_dwordx4 v[176:179], v244, s[4:7], s33 offen offset:0 sc1
    buffer_load_dwordx4 v[180:183], v244, s[4:7], s33 offen offset:1024 sc1
    buffer_load_dwordx4 v[184:187], v244, s[4:7], s33 offen offset:2048 sc1
    buffer_load_dwordx4 v[188:191], v244, s[4:7], s33 offen offset:3072 sc1
    s_add_u32 s33, s33, 4096
    buffer_load_dwordx4 v[192:195], v244, s[4:7], s33 offen offset:0 sc1
    buffer_load_dwordx4 v[196:199], v244, s[4:7], s33 offen offset:1024 sc1
    buffer_load_dwordx4 v[200:203], v244, s[4:7], s33 offen offset:2048 sc1
    buffer_load_dwordx4 v[204:207], v244, s[4:7], s33 offen offset:3072 sc1
    s_add_u32 s33, s33, 4096
    buffer_load_dwordx4 v[208:211], v244, s[4:7], s33 offen offset:0 sc1
    buffer_load_dwordx4 v[212:215], v244, s[4:7], s33 offen offset:1024 sc1
    buffer_load_dwordx4 v[216:219], v244, s[4:7], s33 offen offset:2048 sc1
    buffer_load_dwordx4 v[220:223], v244, s[4:7], s33 offen offset:3072 sc1
    s_add_u32 s33, s33, 4096
    buffer_load_dwordx4 v[224:227], v244, s[4:7], s33 offen offset:0 sc1
    buffer_load_dwordx4 v[228:231], v244, s[4:7], s33 offen offset:1024 sc1
    buffer_load_dwordx4 v[232:235], v244, s[4:7], s33 offen offset:2048 sc1
    buffer_load_dwordx4 v[236:239], v244, s[4:7], s33 offen offset:3072 sc1
    ds_read_b64_tr_b16 a[64:65], v246 offset:0
    ds_read_b64_tr_b16 a[66:67], v246 offset:256
    ds_read_b64_tr_b16 a[68:69], v246 offset:28672
    ds_read_b64_tr_b16 a[70:71], v246 offset:28928
    ds_read_b64_tr_b16 a[72:73], v246 offset:1024
    ds_read_b64_tr_b16 a[74:75], v246 offset:1280
    ds_read_b64_tr_b16 a[76:77], v246 offset:29696
    ds_read_b64_tr_b16 a[78:79], v246 offset:29952
    ds_read_b64_tr_b16 a[80:81], v246 offset:2048
    ds_read_b64_tr_b16 a[82:83], v246 offset:2304
    ds_read_b64_tr_b16 a[84:85], v246 offset:30720
    ds_read_b64_tr_b16 a[86:87], v246 offset:30976
    ds_read_b64_tr_b16 a[88:89], v246 offset:3072
    ds_read_b64_tr_b16 a[90:91], v246 offset:3328
    s_waitcnt lgkmcnt(6)
    s_waitcnt vmcnt(36)
    v_mfma_f32_32x32x16_bf16 v[16:31], a[64:67], v[128:131], 0
    ds_read_b64_tr_b16 a[92:93], v246 offset:31744
    ds_read_b64_tr_b16 a[94:95], v246 offset:32000
    v_mfma_f32_32x32x16_bf16 v[32:47], a[68:71], v[128:131], 0
    ds_read_b64_tr_b16 a[64:65], v246 offset:4096
    ds_read_b64_tr_b16 a[66:67], v246 offset:4352
    s_waitcnt vmcnt(35)
    v_mfma_f32_32x32x16_bf16 v[16:31], a[72:75], v[132:135], v[16:31]
    ds_read_b64_tr_b16 a[68:69], v246 offset:32768
    ds_read_b64_tr_b16 a[70:71], v246 offset:33024
    v_mfma_f32_32x32x16_bf16 v[32:47], a[76:79], v[132:135], v[32:47]
    ds_read_b64_tr_b16 a[72:73], v246 offset:5120
    ds_read_b64_tr_b16 a[74:75], v246 offset:5376
    s_waitcnt lgkmcnt(6)
    s_waitcnt vmcnt(34)
    v_mfma_f32_32x32x16_bf16 v[16:31], a[80:83], v[136:139], v[16:31]
    ds_read_b64_tr_b16 a[76:77], v246 offset:33792
    ds_read_b64_tr_b16 a[78:79], v246 offset:34048
    v_mfma_f32_32x32x16_bf16 v[32:47], a[84:87], v[136:139], v[32:47]
    ds_read_b64_tr_b16 a[80:81], v246 offset:6144
    ds_read_b64_tr_b16 a[82:83], v246 offset:6400
    s_waitcnt vmcnt(33)
    v_mfma_f32_32x32x16_bf16 v[16:31], a[88:91], v[140:143], v[16:31]
    ds_read_b64_tr_b16 a[84:85], v246 offset:34816
    ds_read_b64_tr_b16 a[86:87], v246 offset:35072
    v_mfma_f32_32x32x16_bf16 v[32:47], a[92:95], v[140:143], v[32:47]
    ds_read_b64_tr_b16 a[88:89], v246 offset:7168
    ds_read_b64_tr_b16 a[90:91], v246 offset:7424
    s_waitcnt lgkmcnt(6)
    s_waitcnt vmcnt(23)
    v_mfma_f32_32x32x16_bf16 v[16:31], a[64:67], v[144:147], v[16:31]
    ds_read_b64_tr_b16 a[92:93], v246 offset:35840
    ds_read_b64_tr_b16 a[94:95], v246 offset:36096
    v_add_f32 v0, v112, v114
    v_add_f32 v2, v113, v115
    v_add_f32 v0, v0, v116
    v_add_f32 v2, v2, v117
    v_add_f32 v0, v0, v118
    v_mfma_f32_32x32x16_bf16 v[32:47], a[68:71], v[144:147], v[32:47]
    ds_read_b64_tr_b16 a[64:65], v246 offset:8192
    ds_read_b64_tr_b16 a[66:67], v246 offset:8448
    v_add_f32 v2, v2, v119
    v_add_f32 v0, v0, v120
    v_add_f32 v2, v2, v121
    v_add_f32 v0, v0, v122
    v_add_f32 v2, v2, v123
    s_waitcnt vmcnt(22)
    v_mfma_f32_32x32x16_bf16 v[16:31], a[72:75], v[148:151], v[16:31]
    ds_read_b64_tr_b16 a[68:69], v246 offset:36864
    ds_read_b64_tr_b16 a[70:71], v246 offset:37120
    v_add_f32 v0, v0, v124
    v_add_f32 v2, v2, v125
    v_mfma_f32_32x32x16_bf16 v[32:47], a[76:79], v[148:151], v[32:47]
    ds_read_b64_tr_b16 a[72:73], v246 offset:9216
    ds_read_b64_tr_b16 a[74:75], v246 offset:9472
    s_waitcnt lgkmcnt(6)
    s_waitcnt vmcnt(21)
    v_mfma_f32_32x32x16_bf16 v[16:31], a[80:83], v[152:155], v[16:31]
    ds_read_b64_tr_b16 a[76:77], v246 offset:37888
    ds_read_b64_tr_b16 a[78:79], v246 offset:38144
    v_mfma_f32_32x32x16_bf16 v[32:47], a[84:87], v[152:155], v[32:47]
    ds_read_b64_tr_b16 a[80:81], v246 offset:10240
    ds_read_b64_tr_b16 a[82:83], v246 offset:10496
    s_waitcnt vmcnt(20)
    v_mfma_f32_32x32x16_bf16 v[16:31], a[88:91], v[156:159], v[16:31]
    ds_read_b64_tr_b16 a[84:85], v246 offset:38912
    ds_read_b64_tr_b16 a[86:87], v246 offset:39168
    v_mfma_f32_32x32x16_bf16 v[32:47], a[92:95], v[156:159], v[32:47]
    ds_read_b64_tr_b16 a[88:89], v246 offset:11264
    ds_read_b64_tr_b16 a[90:91], v246 offset:11520
    s_waitcnt lgkmcnt(6)
    s_waitcnt vmcnt(19)
    v_mfma_f32_32x32x16_bf16 v[16:31], a[64:67], v[160:163], v[16:31]
    ds_read_b64_tr_b16 a[92:93], v246 offset:39936
    ds_read_b64_tr_b16 a[94:95], v246 offset:40192
    v_mfma_f32_32x32x16_bf16 v[32:47], a[68:71], v[160:163], v[32:47]
    ds_read_b64_tr_b16 a[64:65], v246 offset:12288
    ds_read_b64_tr_b16 a[66:67], v246 offset:12544
    s_waitcnt vmcnt(18)
    v_mfma_f32_32x32x16_bf16 v[16:31], a[72:75], v[164:167], v[16:31]
    ds_read_b64_tr_b16 a[68:69], v246 offset:40960
    ds_read_b64_tr_b16 a[70:71], v246 offset:41216
    v_mfma_f32_32x32x16_bf16 v[32:47], a[76:79], v[164:167], v[32:47]
    ds_read_b64_tr_b16 a[72:73], v246 offset:13312
    ds_read_b64_tr_b16 a[74:75], v246 offset:13568
    s_waitcnt lgkmcnt(6)
    s_waitcnt vmcnt(17)
    v_mfma_f32_32x32x16_bf16 v[16:31], a[80:83], v[168:171], v[16:31]
    ds_read_b64_tr_b16 a[76:77], v246 offset:41984
    ds_read_b64_tr_b16 a[78:79], v246 offset:42240
    v_mfma_f32_32x32x16_bf16 v[32:47], a[84:87], v[168:171], v[32:47]
    ds_read_b64_tr_b16 a[80:81], v246 offset:14336
    ds_read_b64_tr_b16 a[82:83], v246 offset:14592
    s_waitcnt vmcnt(16)
    v_mfma_f32_32x32x16_bf16 v[16:31], a[88:91], v[172:175], v[16:31]
    ds_read_b64_tr_b16 a[84:85], v246 offset:43008
    ds_read_b64_tr_b16 a[86:87], v246 offset:43264
    v_mfma_f32_32x32x16_bf16 v[32:47], a[92:95], v[172:175], v[32:47]
    ds_read_b64_tr_b16 a[88:89], v246 offset:15360
    ds_read_b64_tr_b16 a[90:91], v246 offset:15616
    s_waitcnt lgkmcnt(6)
    s_waitcnt vmcnt(15)
    v_mfma_f32_32x32x16_bf16 v[16:31], a[64:67], v[176:179], v[16:31]
    ds_read_b64_tr_b16 a[92:93], v246 offset:44032
    ds_read_b64_tr_b16 a[94:95], v246 offset:44288
    v_mfma_f32_32x32x16_bf16 v[32:47], a[68:71], v[176:179], v[32:47]
    ds_read_b64_tr_b16 a[64:65], v246 offset:16384
    ds_read_b64_tr_b16 a[66:67], v246 offset:16640
    s_waitcnt vmcnt(14)
    v_mfma_f32_32x32x16_bf16 v[16:31], a[72:75], v[180:183], v[16:31]
    ds_read_b64_tr_b16 a[68:69], v246 offset:45056
    ds_read_b64_tr_b16 a[70:71], v246 offset:45312
    v_mfma_f32_32x32x16_bf16 v[32:47], a[76:79], v[180:183], v[32:47]
    ds_read_b64_tr_b16 a[72:73], v246 offset:17408
    ds_read_b64_tr_b16 a[74:75], v246 offset:17664
    s_waitcnt lgkmcnt(6)
    s_waitcnt vmcnt(13)
    v_mfma_f32_32x32x16_bf16 v[16:31], a[80:83], v[184:187], v[16:31]
    ds_read_b64_tr_b16 a[76:77], v246 offset:46080
    ds_read_b64_tr_b16 a[78:79], v246 offset:46336
    v_mfma_f32_32x32x16_bf16 v[32:47], a[84:87], v[184:187], v[32:47]
    ds_read_b64_tr_b16 a[80:81], v246 offset:18432
    ds_read_b64_tr_b16 a[82:83], v246 offset:18688
    s_waitcnt vmcnt(12)
    v_mov_b32 v1, v0
    v_mov_b32 v3, v2
    s_nop 1
    v_permlane32_swap_b32 v0, v1
    v_permlane32_swap_b32 v2, v3
    v_add_f32 v0, v0, v1
    v_add_f32 v2, v2, v3
    s_mov_b32 s36, 0x3b124925
    v_mul_f32 v0, s36, v0
    v_mul_f32 v2, s36, v2
    v_fma_f32 v2, -v0, v0, v2
    v_max_f32 v2, 0, v2
    v_cvt_pk_bf16_f32 v0, 0, v0
    v_cvt_pk_bf16_f32 v2, 0, v2
    v_add_f32 v2, 0x3727c5ac, v2
    v_cvt_pk_bf16_f32 v2, 0, v2
    v_sqrt_f32 v2, v2
    s_nop 0
    v_cvt_pk_bf16_f32 v2, 0, v2
    v_rcp_f32 v14, v2
    s_nop 0
    v_mul_f32 v15, v0, v14
    v_sub_f32 v15, 0, v15
    v_xor_b32 v0, 0x80000000, v0
    v_lshrrev_b32 v1, 16, v0
    v_lshrrev_b32 v3, 16, v2
    v_or_b32 v4, v0, v1
    v_or_b32 v5, v2, v1
    v_or_b32 v6, v2, v3
    v_mov_b32 v7, 0
    v_cmp_eq_u32 vcc, 0, v242
    v_cndmask_b32 v4, 0, v4, vcc
    v_cndmask_b32 v5, 0, v5, vcc
    v_cndmask_b32 v6, 0, v6, vcc
    v_mul_f32 v255, v2, v2
    v_mul_f32 v254, 0xbfb8aa3b, v14
    v_mfma_f32_32x32x16_bf16 v[16:31], a[88:91], v[188:191], v[16:31]
    ds_read_b64_tr_b16 a[84:85], v246 offset:47104
    ds_read_b64_tr_b16 a[86:87], v246 offset:47360
    v_mfma_f32_32x32x16_bf16 v[32:47], a[92:95], v[188:191], v[32:47]
    ds_read_b64_tr_b16 a[88:89], v246 offset:19456
    ds_read_b64_tr_b16 a[90:91], v246 offset:19712
    s_waitcnt lgkmcnt(6)
    s_waitcnt vmcnt(11)
    v_mfma_f32_32x32x16_bf16 v[16:31], a[64:67], v[192:195], v[16:31]
    ds_read_b64_tr_b16 a[92:93], v246 offset:48128
    ds_read_b64_tr_b16 a[94:95], v246 offset:48384
    v_mfma_f32_32x32x16_bf16 v[32:47], a[68:71], v[192:195], v[32:47]
    ds_read_b64_tr_b16 a[64:65], v246 offset:20480
    ds_read_b64_tr_b16 a[66:67], v246 offset:20736
    s_waitcnt vmcnt(10)
    v_mfma_f32_32x32x16_bf16 v[16:31], a[72:75], v[196:199], v[16:31]
    ds_read_b64_tr_b16 a[68:69], v246 offset:49152
    ds_read_b64_tr_b16 a[70:71], v246 offset:49408
    v_mfma_f32_32x32x16_bf16 v[32:47], a[76:79], v[196:199], v[32:47]
    ds_read_b64_tr_b16 a[72:73], v246 offset:21504
    ds_read_b64_tr_b16 a[74:75], v246 offset:21760
    s_waitcnt lgkmcnt(6)
    s_waitcnt vmcnt(9)
    v_mfma_f32_32x32x16_bf16 v[16:31], a[80:83], v[200:203], v[16:31]
    ds_read_b64_tr_b16 a[76:77], v246 offset:50176
    ds_read_b64_tr_b16 a[78:79], v246 offset:50432
    v_mfma_f32_32x32x16_bf16 v[32:47], a[84:87], v[200:203], v[32:47]
    ds_read_b64_tr_b16 a[80:81], v246 offset:22528
    ds_read_b64_tr_b16 a[82:83], v246 offset:22784
    s_waitcnt vmcnt(8)
    v_mfma_f32_32x32x16_bf16 v[16:31], a[88:91], v[204:207], v[16:31]
    ds_read_b64_tr_b16 a[84:85], v246 offset:51200
    ds_read_b64_tr_b16 a[86:87], v246 offset:51456
    v_mfma_f32_32x32x16_bf16 v[32:47], a[92:95], v[204:207], v[32:47]
    ds_read_b64_tr_b16 a[88:89], v246 offset:23552
    ds_read_b64_tr_b16 a[90:91], v246 offset:23808
    s_waitcnt lgkmcnt(6)
    s_waitcnt vmcnt(7)
    v_mfma_f32_32x32x16_bf16 v[16:31], a[64:67], v[208:211], v[16:31]
    ds_read_b64_tr_b16 a[92:93], v246 offset:52224
    ds_read_b64_tr_b16 a[94:95], v246 offset:52480
    v_mfma_f32_32x32x16_bf16 v[32:47], a[68:71], v[208:211], v[32:47]
    ds_read_b64_tr_b16 a[64:65], v246 offset:24576
    ds_read_b64_tr_b16 a[66:67], v246 offset:24832
    s_waitcnt vmcnt(6)
    v_mfma_f32_32x32x16_bf16 v[16:31], a[72:75], v[212:215], v[16:31]
    ds_read_b64_tr_b16 a[68:69], v246 offset:53248
    ds_read_b64_tr_b16 a[70:71], v246 offset:53504
    v_mfma_f32_32x32x16_bf16 v[32:47], a[76:79], v[212:215], v[32:47]
    ds_read_b64_tr_b16 a[72:73], v246 offset:25600
    ds_read_b64_tr_b16 a[74:75], v246 offset:25856
    s_waitcnt lgkmcnt(6)
    s_waitcnt vmcnt(5)
    v_mfma_f32_32x32x16_bf16 v[16:31], a[80:83], v[216:219], v[16:31]
    ds_read_b64_tr_b16 a[76:77], v246 offset:54272
    ds_read_b64_tr_b16 a[78:79], v246 offset:54528
    v_mfma_f32_32x32x16_bf16 v[32:47], a[84:87], v[216:219], v[32:47]
    ds_read_b64_tr_b16 a[80:81], v246 offset:26624
    ds_read_b64_tr_b16 a[82:83], v246 offset:26880
    s_waitcnt vmcnt(4)
    v_mfma_f32_32x32x16_bf16 v[16:31], a[88:91], v[220:223], v[16:31]
    ds_read_b64_tr_b16 a[84:85], v246 offset:55296
    ds_read_b64_tr_b16 a[86:87], v246 offset:55552
    v_mfma_f32_32x32x16_bf16 v[32:47], a[92:95], v[220:223], v[32:47]
    ds_read_b64_tr_b16 a[88:89], v246 offset:27648
    ds_read_b64_tr_b16 a[90:91], v246 offset:27904
    s_waitcnt lgkmcnt(6)
    s_waitcnt vmcnt(3)
    v_mfma_f32_32x32x16_bf16 v[16:31], a[64:67], v[224:227], v[16:31]
    ds_read_b64_tr_b16 a[92:93], v246 offset:56320
    ds_read_b64_tr_b16 a[94:95], v246 offset:56576
    v_mfma_f32_32x32x16_bf16 v[32:47], a[68:71], v[224:227], v[32:47]
    s_barrier
    ds_read_b64_tr_b16 a[64:65], v247 offset:0
    ds_read_b64_tr_b16 a[66:67], v247 offset:256
    s_waitcnt vmcnt(2)
    v_mfma_f32_32x32x16_bf16 v[16:31], a[72:75], v[228:231], v[16:31]
    ds_read_b64_tr_b16 a[68:69], v247 offset:28672
    ds_read_b64_tr_b16 a[70:71], v247 offset:28928
    ds_read_b64_tr_b16 a[96:97], v8 offset:0
    ds_read_b64_tr_b16 a[98:99], v8 offset:1024
    ds_read_b64_tr_b16 a[100:101], v9 offset:0
    ds_read_b64_tr_b16 a[102:103], v9 offset:1024
    s_add_u32 m0, s31, 49152
    s_add_u32 s33, s29, 128
    buffer_load_dwordx4 v245, s[88:91], s33 offen lds
    v_mfma_f32_32x32x16_bf16 v[32:47], a[76:79], v[228:231], v[32:47]
    ds_read_b64_tr_b16 a[72:73], v247 offset:1024
    ds_read_b64_tr_b16 a[74:75], v247 offset:1280
    ds_read_b64_tr_b16 a[104:105], v10 offset:0
    ds_read_b64_tr_b16 a[106:107], v10 offset:1024
    ds_read_b64_tr_b16 a[108:109], v11 offset:0
    ds_read_b64_tr_b16 a[110:111], v11 offset:1024
    s_waitcnt lgkmcnt(14)
    s_waitcnt vmcnt(2)
    v_mfma_f32_32x32x16_bf16 v[16:31], a[80:83], v[232:235], v[16:31]
    ds_read_b64_tr_b16 a[76:77], v247 offset:29696
    ds_read_b64_tr_b16 a[78:79], v247 offset:29952
    ds_read_b64_tr_b16 a[112:113], v8 offset:4096
    ds_read_b64_tr_b16 a[114:115], v8 offset:5120
    ds_read_b64_tr_b16 a[116:117], v9 offset:4096
    ds_read_b64_tr_b16 a[118:119], v9 offset:5120
    s_add_u32 m0, s31, 51200
    s_add_u32 s33, s29, 114816
    buffer_load_dwordx4 v245, s[88:91], s33 offen lds
    v_mfma_f32_32x32x16_bf16 v[32:47], a[84:87], v[232:235], v[32:47]
    ds_read_b64_tr_b16 a[80:81], v247 offset:2048
    ds_read_b64_tr_b16 a[82:83], v247 offset:2304
    ds_read_b64_tr_b16 a[120:121], v10 offset:4096
    ds_read_b64_tr_b16 a[122:123], v10 offset:5120
    ds_read_b64_tr_b16 a[124:125], v11 offset:4096
    ds_read_b64_tr_b16 a[126:127], v11 offset:5120
    s_waitcnt vmcnt(2)
    v_mfma_f32_32x32x16_bf16 v[16:31], a[88:91], v[236:239], v[16:31]
    ds_read_b64_tr_b16 a[84:85], v247 offset:30720
    ds_read_b64_tr_b16 a[86:87], v247 offset:30976
    s_add_u32 m0, s31, 53248
    s_add_u32 s33, s29, 229504
    buffer_load_dwordx4 v245, s[88:91], s33 offen lds
    v_mfma_f32_32x32x16_bf16 v[32:47], a[92:95], v[236:239], v[32:47]
    ds_read_b64_tr_b16 a[88:89], v247 offset:3072
    ds_read_b64_tr_b16 a[90:91], v247 offset:3328
    s_waitcnt lgkmcnt(15)
    v_mfma_f32_32x32x16_bf16 v[16:31], a[96:99], v[4:7], v[16:31]
    s_waitcnt lgkmcnt(12)
    v_mfma_f32_32x32x16_bf16 v[32:47], a[112:115], v[4:7], v[32:47]
    v_mfma_f32_32x32x16_bf16 v[48:63], a[64:67], v[128:131], 0
    ds_read_b64_tr_b16 a[92:93], v247 offset:31744
    ds_read_b64_tr_b16 a[94:95], v247 offset:32000
    s_add_u32 m0, s31, 55296
    s_add_u32 s33, s29, 344192
    buffer_load_dwordx4 v245, s[88:91], s33 offen lds
    v_mfma_f32_32x32x16_bf16 v[64:79], a[68:71], v[128:131], 0
    ds_read_b64_tr_b16 a[64:65], v247 offset:4096
    ds_read_b64_tr_b16 a[66:67], v247 offset:4352
    v_mfma_f32_32x32x16_bf16 v[48:63], a[72:75], v[132:135], v[48:63]
    ds_read_b64_tr_b16 a[68:69], v247 offset:32768
    ds_read_b64_tr_b16 a[70:71], v247 offset:33024
    s_add_u32 m0, s31, 57344
    s_add_u32 s33, s29, 458880
    buffer_load_dwordx4 v245, s[88:91], s33 offen lds
    v_mfma_f32_32x32x16_bf16 v[64:79], a[76:79], v[132:135], v[64:79]
    ds_read_b64_tr_b16 a[72:73], v247 offset:5120
    ds_read_b64_tr_b16 a[74:75], v247 offset:5376
    v_mul_f32 v80, v254, v16
    v_mul_f32 v81, v254, v17
    v_mul_f32 v82, v254, v18
    v_mul_f32 v83, v254, v19
    s_waitcnt lgkmcnt(6)
    v_mfma_f32_32x32x16_bf16 v[48:63], a[80:83], v[136:139], v[48:63]
    ds_read_b64_tr_b16 a[76:77], v247 offset:33792
    ds_read_b64_tr_b16 a[78:79], v247 offset:34048
    s_add_u32 m0, s31, 59392
    s_add_u32 s33, s29, 573568
    buffer_load_dwordx4 v245, s[88:91], s33 offen lds
    v_mul_f32 v84, v254, v20
    v_mul_f32 v85, v254, v21
    v_mfma_f32_32x32x16_bf16 v[64:79], a[84:87], v[136:139], v[64:79]
    ds_read_b64_tr_b16 a[80:81], v247 offset:6144
    ds_read_b64_tr_b16 a[82:83], v247 offset:6400
    v_mul_f32 v86, v254, v22
    v_mul_f32 v87, v254, v23
    v_exp_f32 v80, v80
    v_mul_f32 v16, v16, v32
    v_mfma_f32_32x32x16_bf16 v[48:63], a[88:91], v[140:143], v[48:63]
    ds_read_b64_tr_b16 a[84:85], v247 offset:34816
    ds_read_b64_tr_b16 a[86:87], v247 offset:35072
    s_add_u32 m0, s31, 61440
    s_add_u32 s33, s29, 688256
    buffer_load_dwordx4 v245, s[88:91], s33 offen lds
    v_exp_f32 v81, v81
    v_mfma_f32_32x32x16_bf16 v[64:79], a[92:95], v[140:143], v[64:79]
    ds_read_b64_tr_b16 a[88:89], v247 offset:7168
    ds_read_b64_tr_b16 a[90:91], v247 offset:7424
    v_mul_f32 v17, v17, v33
    v_exp_f32 v82, v82
    v_mul_f32 v18, v18, v34
    s_waitcnt lgkmcnt(6)
    v_mfma_f32_32x32x16_bf16 v[48:63], a[64:67], v[144:147], v[48:63]
    s_barrier
    ds_read_b64_tr_b16 a[92:93], v247 offset:35840
    ds_read_b64_tr_b16 a[94:95], v247 offset:36096
    s_add_u32 m0, s31, 63488
    s_add_u32 s33, s29, 802944
    buffer_load_dwordx4 v245, s[88:91], s33 offen lds
    v_mfma_f32_32x32x16_bf16 v[64:79], a[68:71], v[144:147], v[64:79]
    ds_read_b64_tr_b16 a[64:65], v247 offset:8192
    ds_read_b64_tr_b16 a[66:67], v247 offset:8448
    v_exp_f32 v83, v83
    v_mul_f32 v19, v19, v35
    v_exp_f32 v84, v84
    v_mfma_f32_32x32x16_bf16 v[48:63], a[72:75], v[148:151], v[48:63]
    ds_read_b64_tr_b16 a[68:69], v247 offset:36864
    ds_read_b64_tr_b16 a[70:71], v247 offset:37120
    s_add_u32 m0, s31, 65536
    s_add_u32 s33, s29, 917632
    buffer_load_dwordx4 v245, s[88:91], s33 offen lds
    v_mul_f32 v20, v20, v36
    v_exp_f32 v85, v85
    v_mfma_f32_32x32x16_bf16 v[64:79], a[76:79], v[148:151], v[64:79]
    ds_read_b64_tr_b16 a[72:73], v247 offset:9216
    ds_read_b64_tr_b16 a[74:75], v247 offset:9472
    v_mul_f32 v21, v21, v37
    v_exp_f32 v86, v86
    v_mul_f32 v22, v22, v38
    s_waitcnt lgkmcnt(6)
    v_mfma_f32_32x32x16_bf16 v[48:63], a[80:83], v[152:155], v[48:63]
    ds_read_b64_tr_b16 a[76:77], v247 offset:37888
    ds_read_b64_tr_b16 a[78:79], v247 offset:38144
    s_add_u32 m0, s31, 67584
    s_add_u32 s33, s29, 1032320
    buffer_load_dwordx4 v245, s[88:91], s33 offen lds
    v_exp_f32 v87, v87
    v_mfma_f32_32x32x16_bf16 v[64:79], a[84:87], v[152:155], v[64:79]
    ds_read_b64_tr_b16 a[80:81], v247 offset:10240
    ds_read_b64_tr_b16 a[82:83], v247 offset:10496
    v_mul_f32 v23, v23, v39
    v_fma_f32 v80, v80, v255, v255
    v_fma_f32 v81, v81, v255, v255
    v_fma_f32 v82, v82, v255, v255
    v_fma_f32 v83, v83, v255, v255
    v_mfma_f32_32x32x16_bf16 v[48:63], a[88:91], v[156:159], v[48:63]
    ds_read_b64_tr_b16 a[84:85], v247 offset:38912
    ds_read_b64_tr_b16 a[86:87], v247 offset:39168
    s_add_u32 m0, s31, 69632
    s_add_u32 s33, s29, 1147008
    buffer_load_dwordx4 v245, s[88:91], s33 offen lds
    v_fma_f32 v84, v84, v255, v255
    v_fma_f32 v85, v85, v255, v255
    v_mfma_f32_32x32x16_bf16 v[64:79], a[92:95], v[156:159], v[64:79]
    ds_read_b64_tr_b16 a[88:89], v247 offset:11264
    ds_read_b64_tr_b16 a[90:91], v247 offset:11520
    v_fma_f32 v86, v86, v255, v255
    v_fma_f32 v87, v87, v255, v255
    v_rcp_f32 v80, v80
    s_waitcnt lgkmcnt(6)
    v_mfma_f32_32x32x16_bf16 v[48:63], a[64:67], v[160:163], v[48:63]
    ds_read_b64_tr_b16 a[92:93], v247 offset:39936
    ds_read_b64_tr_b16 a[94:95], v247 offset:40192
    s_add_u32 m0, s31, 71680
    s_add_u32 s33, s29, 1261696
    buffer_load_dwordx4 v245, s[88:91], s33 offen lds
    v_rcp_f32 v81, v81
    v_mfma_f32_32x32x16_bf16 v[64:79], a[68:71], v[160:163], v[64:79]
    ds_read_b64_tr_b16 a[64:65], v247 offset:12288
    ds_read_b64_tr_b16 a[66:67], v247 offset:12544
    v_rcp_f32 v82, v82
    v_rcp_f32 v83, v83
    v_rcp_f32 v84, v84
    v_mfma_f32_32x32x16_bf16 v[48:63], a[72:75], v[164:167], v[48:63]
    ds_read_b64_tr_b16 a[68:69], v247 offset:40960
    ds_read_b64_tr_b16 a[70:71], v247 offset:41216
    s_add_u32 m0, s31, 73728
    s_add_u32 s33, s29, 1376384
    buffer_load_dwordx4 v245, s[88:91], s33 offen lds
    v_rcp_f32 v85, v85
    v_mfma_f32_32x32x16_bf16 v[64:79], a[76:79], v[164:167], v[64:79]
    ds_read_b64_tr_b16 a[72:73], v247 offset:13312
    ds_read_b64_tr_b16 a[74:75], v247 offset:13568
    v_rcp_f32 v86, v86
    v_rcp_f32 v87, v87
    s_waitcnt lgkmcnt(6)
    v_mfma_f32_32x32x16_bf16 v[48:63], a[80:83], v[168:171], v[48:63]
    ds_read_b64_tr_b16 a[76:77], v247 offset:41984
    ds_read_b64_tr_b16 a[78:79], v247 offset:42240
    s_add_u32 m0, s31, 75776
    s_add_u32 s33, s29, 1491072
    buffer_load_dwordx4 v245, s[88:91], s33 offen lds
    v_mul_f32 v80, v16, v80
    v_mul_f32 v81, v17, v81
    v_mfma_f32_32x32x16_bf16 v[64:79], a[84:87], v[168:171], v[64:79]
    ds_read_b64_tr_b16 a[80:81], v247 offset:14336
    ds_read_b64_tr_b16 a[82:83], v247 offset:14592
    v_mul_f32 v82, v18, v82
    v_mul_f32 v83, v19, v83
    v_mul_f32 v84, v20, v84
    v_mul_f32 v85, v21, v85
    v_mul_f32 v86, v22, v86
    v_mfma_f32_32x32x16_bf16 v[48:63], a[88:91], v[172:175], v[48:63]
    ds_read_b64_tr_b16 a[84:85], v247 offset:43008
    ds_read_b64_tr_b16 a[86:87], v247 offset:43264
    s_add_u32 m0, s49, 0
    s_add_u32 s34, s35, 1146880
    buffer_load_dwordx4 v250, s[12:15], s34 offen lds
    v_mul_f32 v87, v23, v87
    v_cvt_pk_bf16_f32 v96, v80, v81
    v_mfma_f32_32x32x16_bf16 v[64:79], a[92:95], v[172:175], v[64:79]
    ds_read_b64_tr_b16 a[88:89], v247 offset:15360
    ds_read_b64_tr_b16 a[90:91], v247 offset:15616
    v_cvt_pk_bf16_f32 v97, v82, v83
    v_cvt_pk_bf16_f32 v98, v84, v85
    v_cvt_pk_bf16_f32 v99, v86, v87
    buffer_store_dwordx4 v[96:99], v244, s[24:27], s58 offen offset:0 sc1
    s_waitcnt lgkmcnt(6)
    v_mfma_f32_32x32x16_bf16 v[48:63], a[64:67], v[176:179], v[48:63]
    ds_read_b64_tr_b16 a[92:93], v247 offset:44032
    ds_read_b64_tr_b16 a[94:95], v247 offset:44288
    v_mul_f32 v88, v254, v24
    v_mul_f32 v89, v254, v25
    v_mul_f32 v90, v254, v26
    v_mul_f32 v91, v254, v27
    v_mul_f32 v92, v254, v28
    v_mfma_f32_32x32x16_bf16 v[64:79], a[68:71], v[176:179], v[64:79]
    ds_read_b64_tr_b16 a[64:65], v247 offset:16384
    ds_read_b64_tr_b16 a[66:67], v247 offset:16640
    s_add_u32 m0, s49, 1024
    s_add_u32 s34, s35, 1154048
    buffer_load_dwordx4 v250, s[12:15], s34 offen lds
    v_mul_f32 v93, v254, v29
    v_mul_f32 v94, v254, v30
    v_mfma_f32_32x32x16_bf16 v[48:63], a[72:75], v[180:183], v[48:63]
    ds_read_b64_tr_b16 a[68:69], v247 offset:45056
    ds_read_b64_tr_b16 a[70:71], v247 offset:45312
    v_mul_f32 v95, v254, v31
    v_exp_f32 v88, v88
    v_mul_f32 v24, v24, v40
    v_exp_f32 v89, v89
    v_mfma_f32_32x32x16_bf16 v[64:79], a[76:79], v[180:183], v[64:79]
    ds_read_b64_tr_b16 a[72:73], v247 offset:17408
    ds_read_b64_tr_b16 a[74:75], v247 offset:17664
    v_mul_f32 v25, v25, v41
    v_exp_f32 v90, v90
    v_mul_f32 v26, v26, v42
    s_waitcnt lgkmcnt(6)
    v_mfma_f32_32x32x16_bf16 v[48:63], a[80:83], v[184:187], v[48:63]
    ds_read_b64_tr_b16 a[76:77], v247 offset:46080
    ds_read_b64_tr_b16 a[78:79], v247 offset:46336
    s_add_u32 m0, s49, 2048
    s_add_u32 s34, s35, 1161216
    buffer_load_dwordx4 v250, s[12:15], s34 offen lds
    v_exp_f32 v91, v91
    v_mfma_f32_32x32x16_bf16 v[64:79], a[84:87], v[184:187], v[64:79]
    ds_read_b64_tr_b16 a[80:81], v247 offset:18432
    ds_read_b64_tr_b16 a[82:83], v247 offset:18688
    v_mul_f32 v27, v27, v43
    v_exp_f32 v92, v92
    v_mul_f32 v28, v28, v44
    v_exp_f32 v93, v93
    v_mfma_f32_32x32x16_bf16 v[48:63], a[88:91], v[188:191], v[48:63]
    ds_read_b64_tr_b16 a[84:85], v247 offset:47104
    ds_read_b64_tr_b16 a[86:87], v247 offset:47360
    v_mul_f32 v29, v29, v45
    v_exp_f32 v94, v94
    v_mul_f32 v30, v30, v46
    v_exp_f32 v95, v95
    v_mfma_f32_32x32x16_bf16 v[64:79], a[92:95], v[188:191], v[64:79]
    ds_read_b64_tr_b16 a[88:89], v247 offset:19456
    ds_read_b64_tr_b16 a[90:91], v247 offset:19712
    v_mfma_f32_32x32x16_bf16 v[48:63], a[100:103], v[4:7], v[48:63]
    v_mfma_f32_32x32x16_bf16 v[64:79], a[116:119], v[4:7], v[64:79]
    s_add_u32 m0, s49, 3072
    s_add_u32 s34, s35, 1168384
    buffer_load_dwordx4 v250, s[12:15], s34 offen lds
    v_mul_f32 v31, v31, v47
    v_fma_f32 v88, v88, v255, v255
    v_fma_f32 v89, v89, v255, v255
    v_fma_f32 v90, v90, v255, v255
    v_fma_f32 v91, v91, v255, v255
    v_fma_f32 v92, v92, v255, v255
    v_fma_f32 v93, v93, v255, v255
    v_fma_f32 v94, v94, v255, v255
    v_fma_f32 v95, v95, v255, v255
    v_rcp_f32 v88, v88
    s_waitcnt lgkmcnt(6)
    v_mfma_f32_32x32x16_bf16 v[48:63], a[64:67], v[192:195], v[48:63]
    ds_read_b64_tr_b16 a[92:93], v247 offset:48128
    ds_read_b64_tr_b16 a[94:95], v247 offset:48384
    v_rcp_f32 v89, v89
    v_rcp_f32 v90, v90
    v_rcp_f32 v91, v91
    v_mfma_f32_32x32x16_bf16 v[64:79], a[68:71], v[192:195], v[64:79]
    ds_read_b64_tr_b16 a[64:65], v247 offset:20480
    ds_read_b64_tr_b16 a[66:67], v247 offset:20736
    v_rcp_f32 v92, v92
    v_rcp_f32 v93, v93
    v_rcp_f32 v94, v94
    v_mfma_f32_32x32x16_bf16 v[48:63], a[72:75], v[196:199], v[48:63]
    ds_read_b64_tr_b16 a[68:69], v247 offset:49152
    ds_read_b64_tr_b16 a[70:71], v247 offset:49408
    s_add_u32 m0, s49, 16384
    s_add_u32 s34, s35, 1261568
    buffer_load_dwordx4 v250, s[12:15], s34 offen lds
    v_rcp_f32 v95, v95
    v_mfma_f32_32x32x16_bf16 v[64:79], a[76:79], v[196:199], v[64:79]
    ds_read_b64_tr_b16 a[72:73], v247 offset:21504
    ds_read_b64_tr_b16 a[74:75], v247 offset:21760
    v_mul_f32 v88, v24, v88
    v_mul_f32 v89, v25, v89
    v_mul_f32 v90, v26, v90
    v_mul_f32 v91, v27, v91
    s_waitcnt lgkmcnt(6)
    v_mfma_f32_32x32x16_bf16 v[48:63], a[80:83], v[200:203], v[48:63]
    ds_read_b64_tr_b16 a[76:77], v247 offset:50176
    ds_read_b64_tr_b16 a[78:79], v247 offset:50432
    v_mul_f32 v92, v28, v92
    v_mul_f32 v93, v29, v93
    v_mul_f32 v94, v30, v94
    v_mul_f32 v95, v31, v95
    v_cvt_pk_bf16_f32 v100, v88, v89
    v_mfma_f32_32x32x16_bf16 v[64:79], a[84:87], v[200:203], v[64:79]
    ds_read_b64_tr_b16 a[80:81], v247 offset:22528
    ds_read_b64_tr_b16 a[82:83], v247 offset:22784
    s_add_u32 m0, s49, 17408
    s_add_u32 s34, s35, 1268736
    buffer_load_dwordx4 v250, s[12:15], s34 offen lds
    v_cvt_pk_bf16_f32 v101, v90, v91
    v_cvt_pk_bf16_f32 v102, v92, v93
    v_mfma_f32_32x32x16_bf16 v[48:63], a[88:91], v[204:207], v[48:63]
    ds_read_b64_tr_b16 a[84:85], v247 offset:51200
    ds_read_b64_tr_b16 a[86:87], v247 offset:51456
    v_cvt_pk_bf16_f32 v103, v94, v95
    buffer_store_dwordx4 v[100:103], v244, s[24:27], s58 offen offset:1024 sc1
    v_mfma_f32_32x32x16_bf16 v[64:79], a[92:95], v[204:207], v[64:79]
    ds_read_b64_tr_b16 a[88:89], v247 offset:23552
    ds_read_b64_tr_b16 a[90:91], v247 offset:23808
    s_waitcnt lgkmcnt(6)
    v_mfma_f32_32x32x16_bf16 v[48:63], a[64:67], v[208:211], v[48:63]
    ds_read_b64_tr_b16 a[92:93], v247 offset:52224
    ds_read_b64_tr_b16 a[94:95], v247 offset:52480
    s_add_u32 m0, s49, 18432
    s_add_u32 s34, s35, 1275904
    buffer_load_dwordx4 v250, s[12:15], s34 offen lds
    v_mfma_f32_32x32x16_bf16 v[64:79], a[68:71], v[208:211], v[64:79]
    ds_read_b64_tr_b16 a[64:65], v247 offset:24576
    ds_read_b64_tr_b16 a[66:67], v247 offset:24832
    v_mfma_f32_32x32x16_bf16 v[48:63], a[72:75], v[212:215], v[48:63]
    ds_read_b64_tr_b16 a[68:69], v247 offset:53248
    ds_read_b64_tr_b16 a[70:71], v247 offset:53504
    v_mfma_f32_32x32x16_bf16 v[64:79], a[76:79], v[212:215], v[64:79]
    ds_read_b64_tr_b16 a[72:73], v247 offset:25600
    ds_read_b64_tr_b16 a[74:75], v247 offset:25856
    s_add_u32 m0, s49, 19456
    s_add_u32 s34, s35, 1283072
    buffer_load_dwordx4 v250, s[12:15], s34 offen lds
    s_waitcnt lgkmcnt(6)
    v_mfma_f32_32x32x16_bf16 v[48:63], a[80:83], v[216:219], v[48:63]
    ds_read_b64_tr_b16 a[76:77], v247 offset:54272
    ds_read_b64_tr_b16 a[78:79], v247 offset:54528
    v_mfma_f32_32x32x16_bf16 v[64:79], a[84:87], v[216:219], v[64:79]
    ds_read_b64_tr_b16 a[80:81], v247 offset:26624
    ds_read_b64_tr_b16 a[82:83], v247 offset:26880
    v_mfma_f32_32x32x16_bf16 v[48:63], a[88:91], v[220:223], v[48:63]
    ds_read_b64_tr_b16 a[84:85], v247 offset:55296
    ds_read_b64_tr_b16 a[86:87], v247 offset:55552
    v_mfma_f32_32x32x16_bf16 v[64:79], a[92:95], v[220:223], v[64:79]
    ds_read_b64_tr_b16 a[88:89], v247 offset:27648
    ds_read_b64_tr_b16 a[90:91], v247 offset:27904
    s_waitcnt lgkmcnt(6)
    v_mfma_f32_32x32x16_bf16 v[48:63], a[64:67], v[224:227], v[48:63]
    ds_read_b64_tr_b16 a[92:93], v247 offset:56320
    ds_read_b64_tr_b16 a[94:95], v247 offset:56576
    v_mfma_f32_32x32x16_bf16 v[64:79], a[68:71], v[224:227], v[64:79]
    s_waitcnt vmcnt(10)
    s_barrier
    ds_read_b64_tr_b16 a[64:65], v246 offset:0
    ds_read_b64_tr_b16 a[66:67], v246 offset:256
    v_mfma_f32_32x32x16_bf16 v[48:63], a[72:75], v[228:231], v[48:63]
    ds_read_b64_tr_b16 a[68:69], v246 offset:28672
    ds_read_b64_tr_b16 a[70:71], v246 offset:28928
    s_add_u32 m0, s31, 106496
    s_add_u32 s33, s29, 192
    buffer_load_dwordx4 v245, s[88:91], s33 offen lds
    v_mfma_f32_32x32x16_bf16 v[64:79], a[76:79], v[228:231], v[64:79]
    ds_read_b64_tr_b16 a[72:73], v246 offset:1024
    ds_read_b64_tr_b16 a[74:75], v246 offset:1280
    s_waitcnt lgkmcnt(6)
    v_mfma_f32_32x32x16_bf16 v[48:63], a[80:83], v[232:235], v[48:63]
    ds_read_b64_tr_b16 a[76:77], v246 offset:29696
    ds_read_b64_tr_b16 a[78:79], v246 offset:29952
    s_add_u32 m0, s31, 108544
    s_add_u32 s33, s29, 114880
    buffer_load_dwordx4 v245, s[88:91], s33 offen lds
    v_mfma_f32_32x32x16_bf16 v[64:79], a[84:87], v[232:235], v[64:79]
    ds_read_b64_tr_b16 a[80:81], v246 offset:2048
    ds_read_b64_tr_b16 a[82:83], v246 offset:2304
    v_mfma_f32_32x32x16_bf16 v[48:63], a[88:91], v[236:239], v[48:63]
    ds_read_b64_tr_b16 a[84:85], v246 offset:30720
    ds_read_b64_tr_b16 a[86:87], v246 offset:30976
    s_add_u32 m0, s31, 110592
    s_add_u32 s33, s29, 229568
    buffer_load_dwordx4 v245, s[88:91], s33 offen lds
    v_mfma_f32_32x32x16_bf16 v[64:79], a[92:95], v[236:239], v[64:79]
    ds_read_b64_tr_b16 a[88:89], v246 offset:3072
    ds_read_b64_tr_b16 a[90:91], v246 offset:3328
    s_waitcnt lgkmcnt(6)
    v_mfma_f32_32x32x16_bf16 v[16:31], a[64:67], v[128:131], 0
    ds_read_b64_tr_b16 a[92:93], v246 offset:31744
    ds_read_b64_tr_b16 a[94:95], v246 offset:32000
    s_add_u32 m0, s31, 112640
    s_add_u32 s33, s29, 344256
    buffer_load_dwordx4 v245, s[88:91], s33 offen lds
    v_mfma_f32_32x32x16_bf16 v[32:47], a[68:71], v[128:131], 0
    ds_read_b64_tr_b16 a[64:65], v246 offset:4096
    ds_read_b64_tr_b16 a[66:67], v246 offset:4352
    v_mfma_f32_32x32x16_bf16 v[16:31], a[72:75], v[132:135], v[16:31]
    ds_read_b64_tr_b16 a[68:69], v246 offset:32768
    ds_read_b64_tr_b16 a[70:71], v246 offset:33024
    s_add_u32 m0, s31, 114688
    s_add_u32 s33, s29, 458944
    buffer_load_dwordx4 v245, s[88:91], s33 offen lds
    v_mfma_f32_32x32x16_bf16 v[32:47], a[76:79], v[132:135], v[32:47]
    ds_read_b64_tr_b16 a[72:73], v246 offset:5120
    ds_read_b64_tr_b16 a[74:75], v246 offset:5376
    v_mul_f32 v80, v254, v48
    v_mul_f32 v81, v254, v49
    v_mul_f32 v82, v254, v50
    v_mul_f32 v83, v254, v51
    s_waitcnt lgkmcnt(6)
    v_mfma_f32_32x32x16_bf16 v[16:31], a[80:83], v[136:139], v[16:31]
    ds_read_b64_tr_b16 a[76:77], v246 offset:33792
    ds_read_b64_tr_b16 a[78:79], v246 offset:34048
    s_add_u32 m0, s31, 116736
    s_add_u32 s33, s29, 573632
    buffer_load_dwordx4 v245, s[88:91], s33 offen lds
    v_mul_f32 v84, v254, v52
    v_mul_f32 v85, v254, v53
    v_mfma_f32_32x32x16_bf16 v[32:47], a[84:87], v[136:139], v[32:47]
    ds_read_b64_tr_b16 a[80:81], v246 offset:6144
    ds_read_b64_tr_b16 a[82:83], v246 offset:6400
    v_mul_f32 v86, v254, v54
    v_mul_f32 v87, v254, v55
    v_exp_f32 v80, v80
    v_mul_f32 v48, v48, v64
    v_mfma_f32_32x32x16_bf16 v[16:31], a[88:91], v[140:143], v[16:31]
    ds_read_b64_tr_b16 a[84:85], v246 offset:34816
    ds_read_b64_tr_b16 a[86:87], v246 offset:35072
    s_add_u32 m0, s31, 118784
    s_add_u32 s33, s29, 688320
    buffer_load_dwordx4 v245, s[88:91], s33 offen lds
    v_exp_f32 v81, v81
    v_mfma_f32_32x32x16_bf16 v[32:47], a[92:95], v[140:143], v[32:47]
    ds_read_b64_tr_b16 a[88:89], v246 offset:7168
    ds_read_b64_tr_b16 a[90:91], v246 offset:7424
    v_mul_f32 v49, v49, v65
    v_exp_f32 v82, v82
    v_mul_f32 v50, v50, v66
    s_waitcnt lgkmcnt(6)
    v_mfma_f32_32x32x16_bf16 v[16:31], a[64:67], v[144:147], v[16:31]
    s_barrier
    ds_read_b64_tr_b16 a[92:93], v246 offset:35840
    ds_read_b64_tr_b16 a[94:95], v246 offset:36096
    s_add_u32 m0, s31, 120832
    s_add_u32 s33, s29, 803008
    buffer_load_dwordx4 v245, s[88:91], s33 offen lds
    v_mfma_f32_32x32x16_bf16 v[32:47], a[68:71], v[144:147], v[32:47]
    ds_read_b64_tr_b16 a[64:65], v246 offset:8192
    ds_read_b64_tr_b16 a[66:67], v246 offset:8448
    v_exp_f32 v83, v83
    v_mul_f32 v51, v51, v67
    v_exp_f32 v84, v84
    v_mfma_f32_32x32x16_bf16 v[16:31], a[72:75], v[148:151], v[16:31]
    ds_read_b64_tr_b16 a[68:69], v246 offset:36864
    ds_read_b64_tr_b16 a[70:71], v246 offset:37120
    s_add_u32 m0, s31, 122880
    s_add_u32 s33, s29, 917696
    buffer_load_dwordx4 v245, s[88:91], s33 offen lds
    v_mul_f32 v52, v52, v68
    v_exp_f32 v85, v85
    v_mfma_f32_32x32x16_bf16 v[32:47], a[76:79], v[148:151], v[32:47]
    ds_read_b64_tr_b16 a[72:73], v246 offset:9216
    ds_read_b64_tr_b16 a[74:75], v246 offset:9472
    v_mul_f32 v53, v53, v69
    v_exp_f32 v86, v86
    v_mul_f32 v54, v54, v70
    s_waitcnt lgkmcnt(6)
    v_mfma_f32_32x32x16_bf16 v[16:31], a[80:83], v[152:155], v[16:31]
    ds_read_b64_tr_b16 a[76:77], v246 offset:37888
    ds_read_b64_tr_b16 a[78:79], v246 offset:38144
    s_add_u32 m0, s31, 124928
    s_add_u32 s33, s29, 1032384
    buffer_load_dwordx4 v245, s[88:91], s33 offen lds
    v_exp_f32 v87, v87
    v_mfma_f32_32x32x16_bf16 v[32:47], a[84:87], v[152:155], v[32:47]
    ds_read_b64_tr_b16 a[80:81], v246 offset:10240
    ds_read_b64_tr_b16 a[82:83], v246 offset:10496
    v_mul_f32 v55, v55, v71
    v_fma_f32 v80, v80, v255, v255
    v_fma_f32 v81, v81, v255, v255
    v_fma_f32 v82, v82, v255, v255
    v_fma_f32 v83, v83, v255, v255
    v_mfma_f32_32x32x16_bf16 v[16:31], a[88:91], v[156:159], v[16:31]
    ds_read_b64_tr_b16 a[84:85], v246 offset:38912
    ds_read_b64_tr_b16 a[86:87], v246 offset:39168
    s_add_u32 m0, s31, 126976
    s_add_u32 s33, s29, 1147072
    buffer_load_dwordx4 v245, s[88:91], s33 offen lds
    v_fma_f32 v84, v84, v255, v255
    v_fma_f32 v85, v85, v255, v255
    v_mfma_f32_32x32x16_bf16 v[32:47], a[92:95], v[156:159], v[32:47]
    ds_read_b64_tr_b16 a[88:89], v246 offset:11264
    ds_read_b64_tr_b16 a[90:91], v246 offset:11520
    v_fma_f32 v86, v86, v255, v255
    v_fma_f32 v87, v87, v255, v255
    v_rcp_f32 v80, v80
    s_waitcnt lgkmcnt(6)
    v_mfma_f32_32x32x16_bf16 v[16:31], a[64:67], v[160:163], v[16:31]
    ds_read_b64_tr_b16 a[92:93], v246 offset:39936
    ds_read_b64_tr_b16 a[94:95], v246 offset:40192
    s_add_u32 m0, s31, 129024
    s_add_u32 s33, s29, 1261760
    buffer_load_dwordx4 v245, s[88:91], s33 offen lds
    v_rcp_f32 v81, v81
    v_mfma_f32_32x32x16_bf16 v[32:47], a[68:71], v[160:163], v[32:47]
    ds_read_b64_tr_b16 a[64:65], v246 offset:12288
    ds_read_b64_tr_b16 a[66:67], v246 offset:12544
    v_rcp_f32 v82, v82
    v_rcp_f32 v83, v83
    v_rcp_f32 v84, v84
    v_mfma_f32_32x32x16_bf16 v[16:31], a[72:75], v[164:167], v[16:31]
    ds_read_b64_tr_b16 a[68:69], v246 offset:40960
    ds_read_b64_tr_b16 a[70:71], v246 offset:41216
    s_add_u32 m0, s31, 131072
    s_add_u32 s33, s29, 1376448
    buffer_load_dwordx4 v245, s[88:91], s33 offen lds
    v_rcp_f32 v85, v85
    v_mfma_f32_32x32x16_bf16 v[32:47], a[76:79], v[164:167], v[32:47]
    ds_read_b64_tr_b16 a[72:73], v246 offset:13312
    ds_read_b64_tr_b16 a[74:75], v246 offset:13568
    v_rcp_f32 v86, v86
    v_rcp_f32 v87, v87
    s_waitcnt lgkmcnt(6)
    v_mfma_f32_32x32x16_bf16 v[16:31], a[80:83], v[168:171], v[16:31]
    ds_read_b64_tr_b16 a[76:77], v246 offset:41984
    ds_read_b64_tr_b16 a[78:79], v246 offset:42240
    s_add_u32 m0, s31, 133120
    s_add_u32 s33, s29, 1491136
    buffer_load_dwordx4 v245, s[88:91], s33 offen lds
    v_mul_f32 v80, v48, v80
    v_mul_f32 v81, v49, v81
    v_mfma_f32_32x32x16_bf16 v[32:47], a[84:87], v[168:171], v[32:47]
    ds_read_b64_tr_b16 a[80:81], v246 offset:14336
    ds_read_b64_tr_b16 a[82:83], v246 offset:14592
    v_mul_f32 v82, v50, v82
    v_mul_f32 v83, v51, v83
    v_mul_f32 v84, v52, v84
    v_mul_f32 v85, v53, v85
    v_mul_f32 v86, v54, v86
    v_mfma_f32_32x32x16_bf16 v[16:31], a[88:91], v[172:175], v[16:31]
    ds_read_b64_tr_b16 a[84:85], v246 offset:43008
    ds_read_b64_tr_b16 a[86:87], v246 offset:43264
    v_mul_f32 v87, v55, v87
    v_cvt_pk_bf16_f32 v104, v80, v81
    v_cvt_pk_bf16_f32 v105, v82, v83
    v_cvt_pk_bf16_f32 v106, v84, v85
    v_cvt_pk_bf16_f32 v107, v86, v87
    v_mfma_f32_32x32x16_bf16 v[32:47], a[92:95], v[172:175], v[32:47]
    ds_read_b64_tr_b16 a[88:89], v246 offset:15360
    ds_read_b64_tr_b16 a[90:91], v246 offset:15616
    buffer_store_dwordx4 v[104:107], v244, s[24:27], s58 offen offset:2048 sc1
    v_mul_f32 v88, v254, v56
    v_mul_f32 v89, v254, v57
    v_mul_f32 v90, v254, v58
    s_waitcnt lgkmcnt(6)
    v_mfma_f32_32x32x16_bf16 v[16:31], a[64:67], v[176:179], v[16:31]
    ds_read_b64_tr_b16 a[92:93], v246 offset:44032
    ds_read_b64_tr_b16 a[94:95], v246 offset:44288
    s_add_u32 m0, s49, 32768
    s_add_u32 s34, s35, 1376256
    buffer_load_dwordx4 v250, s[12:15], s34 offen lds
    v_mul_f32 v91, v254, v59
    v_mul_f32 v92, v254, v60
    v_mfma_f32_32x32x16_bf16 v[32:47], a[68:71], v[176:179], v[32:47]
    ds_read_b64_tr_b16 a[64:65], v246 offset:16384
    ds_read_b64_tr_b16 a[66:67], v246 offset:16640
    v_mul_f32 v93, v254, v61
    v_mul_f32 v94, v254, v62
    v_mul_f32 v95, v254, v63
    v_exp_f32 v88, v88
    v_mfma_f32_32x32x16_bf16 v[16:31], a[72:75], v[180:183], v[16:31]
    ds_read_b64_tr_b16 a[68:69], v246 offset:45056
    ds_read_b64_tr_b16 a[70:71], v246 offset:45312
    v_mul_f32 v56, v56, v72
    v_exp_f32 v89, v89
    v_mul_f32 v57, v57, v73
    v_exp_f32 v90, v90
    v_mfma_f32_32x32x16_bf16 v[32:47], a[76:79], v[180:183], v[32:47]
    ds_read_b64_tr_b16 a[72:73], v246 offset:17408
    ds_read_b64_tr_b16 a[74:75], v246 offset:17664
    v_mul_f32 v58, v58, v74
    v_exp_f32 v91, v91
    v_mul_f32 v59, v59, v75
    s_waitcnt lgkmcnt(6)
    v_mfma_f32_32x32x16_bf16 v[16:31], a[80:83], v[184:187], v[16:31]
    ds_read_b64_tr_b16 a[76:77], v246 offset:46080
    ds_read_b64_tr_b16 a[78:79], v246 offset:46336
    s_add_u32 m0, s49, 33792
    s_add_u32 s34, s35, 1383424
    buffer_load_dwordx4 v250, s[12:15], s34 offen lds
    v_exp_f32 v92, v92
    v_mfma_f32_32x32x16_bf16 v[32:47], a[84:87], v[184:187], v[32:47]
    ds_read_b64_tr_b16 a[80:81], v246 offset:18432
    ds_read_b64_tr_b16 a[82:83], v246 offset:18688
    v_mul_f32 v60, v60, v76
    v_exp_f32 v93, v93
    v_mul_f32 v61, v61, v77
    v_exp_f32 v94, v94
    v_mfma_f32_32x32x16_bf16 v[16:31], a[88:91], v[188:191], v[16:31]
    ds_read_b64_tr_b16 a[84:85], v246 offset:47104
    ds_read_b64_tr_b16 a[86:87], v246 offset:47360
    v_mul_f32 v62, v62, v78
    v_exp_f32 v95, v95
    v_mul_f32 v63, v63, v79
    v_fma_f32 v88, v88, v255, v255
    v_mfma_f32_32x32x16_bf16 v[32:47], a[92:95], v[188:191], v[32:47]
    ds_read_b64_tr_b16 a[88:89], v246 offset:19456
    ds_read_b64_tr_b16 a[90:91], v246 offset:19712
    v_mfma_f32_32x32x16_bf16 v[16:31], a[104:107], v[4:7], v[16:31]
    v_mfma_f32_32x32x16_bf16 v[32:47], a[120:123], v[4:7], v[32:47]
    v_fma_f32 v89, v89, v255, v255
    v_fma_f32 v90, v90, v255, v255
    v_fma_f32 v91, v91, v255, v255
    v_fma_f32 v92, v92, v255, v255
    v_fma_f32 v93, v93, v255, v255
    v_fma_f32 v94, v94, v255, v255
    v_fma_f32 v95, v95, v255, v255
    v_rcp_f32 v88, v88
    v_rcp_f32 v89, v89
    v_rcp_f32 v90, v90
    v_rcp_f32 v91, v91
    s_waitcnt lgkmcnt(6)
    v_mfma_f32_32x32x16_bf16 v[16:31], a[64:67], v[192:195], v[16:31]
    ds_read_b64_tr_b16 a[92:93], v246 offset:48128
    ds_read_b64_tr_b16 a[94:95], v246 offset:48384
    s_add_u32 m0, s49, 34816
    s_add_u32 s34, s35, 1390592
    buffer_load_dwordx4 v250, s[12:15], s34 offen lds
    v_rcp_f32 v92, v92
    v_mfma_f32_32x32x16_bf16 v[32:47], a[68:71], v[192:195], v[32:47]
    ds_read_b64_tr_b16 a[64:65], v246 offset:20480
    ds_read_b64_tr_b16 a[66:67], v246 offset:20736
    v_rcp_f32 v93, v93
    v_rcp_f32 v94, v94
    v_rcp_f32 v95, v95
    v_mfma_f32_32x32x16_bf16 v[16:31], a[72:75], v[196:199], v[16:31]
    ds_read_b64_tr_b16 a[68:69], v246 offset:49152
    ds_read_b64_tr_b16 a[70:71], v246 offset:49408
    v_mul_f32 v88, v56, v88
    v_mul_f32 v89, v57, v89
    v_mul_f32 v90, v58, v90
    v_mul_f32 v91, v59, v91
    v_mul_f32 v92, v60, v92
    v_mfma_f32_32x32x16_bf16 v[32:47], a[76:79], v[196:199], v[32:47]
    ds_read_b64_tr_b16 a[72:73], v246 offset:21504
    ds_read_b64_tr_b16 a[74:75], v246 offset:21760
    v_mul_f32 v93, v61, v93
    v_mul_f32 v94, v62, v94
    v_mul_f32 v95, v63, v95
    v_cvt_pk_bf16_f32 v108, v88, v89
    s_waitcnt lgkmcnt(6)
    v_mfma_f32_32x32x16_bf16 v[16:31], a[80:83], v[200:203], v[16:31]
    ds_read_b64_tr_b16 a[76:77], v246 offset:50176
    ds_read_b64_tr_b16 a[78:79], v246 offset:50432
    s_add_u32 m0, s49, 35840
    s_add_u32 s34, s35, 1397760
    buffer_load_dwordx4 v250, s[12:15], s34 offen lds
    v_cvt_pk_bf16_f32 v109, v90, v91
    v_cvt_pk_bf16_f32 v110, v92, v93
    v_mfma_f32_32x32x16_bf16 v[32:47], a[84:87], v[200:203], v[32:47]
    ds_read_b64_tr_b16 a[80:81], v246 offset:22528
    ds_read_b64_tr_b16 a[82:83], v246 offset:22784
    v_cvt_pk_bf16_f32 v111, v94, v95
    buffer_store_dwordx4 v[108:111], v244, s[24:27], s58 offen offset:3072 sc1
    v_mfma_f32_32x32x16_bf16 v[16:31], a[88:91], v[204:207], v[16:31]
    ds_read_b64_tr_b16 a[84:85], v246 offset:51200
    ds_read_b64_tr_b16 a[86:87], v246 offset:51456
    v_mfma_f32_32x32x16_bf16 v[32:47], a[92:95], v[204:207], v[32:47]
    ds_read_b64_tr_b16 a[88:89], v246 offset:23552
    ds_read_b64_tr_b16 a[90:91], v246 offset:23808
    s_waitcnt lgkmcnt(6)
    v_mfma_f32_32x32x16_bf16 v[16:31], a[64:67], v[208:211], v[16:31]
    ds_read_b64_tr_b16 a[92:93], v246 offset:52224
    ds_read_b64_tr_b16 a[94:95], v246 offset:52480
    v_mfma_f32_32x32x16_bf16 v[32:47], a[68:71], v[208:211], v[32:47]
    ds_read_b64_tr_b16 a[64:65], v246 offset:24576
    ds_read_b64_tr_b16 a[66:67], v246 offset:24832
    v_mfma_f32_32x32x16_bf16 v[16:31], a[72:75], v[212:215], v[16:31]
    ds_read_b64_tr_b16 a[68:69], v246 offset:53248
    ds_read_b64_tr_b16 a[70:71], v246 offset:53504
    v_mfma_f32_32x32x16_bf16 v[32:47], a[76:79], v[212:215], v[32:47]
    ds_read_b64_tr_b16 a[72:73], v246 offset:25600
    ds_read_b64_tr_b16 a[74:75], v246 offset:25856
    s_waitcnt lgkmcnt(6)
    v_mfma_f32_32x32x16_bf16 v[16:31], a[80:83], v[216:219], v[16:31]
    ds_read_b64_tr_b16 a[76:77], v246 offset:54272
    ds_read_b64_tr_b16 a[78:79], v246 offset:54528
    v_mfma_f32_32x32x16_bf16 v[32:47], a[84:87], v[216:219], v[32:47]
    ds_read_b64_tr_b16 a[80:81], v246 offset:26624
    ds_read_b64_tr_b16 a[82:83], v246 offset:26880
    v_mfma_f32_32x32x16_bf16 v[16:31], a[88:91], v[220:223], v[16:31]
    ds_read_b64_tr_b16 a[84:85], v246 offset:55296
    ds_read_b64_tr_b16 a[86:87], v246 offset:55552
    v_mfma_f32_32x32x16_bf16 v[32:47], a[92:95], v[220:223], v[32:47]
    ds_read_b64_tr_b16 a[88:89], v246 offset:27648
    ds_read_b64_tr_b16 a[90:91], v246 offset:27904
    s_waitcnt lgkmcnt(6)
    v_mfma_f32_32x32x16_bf16 v[16:31], a[64:67], v[224:227], v[16:31]
    ds_read_b64_tr_b16 a[92:93], v246 offset:56320
    ds_read_b64_tr_b16 a[94:95], v246 offset:56576
    v_mfma_f32_32x32x16_bf16 v[32:47], a[68:71], v[224:227], v[32:47]
    s_waitcnt vmcnt(6)
    s_barrier
    ds_read_b64_tr_b16 a[64:65], v247 offset:0
    ds_read_b64_tr_b16 a[66:67], v247 offset:256
    v_mfma_f32_32x32x16_bf16 v[16:31], a[72:75], v[228:231], v[16:31]
    ds_read_b64_tr_b16 a[68:69], v247 offset:28672
    ds_read_b64_tr_b16 a[70:71], v247 offset:28928
    s_add_u32 m0, s49, 49152
    s_add_u32 s34, s35, 1490944
    buffer_load_dwordx4 v250, s[12:15], s34 offen lds
    v_mfma_f32_32x32x16_bf16 v[32:47], a[76:79], v[228:231], v[32:47]
    ds_read_b64_tr_b16 a[72:73], v247 offset:1024
    ds_read_b64_tr_b16 a[74:75], v247 offset:1280
    s_waitcnt lgkmcnt(6)
    v_mfma_f32_32x32x16_bf16 v[16:31], a[80:83], v[232:235], v[16:31]
    ds_read_b64_tr_b16 a[76:77], v247 offset:29696
    ds_read_b64_tr_b16 a[78:79], v247 offset:29952
    s_add_u32 m0, s49, 50176
    s_add_u32 s34, s35, 1498112
    buffer_load_dwordx4 v250, s[12:15], s34 offen lds
    v_mfma_f32_32x32x16_bf16 v[32:47], a[84:87], v[232:235], v[32:47]
    ds_read_b64_tr_b16 a[80:81], v247 offset:2048
    ds_read_b64_tr_b16 a[82:83], v247 offset:2304
    v_mfma_f32_32x32x16_bf16 v[16:31], a[88:91], v[236:239], v[16:31]
    ds_read_b64_tr_b16 a[84:85], v247 offset:30720
    ds_read_b64_tr_b16 a[86:87], v247 offset:30976
    s_add_u32 m0, s49, 51200
    s_add_u32 s34, s35, 1505280
    buffer_load_dwordx4 v250, s[12:15], s34 offen lds
    v_mfma_f32_32x32x16_bf16 v[32:47], a[92:95], v[236:239], v[32:47]
    ds_read_b64_tr_b16 a[88:89], v247 offset:3072
    ds_read_b64_tr_b16 a[90:91], v247 offset:3328
    s_waitcnt lgkmcnt(6)
    v_mfma_f32_32x32x16_bf16 v[48:63], a[64:67], v[128:131], 0
    ds_read_b64_tr_b16 a[92:93], v247 offset:31744
    ds_read_b64_tr_b16 a[94:95], v247 offset:32000
    s_add_u32 m0, s49, 52224
    s_add_u32 s34, s35, 1512448
    buffer_load_dwordx4 v250, s[12:15], s34 offen lds
    v_mfma_f32_32x32x16_bf16 v[64:79], a[68:71], v[128:131], 0
    ds_read_b64_tr_b16 a[64:65], v247 offset:4096
    ds_read_b64_tr_b16 a[66:67], v247 offset:4352
    v_mfma_f32_32x32x16_bf16 v[48:63], a[72:75], v[132:135], v[48:63]
    ds_read_b64_tr_b16 a[68:69], v247 offset:32768
    ds_read_b64_tr_b16 a[70:71], v247 offset:33024
    v_mfma_f32_32x32x16_bf16 v[64:79], a[76:79], v[132:135], v[64:79]
    ds_read_b64_tr_b16 a[72:73], v247 offset:5120
    ds_read_b64_tr_b16 a[74:75], v247 offset:5376
    s_add_u32 m0, s49, 81920
    s_add_u32 s34, s35, 458752
    buffer_load_dwordx4 v250, s[12:15], s34 offen lds
    v_mul_f32 v80, v254, v16
    s_waitcnt lgkmcnt(6)
    v_mfma_f32_32x32x16_bf16 v[48:63], a[80:83], v[136:139], v[48:63]
    ds_read_b64_tr_b16 a[76:77], v247 offset:33792
    ds_read_b64_tr_b16 a[78:79], v247 offset:34048
    v_mul_f32 v81, v254, v17
    v_mul_f32 v82, v254, v18
    v_mul_f32 v83, v254, v19
    v_mul_f32 v84, v254, v20
    v_mul_f32 v85, v254, v21
    v_mfma_f32_32x32x16_bf16 v[64:79], a[84:87], v[136:139], v[64:79]
    ds_read_b64_tr_b16 a[80:81], v247 offset:6144
    ds_read_b64_tr_b16 a[82:83], v247 offset:6400
    v_mul_f32 v86, v254, v22
    v_mul_f32 v87, v254, v23
    v_exp_f32 v80, v80
    v_mul_f32 v16, v16, v32
    v_mfma_f32_32x32x16_bf16 v[48:63], a[88:91], v[140:143], v[48:63]
    ds_read_b64_tr_b16 a[84:85], v247 offset:34816
    ds_read_b64_tr_b16 a[86:87], v247 offset:35072
    s_add_u32 m0, s49, 82944
    s_add_u32 s34, s35, 465920
    buffer_load_dwordx4 v250, s[12:15], s34 offen lds
    v_exp_f32 v81, v81
    v_mfma_f32_32x32x16_bf16 v[64:79], a[92:95], v[140:143], v[64:79]
    ds_read_b64_tr_b16 a[88:89], v247 offset:7168
    ds_read_b64_tr_b16 a[90:91], v247 offset:7424
    v_mul_f32 v17, v17, v33
    v_exp_f32 v82, v82
    v_mul_f32 v18, v18, v34
    s_waitcnt lgkmcnt(6)
    v_mfma_f32_32x32x16_bf16 v[48:63], a[64:67], v[144:147], v[48:63]
    s_barrier
    ds_read_b64_tr_b16 a[92:93], v247 offset:35840
    ds_read_b64_tr_b16 a[94:95], v247 offset:36096
    v_exp_f32 v83, v83
    v_mul_f32 v19, v19, v35
    v_mfma_f32_32x32x16_bf16 v[64:79], a[68:71], v[144:147], v[64:79]
    ds_read_b64_tr_b16 a[64:65], v247 offset:8192
    ds_read_b64_tr_b16 a[66:67], v247 offset:8448
    s_add_u32 m0, s49, 83968
    s_add_u32 s34, s35, 473088
    buffer_load_dwordx4 v250, s[12:15], s34 offen lds
    v_exp_f32 v84, v84
    v_mfma_f32_32x32x16_bf16 v[48:63], a[72:75], v[148:151], v[48:63]
    ds_read_b64_tr_b16 a[68:69], v247 offset:36864
    ds_read_b64_tr_b16 a[70:71], v247 offset:37120
    v_mul_f32 v20, v20, v36
    v_exp_f32 v85, v85
    v_mul_f32 v21, v21, v37
    v_exp_f32 v86, v86
    v_mfma_f32_32x32x16_bf16 v[64:79], a[76:79], v[148:151], v[64:79]
    ds_read_b64_tr_b16 a[72:73], v247 offset:9216
    ds_read_b64_tr_b16 a[74:75], v247 offset:9472
    v_mul_f32 v22, v22, v38
    v_exp_f32 v87, v87
    v_mul_f32 v23, v23, v39
    s_waitcnt lgkmcnt(6)
    v_mfma_f32_32x32x16_bf16 v[48:63], a[80:83], v[152:155], v[48:63]
    ds_read_b64_tr_b16 a[76:77], v247 offset:37888
    ds_read_b64_tr_b16 a[78:79], v247 offset:38144
    s_add_u32 m0, s49, 84992
    s_add_u32 s34, s35, 480256
    buffer_load_dwordx4 v250, s[12:15], s34 offen lds
    v_fma_f32 v80, v80, v255, v255
    v_fma_f32 v81, v81, v255, v255
    v_mfma_f32_32x32x16_bf16 v[64:79], a[84:87], v[152:155], v[64:79]
    ds_read_b64_tr_b16 a[80:81], v247 offset:10240
    ds_read_b64_tr_b16 a[82:83], v247 offset:10496
    v_fma_f32 v82, v82, v255, v255
    v_fma_f32 v83, v83, v255, v255
    v_fma_f32 v84, v84, v255, v255
    v_fma_f32 v85, v85, v255, v255
    v_fma_f32 v86, v86, v255, v255
    v_mfma_f32_32x32x16_bf16 v[48:63], a[88:91], v[156:159], v[48:63]
    ds_read_b64_tr_b16 a[84:85], v247 offset:38912
    ds_read_b64_tr_b16 a[86:87], v247 offset:39168
    v_fma_f32 v87, v87, v255, v255
    v_rcp_f32 v80, v80
    v_rcp_f32 v81, v81
    v_mfma_f32_32x32x16_bf16 v[64:79], a[92:95], v[156:159], v[64:79]
    ds_read_b64_tr_b16 a[88:89], v247 offset:11264
    ds_read_b64_tr_b16 a[90:91], v247 offset:11520
    s_add_u32 m0, s49, 65536
    s_add_u32 s34, s35, 573440
    buffer_load_dwordx4 v250, s[12:15], s34 offen lds
    v_rcp_f32 v82, v82
    s_waitcnt lgkmcnt(6)
    v_mfma_f32_32x32x16_bf16 v[48:63], a[64:67], v[160:163], v[48:63]
    ds_read_b64_tr_b16 a[92:93], v247 offset:39936
    ds_read_b64_tr_b16 a[94:95], v247 offset:40192
    v_rcp_f32 v83, v83
    v_rcp_f32 v84, v84
    v_rcp_f32 v85, v85
    v_mfma_f32_32x32x16_bf16 v[64:79], a[68:71], v[160:163], v[64:79]
    ds_read_b64_tr_b16 a[64:65], v247 offset:12288
    ds_read_b64_tr_b16 a[66:67], v247 offset:12544
    v_rcp_f32 v86, v86
    v_rcp_f32 v87, v87
    v_mul_f32 v80, v16, v80
    v_mfma_f32_32x32x16_bf16 v[48:63], a[72:75], v[164:167], v[48:63]
    ds_read_b64_tr_b16 a[68:69], v247 offset:40960
    ds_read_b64_tr_b16 a[70:71], v247 offset:41216
    s_add_u32 m0, s49, 66560
    s_add_u32 s34, s35, 580608
    buffer_load_dwordx4 v250, s[12:15], s34 offen lds
    v_mul_f32 v81, v17, v81
    v_mul_f32 v82, v18, v82
    v_mfma_f32_32x32x16_bf16 v[64:79], a[76:79], v[164:167], v[64:79]
    ds_read_b64_tr_b16 a[72:73], v247 offset:13312
    ds_read_b64_tr_b16 a[74:75], v247 offset:13568
    v_mul_f32 v83, v19, v83
    v_mul_f32 v84, v20, v84
    v_mul_f32 v85, v21, v85
    v_mul_f32 v86, v22, v86
    s_waitcnt lgkmcnt(6)
    v_mfma_f32_32x32x16_bf16 v[48:63], a[80:83], v[168:171], v[48:63]
    ds_read_b64_tr_b16 a[76:77], v247 offset:41984
    ds_read_b64_tr_b16 a[78:79], v247 offset:42240
    v_mul_f32 v87, v23, v87
    v_cvt_pk_bf16_f32 v96, v80, v81
    v_cvt_pk_bf16_f32 v97, v82, v83
    v_cvt_pk_bf16_f32 v98, v84, v85
    v_cvt_pk_bf16_f32 v99, v86, v87
    v_mfma_f32_32x32x16_bf16 v[64:79], a[84:87], v[168:171], v[64:79]
    ds_read_b64_tr_b16 a[80:81], v247 offset:14336
    ds_read_b64_tr_b16 a[82:83], v247 offset:14592
    s_add_u32 m0, s49, 67584
    s_add_u32 s34, s35, 587776
    buffer_load_dwordx4 v250, s[12:15], s34 offen lds
    buffer_store_dwordx4 v[96:99], v244, s[24:27], s59 offen offset:0 sc1
    v_mul_f32 v88, v254, v24
    v_mfma_f32_32x32x16_bf16 v[48:63], a[88:91], v[172:175], v[48:63]
    ds_read_b64_tr_b16 a[84:85], v247 offset:43008
    ds_read_b64_tr_b16 a[86:87], v247 offset:43264
    v_mul_f32 v89, v254, v25
    v_mul_f32 v90, v254, v26
    v_mul_f32 v91, v254, v27
    v_mul_f32 v92, v254, v28
    v_mul_f32 v93, v254, v29
    v_mfma_f32_32x32x16_bf16 v[64:79], a[92:95], v[172:175], v[64:79]
    ds_read_b64_tr_b16 a[88:89], v247 offset:15360
    ds_read_b64_tr_b16 a[90:91], v247 offset:15616
    v_mul_f32 v94, v254, v30
    v_mul_f32 v95, v254, v31
    v_exp_f32 v88, v88
    s_waitcnt lgkmcnt(6)
    v_mfma_f32_32x32x16_bf16 v[48:63], a[64:67], v[176:179], v[48:63]
    ds_read_b64_tr_b16 a[92:93], v247 offset:44032
    ds_read_b64_tr_b16 a[94:95], v247 offset:44288
    s_add_u32 m0, s49, 68608
    s_add_u32 s34, s35, 594944
    buffer_load_dwordx4 v250, s[12:15], s34 offen lds
    v_mul_f32 v24, v24, v40
    v_exp_f32 v89, v89
    v_mfma_f32_32x32x16_bf16 v[64:79], a[68:71], v[176:179], v[64:79]
    ds_read_b64_tr_b16 a[64:65], v247 offset:16384
    ds_read_b64_tr_b16 a[66:67], v247 offset:16640
    v_mul_f32 v25, v25, v41
    v_exp_f32 v90, v90
    v_mul_f32 v26, v26, v42
    v_exp_f32 v91, v91
    v_mfma_f32_32x32x16_bf16 v[48:63], a[72:75], v[180:183], v[48:63]
    ds_read_b64_tr_b16 a[68:69], v247 offset:45056
    ds_read_b64_tr_b16 a[70:71], v247 offset:45312
    v_mul_f32 v27, v27, v43
    v_exp_f32 v92, v92
    v_mul_f32 v28, v28, v44
    v_exp_f32 v93, v93
    v_mfma_f32_32x32x16_bf16 v[64:79], a[76:79], v[180:183], v[64:79]
    ds_read_b64_tr_b16 a[72:73], v247 offset:17408
    ds_read_b64_tr_b16 a[74:75], v247 offset:17664
    v_mul_f32 v29, v29, v45
    v_exp_f32 v94, v94
    v_mul_f32 v30, v30, v46
    s_waitcnt lgkmcnt(6)
    v_mfma_f32_32x32x16_bf16 v[48:63], a[80:83], v[184:187], v[48:63]
    ds_read_b64_tr_b16 a[76:77], v247 offset:46080
    ds_read_b64_tr_b16 a[78:79], v247 offset:46336
    v_exp_f32 v95, v95
    v_mul_f32 v31, v31, v47
    v_fma_f32 v88, v88, v255, v255
    v_fma_f32 v89, v89, v255, v255
    v_mfma_f32_32x32x16_bf16 v[64:79], a[84:87], v[184:187], v[64:79]
    ds_read_b64_tr_b16 a[80:81], v247 offset:18432
    ds_read_b64_tr_b16 a[82:83], v247 offset:18688
    v_fma_f32 v90, v90, v255, v255
    v_fma_f32 v91, v91, v255, v255
    v_fma_f32 v92, v92, v255, v255
    v_fma_f32 v93, v93, v255, v255
    v_fma_f32 v94, v94, v255, v255
    v_mfma_f32_32x32x16_bf16 v[48:63], a[88:91], v[188:191], v[48:63]
    ds_read_b64_tr_b16 a[84:85], v247 offset:47104
    ds_read_b64_tr_b16 a[86:87], v247 offset:47360
    v_fma_f32 v95, v95, v255, v255
    v_rcp_f32 v88, v88
    v_rcp_f32 v89, v89
    v_mfma_f32_32x32x16_bf16 v[64:79], a[92:95], v[188:191], v[64:79]
    ds_read_b64_tr_b16 a[88:89], v247 offset:19456
    ds_read_b64_tr_b16 a[90:91], v247 offset:19712
    v_mfma_f32_32x32x16_bf16 v[48:63], a[108:111], v[4:7], v[48:63]
    v_mfma_f32_32x32x16_bf16 v[64:79], a[124:127], v[4:7], v[64:79]
    v_rcp_f32 v90, v90
    v_rcp_f32 v91, v91
    v_rcp_f32 v92, v92
    v_rcp_f32 v93, v93
    v_rcp_f32 v94, v94
    v_rcp_f32 v95, v95
    v_mul_f32 v88, v24, v88
    v_mul_f32 v89, v25, v89
    s_waitcnt lgkmcnt(6)
    v_mfma_f32_32x32x16_bf16 v[48:63], a[64:67], v[192:195], v[48:63]
    ds_read_b64_tr_b16 a[92:93], v247 offset:48128
    ds_read_b64_tr_b16 a[94:95], v247 offset:48384
    v_mul_f32 v90, v26, v90
    v_mul_f32 v91, v27, v91
    v_mul_f32 v92, v28, v92
    v_mul_f32 v93, v29, v93
    v_mul_f32 v94, v30, v94
    v_mfma_f32_32x32x16_bf16 v[64:79], a[68:71], v[192:195], v[64:79]
    ds_read_b64_tr_b16 a[64:65], v247 offset:20480
    ds_read_b64_tr_b16 a[66:67], v247 offset:20736
    v_mul_f32 v95, v31, v95
    v_cvt_pk_bf16_f32 v100, v88, v89
    v_cvt_pk_bf16_f32 v101, v90, v91
    v_cvt_pk_bf16_f32 v102, v92, v93
    v_cvt_pk_bf16_f32 v103, v94, v95
    v_mfma_f32_32x32x16_bf16 v[48:63], a[72:75], v[196:199], v[48:63]
    ds_read_b64_tr_b16 a[68:69], v247 offset:49152
    ds_read_b64_tr_b16 a[70:71], v247 offset:49408
    buffer_store_dwordx4 v[100:103], v244, s[24:27], s59 offen offset:1024 sc1
    v_mfma_f32_32x32x16_bf16 v[64:79], a[76:79], v[196:199], v[64:79]
    ds_read_b64_tr_b16 a[72:73], v247 offset:21504
    ds_read_b64_tr_b16 a[74:75], v247 offset:21760
    s_waitcnt lgkmcnt(6)
    v_mfma_f32_32x32x16_bf16 v[48:63], a[80:83], v[200:203], v[48:63]
    ds_read_b64_tr_b16 a[76:77], v247 offset:50176
    ds_read_b64_tr_b16 a[78:79], v247 offset:50432
    v_mfma_f32_32x32x16_bf16 v[64:79], a[84:87], v[200:203], v[64:79]
    ds_read_b64_tr_b16 a[80:81], v247 offset:22528
    ds_read_b64_tr_b16 a[82:83], v247 offset:22784
    v_mfma_f32_32x32x16_bf16 v[48:63], a[88:91], v[204:207], v[48:63]
    ds_read_b64_tr_b16 a[84:85], v247 offset:51200
    ds_read_b64_tr_b16 a[86:87], v247 offset:51456
    v_mfma_f32_32x32x16_bf16 v[64:79], a[92:95], v[204:207], v[64:79]
    ds_read_b64_tr_b16 a[88:89], v247 offset:23552
    ds_read_b64_tr_b16 a[90:91], v247 offset:23808
    s_waitcnt lgkmcnt(6)
    v_mfma_f32_32x32x16_bf16 v[48:63], a[64:67], v[208:211], v[48:63]
    ds_read_b64_tr_b16 a[92:93], v247 offset:52224
    ds_read_b64_tr_b16 a[94:95], v247 offset:52480
    v_mfma_f32_32x32x16_bf16 v[64:79], a[68:71], v[208:211], v[64:79]
    ds_read_b64_tr_b16 a[64:65], v247 offset:24576
    ds_read_b64_tr_b16 a[66:67], v247 offset:24832
    v_mfma_f32_32x32x16_bf16 v[48:63], a[72:75], v[212:215], v[48:63]
    ds_read_b64_tr_b16 a[68:69], v247 offset:53248
    ds_read_b64_tr_b16 a[70:71], v247 offset:53504
    v_mfma_f32_32x32x16_bf16 v[64:79], a[76:79], v[212:215], v[64:79]
    ds_read_b64_tr_b16 a[72:73], v247 offset:25600
    ds_read_b64_tr_b16 a[74:75], v247 offset:25856
    s_waitcnt lgkmcnt(6)
    v_mfma_f32_32x32x16_bf16 v[48:63], a[80:83], v[216:219], v[48:63]
    ds_read_b64_tr_b16 a[76:77], v247 offset:54272
    ds_read_b64_tr_b16 a[78:79], v247 offset:54528
    v_mfma_f32_32x32x16_bf16 v[64:79], a[84:87], v[216:219], v[64:79]
    ds_read_b64_tr_b16 a[80:81], v247 offset:26624
    ds_read_b64_tr_b16 a[82:83], v247 offset:26880
    v_mfma_f32_32x32x16_bf16 v[48:63], a[88:91], v[220:223], v[48:63]
    ds_read_b64_tr_b16 a[84:85], v247 offset:55296
    ds_read_b64_tr_b16 a[86:87], v247 offset:55552
    v_mfma_f32_32x32x16_bf16 v[64:79], a[92:95], v[220:223], v[64:79]
    ds_read_b64_tr_b16 a[88:89], v247 offset:27648
    ds_read_b64_tr_b16 a[90:91], v247 offset:27904
    s_waitcnt lgkmcnt(6)
    v_mfma_f32_32x32x16_bf16 v[48:63], a[64:67], v[224:227], v[48:63]
    ds_read_b64_tr_b16 a[92:93], v247 offset:56320
    ds_read_b64_tr_b16 a[94:95], v247 offset:56576
    v_mfma_f32_32x32x16_bf16 v[64:79], a[68:71], v[224:227], v[64:79]
    v_mfma_f32_32x32x16_bf16 v[48:63], a[72:75], v[228:231], v[48:63]
    v_mfma_f32_32x32x16_bf16 v[64:79], a[76:79], v[228:231], v[64:79]
    s_waitcnt lgkmcnt(0)
    v_mfma_f32_32x32x16_bf16 v[48:63], a[80:83], v[232:235], v[48:63]
    v_mfma_f32_32x32x16_bf16 v[64:79], a[84:87], v[232:235], v[64:79]
    v_mfma_f32_32x32x16_bf16 v[48:63], a[88:91], v[236:239], v[48:63]
    v_mfma_f32_32x32x16_bf16 v[64:79], a[92:95], v[236:239], v[64:79]
    s_nop 15
    s_nop 3
    s_barrier
    s_mov_b32 s73, s57
    v_mul_f32 v80, v254, v48
    v_mul_f32 v81, v254, v49
    v_mul_f32 v82, v254, v50
    v_mul_f32 v83, v254, v51
    v_mul_f32 v84, v254, v52
    v_mul_f32 v85, v254, v53
    v_mul_f32 v86, v254, v54
    v_mul_f32 v87, v254, v55
    v_exp_f32 v80, v80
    v_mul_f32 v48, v48, v64
    v_exp_f32 v81, v81
    v_mul_f32 v49, v49, v65
    v_exp_f32 v82, v82
    v_mul_f32 v50, v50, v66
    v_exp_f32 v83, v83
    v_mul_f32 v51, v51, v67
    v_exp_f32 v84, v84
    v_mul_f32 v52, v52, v68
    v_exp_f32 v85, v85
    v_mul_f32 v53, v53, v69
    v_exp_f32 v86, v86
    v_mul_f32 v54, v54, v70
    v_exp_f32 v87, v87
    v_mul_f32 v55, v55, v71
    v_fma_f32 v80, v80, v255, v255
    v_fma_f32 v81, v81, v255, v255
    v_fma_f32 v82, v82, v255, v255
    v_fma_f32 v83, v83, v255, v255
    v_fma_f32 v84, v84, v255, v255
    v_fma_f32 v85, v85, v255, v255
    v_fma_f32 v86, v86, v255, v255
    v_fma_f32 v87, v87, v255, v255
    v_rcp_f32 v80, v80
    v_rcp_f32 v81, v81
    v_rcp_f32 v82, v82
    v_rcp_f32 v83, v83
    v_rcp_f32 v84, v84
    v_rcp_f32 v85, v85
    v_rcp_f32 v86, v86
    v_rcp_f32 v87, v87
    v_mul_f32 v80, v48, v80
    v_mul_f32 v81, v49, v81
    v_mul_f32 v82, v50, v82
    v_mul_f32 v83, v51, v83
    v_mul_f32 v84, v52, v84
    v_mul_f32 v85, v53, v85
    v_mul_f32 v86, v54, v86
    v_mul_f32 v87, v55, v87
    v_cvt_pk_bf16_f32 v104, v80, v81
    v_cvt_pk_bf16_f32 v105, v82, v83
    v_cvt_pk_bf16_f32 v106, v84, v85
    v_cvt_pk_bf16_f32 v107, v86, v87
    buffer_store_dwordx4 v[104:107], v244, s[24:27], s59 offen offset:2048 sc1
    v_mul_f32 v88, v254, v56
    v_mul_f32 v89, v254, v57
    v_mul_f32 v90, v254, v58
    v_mul_f32 v91, v254, v59
    v_mul_f32 v92, v254, v60
    v_mul_f32 v93, v254, v61
    v_mul_f32 v94, v254, v62
    v_mul_f32 v95, v254, v63
    v_exp_f32 v88, v88
    v_mul_f32 v56, v56, v72
    v_exp_f32 v89, v89
    v_mul_f32 v57, v57, v73
    v_exp_f32 v90, v90
    v_mul_f32 v58, v58, v74
    v_exp_f32 v91, v91
    v_mul_f32 v59, v59, v75
    v_exp_f32 v92, v92
    v_mul_f32 v60, v60, v76
    v_exp_f32 v93, v93
    v_mul_f32 v61, v61, v77
    v_exp_f32 v94, v94
    v_mul_f32 v62, v62, v78
    v_exp_f32 v95, v95
    v_mul_f32 v63, v63, v79
    v_fma_f32 v88, v88, v255, v255
    v_fma_f32 v89, v89, v255, v255
    v_fma_f32 v90, v90, v255, v255
    v_fma_f32 v91, v91, v255, v255
    v_fma_f32 v92, v92, v255, v255
    v_fma_f32 v93, v93, v255, v255
    v_fma_f32 v94, v94, v255, v255
    v_fma_f32 v95, v95, v255, v255
    v_rcp_f32 v88, v88
    v_rcp_f32 v89, v89
    v_rcp_f32 v90, v90
    v_rcp_f32 v91, v91
    v_rcp_f32 v92, v92
    v_rcp_f32 v93, v93
    v_rcp_f32 v94, v94
    v_rcp_f32 v95, v95
    v_mul_f32 v88, v56, v88
    v_mul_f32 v89, v57, v89
    v_mul_f32 v90, v58, v90
    v_mul_f32 v91, v59, v91
    v_mul_f32 v92, v60, v92
    v_mul_f32 v93, v61, v93
    v_mul_f32 v94, v62, v94
    v_mul_f32 v95, v63, v95
    v_cvt_pk_bf16_f32 v108, v88, v89
    v_cvt_pk_bf16_f32 v109, v90, v91
    v_cvt_pk_bf16_f32 v110, v92, v93
    v_cvt_pk_bf16_f32 v111, v94, v95
    buffer_store_dwordx4 v[108:111], v244, s[24:27], s59 offen offset:3072 sc1
    s_add_u32 m0, s49, 98304
    s_add_u32 s34, s35, 688128
    buffer_load_dwordx4 v250, s[12:15], s34 offen lds
    s_add_u32 m0, s49, 99328
    s_add_u32 s34, s35, 695296
    buffer_load_dwordx4 v250, s[12:15], s34 offen lds
    s_add_u32 m0, s49, 100352
    s_add_u32 s34, s35, 702464
    buffer_load_dwordx4 v250, s[12:15], s34 offen lds
    s_add_u32 m0, s49, 101376
    s_add_u32 s34, s35, 709632
    buffer_load_dwordx4 v250, s[12:15], s34 offen lds
    s_add_u32 m0, s49, 114688
    s_add_u32 s34, s35, 802816
    buffer_load_dwordx4 v250, s[12:15], s34 offen lds
    s_add_u32 m0, s49, 115712
    s_add_u32 s34, s35, 809984
    buffer_load_dwordx4 v250, s[12:15], s34 offen lds
    s_add_u32 m0, s49, 116736
    s_add_u32 s34, s35, 817152
    buffer_load_dwordx4 v250, s[12:15], s34 offen lds
    s_add_u32 m0, s49, 117760
    s_add_u32 s34, s35, 824320
    buffer_load_dwordx4 v250, s[12:15], s34 offen lds
    s_add_u32 m0, s49, 131072
    s_add_u32 s34, s35, 917504
    buffer_load_dwordx4 v250, s[12:15], s34 offen lds
    s_add_u32 m0, s49, 132096
    s_add_u32 s34, s35, 924672
    buffer_load_dwordx4 v250, s[12:15], s34 offen lds
    s_add_u32 m0, s49, 133120
    s_add_u32 s34, s35, 931840
    buffer_load_dwordx4 v250, s[12:15], s34 offen lds
    s_add_u32 m0, s49, 134144
    s_add_u32 s34, s35, 939008
    buffer_load_dwordx4 v250, s[12:15], s34 offen lds
    s_add_u32 m0, s49, 147456
    s_add_u32 s34, s35, 1032192
    buffer_load_dwordx4 v250, s[12:15], s34 offen lds
    s_add_u32 m0, s49, 148480
    s_add_u32 s34, s35, 1039360
    buffer_load_dwordx4 v250, s[12:15], s34 offen lds
    s_add_u32 m0, s49, 149504
    s_add_u32 s34, s35, 1046528
    buffer_load_dwordx4 v250, s[12:15], s34 offen lds
    s_add_u32 m0, s49, 150528
    s_add_u32 s34, s35, 1053696
    buffer_load_dwordx4 v250, s[12:15], s34 offen lds
    s_load_dwordx2 s[38:39], s[0:1], 0
    s_load_dwordx2 s[40:41], s[0:1], 88
    s_load_dwordx2 s[44:45], s[0:1], 104
    v_mov_b32 v160, v240
    v_mov_b32 v161, v241
    v_mov_b32 v162, v242
    s_and_b32 s51, s2, 7
    s_lshr_b32 s52, s2, 3
    s_mul_i32 s53, s52, 37
    s_lshr_b32 s53, s53, 8
    s_mul_i32 s54, s53, 7
    s_sub_u32 s54, s52, s54
    s_lshl_b32 s53, s53, 3
    s_add_u32 s53, s53, s51
    v_lshlrev_b32 v163, 4, v160
    s_and_b32 s30, s28, 1
    s_mul_i32 s30, s30, 114688
    v_add_u32 v164, s30, v163
    s_sub_u32 s30, 114688, s30
    v_add_u32 v165, s30, v163
    s_mul_i32 s29, s53, 229376
    s_lshl_b32 s30, s28, 11
    s_add_u32 s29, s29, s30
    v_lshrrev_b32 v168, 4, v160
    v_and_b32 v169, 15, v160
    v_lshrrev_b32 v170, 2, v169
    v_lshrrev_b32 v171, 1, v168
    v_lshl_add_u32 v171, v171, 3, v170
    v_lshlrev_b32 v171, 7, v171
    v_and_b32 v172, 1, v168
    v_lshl_add_u32 v171, v172, 5, v171
    v_and_b32 v172, 3, v169
    v_lshl_add_u32 v171, v172, 3, v171
    v_add_u32 v171, s49, v171
    v_lshrrev_b32 v170, 3, v169
    s_lshr_b32 s30, s28, 1
    v_xor_b32 v170, s30, v170
    v_xor_b32 v172, 0, v170
    v_lshl_add_u32 v166, v172, 6, v171
    v_xor_b32 v172, 1, v170
    v_lshl_add_u32 v167, v172, 6, v171
    v_add_u32 v172, 0x10000, v166
    v_add_u32 v174, 0x20000, v166
    v_add_u32 v173, 0x10000, v167
    v_add_u32 v175, 0x20000, v167
    s_waitcnt lgkmcnt(0)
    s_add_u32 s4, s44, 20971520
    s_addc_u32 s5, s45, 0
    s_mov_b32 s6, 7340032
    s_mov_b32 s7, 0x00020000
    s_add_u32 s8, s44, 18874368
    s_addc_u32 s9, s45, 0
    s_mov_b32 s10, 1835008
    s_mov_b32 s11, 0x00020000
    s_mov_b32 s16, s40
    s_mov_b32 s17, s41
    s_mov_b32 s18, 1835008
    s_mov_b32 s19, 0x00020000
    s_mov_b32 s20, s44
    s_mov_b32 s21, s45
    s_mov_b32 s22, 10752
    s_mov_b32 s23, 0x00020000
    ds_read_b64_tr_b16 a[0:1], v166 offset:0
    ds_read_b64_tr_b16 a[2:3], v166 offset:512
    ds_read_b64_tr_b16 a[4:5], v167 offset:0
    ds_read_b64_tr_b16 a[6:7], v167 offset:512
    ds_read_b64_tr_b16 a[8:9], v166 offset:2048
    ds_read_b64_tr_b16 a[10:11], v166 offset:2560
    ds_read_b64_tr_b16 a[12:13], v167 offset:2048
    ds_read_b64_tr_b16 a[14:15], v167 offset:2560
    ds_read_b64_tr_b16 a[16:17], v166 offset:16384
    ds_read_b64_tr_b16 a[18:19], v166 offset:16896
    ds_read_b64_tr_b16 a[20:21], v167 offset:16384
    ds_read_b64_tr_b16 a[22:23], v167 offset:16896
    ds_read_b64_tr_b16 a[24:25], v166 offset:18432
    ds_read_b64_tr_b16 a[26:27], v166 offset:18944
    ds_read_b64_tr_b16 a[28:29], v167 offset:18432
    ds_read_b64_tr_b16 a[30:31], v167 offset:18944
    s_waitcnt vmcnt(33)
    ds_read_b64_tr_b16 a[32:33], v166 offset:32768
    ds_read_b64_tr_b16 a[34:35], v166 offset:33280
    ds_read_b64_tr_b16 a[36:37], v167 offset:32768
    ds_read_b64_tr_b16 a[38:39], v167 offset:33280
    ds_read_b64_tr_b16 a[40:41], v166 offset:34816
    ds_read_b64_tr_b16 a[42:43], v166 offset:35328
    ds_read_b64_tr_b16 a[44:45], v167 offset:34816
    ds_read_b64_tr_b16 a[46:47], v167 offset:35328
    s_waitcnt vmcnt(28)
    ds_read_b64_tr_b16 a[48:49], v166 offset:49152
    ds_read_b64_tr_b16 a[50:51], v166 offset:49664
    ds_read_b64_tr_b16 a[52:53], v167 offset:49152
    ds_read_b64_tr_b16 a[54:55], v167 offset:49664
    ds_read_b64_tr_b16 a[56:57], v166 offset:51200
    ds_read_b64_tr_b16 a[58:59], v166 offset:51712
    ds_read_b64_tr_b16 a[60:61], v167 offset:51200
    ds_read_b64_tr_b16 a[62:63], v167 offset:51712
    s_waitcnt vmcnt(16)
    s_barrier
    s_cmp_lg_u32 s28, 0
    s_cbranch_scc1 SIG5
    s_mov_b64 exec, 1
    v_mov_b32 v0, 0
    v_mov_b32 v1, 1
    buffer_atomic_add v1, v0, s[68:71], s73 offen sc1
    s_mov_b64 exec, -1
SIG5:
    s_waitcnt lgkmcnt(15)
    s_add_u32 m0, s49, 0
    s_add_u32 s34, s35, 0
    buffer_load_dwordx4 v250, s[12:15], s34 offen lds
    s_add_u32 m0, s49, 1024
    s_add_u32 s34, s35, 7168
    buffer_load_dwordx4 v250, s[12:15], s34 offen lds
    s_add_u32 m0, s49, 2048
    s_add_u32 s34, s35, 14336
    buffer_load_dwordx4 v250, s[12:15], s34 offen lds
    s_add_u32 m0, s49, 3072
    s_add_u32 s34, s35, 21504
    buffer_load_dwordx4 v250, s[12:15], s34 offen lds
    s_add_u32 m0, s49, 16384
    s_add_u32 s34, s35, 114688
    buffer_load_dwordx4 v250, s[12:15], s34 offen lds
    s_add_u32 m0, s49, 17408
    s_add_u32 s34, s35, 121856
    buffer_load_dwordx4 v250, s[12:15], s34 offen lds
    s_add_u32 m0, s49, 18432
    s_add_u32 s34, s35, 129024
    buffer_load_dwordx4 v250, s[12:15], s34 offen lds
    s_add_u32 m0, s49, 19456
    s_add_u32 s34, s35, 136192
    buffer_load_dwordx4 v250, s[12:15], s34 offen lds
    s_waitcnt lgkmcnt(8)
    s_add_u32 m0, s49, 32768
    s_add_u32 s34, s35, 229376
    buffer_load_dwordx4 v250, s[12:15], s34 offen lds
    s_add_u32 m0, s49, 33792
    s_add_u32 s34, s35, 236544
    buffer_load_dwordx4 v250, s[12:15], s34 offen lds
    s_add_u32 m0, s49, 34816
    s_add_u32 s34, s35, 243712
    buffer_load_dwordx4 v250, s[12:15], s34 offen lds
    s_add_u32 m0, s49, 35840
    s_add_u32 s34, s35, 250880
    buffer_load_dwordx4 v250, s[12:15], s34 offen lds
    s_waitcnt lgkmcnt(0)
    s_add_u32 m0, s49, 49152
    s_add_u32 s34, s35, 344064
    buffer_load_dwordx4 v250, s[12:15], s34 offen lds
    s_add_u32 m0, s49, 50176
    s_add_u32 s34, s35, 351232
    buffer_load_dwordx4 v250, s[12:15], s34 offen lds
    s_add_u32 m0, s49, 51200
    s_add_u32 s34, s35, 358400
    buffer_load_dwordx4 v250, s[12:15], s34 offen lds
    s_add_u32 m0, s49, 52224
    s_add_u32 s34, s35, 365568
    buffer_load_dwordx4 v250, s[12:15], s34 offen lds
    s_lshr_b32 s55, s28, 1
    s_and_b32 s56, s28, 1
    s_lshl_b32 s57, s53, 6
    s_lshl_b32 s58, s56, 5
    s_add_u32 s57, s57, s58
    v_add_u32 v168, s57, v161
    v_mul_u32_u24 v168, 896, v168
    v_lshl_add_u32 v168, v162, 3, v168
    s_lshl_b32 s58, s54, 7
    s_lshl_b32 s59, s55, 6
    s_add_u32 s58, s58, s59
    s_lshr_b32 s61, s57, 5
    s_mul_i32 s61, s61, 28
    s_lshl_b32 s62, s54, 2
    s_add_u32 s61, s61, s62
    s_lshl_b32 s62, s55, 1
    s_add_u32 s61, s61, s62
    s_lshl_b32 s61, s61, 10
    v_lshlrev_b32 v171, 4, v161
    v_lshl_add_u32 v171, v162, 3, v171
    buffer_load_dwordx2 v[176:177], v171, s[8:11], s61 offen offset:0 sc1
    buffer_load_dwordx2 v[178:179], v171, s[8:11], s61 offen offset:512 sc1
    buffer_load_dwordx2 v[180:181], v171, s[8:11], s61 offen offset:1024 sc1
    buffer_load_dwordx2 v[182:183], v171, s[8:11], s61 offen offset:1536 sc1
    v_lshlrev_b32 v169, 4, v162
    s_lshl_b32 s59, s58, 1
    s_add_u32 s59, s59, 8960
    buffer_load_dwordx4 v[184:187], v169, s[20:23], s59 offen offset:0 sc1
    buffer_load_dwordx4 v[188:191], v169, s[20:23], s59 offen offset:32 sc1
    buffer_load_dwordx4 v[192:195], v169, s[20:23], s59 offen offset:64 sc1
    buffer_load_dwordx4 v[196:199], v169, s[20:23], s59 offen offset:96 sc1
    s_lshr_b32 s74, s53, 1
    s_lshl_b32 s74, s74, 8
    s_add_u32 s74, s74, 8192
    s_cmp_lg_u32 s28, 0
    s_cbranch_scc1 WF6_D
    v_mbcnt_lo_u32_b32 v0, -1, 0
    v_and_b32 v0, 0, v0
    v_lshlrev_b32 v0, 6, v0
    s_mov_b32 s72, 0
WF6_P:
    buffer_load_dword v1, v0, s[68:71], s74 offen sc1
    s_waitcnt vmcnt(0)
    v_cmp_gt_u32 vcc, 14, v1
    s_cmp_eq_u64 vcc, 0
    s_cbranch_scc1 WF6_D
    s_sleep 1
    s_add_u32 s72, s72, 1
    s_cmp_lt_u32 s72, 0x400000
    s_cbranch_scc1 WF6_P
WF6_D:
    s_barrier
    s_add_u32 s33, s29, 81920
    buffer_load_dwordx4 v[64:67], v164, s[4:7], s33 offen offset:0 sc1
    buffer_load_dwordx4 v[68:71], v165, s[4:7], s33 offen offset:0 sc1
    buffer_load_dwordx4 v[72:75], v164, s[4:7], s33 offen offset:1024 sc1
    buffer_load_dwordx4 v[76:79], v165, s[4:7], s33 offen offset:1024 sc1
    s_add_u32 s33, s29, 90112
    buffer_load_dwordx4 v[80:83], v164, s[4:7], s33 offen offset:0 sc1
    buffer_load_dwordx4 v[84:87], v165, s[4:7], s33 offen offset:0 sc1
    buffer_load_dwordx4 v[88:91], v164, s[4:7], s33 offen offset:1024 sc1
    buffer_load_dwordx4 v[92:95], v165, s[4:7], s33 offen offset:1024 sc1
    s_add_u32 s33, s29, 98304
    buffer_load_dwordx4 v[96:99], v164, s[4:7], s33 offen offset:0 sc1
    buffer_load_dwordx4 v[100:103], v165, s[4:7], s33 offen offset:0 sc1
    buffer_load_dwordx4 v[104:107], v164, s[4:7], s33 offen offset:1024 sc1
    buffer_load_dwordx4 v[108:111], v165, s[4:7], s33 offen offset:1024 sc1
    s_add_u32 s33, s29, 106496
    buffer_load_dwordx4 v[112:115], v164, s[4:7], s33 offen offset:0 sc1
    buffer_load_dwordx4 v[116:119], v165, s[4:7], s33 offen offset:0 sc1
    buffer_load_dwordx4 v[120:123], v164, s[4:7], s33 offen offset:1024 sc1
    buffer_load_dwordx4 v[124:127], v165, s[4:7], s33 offen offset:1024 sc1
    s_add_u32 s33, s29, 32768
    buffer_load_dwordx4 v[200:203], v164, s[4:7], s33 offen offset:0 sc1
    buffer_load_dwordx4 v[204:207], v165, s[4:7], s33 offen offset:0 sc1
    buffer_load_dwordx4 v[208:211], v164, s[4:7], s33 offen offset:1024 sc1
    buffer_load_dwordx4 v[212:215], v165, s[4:7], s33 offen offset:1024 sc1
    s_waitcnt vmcnt(16)
    v_mfma_f32_32x32x16_bf16 v[0:15], a[0:3], v[64:67], 0
    v_mfma_f32_32x32x16_bf16 v[16:31], a[0:3], v[68:71], 0
    s_add_u32 s33, s29, 40960
    buffer_load_dwordx4 v[216:219], v164, s[4:7], s33 offen offset:0 sc1
    buffer_load_dwordx4 v[220:223], v165, s[4:7], s33 offen offset:0 sc1
    buffer_load_dwordx4 v[224:227], v164, s[4:7], s33 offen offset:1024 sc1
    buffer_load_dwordx4 v[228:231], v165, s[4:7], s33 offen offset:1024 sc1
    v_mfma_f32_32x32x16_bf16 v[32:47], a[4:7], v[64:67], 0
    v_mfma_f32_32x32x16_bf16 v[48:63], a[4:7], v[68:71], 0
    v_mfma_f32_32x32x16_bf16 v[0:15], a[8:11], v[72:75], v[0:15]
    v_mfma_f32_32x32x16_bf16 v[16:31], a[8:11], v[76:79], v[16:31]
    v_mfma_f32_32x32x16_bf16 v[32:47], a[12:15], v[72:75], v[32:47]
    v_mfma_f32_32x32x16_bf16 v[48:63], a[12:15], v[76:79], v[48:63]
    s_waitcnt vmcnt(16)
    v_mfma_f32_32x32x16_bf16 v[0:15], a[16:19], v[80:83], v[0:15]
    v_mfma_f32_32x32x16_bf16 v[16:31], a[16:19], v[84:87], v[16:31]
    s_add_u32 s33, s29, 49152
    buffer_load_dwordx4 v[64:67], v164, s[4:7], s33 offen offset:0 sc1
    buffer_load_dwordx4 v[68:71], v165, s[4:7], s33 offen offset:0 sc1
    buffer_load_dwordx4 v[72:75], v164, s[4:7], s33 offen offset:1024 sc1
    buffer_load_dwordx4 v[76:79], v165, s[4:7], s33 offen offset:1024 sc1
    v_mfma_f32_32x32x16_bf16 v[32:47], a[20:23], v[80:83], v[32:47]
    v_mfma_f32_32x32x16_bf16 v[48:63], a[20:23], v[84:87], v[48:63]
    v_mfma_f32_32x32x16_bf16 v[0:15], a[24:27], v[88:91], v[0:15]
    v_mfma_f32_32x32x16_bf16 v[16:31], a[24:27], v[92:95], v[16:31]
    v_mfma_f32_32x32x16_bf16 v[32:47], a[28:31], v[88:91], v[32:47]
    v_mfma_f32_32x32x16_bf16 v[48:63], a[28:31], v[92:95], v[48:63]
    s_waitcnt vmcnt(16)
    v_mfma_f32_32x32x16_bf16 v[0:15], a[32:35], v[96:99], v[0:15]
    v_mfma_f32_32x32x16_bf16 v[16:31], a[32:35], v[100:103], v[16:31]
    s_add_u32 s33, s29, 57344
    buffer_load_dwordx4 v[80:83], v164, s[4:7], s33 offen offset:0 sc1
    buffer_load_dwordx4 v[84:87], v165, s[4:7], s33 offen offset:0 sc1
    buffer_load_dwordx4 v[88:91], v164, s[4:7], s33 offen offset:1024 sc1
    buffer_load_dwordx4 v[92:95], v165, s[4:7], s33 offen offset:1024 sc1
    v_mfma_f32_32x32x16_bf16 v[32:47], a[36:39], v[96:99], v[32:47]
    v_mfma_f32_32x32x16_bf16 v[48:63], a[36:39], v[100:103], v[48:63]
    v_mfma_f32_32x32x16_bf16 v[0:15], a[40:43], v[104:107], v[0:15]
    v_mfma_f32_32x32x16_bf16 v[16:31], a[40:43], v[108:111], v[16:31]
    v_mfma_f32_32x32x16_bf16 v[32:47], a[44:47], v[104:107], v[32:47]
    v_mfma_f32_32x32x16_bf16 v[48:63], a[44:47], v[108:111], v[48:63]
    s_waitcnt vmcnt(16)
    v_mfma_f32_32x32x16_bf16 v[0:15], a[48:51], v[112:115], v[0:15]
    ds_read_b64_tr_b16 v[128:129], v172 offset:16384
    ds_read_b64_tr_b16 v[130:131], v172 offset:16896
    v_mfma_f32_32x32x16_bf16 v[16:31], a[48:51], v[116:119], v[16:31]
    ds_read_b64_tr_b16 v[132:133], v173 offset:16384
    ds_read_b64_tr_b16 v[134:135], v173 offset:16896
    s_add_u32 s33, s29, 65536
    buffer_load_dwordx4 v[96:99], v164, s[4:7], s33 offen offset:0 sc1
    buffer_load_dwordx4 v[100:103], v165, s[4:7], s33 offen offset:0 sc1
    buffer_load_dwordx4 v[104:107], v164, s[4:7], s33 offen offset:1024 sc1
    buffer_load_dwordx4 v[108:111], v165, s[4:7], s33 offen offset:1024 sc1
    v_mfma_f32_32x32x16_bf16 v[32:47], a[52:55], v[112:115], v[32:47]
    ds_read_b64_tr_b16 v[136:137], v172 offset:18432
    ds_read_b64_tr_b16 v[138:139], v172 offset:18944
    v_mfma_f32_32x32x16_bf16 v[48:63], a[52:55], v[116:119], v[48:63]
    ds_read_b64_tr_b16 v[140:141], v173 offset:18432
    ds_read_b64_tr_b16 v[142:143], v173 offset:18944
    v_mfma_f32_32x32x16_bf16 v[0:15], a[56:59], v[120:123], v[0:15]
    v_mfma_f32_32x32x16_bf16 v[16:31], a[56:59], v[124:127], v[16:31]
    v_mfma_f32_32x32x16_bf16 v[32:47], a[60:63], v[120:123], v[32:47]
    v_mfma_f32_32x32x16_bf16 v[48:63], a[60:63], v[124:127], v[48:63]
    s_waitcnt vmcnt(16)
    s_waitcnt lgkmcnt(0)
    v_mfma_f32_32x32x16_bf16 v[0:15], v[128:131], v[200:203], v[0:15]
    ds_read_b64_tr_b16 v[144:145], v172 offset:0
    ds_read_b64_tr_b16 v[146:147], v172 offset:512
    v_mfma_f32_32x32x16_bf16 v[16:31], v[128:131], v[204:207], v[16:31]
    ds_read_b64_tr_b16 v[148:149], v173 offset:0
    ds_read_b64_tr_b16 v[150:151], v173 offset:512
    s_add_u32 s33, s29, 73728
    buffer_load_dwordx4 v[112:115], v164, s[4:7], s33 offen offset:0 sc1
    buffer_load_dwordx4 v[116:119], v165, s[4:7], s33 offen offset:0 sc1
    buffer_load_dwordx4 v[120:123], v164, s[4:7], s33 offen offset:1024 sc1
    buffer_load_dwordx4 v[124:127], v165, s[4:7], s33 offen offset:1024 sc1
    v_mfma_f32_32x32x16_bf16 v[32:47], v[132:135], v[200:203], v[32:47]
    ds_read_b64_tr_b16 v[152:153], v172 offset:2048
    ds_read_b64_tr_b16 v[154:155], v172 offset:2560
    v_mfma_f32_32x32x16_bf16 v[48:63], v[132:135], v[204:207], v[48:63]
    ds_read_b64_tr_b16 v[156:157], v173 offset:2048
    ds_read_b64_tr_b16 v[158:159], v173 offset:2560
    v_mfma_f32_32x32x16_bf16 v[0:15], v[136:139], v[208:211], v[0:15]
    v_mfma_f32_32x32x16_bf16 v[16:31], v[136:139], v[212:215], v[16:31]
    v_mfma_f32_32x32x16_bf16 v[32:47], v[140:143], v[208:211], v[32:47]
    v_mfma_f32_32x32x16_bf16 v[48:63], v[140:143], v[212:215], v[48:63]
    s_waitcnt vmcnt(16)
    s_waitcnt lgkmcnt(0)
    v_mfma_f32_32x32x16_bf16 v[0:15], v[144:147], v[216:219], v[0:15]
    ds_read_b64_tr_b16 v[128:129], v172 offset:32768
    ds_read_b64_tr_b16 v[130:131], v172 offset:33280
    v_mfma_f32_32x32x16_bf16 v[16:31], v[144:147], v[220:223], v[16:31]
    ds_read_b64_tr_b16 v[132:133], v173 offset:32768
    ds_read_b64_tr_b16 v[134:135], v173 offset:33280
    s_add_u32 s33, s29, 0
    buffer_load_dwordx4 v[200:203], v164, s[4:7], s33 offen offset:0 sc1
    buffer_load_dwordx4 v[204:207], v165, s[4:7], s33 offen offset:0 sc1
    buffer_load_dwordx4 v[208:211], v164, s[4:7], s33 offen offset:1024 sc1
    buffer_load_dwordx4 v[212:215], v165, s[4:7], s33 offen offset:1024 sc1
    v_mfma_f32_32x32x16_bf16 v[32:47], v[148:151], v[216:219], v[32:47]
    ds_read_b64_tr_b16 v[136:137], v172 offset:34816
    ds_read_b64_tr_b16 v[138:139], v172 offset:35328
    v_mfma_f32_32x32x16_bf16 v[48:63], v[148:151], v[220:223], v[48:63]
    ds_read_b64_tr_b16 v[140:141], v173 offset:34816
    ds_read_b64_tr_b16 v[142:143], v173 offset:35328
    v_mfma_f32_32x32x16_bf16 v[0:15], v[152:155], v[224:227], v[0:15]
    v_mfma_f32_32x32x16_bf16 v[16:31], v[152:155], v[228:231], v[16:31]
    v_mfma_f32_32x32x16_bf16 v[32:47], v[156:159], v[224:227], v[32:47]
    v_mfma_f32_32x32x16_bf16 v[48:63], v[156:159], v[228:231], v[48:63]
    s_waitcnt vmcnt(16)
    s_waitcnt lgkmcnt(0)
    v_mfma_f32_32x32x16_bf16 v[0:15], v[128:131], v[64:67], v[0:15]
    ds_read_b64_tr_b16 v[144:145], v172 offset:49152
    ds_read_b64_tr_b16 v[146:147], v172 offset:49664
    v_mfma_f32_32x32x16_bf16 v[16:31], v[128:131], v[68:71], v[16:31]
    ds_read_b64_tr_b16 v[148:149], v173 offset:49152
    ds_read_b64_tr_b16 v[150:151], v173 offset:49664
    s_add_u32 s33, s29, 8192
    buffer_load_dwordx4 v[216:219], v164, s[4:7], s33 offen offset:0 sc1
    buffer_load_dwordx4 v[220:223], v165, s[4:7], s33 offen offset:0 sc1
    buffer_load_dwordx4 v[224:227], v164, s[4:7], s33 offen offset:1024 sc1
    buffer_load_dwordx4 v[228:231], v165, s[4:7], s33 offen offset:1024 sc1
    v_mfma_f32_32x32x16_bf16 v[32:47], v[132:135], v[64:67], v[32:47]
    ds_read_b64_tr_b16 v[152:153], v172 offset:51200
    ds_read_b64_tr_b16 v[154:155], v172 offset:51712
    v_mfma_f32_32x32x16_bf16 v[48:63], v[132:135], v[68:71], v[48:63]
    ds_read_b64_tr_b16 v[156:157], v173 offset:51200
    ds_read_b64_tr_b16 v[158:159], v173 offset:51712
    v_mfma_f32_32x32x16_bf16 v[0:15], v[136:139], v[72:75], v[0:15]
    v_mfma_f32_32x32x16_bf16 v[16:31], v[136:139], v[76:79], v[16:31]
    v_mfma_f32_32x32x16_bf16 v[32:47], v[140:143], v[72:75], v[32:47]
    v_mfma_f32_32x32x16_bf16 v[48:63], v[140:143], v[76:79], v[48:63]
    s_waitcnt vmcnt(16)
    s_waitcnt lgkmcnt(0)
    v_mfma_f32_32x32x16_bf16 v[0:15], v[144:147], v[80:83], v[0:15]
    ds_read_b64_tr_b16 v[128:129], v174 offset:0
    ds_read_b64_tr_b16 v[130:131], v174 offset:512
    v_mfma_f32_32x32x16_bf16 v[16:31], v[144:147], v[84:87], v[16:31]
    ds_read_b64_tr_b16 v[132:133], v175 offset:0
    ds_read_b64_tr_b16 v[134:135], v175 offset:512
    s_add_u32 s33, s29, 16384
    buffer_load_dwordx4 v[64:67], v164, s[4:7], s33 offen offset:0 sc1
    buffer_load_dwordx4 v[68:71], v165, s[4:7], s33 offen offset:0 sc1
    buffer_load_dwordx4 v[72:75], v164, s[4:7], s33 offen offset:1024 sc1
    buffer_load_dwordx4 v[76:79], v165, s[4:7], s33 offen offset:1024 sc1
    v_mfma_f32_32x32x16_bf16 v[32:47], v[148:151], v[80:83], v[32:47]
    ds_read_b64_tr_b16 v[136:137], v174 offset:2048
    ds_read_b64_tr_b16 v[138:139], v174 offset:2560
    v_mfma_f32_32x32x16_bf16 v[48:63], v[148:151], v[84:87], v[48:63]
    ds_read_b64_tr_b16 v[140:141], v175 offset:2048
    ds_read_b64_tr_b16 v[142:143], v175 offset:2560
    v_mfma_f32_32x32x16_bf16 v[0:15], v[152:155], v[88:91], v[0:15]
    v_mfma_f32_32x32x16_bf16 v[16:31], v[152:155], v[92:95], v[16:31]
    v_mfma_f32_32x32x16_bf16 v[32:47], v[156:159], v[88:91], v[32:47]
    v_mfma_f32_32x32x16_bf16 v[48:63], v[156:159], v[92:95], v[48:63]
    s_waitcnt vmcnt(16)
    s_waitcnt lgkmcnt(0)
    v_mfma_f32_32x32x16_bf16 v[0:15], v[128:131], v[96:99], v[0:15]
    ds_read_b64_tr_b16 v[144:145], v174 offset:16384
    ds_read_b64_tr_b16 v[146:147], v174 offset:16896
    v_mfma_f32_32x32x16_bf16 v[16:31], v[128:131], v[100:103], v[16:31]
    ds_read_b64_tr_b16 v[148:149], v175 offset:16384
    ds_read_b64_tr_b16 v[150:151], v175 offset:16896
    s_add_u32 s33, s29, 24576
    buffer_load_dwordx4 v[80:83], v164, s[4:7], s33 offen offset:0 sc1
    buffer_load_dwordx4 v[84:87], v165, s[4:7], s33 offen offset:0 sc1
    buffer_load_dwordx4 v[88:91], v164, s[4:7], s33 offen offset:1024 sc1
    buffer_load_dwordx4 v[92:95], v165, s[4:7], s33 offen offset:1024 sc1
    v_mfma_f32_32x32x16_bf16 v[32:47], v[132:135], v[96:99], v[32:47]
    ds_read_b64_tr_b16 v[152:153], v174 offset:18432
    ds_read_b64_tr_b16 v[154:155], v174 offset:18944
    v_mfma_f32_32x32x16_bf16 v[48:63], v[132:135], v[100:103], v[48:63]
    ds_read_b64_tr_b16 v[156:157], v175 offset:18432
    ds_read_b64_tr_b16 v[158:159], v175 offset:18944
    v_mfma_f32_32x32x16_bf16 v[0:15], v[136:139], v[104:107], v[0:15]
    v_mfma_f32_32x32x16_bf16 v[16:31], v[136:139], v[108:111], v[16:31]
    v_mfma_f32_32x32x16_bf16 v[32:47], v[140:143], v[104:107], v[32:47]
    v_mfma_f32_32x32x16_bf16 v[48:63], v[140:143], v[108:111], v[48:63]
    s_waitcnt vmcnt(16)
    s_waitcnt lgkmcnt(0)
    v_mfma_f32_32x32x16_bf16 v[0:15], v[144:147], v[112:115], v[0:15]
    ds_read_b64_tr_b16 v[128:129], v166 offset:0
    ds_read_b64_tr_b16 v[130:131], v166 offset:512
    v_mfma_f32_32x32x16_bf16 v[16:31], v[144:147], v[116:119], v[16:31]
    ds_read_b64_tr_b16 v[132:133], v167 offset:0
    ds_read_b64_tr_b16 v[134:135], v167 offset:512
    v_mfma_f32_32x32x16_bf16 v[32:47], v[148:151], v[112:115], v[32:47]
    ds_read_b64_tr_b16 v[136:137], v166 offset:2048
    ds_read_b64_tr_b16 v[138:139], v166 offset:2560
    v_mfma_f32_32x32x16_bf16 v[48:63], v[148:151], v[116:119], v[48:63]
    ds_read_b64_tr_b16 v[140:141], v167 offset:2048
    ds_read_b64_tr_b16 v[142:143], v167 offset:2560
    v_mfma_f32_32x32x16_bf16 v[0:15], v[152:155], v[120:123], v[0:15]
    v_mfma_f32_32x32x16_bf16 v[16:31], v[152:155], v[124:127], v[16:31]
    v_mfma_f32_32x32x16_bf16 v[32:47], v[156:159], v[120:123], v[32:47]
    v_mfma_f32_32x32x16_bf16 v[48:63], v[156:159], v[124:127], v[48:63]
    s_waitcnt vmcnt(12)
    s_waitcnt lgkmcnt(0)
    v_mfma_f32_32x32x16_bf16 v[0:15], v[128:131], v[200:203], v[0:15]
    ds_read_b64_tr_b16 v[144:145], v166 offset:16384
    ds_read_b64_tr_b16 v[146:147], v166 offset:16896
    v_mfma_f32_32x32x16_bf16 v[16:31], v[128:131], v[204:207], v[16:31]
    ds_read_b64_tr_b16 v[148:149], v167 offset:16384
    ds_read_b64_tr_b16 v[150:151], v167 offset:16896
    v_mfma_f32_32x32x16_bf16 v[32:47], v[132:135], v[200:203], v[32:47]
    ds_read_b64_tr_b16 v[152:153], v166 offset:18432
    ds_read_b64_tr_b16 v[154:155], v166 offset:18944
    v_mfma_f32_32x32x16_bf16 v[48:63], v[132:135], v[204:207], v[48:63]
    ds_read_b64_tr_b16 v[156:157], v167 offset:18432
    ds_read_b64_tr_b16 v[158:159], v167 offset:18944
    v_mfma_f32_32x32x16_bf16 v[0:15], v[136:139], v[208:211], v[0:15]
    v_mfma_f32_32x32x16_bf16 v[16:31], v[136:139], v[212:215], v[16:31]
    v_mfma_f32_32x32x16_bf16 v[32:47], v[140:143], v[208:211], v[32:47]
    v_mfma_f32_32x32x16_bf16 v[48:63], v[140:143], v[212:215], v[48:63]
    s_waitcnt vmcnt(8)
    s_waitcnt lgkmcnt(0)
    v_mfma_f32_32x32x16_bf16 v[0:15], v[144:147], v[216:219], v[0:15]
    ds_read_b64_tr_b16 v[128:129], v166 offset:32768
    ds_read_b64_tr_b16 v[130:131], v166 offset:33280
    v_mfma_f32_32x32x16_bf16 v[16:31], v[144:147], v[220:223], v[16:31]
    ds_read_b64_tr_b16 v[132:133], v167 offset:32768
    ds_read_b64_tr_b16 v[134:135], v167 offset:33280
    v_mfma_f32_32x32x16_bf16 v[32:47], v[148:151], v[216:219], v[32:47]
    ds_read_b64_tr_b16 v[136:137], v166 offset:34816
    ds_read_b64_tr_b16 v[138:139], v166 offset:35328
    v_mfma_f32_32x32x16_bf16 v[48:63], v[148:151], v[220:223], v[48:63]
    ds_read_b64_tr_b16 v[140:141], v167 offset:34816
    ds_read_b64_tr_b16 v[142:143], v167 offset:35328
    v_mfma_f32_32x32x16_bf16 v[0:15], v[152:155], v[224:227], v[0:15]
    v_mfma_f32_32x32x16_bf16 v[16:31], v[152:155], v[228:231], v[16:31]
    v_mfma_f32_32x32x16_bf16 v[32:47], v[156:159], v[224:227], v[32:47]
    v_mfma_f32_32x32x16_bf16 v[48:63], v[156:159], v[228:231], v[48:63]
    s_waitcnt vmcnt(4)
    s_waitcnt lgkmcnt(0)
    v_mfma_f32_32x32x16_bf16 v[0:15], v[128:131], v[64:67], v[0:15]
    ds_read_b64_tr_b16 v[144:145], v166 offset:49152
    ds_read_b64_tr_b16 v[146:147], v166 offset:49664
    v_mfma_f32_32x32x16_bf16 v[16:31], v[128:131], v[68:71], v[16:31]
    ds_read_b64_tr_b16 v[148:149], v167 offset:49152
    ds_read_b64_tr_b16 v[150:151], v167 offset:49664
    v_mfma_f32_32x32x16_bf16 v[32:47], v[132:135], v[64:67], v[32:47]
    ds_read_b64_tr_b16 v[152:153], v166 offset:51200
    ds_read_b64_tr_b16 v[154:155], v166 offset:51712
    v_mfma_f32_32x32x16_bf16 v[48:63], v[132:135], v[68:71], v[48:63]
    ds_read_b64_tr_b16 v[156:157], v167 offset:51200
    ds_read_b64_tr_b16 v[158:159], v167 offset:51712
    v_mfma_f32_32x32x16_bf16 v[0:15], v[136:139], v[72:75], v[0:15]
    v_mfma_f32_32x32x16_bf16 v[16:31], v[136:139], v[76:79], v[16:31]
    v_mfma_f32_32x32x16_bf16 v[32:47], v[140:143], v[72:75], v[32:47]
    v_mfma_f32_32x32x16_bf16 v[48:63], v[140:143], v[76:79], v[48:63]
    s_waitcnt vmcnt(0)
    s_waitcnt lgkmcnt(0)
    v_mfma_f32_32x32x16_bf16 v[0:15], v[144:147], v[80:83], v[0:15]
    v_mfma_f32_32x32x16_bf16 v[16:31], v[144:147], v[84:87], v[16:31]
    v_mfma_f32_32x32x16_bf16 v[32:47], v[148:151], v[80:83], v[32:47]
    v_mfma_f32_32x32x16_bf16 v[48:63], v[148:151], v[84:87], v[48:63]
    v_mfma_f32_32x32x16_bf16 v[0:15], v[152:155], v[88:91], v[0:15]
    v_mfma_f32_32x32x16_bf16 v[16:31], v[152:155], v[92:95], v[16:31]
    v_mfma_f32_32x32x16_bf16 v[32:47], v[156:159], v[88:91], v[32:47]
    v_mfma_f32_32x32x16_bf16 v[48:63], v[156:159], v[92:95], v[48:63]
    s_nop 15
    s_barrier
    s_xor_b32 s60, s28, 1
    s_mul_i32 s60, s60, 12288
    v_add_u32 v170, s60, v163
    ds_write_b128 v170, v[16:19] offset:0
    ds_write_b128 v170, v[20:23] offset:1024
    ds_write_b128 v170, v[24:27] offset:2048
    ds_write_b128 v170, v[28:31] offset:3072
    s_xor_b32 s60, s28, 2
    s_mul_i32 s60, s60, 12288
    v_add_u32 v170, s60, v163
    ds_write_b128 v170, v[32:35] offset:4096
    ds_write_b128 v170, v[36:39] offset:5120
    ds_write_b128 v170, v[40:43] offset:6144
    ds_write_b128 v170, v[44:47] offset:7168
    s_xor_b32 s60, s28, 3
    s_mul_i32 s60, s60, 12288
    v_add_u32 v170, s60, v163
    ds_write_b128 v170, v[48:51] offset:8192
    ds_write_b128 v170, v[52:55] offset:9216
    ds_write_b128 v170, v[56:59] offset:10240
    ds_write_b128 v170, v[60:63] offset:11264
    s_waitcnt lgkmcnt(0)
    s_barrier
    s_mul_i32 s60, s28, 12288
    v_add_u32 v170, s60, v163
    ds_read_b128 v[64:67], v170 offset:0
    ds_read_b128 v[68:71], v170 offset:1024
    ds_read_b128 v[72:75], v170 offset:2048
    ds_read_b128 v[76:79], v170 offset:3072
    ds_read_b128 v[80:83], v170 offset:4096
    ds_read_b128 v[84:87], v170 offset:5120
    ds_read_b128 v[88:91], v170 offset:6144
    ds_read_b128 v[92:95], v170 offset:7168
    ds_read_b128 v[96:99], v170 offset:8192
    ds_read_b128 v[100:103], v170 offset:9216
    ds_read_b128 v[104:107], v170 offset:10240
    ds_read_b128 v[108:111], v170 offset:11264
    s_waitcnt lgkmcnt(0)
    v_add_f32 v112, v0, v64
    v_add_f32 v113, v1, v65
    v_add_f32 v114, v2, v66
    v_add_f32 v115, v3, v67
    v_add_f32 v116, v4, v68
    v_add_f32 v117, v5, v69
    v_add_f32 v118, v6, v70
    v_add_f32 v119, v7, v71
    v_add_f32 v120, v8, v72
    v_add_f32 v121, v9, v73
    v_add_f32 v122, v10, v74
    v_add_f32 v123, v11, v75
    v_add_f32 v124, v12, v76
    v_add_f32 v125, v13, v77
    v_add_f32 v126, v14, v78
    v_add_f32 v127, v15, v79
    v_add_f32 v112, v112, v80
    v_add_f32 v113, v113, v81
    v_add_f32 v114, v114, v82
    v_add_f32 v115, v115, v83
    v_add_f32 v116, v116, v84
    v_add_f32 v117, v117, v85
    v_add_f32 v118, v118, v86
    v_add_f32 v119, v119, v87
    v_add_f32 v120, v120, v88
    v_add_f32 v121, v121, v89
    v_add_f32 v122, v122, v90
    v_add_f32 v123, v123, v91
    v_add_f32 v124, v124, v92
    v_add_f32 v125, v125, v93
    v_add_f32 v126, v126, v94
    v_add_f32 v127, v127, v95
    v_add_f32 v112, v112, v96
    v_add_f32 v113, v113, v97
    v_add_f32 v114, v114, v98
    v_add_f32 v115, v115, v99
    v_add_f32 v116, v116, v100
    v_add_f32 v117, v117, v101
    v_add_f32 v118, v118, v102
    v_add_f32 v119, v119, v103
    v_add_f32 v120, v120, v104
    v_add_f32 v121, v121, v105
    v_add_f32 v122, v122, v106
    v_add_f32 v123, v123, v107
    v_add_f32 v124, v124, v108
    v_add_f32 v125, v125, v109
    v_add_f32 v126, v126, v110
    v_add_f32 v127, v127, v111
    s_waitcnt vmcnt(0)
    v_cvt_pk_bf16_f32 v112, 0, v112
    v_mul_f32 v112, v112, v184
    v_cvt_pk_bf16_f32 v112, 0, v112
    v_lshlrev_b32 v152, 16, v176
    v_add_f32 v112, v112, v152
    v_cvt_pk_bf16_f32 v113, 0, v113
    v_mul_f32 v113, v113, v185
    v_cvt_pk_bf16_f32 v113, 0, v113
    v_and_b32 v152, 0xffff0000, v176
    v_add_f32 v113, v113, v152
    v_cvt_pk_bf16_f32 v114, 0, v114
    v_mul_f32 v114, v114, v186
    v_cvt_pk_bf16_f32 v114, 0, v114
    v_lshlrev_b32 v152, 16, v177
    v_add_f32 v114, v114, v152
    v_cvt_pk_bf16_f32 v115, 0, v115
    v_mul_f32 v115, v115, v187
    v_cvt_pk_bf16_f32 v115, 0, v115
    v_and_b32 v152, 0xffff0000, v177
    v_add_f32 v115, v115, v152
    v_cvt_pk_bf16_f32 v154, v112, v113
    v_cvt_pk_bf16_f32 v155, v114, v115
    buffer_store_dwordx2 v[154:155], v168, s[16:19], s58 offen offset:0
    v_cvt_pk_bf16_f32 v116, 0, v116
    v_mul_f32 v116, v116, v188
    v_cvt_pk_bf16_f32 v116, 0, v116
    v_lshlrev_b32 v152, 16, v178
    v_add_f32 v116, v116, v152
    v_cvt_pk_bf16_f32 v117, 0, v117
    v_mul_f32 v117, v117, v189
    v_cvt_pk_bf16_f32 v117, 0, v117
    v_and_b32 v152, 0xffff0000, v178
    v_add_f32 v117, v117, v152
    v_cvt_pk_bf16_f32 v118, 0, v118
    v_mul_f32 v118, v118, v190
    v_cvt_pk_bf16_f32 v118, 0, v118
    v_lshlrev_b32 v152, 16, v179
    v_add_f32 v118, v118, v152
    v_cvt_pk_bf16_f32 v119, 0, v119
    v_mul_f32 v119, v119, v191
    v_cvt_pk_bf16_f32 v119, 0, v119
    v_and_b32 v152, 0xffff0000, v179
    v_add_f32 v119, v119, v152
    v_cvt_pk_bf16_f32 v156, v116, v117
    v_cvt_pk_bf16_f32 v157, v118, v119
    buffer_store_dwordx2 v[156:157], v168, s[16:19], s58 offen offset:16
    v_cvt_pk_bf16_f32 v120, 0, v120
    v_mul_f32 v120, v120, v192
    v_cvt_pk_bf16_f32 v120, 0, v120
    v_lshlrev_b32 v152, 16, v180
    v_add_f32 v120, v120, v152
    v_cvt_pk_bf16_f32 v121, 0, v121
    v_mul_f32 v121, v121, v193
    v_cvt_pk_bf16_f32 v121, 0, v121
    v_and_b32 v152, 0xffff0000, v180
    v_add_f32 v121, v121, v152
    v_cvt_pk_bf16_f32 v122, 0, v122
    v_mul_f32 v122, v122, v194
    v_cvt_pk_bf16_f32 v122, 0, v122
    v_lshlrev_b32 v152, 16, v181
    v_add_f32 v122, v122, v152
    v_cvt_pk_bf16_f32 v123, 0, v123
    v_mul_f32 v123, v123, v195
    v_cvt_pk_bf16_f32 v123, 0, v123
    v_and_b32 v152, 0xffff0000, v181
    v_add_f32 v123, v123, v152
    v_cvt_pk_bf16_f32 v158, v120, v121
    v_cvt_pk_bf16_f32 v159, v122, v123
    buffer_store_dwordx2 v[158:159], v168, s[16:19], s58 offen offset:32
    v_cvt_pk_bf16_f32 v124, 0, v124
    v_mul_f32 v124, v124, v196
    v_cvt_pk_bf16_f32 v124, 0, v124
    v_lshlrev_b32 v152, 16, v182
    v_add_f32 v124, v124, v152
    v_cvt_pk_bf16_f32 v125, 0, v125
    v_mul_f32 v125, v125, v197
    v_cvt_pk_bf16_f32 v125, 0, v125
    v_and_b32 v152, 0xffff0000, v182
    v_add_f32 v125, v125, v152
    v_cvt_pk_bf16_f32 v126, 0, v126
    v_mul_f32 v126, v126, v198
    v_cvt_pk_bf16_f32 v126, 0, v126
    v_lshlrev_b32 v152, 16, v183
    v_add_f32 v126, v126, v152
    v_cvt_pk_bf16_f32 v127, 0, v127
    v_mul_f32 v127, v127, v199
    v_cvt_pk_bf16_f32 v127, 0, v127
    v_and_b32 v152, 0xffff0000, v183
    v_add_f32 v127, v127, v152
    v_cvt_pk_bf16_f32 v160, v124, v125
    v_cvt_pk_bf16_f32 v161, v126, v127
    buffer_store_dwordx2 v[160:161], v168, s[16:19], s58 offen offset:48
    s_waitcnt vmcnt(0)
ALL_WAIT:
    s_waitcnt vmcnt(0)
ALL_END:
    s_endpgm
UV_GO:
    s_mov_b64 exec, -1
    v_mbcnt_lo_u32_b32 v0, -1, 0
    v_mbcnt_hi_u32_b32 v0, -1, v0
    s_lshl_b32 s72, s28, 6
    v_or_b32 v0, s72, v0
    s_load_dwordx4 s[36:39], s[0:1], 48
    s_load_dwordx2 s[44:45], s[0:1], 104
    s_load_dwordx4 s[4:7], s[0:1], 72
    s_sub_u32 s51, s2, 224
    s_and_b32 s52, s51, 15
    s_mul_i32 s52, s52, 224
    v_mul_u32_u24 v6, 9363, v0
    v_lshrrev_b32 v6, 16, v6
    v_mul_u32_u24 v7, 7, v6
    v_sub_u32 v7, v0, v7
    v_min_u32 v6, 31, v6
    v_mul_u32_u24 v8, 28, v6
    s_mov_b32 s30, 75264
    v_mul_lo_u32 v9, v6, s30
    v_lshl_add_u32 v9, v7, 4, v9
    s_mul_i32 s31, s51, 112
    v_lshrrev_b32 v1, 4, v240
    v_and_b32 v2, 15, v240
    v_lshlrev_b32 v3, 2, v1
    v_xor_b32 v3, v2, v3
    v_lshlrev_b32 v3, 4, v3
    v_mul_u32_u24 v4, 3584, v1
    v_add_u32 v3, v3, v4
    v_lshrrev_b32 v4, 2, v2
    v_lshrrev_b32 v5, 1, v1
    v_lshl_add_u32 v5, v5, 3, v4
    v_lshlrev_b32 v5, 8, v5
    v_and_b32 v10, 1, v1
    v_lshl_add_u32 v5, v10, 5, v5
    v_and_b32 v10, 3, v2
    v_lshl_add_u32 v5, v10, 3, v5
    v_xor_b32 v4, s28, v4
    v_lshl_add_u32 v14, v4, 6, v5
    v_add_u32 v14, 8192, v14
    v_add_u32 v15, 0x10000, v14
    s_waitcnt lgkmcnt(0)
    s_cmp_ge_u32 s51, 16
    s_cselect_b32 s8, s38, s36
    s_cselect_b32 s9, s39, s37
    s_mov_b32 s10, 1605632
    s_mov_b32 s11, 0x00020000
    s_cselect_b32 s53, 57344, 0
    s_mov_b32 s20, s44
    s_mov_b32 s21, s45
    s_mov_b32 s22, 12544
    s_mov_b32 s23, 0x00020000
    s_add_u32 s24, s44, 30408704
    s_addc_u32 s25, s45, 0
    s_mov_b32 s26, 114688
    s_mov_b32 s27, 0x00020000
    s_mov_b32 s12, s4
    s_mov_b32 s13, s5
    s_mov_b32 s14, 896
    s_mov_b32 s15, 0x00020000
    s_mov_b32 s16, s6
    s_mov_b32 s17, s7
    s_mov_b32 s18, 2408448
    s_mov_b32 s19, 0x00020000
    buffer_load_ushort v16, v8, s[12:15], 0 offen offset:0
    buffer_load_ushort v17, v8, s[12:15], 0 offen offset:2
    buffer_load_ushort v18, v8, s[12:15], 0 offen offset:4
    buffer_load_ushort v19, v8, s[12:15], 0 offen offset:6
    buffer_load_ushort v20, v8, s[12:15], 0 offen offset:8
    buffer_load_ushort v21, v8, s[12:15], 0 offen offset:10
    buffer_load_ushort v22, v8, s[12:15], 0 offen offset:12
    buffer_load_ushort v23, v8, s[12:15], 0 offen offset:14
    buffer_load_ushort v24, v8, s[12:15], 0 offen offset:16
    buffer_load_ushort v25, v8, s[12:15], 0 offen offset:18
    buffer_load_ushort v26, v8, s[12:15], 0 offen offset:20
    buffer_load_ushort v27, v8, s[12:15], 0 offen offset:22
    buffer_load_ushort v28, v8, s[12:15], 0 offen offset:24
    buffer_load_ushort v29, v8, s[12:15], 0 offen offset:26
    s_add_u32 s30, s31, 1792
    buffer_load_dwordx4 v[32:35], v9, s[16:19], s30 offen
    s_add_u32 s30, s31, 7168
    buffer_load_dwordx4 v[36:39], v9, s[16:19], s30 offen
    s_add_u32 s30, s31, 12544
    buffer_load_dwordx4 v[40:43], v9, s[16:19], s30 offen
    s_add_u32 s30, s31, 17920
    buffer_load_dwordx4 v[44:47], v9, s[16:19], s30 offen
    s_add_u32 s30, s31, 23296
    buffer_load_dwordx4 v[48:51], v9, s[16:19], s30 offen
    s_add_u32 s30, s31, 28672
    buffer_load_dwordx4 v[52:55], v9, s[16:19], s30 offen
    s_add_u32 s30, s31, 34048
    buffer_load_dwordx4 v[56:59], v9, s[16:19], s30 offen
    s_add_u32 s30, s31, 39424
    buffer_load_dwordx4 v[60:63], v9, s[16:19], s30 offen
    s_add_u32 s30, s31, 44800
    buffer_load_dwordx4 v[64:67], v9, s[16:19], s30 offen
    s_add_u32 s30, s31, 50176
    buffer_load_dwordx4 v[68:71], v9, s[16:19], s30 offen
    s_add_u32 s30, s31, 55552
    buffer_load_dwordx4 v[72:75], v9, s[16:19], s30 offen
    s_add_u32 s30, s31, 60928
    buffer_load_dwordx4 v[76:79], v9, s[16:19], s30 offen
    s_add_u32 s30, s31, 66304
    buffer_load_dwordx4 v[80:83], v9, s[16:19], s30 offen
    s_add_u32 s30, s31, 71680
    buffer_load_dwordx4 v[84:87], v9, s[16:19], s30 offen
    v_mov_b32 v96, 0
    v_mov_b32 v97, 0
    v_mov_b32 v98, 0
    v_mov_b32 v99, 0
    v_mov_b32 v100, 0
    v_mov_b32 v101, 0
    v_mov_b32 v102, 0
    v_mov_b32 v103, 0
    s_mov_b32 s40, 0xbfb8aa3b
    s_waitcnt vmcnt(14)
    s_barrier
    v_lshlrev_b32 v16, 16, v16
    v_mul_f32 v104, s40, v16
    v_exp_f32 v104, v104
    s_nop 0
    v_add_f32 v104, 1.0, v104
    v_rcp_f32 v104, v104
    s_nop 0
    v_mul_f32 v104, v16, v104
    v_cvt_pk_bf16_f32 v16, 0, v104
    v_lshlrev_b32 v17, 16, v17
    v_mul_f32 v104, s40, v17
    v_exp_f32 v104, v104
    s_nop 0
    v_add_f32 v104, 1.0, v104
    v_rcp_f32 v104, v104
    s_nop 0
    v_mul_f32 v104, v17, v104
    v_cvt_pk_bf16_f32 v17, 0, v104
    v_lshlrev_b32 v18, 16, v18
    v_mul_f32 v104, s40, v18
    v_exp_f32 v104, v104
    s_nop 0
    v_add_f32 v104, 1.0, v104
    v_rcp_f32 v104, v104
    s_nop 0
    v_mul_f32 v104, v18, v104
    v_cvt_pk_bf16_f32 v18, 0, v104
    v_lshlrev_b32 v19, 16, v19
    v_mul_f32 v104, s40, v19
    v_exp_f32 v104, v104
    s_nop 0
    v_add_f32 v104, 1.0, v104
    v_rcp_f32 v104, v104
    s_nop 0
    v_mul_f32 v104, v19, v104
    v_cvt_pk_bf16_f32 v19, 0, v104
    v_lshlrev_b32 v20, 16, v20
    v_mul_f32 v104, s40, v20
    v_exp_f32 v104, v104
    s_nop 0
    v_add_f32 v104, 1.0, v104
    v_rcp_f32 v104, v104
    s_nop 0
    v_mul_f32 v104, v20, v104
    v_cvt_pk_bf16_f32 v20, 0, v104
    v_lshlrev_b32 v21, 16, v21
    v_mul_f32 v104, s40, v21
    v_exp_f32 v104, v104
    s_nop 0
    v_add_f32 v104, 1.0, v104
    v_rcp_f32 v104, v104
    s_nop 0
    v_mul_f32 v104, v21, v104
    v_cvt_pk_bf16_f32 v21, 0, v104
    v_lshlrev_b32 v22, 16, v22
    v_mul_f32 v104, s40, v22
    v_exp_f32 v104, v104
    s_nop 0
    v_add_f32 v104, 1.0, v104
    v_rcp_f32 v104, v104
    s_nop 0
    v_mul_f32 v104, v22, v104
    v_cvt_pk_bf16_f32 v22, 0, v104
    v_lshlrev_b32 v23, 16, v23
    v_mul_f32 v104, s40, v23
    v_exp_f32 v104, v104
    s_nop 0
    v_add_f32 v104, 1.0, v104
    v_rcp_f32 v104, v104
    s_nop 0
    v_mul_f32 v104, v23, v104
    v_cvt_pk_bf16_f32 v23, 0, v104
    v_lshlrev_b32 v24, 16, v24
    v_mul_f32 v104, s40, v24
    v_exp_f32 v104, v104
    s_nop 0
    v_add_f32 v104, 1.0, v104
    v_rcp_f32 v104, v104
    s_nop 0
    v_mul_f32 v104, v24, v104
    v_cvt_pk_bf16_f32 v24, 0, v104
    v_lshlrev_b32 v25, 16, v25
    v_mul_f32 v104, s40, v25
    v_exp_f32 v104, v104
    s_nop 0
    v_add_f32 v104, 1.0, v104
    v_rcp_f32 v104, v104
    s_nop 0
    v_mul_f32 v104, v25, v104
    v_cvt_pk_bf16_f32 v25, 0, v104
    v_lshlrev_b32 v26, 16, v26
    v_mul_f32 v104, s40, v26
    v_exp_f32 v104, v104
    s_nop 0
    v_add_f32 v104, 1.0, v104
    v_rcp_f32 v104, v104
    s_nop 0
    v_mul_f32 v104, v26, v104
    v_cvt_pk_bf16_f32 v26, 0, v104
    v_lshlrev_b32 v27, 16, v27
    v_mul_f32 v104, s40, v27
    v_exp_f32 v104, v104
    s_nop 0
    v_add_f32 v104, 1.0, v104
    v_rcp_f32 v104, v104
    s_nop 0
    v_mul_f32 v104, v27, v104
    v_cvt_pk_bf16_f32 v27, 0, v104
    v_lshlrev_b32 v28, 16, v28
    v_mul_f32 v104, s40, v28
    v_exp_f32 v104, v104
    s_nop 0
    v_add_f32 v104, 1.0, v104
    v_rcp_f32 v104, v104
    s_nop 0
    v_mul_f32 v104, v28, v104
    v_cvt_pk_bf16_f32 v28, 0, v104
    v_lshlrev_b32 v29, 16, v29
    v_mul_f32 v104, s40, v29
    v_exp_f32 v104, v104
    s_nop 0
    v_add_f32 v104, 1.0, v104
    v_rcp_f32 v104, v104
    s_nop 0
    v_mul_f32 v104, v29, v104
    v_cvt_pk_bf16_f32 v29, 0, v104
    s_waitcnt vmcnt(13)
    v_lshlrev_b32 v104, 16, v32
    v_and_b32 v105, 0xffff0000, v32
    v_fmac_f32 v96, v16, v104
    v_fmac_f32 v97, v16, v105
    v_lshlrev_b32 v104, 16, v33
    v_and_b32 v105, 0xffff0000, v33
    v_fmac_f32 v98, v16, v104
    v_fmac_f32 v99, v16, v105
    v_lshlrev_b32 v104, 16, v34
    v_and_b32 v105, 0xffff0000, v34
    v_fmac_f32 v100, v16, v104
    v_fmac_f32 v101, v16, v105
    v_lshlrev_b32 v104, 16, v35
    v_and_b32 v105, 0xffff0000, v35
    v_fmac_f32 v102, v16, v104
    v_fmac_f32 v103, v16, v105
    s_waitcnt vmcnt(12)
    v_lshlrev_b32 v104, 16, v36
    v_and_b32 v105, 0xffff0000, v36
    v_fmac_f32 v96, v17, v104
    v_fmac_f32 v97, v17, v105
    v_lshlrev_b32 v104, 16, v37
    v_and_b32 v105, 0xffff0000, v37
    v_fmac_f32 v98, v17, v104
    v_fmac_f32 v99, v17, v105
    v_lshlrev_b32 v104, 16, v38
    v_and_b32 v105, 0xffff0000, v38
    v_fmac_f32 v100, v17, v104
    v_fmac_f32 v101, v17, v105
    v_lshlrev_b32 v104, 16, v39
    v_and_b32 v105, 0xffff0000, v39
    v_fmac_f32 v102, v17, v104
    v_fmac_f32 v103, v17, v105
    s_waitcnt vmcnt(11)
    v_lshlrev_b32 v104, 16, v40
    v_and_b32 v105, 0xffff0000, v40
    v_fmac_f32 v96, v18, v104
    v_fmac_f32 v97, v18, v105
    v_lshlrev_b32 v104, 16, v41
    v_and_b32 v105, 0xffff0000, v41
    v_fmac_f32 v98, v18, v104
    v_fmac_f32 v99, v18, v105
    v_lshlrev_b32 v104, 16, v42
    v_and_b32 v105, 0xffff0000, v42
    v_fmac_f32 v100, v18, v104
    v_fmac_f32 v101, v18, v105
    v_lshlrev_b32 v104, 16, v43
    v_and_b32 v105, 0xffff0000, v43
    v_fmac_f32 v102, v18, v104
    v_fmac_f32 v103, v18, v105
    s_waitcnt vmcnt(10)
    v_lshlrev_b32 v104, 16, v44
    v_and_b32 v105, 0xffff0000, v44
    v_fmac_f32 v96, v19, v104
    v_fmac_f32 v97, v19, v105
    v_lshlrev_b32 v104, 16, v45
    v_and_b32 v105, 0xffff0000, v45
    v_fmac_f32 v98, v19, v104
    v_fmac_f32 v99, v19, v105
    v_lshlrev_b32 v104, 16, v46
    v_and_b32 v105, 0xffff0000, v46
    v_fmac_f32 v100, v19, v104
    v_fmac_f32 v101, v19, v105
    v_lshlrev_b32 v104, 16, v47
    v_and_b32 v105, 0xffff0000, v47
    v_fmac_f32 v102, v19, v104
    v_fmac_f32 v103, v19, v105
    s_waitcnt vmcnt(9)
    v_lshlrev_b32 v104, 16, v48
    v_and_b32 v105, 0xffff0000, v48
    v_fmac_f32 v96, v20, v104
    v_fmac_f32 v97, v20, v105
    v_lshlrev_b32 v104, 16, v49
    v_and_b32 v105, 0xffff0000, v49
    v_fmac_f32 v98, v20, v104
    v_fmac_f32 v99, v20, v105
    v_lshlrev_b32 v104, 16, v50
    v_and_b32 v105, 0xffff0000, v50
    v_fmac_f32 v100, v20, v104
    v_fmac_f32 v101, v20, v105
    v_lshlrev_b32 v104, 16, v51
    v_and_b32 v105, 0xffff0000, v51
    v_fmac_f32 v102, v20, v104
    v_fmac_f32 v103, v20, v105
    s_waitcnt vmcnt(8)
    v_lshlrev_b32 v104, 16, v52
    v_and_b32 v105, 0xffff0000, v52
    v_fmac_f32 v96, v21, v104
    v_fmac_f32 v97, v21, v105
    v_lshlrev_b32 v104, 16, v53
    v_and_b32 v105, 0xffff0000, v53
    v_fmac_f32 v98, v21, v104
    v_fmac_f32 v99, v21, v105
    v_lshlrev_b32 v104, 16, v54
    v_and_b32 v105, 0xffff0000, v54
    v_fmac_f32 v100, v21, v104
    v_fmac_f32 v101, v21, v105
    v_lshlrev_b32 v104, 16, v55
    v_and_b32 v105, 0xffff0000, v55
    v_fmac_f32 v102, v21, v104
    v_fmac_f32 v103, v21, v105
    s_waitcnt vmcnt(7)
    v_lshlrev_b32 v104, 16, v56
    v_and_b32 v105, 0xffff0000, v56
    v_fmac_f32 v96, v22, v104
    v_fmac_f32 v97, v22, v105
    v_lshlrev_b32 v104, 16, v57
    v_and_b32 v105, 0xffff0000, v57
    v_fmac_f32 v98, v22, v104
    v_fmac_f32 v99, v22, v105
    v_lshlrev_b32 v104, 16, v58
    v_and_b32 v105, 0xffff0000, v58
    v_fmac_f32 v100, v22, v104
    v_fmac_f32 v101, v22, v105
    v_lshlrev_b32 v104, 16, v59
    v_and_b32 v105, 0xffff0000, v59
    v_fmac_f32 v102, v22, v104
    v_fmac_f32 v103, v22, v105
    s_waitcnt vmcnt(6)
    v_lshlrev_b32 v104, 16, v60
    v_and_b32 v105, 0xffff0000, v60
    v_fmac_f32 v96, v23, v104
    v_fmac_f32 v97, v23, v105
    v_lshlrev_b32 v104, 16, v61
    v_and_b32 v105, 0xffff0000, v61
    v_fmac_f32 v98, v23, v104
    v_fmac_f32 v99, v23, v105
    v_lshlrev_b32 v104, 16, v62
    v_and_b32 v105, 0xffff0000, v62
    v_fmac_f32 v100, v23, v104
    v_fmac_f32 v101, v23, v105
    v_lshlrev_b32 v104, 16, v63
    v_and_b32 v105, 0xffff0000, v63
    v_fmac_f32 v102, v23, v104
    v_fmac_f32 v103, v23, v105
    s_waitcnt vmcnt(5)
    v_lshlrev_b32 v104, 16, v64
    v_and_b32 v105, 0xffff0000, v64
    v_fmac_f32 v96, v24, v104
    v_fmac_f32 v97, v24, v105
    v_lshlrev_b32 v104, 16, v65
    v_and_b32 v105, 0xffff0000, v65
    v_fmac_f32 v98, v24, v104
    v_fmac_f32 v99, v24, v105
    v_lshlrev_b32 v104, 16, v66
    v_and_b32 v105, 0xffff0000, v66
    v_fmac_f32 v100, v24, v104
    v_fmac_f32 v101, v24, v105
    v_lshlrev_b32 v104, 16, v67
    v_and_b32 v105, 0xffff0000, v67
    v_fmac_f32 v102, v24, v104
    v_fmac_f32 v103, v24, v105
    s_waitcnt vmcnt(4)
    v_lshlrev_b32 v104, 16, v68
    v_and_b32 v105, 0xffff0000, v68
    v_fmac_f32 v96, v25, v104
    v_fmac_f32 v97, v25, v105
    v_lshlrev_b32 v104, 16, v69
    v_and_b32 v105, 0xffff0000, v69
    v_fmac_f32 v98, v25, v104
    v_fmac_f32 v99, v25, v105
    v_lshlrev_b32 v104, 16, v70
    v_and_b32 v105, 0xffff0000, v70
    v_fmac_f32 v100, v25, v104
    v_fmac_f32 v101, v25, v105
    v_lshlrev_b32 v104, 16, v71
    v_and_b32 v105, 0xffff0000, v71
    v_fmac_f32 v102, v25, v104
    v_fmac_f32 v103, v25, v105
    s_waitcnt vmcnt(3)
    v_lshlrev_b32 v104, 16, v72
    v_and_b32 v105, 0xffff0000, v72
    v_fmac_f32 v96, v26, v104
    v_fmac_f32 v97, v26, v105
    v_lshlrev_b32 v104, 16, v73
    v_and_b32 v105, 0xffff0000, v73
    v_fmac_f32 v98, v26, v104
    v_fmac_f32 v99, v26, v105
    v_lshlrev_b32 v104, 16, v74
    v_and_b32 v105, 0xffff0000, v74
    v_fmac_f32 v100, v26, v104
    v_fmac_f32 v101, v26, v105
    v_lshlrev_b32 v104, 16, v75
    v_and_b32 v105, 0xffff0000, v75
    v_fmac_f32 v102, v26, v104
    v_fmac_f32 v103, v26, v105
    s_waitcnt vmcnt(2)
    v_lshlrev_b32 v104, 16, v76
    v_and_b32 v105, 0xffff0000, v76
    v_fmac_f32 v96, v27, v104
    v_fmac_f32 v97, v27, v105
    v_lshlrev_b32 v104, 16, v77
    v_and_b32 v105, 0xffff0000, v77
    v_fmac_f32 v98, v27, v104
    v_fmac_f32 v99, v27, v105
    v_lshlrev_b32 v104, 16, v78
    v_and_b32 v105, 0xffff0000, v78
    v_fmac_f32 v100, v27, v104
    v_fmac_f32 v101, v27, v105
    v_lshlrev_b32 v104, 16, v79
    v_and_b32 v105, 0xffff0000, v79
    v_fmac_f32 v102, v27, v104
    v_fmac_f32 v103, v27, v105
    s_waitcnt vmcnt(1)
    v_lshlrev_b32 v104, 16, v80
    v_and_b32 v105, 0xffff0000, v80
    v_fmac_f32 v96, v28, v104
    v_fmac_f32 v97, v28, v105
    v_lshlrev_b32 v104, 16, v81
    v_and_b32 v105, 0xffff0000, v81
    v_fmac_f32 v98, v28, v104
    v_fmac_f32 v99, v28, v105
    v_lshlrev_b32 v104, 16, v82
    v_and_b32 v105, 0xffff0000, v82
    v_fmac_f32 v100, v28, v104
    v_fmac_f32 v101, v28, v105
    v_lshlrev_b32 v104, 16, v83
    v_and_b32 v105, 0xffff0000, v83
    v_fmac_f32 v102, v28, v104
    v_fmac_f32 v103, v28, v105
    s_waitcnt vmcnt(0)
    v_lshlrev_b32 v104, 16, v84
    v_and_b32 v105, 0xffff0000, v84
    v_fmac_f32 v96, v29, v104
    v_fmac_f32 v97, v29, v105
    v_lshlrev_b32 v104, 16, v85
    v_and_b32 v105, 0xffff0000, v85
    v_fmac_f32 v98, v29, v104
    v_fmac_f32 v99, v29, v105
    v_lshlrev_b32 v104, 16, v86
    v_and_b32 v105, 0xffff0000, v86
    v_fmac_f32 v100, v29, v104
    v_fmac_f32 v101, v29, v105
    v_lshlrev_b32 v104, 16, v87
    v_and_b32 v105, 0xffff0000, v87
    v_fmac_f32 v102, v29, v104
    v_fmac_f32 v103, v29, v105
    v_mul_u32_u24 v10, 224, v6
    v_lshl_add_u32 v10, v7, 5, v10
    v_cmp_gt_u32 vcc, 224, v0
    s_and_saveexec_b64 s[40:41], vcc
    ds_write_b128 v10, v[96:99]
    ds_write_b128 v10, v[100:103] offset:16
    s_mov_b64 exec, -1
    s_waitcnt lgkmcnt(0)
    s_barrier
    s_cmp_lg_u32 s28, 0
    s_cbranch_scc1 UV_M1
    v_min_u32 v10, 55, v0
    v_lshlrev_b32 v11, 1, v10
    v_lshlrev_b32 v10, 2, v10
    ds_read_b32 v32, v10 offset:0
    ds_read_b32 v33, v10 offset:224
    ds_read_b32 v34, v10 offset:448
    ds_read_b32 v35, v10 offset:672
    ds_read_b32 v36, v10 offset:896
    ds_read_b32 v37, v10 offset:1120
    ds_read_b32 v38, v10 offset:1344
    ds_read_b32 v39, v10 offset:1568
    ds_read_b32 v40, v10 offset:1792
    ds_read_b32 v41, v10 offset:2016
    ds_read_b32 v42, v10 offset:2240
    ds_read_b32 v43, v10 offset:2464
    ds_read_b32 v44, v10 offset:2688
    ds_read_b32 v45, v10 offset:2912
    ds_read_b32 v46, v10 offset:3136
    ds_read_b32 v47, v10 offset:3360
    ds_read_b32 v48, v10 offset:3584
    ds_read_b32 v49, v10 offset:3808
    ds_read_b32 v50, v10 offset:4032
    ds_read_b32 v51, v10 offset:4256
    ds_read_b32 v52, v10 offset:4480
    ds_read_b32 v53, v10 offset:4704
    ds_read_b32 v54, v10 offset:4928
    ds_read_b32 v55, v10 offset:5152
    ds_read_b32 v56, v10 offset:5376
    ds_read_b32 v57, v10 offset:5600
    ds_read_b32 v58, v10 offset:5824
    ds_read_b32 v59, v10 offset:6048
    ds_read_b32 v60, v10 offset:6272
    ds_read_b32 v61, v10 offset:6496
    ds_read_b32 v62, v10 offset:6720
    ds_read_b32 v63, v10 offset:6944
    s_waitcnt lgkmcnt(0)
    v_add_f32 v32, v32, v34
    v_add_f32 v33, v33, v35
    v_add_f32 v32, v32, v36
    v_add_f32 v33, v33, v37
    v_add_f32 v32, v32, v38
    v_add_f32 v33, v33, v39
    v_add_f32 v32, v32, v40
    v_add_f32 v33, v33, v41
    v_add_f32 v32, v32, v42
    v_add_f32 v33, v33, v43
    v_add_f32 v32, v32, v44
    v_add_f32 v33, v33, v45
    v_add_f32 v32, v32, v46
    v_add_f32 v33, v33, v47
    v_add_f32 v32, v32, v48
    v_add_f32 v33, v33, v49
    v_add_f32 v32, v32, v50
    v_add_f32 v33, v33, v51
    v_add_f32 v32, v32, v52
    v_add_f32 v33, v33, v53
    v_add_f32 v32, v32, v54
    v_add_f32 v33, v33, v55
    v_add_f32 v32, v32, v56
    v_add_f32 v33, v33, v57
    v_add_f32 v32, v32, v58
    v_add_f32 v33, v33, v59
    v_add_f32 v32, v32, v60
    v_add_f32 v33, v33, v61
    v_add_f32 v32, v32, v62
    v_add_f32 v33, v33, v63
    v_add_f32 v32, v32, v33
    v_cvt_pk_bf16_f32 v32, 0, v32
    s_lshr_b32 s30, s51, 3
    s_and_b32 s33, s51, 7
    s_mul_i32 s33, s33, 112
    s_cmp_lg_u32 s30, 2
    s_cbranch_scc1 UV_M0
    v_add_f32 v32, 1.0, v32
    v_cvt_pk_bf16_f32 v32, 0, v32
    s_add_u32 s34, s33, 10752
    buffer_store_short_d16_hi v32, v11, s[20:23], s34 offen sc1
UV_M0:
    s_cmp_lg_u32 s30, 1
    s_cbranch_scc1 UV_M2
    s_add_u32 s34, s33, 11648
    buffer_store_short_d16_hi v32, v11, s[20:23], s34 offen sc1
UV_M2:
    s_mul_i32 s30, s51, 224
    s_add_u32 s30, s30, 3584
    buffer_store_dword v32, v10, s[20:23], s30 offen sc1
    s_mov_b32 exec_hi, 0
    v_lshlrev_b32 v10, 8, v0
    v_add_u32 v10, 12288, v10
    v_mov_b32 v11, 1
    s_waitcnt vmcnt(0)
    buffer_atomic_add v11, v10, s[68:71], 0 offen sc1
    s_mov_b64 exec, -1
UV_M1:
    s_mul_i32 s32, s28, 28672
    s_mul_i32 s33, s28, 401408
    s_add_u32 s33, s33, s52
    s_add_u32 m0, s32, 8192
    s_add_u32 s30, s33, 0
    buffer_load_dwordx4 v3, s[8:11], s30 offen lds
    s_add_u32 m0, s32, 9216
    s_add_u32 s30, s33, 14336
    buffer_load_dwordx4 v3, s[8:11], s30 offen lds
    s_add_u32 m0, s32, 10240
    s_add_u32 s30, s33, 28672
    buffer_load_dwordx4 v3, s[8:11], s30 offen lds
    s_add_u32 m0, s32, 11264
    s_add_u32 s30, s33, 43008
    buffer_load_dwordx4 v3, s[8:11], s30 offen lds
    s_add_u32 m0, s32, 12288
    s_add_u32 s30, s33, 57344
    buffer_load_dwordx4 v3, s[8:11], s30 offen lds
    s_add_u32 m0, s32, 13312
    s_add_u32 s30, s33, 71680
    buffer_load_dwordx4 v3, s[8:11], s30 offen lds
    s_add_u32 m0, s32, 14336
    s_add_u32 s30, s33, 86016
    buffer_load_dwordx4 v3, s[8:11], s30 offen lds
    s_add_u32 m0, s32, 15360
    s_add_u32 s30, s33, 100352
    buffer_load_dwordx4 v3, s[8:11], s30 offen lds
    s_add_u32 m0, s32, 16384
    s_add_u32 s30, s33, 114688
    buffer_load_dwordx4 v3, s[8:11], s30 offen lds
    s_add_u32 m0, s32, 17408
    s_add_u32 s30, s33, 129024
    buffer_load_dwordx4 v3, s[8:11], s30 offen lds
    s_add_u32 m0, s32, 18432
    s_add_u32 s30, s33, 143360
    buffer_load_dwordx4 v3, s[8:11], s30 offen lds
    s_add_u32 m0, s32, 19456
    s_add_u32 s30, s33, 157696
    buffer_load_dwordx4 v3, s[8:11], s30 offen lds
    s_add_u32 m0, s32, 20480
    s_add_u32 s30, s33, 172032
    buffer_load_dwordx4 v3, s[8:11], s30 offen lds
    s_add_u32 m0, s32, 21504
    s_add_u32 s30, s33, 186368
    buffer_load_dwordx4 v3, s[8:11], s30 offen lds
    s_add_u32 m0, s32, 22528
    s_add_u32 s30, s33, 200704
    buffer_load_dwordx4 v3, s[8:11], s30 offen lds
    s_add_u32 m0, s32, 23552
    s_add_u32 s30, s33, 215040
    buffer_load_dwordx4 v3, s[8:11], s30 offen lds
    s_add_u32 m0, s32, 24576
    s_add_u32 s30, s33, 229376
    buffer_load_dwordx4 v3, s[8:11], s30 offen lds
    s_add_u32 m0, s32, 25600
    s_add_u32 s30, s33, 243712
    buffer_load_dwordx4 v3, s[8:11], s30 offen lds
    s_add_u32 m0, s32, 26624
    s_add_u32 s30, s33, 258048
    buffer_load_dwordx4 v3, s[8:11], s30 offen lds
    s_add_u32 m0, s32, 27648
    s_add_u32 s30, s33, 272384
    buffer_load_dwordx4 v3, s[8:11], s30 offen lds
    s_add_u32 m0, s32, 28672
    s_add_u32 s30, s33, 286720
    buffer_load_dwordx4 v3, s[8:11], s30 offen lds
    s_add_u32 m0, s32, 29696
    s_add_u32 s30, s33, 301056
    buffer_load_dwordx4 v3, s[8:11], s30 offen lds
    s_add_u32 m0, s32, 30720
    s_add_u32 s30, s33, 315392
    buffer_load_dwordx4 v3, s[8:11], s30 offen lds
    s_add_u32 m0, s32, 31744
    s_add_u32 s30, s33, 329728
    buffer_load_dwordx4 v3, s[8:11], s30 offen lds
    s_add_u32 m0, s32, 32768
    s_add_u32 s30, s33, 344064
    buffer_load_dwordx4 v3, s[8:11], s30 offen lds
    s_add_u32 m0, s32, 33792
    s_add_u32 s30, s33, 358400
    buffer_load_dwordx4 v3, s[8:11], s30 offen lds
    s_add_u32 m0, s32, 34816
    s_add_u32 s30, s33, 372736
    buffer_load_dwordx4 v3, s[8:11], s30 offen lds
    s_add_u32 m0, s32, 35840
    s_add_u32 s30, s33, 387072
    buffer_load_dwordx4 v3, s[8:11], s30 offen lds
    v_mov_b32 v106, 0
    s_add_u32 s30, s52, s53
    v_add_u32 v107, 0, v0
    v_mul_u32_u24 v108, 1171, v107
    v_lshrrev_b32 v108, 16, v108
    v_mul_u32_u24 v109, 56, v108
    v_sub_u32 v109, v107, v109
    v_add_u32 v108, 6, v108
    v_min_u32 v108, 15, v108
    v_mul_u32_u24 v108, 3584, v108
    v_lshl_add_u32 v108, v109, 2, v108
    buffer_store_dword v106, v108, s[24:27], s30 offen sc1
    v_add_u32 v107, 256, v0
    v_mul_u32_u24 v108, 1171, v107
    v_lshrrev_b32 v108, 16, v108
    v_mul_u32_u24 v109, 56, v108
    v_sub_u32 v109, v107, v109
    v_add_u32 v108, 6, v108
    v_min_u32 v108, 15, v108
    v_mul_u32_u24 v108, 3584, v108
    v_lshl_add_u32 v108, v109, 2, v108
    buffer_store_dword v106, v108, s[24:27], s30 offen sc1
    v_add_u32 v107, 512, v0
    v_mul_u32_u24 v108, 1171, v107
    v_lshrrev_b32 v108, 16, v108
    v_mul_u32_u24 v109, 56, v108
    v_sub_u32 v109, v107, v109
    v_add_u32 v108, 6, v108
    v_min_u32 v108, 15, v108
    v_mul_u32_u24 v108, 3584, v108
    v_lshl_add_u32 v108, v109, 2, v108
    buffer_store_dword v106, v108, s[24:27], s30 offen sc1
    v_mov_b32 v12, v0
    v_mul_u32_u24 v13, 896, v241
    v_lshl_add_u32 v13, v242, 4, v13
    v_mov_b32 v10, 0x7fff0000
    v_cmp_gt_u32 vcc, 2, v241
    v_cndmask_b32 v13, v10, v13, vcc
    s_and_b32 s74, s2, 31
    s_lshl_b32 s74, s74, 8
    s_add_u32 s74, s74, 12288
    s_waitcnt vmcnt(0)
    s_cmp_lg_u32 s28, 0
    s_cbranch_scc1 WF7_D
    v_mbcnt_lo_u32_b32 v0, -1, 0
    v_and_b32 v0, 0, v0
    v_lshlrev_b32 v0, 6, v0
    s_mov_b32 s72, 0
WF7_P:
    buffer_load_dword v1, v0, s[68:71], s74 offen sc1
    s_waitcnt vmcnt(0)
    v_cmp_gt_u32 vcc, 60, v1
    s_cmp_eq_u64 vcc, 0
    s_cbranch_scc1 WF7_D
    s_sleep 1
    s_add_u32 s72, s72, 1
    s_cmp_lt_u32 s72, 0x400000
    s_cbranch_scc1 WF7_P
WF7_D:
    s_barrier
    s_mov_b32 s30, 10752
    buffer_load_dwordx4 v[128:131], v13, s[20:23], s30 offen offset:0 sc1
    buffer_load_dwordx4 v[132:135], v13, s[20:23], s30 offen offset:32 sc1
    buffer_load_dwordx4 v[136:139], v13, s[20:23], s30 offen offset:64 sc1
    buffer_load_dwordx4 v[140:143], v13, s[20:23], s30 offen offset:96 sc1
    buffer_load_dwordx4 v[144:147], v13, s[20:23], s30 offen offset:128 sc1
    buffer_load_dwordx4 v[148:151], v13, s[20:23], s30 offen offset:160 sc1
    buffer_load_dwordx4 v[152:155], v13, s[20:23], s30 offen offset:192 sc1
    buffer_load_dwordx4 v[156:159], v13, s[20:23], s30 offen offset:224 sc1
    buffer_load_dwordx4 v[160:163], v13, s[20:23], s30 offen offset:256 sc1
    buffer_load_dwordx4 v[164:167], v13, s[20:23], s30 offen offset:288 sc1
    buffer_load_dwordx4 v[168:171], v13, s[20:23], s30 offen offset:320 sc1
    buffer_load_dwordx4 v[172:175], v13, s[20:23], s30 offen offset:352 sc1
    buffer_load_dwordx4 v[176:179], v13, s[20:23], s30 offen offset:384 sc1
    buffer_load_dwordx4 v[180:183], v13, s[20:23], s30 offen offset:416 sc1
    buffer_load_dwordx4 v[184:187], v13, s[20:23], s30 offen offset:448 sc1
    buffer_load_dwordx4 v[188:191], v13, s[20:23], s30 offen offset:480 sc1
    buffer_load_dwordx4 v[192:195], v13, s[20:23], s30 offen offset:512 sc1
    buffer_load_dwordx4 v[196:199], v13, s[20:23], s30 offen offset:544 sc1
    buffer_load_dwordx4 v[200:203], v13, s[20:23], s30 offen offset:576 sc1
    buffer_load_dwordx4 v[204:207], v13, s[20:23], s30 offen offset:608 sc1
    buffer_load_dwordx4 v[208:211], v13, s[20:23], s30 offen offset:640 sc1
    buffer_load_dwordx4 v[212:215], v13, s[20:23], s30 offen offset:672 sc1
    buffer_load_dwordx4 v[216:219], v13, s[20:23], s30 offen offset:704 sc1
    buffer_load_dwordx4 v[220:223], v13, s[20:23], s30 offen offset:736 sc1
    buffer_load_dwordx4 v[224:227], v13, s[20:23], s30 offen offset:768 sc1
    buffer_load_dwordx4 v[228:231], v13, s[20:23], s30 offen offset:800 sc1
    buffer_load_dwordx4 v[232:235], v13, s[20:23], s30 offen offset:832 sc1
    buffer_load_dwordx4 v[236:239], v13, s[20:23], s30 offen offset:864 sc1
    ds_read_b64_tr_b16 v[32:33], v14 offset:0
    ds_read_b64_tr_b16 v[34:35], v14 offset:1024
    ds_read_b64_tr_b16 v[36:37], v14 offset:4096
    ds_read_b64_tr_b16 v[38:39], v14 offset:5120
    ds_read_b64_tr_b16 v[40:41], v14 offset:8192
    ds_read_b64_tr_b16 v[42:43], v14 offset:9216
    ds_read_b64_tr_b16 v[44:45], v14 offset:12288
    ds_read_b64_tr_b16 v[46:47], v14 offset:13312
    ds_read_b64_tr_b16 v[48:49], v14 offset:16384
    ds_read_b64_tr_b16 v[50:51], v14 offset:17408
    ds_read_b64_tr_b16 v[52:53], v14 offset:20480
    ds_read_b64_tr_b16 v[54:55], v14 offset:21504
    ds_read_b64_tr_b16 v[56:57], v14 offset:24576
    ds_read_b64_tr_b16 v[58:59], v14 offset:25600
    s_waitcnt lgkmcnt(12)
    s_waitcnt vmcnt(27)
    v_mfma_f32_32x32x16_bf16 v[16:31], v[32:35], v[128:131], 0
    ds_read_b64_tr_b16 v[60:61], v14 offset:28672
    ds_read_b64_tr_b16 v[62:63], v14 offset:29696
    s_waitcnt lgkmcnt(12)
    s_waitcnt vmcnt(26)
    v_mfma_f32_32x32x16_bf16 v[16:31], v[36:39], v[132:135], v[16:31]
    ds_read_b64_tr_b16 v[32:33], v14 offset:32768
    ds_read_b64_tr_b16 v[34:35], v14 offset:33792
    s_waitcnt lgkmcnt(12)
    s_waitcnt vmcnt(25)
    v_mfma_f32_32x32x16_bf16 v[16:31], v[40:43], v[136:139], v[16:31]
    ds_read_b64_tr_b16 v[36:37], v14 offset:36864
    ds_read_b64_tr_b16 v[38:39], v14 offset:37888
    s_waitcnt lgkmcnt(12)
    s_waitcnt vmcnt(24)
    v_mfma_f32_32x32x16_bf16 v[16:31], v[44:47], v[140:143], v[16:31]
    ds_read_b64_tr_b16 v[40:41], v14 offset:40960
    ds_read_b64_tr_b16 v[42:43], v14 offset:41984
    s_waitcnt lgkmcnt(12)
    s_waitcnt vmcnt(23)
    v_mfma_f32_32x32x16_bf16 v[16:31], v[48:51], v[144:147], v[16:31]
    ds_read_b64_tr_b16 v[44:45], v14 offset:45056
    ds_read_b64_tr_b16 v[46:47], v14 offset:46080
    s_waitcnt lgkmcnt(12)
    s_waitcnt vmcnt(22)
    v_mfma_f32_32x32x16_bf16 v[16:31], v[52:55], v[148:151], v[16:31]
    ds_read_b64_tr_b16 v[48:49], v14 offset:49152
    ds_read_b64_tr_b16 v[50:51], v14 offset:50176
    s_waitcnt lgkmcnt(12)
    s_waitcnt vmcnt(21)
    v_mfma_f32_32x32x16_bf16 v[16:31], v[56:59], v[152:155], v[16:31]
    ds_read_b64_tr_b16 v[52:53], v14 offset:53248
    ds_read_b64_tr_b16 v[54:55], v14 offset:54272
    s_waitcnt lgkmcnt(12)
    s_waitcnt vmcnt(20)
    v_mfma_f32_32x32x16_bf16 v[16:31], v[60:63], v[156:159], v[16:31]
    ds_read_b64_tr_b16 v[56:57], v14 offset:57344
    ds_read_b64_tr_b16 v[58:59], v14 offset:58368
    s_waitcnt lgkmcnt(12)
    s_waitcnt vmcnt(19)
    v_mfma_f32_32x32x16_bf16 v[16:31], v[32:35], v[160:163], v[16:31]
    ds_read_b64_tr_b16 v[60:61], v14 offset:61440
    ds_read_b64_tr_b16 v[62:63], v14 offset:62464
    s_waitcnt lgkmcnt(12)
    s_waitcnt vmcnt(18)
    v_mfma_f32_32x32x16_bf16 v[16:31], v[36:39], v[164:167], v[16:31]
    ds_read_b64_tr_b16 v[32:33], v15 offset:0
    ds_read_b64_tr_b16 v[34:35], v15 offset:1024
    s_waitcnt lgkmcnt(12)
    s_waitcnt vmcnt(17)
    v_mfma_f32_32x32x16_bf16 v[16:31], v[40:43], v[168:171], v[16:31]
    ds_read_b64_tr_b16 v[36:37], v15 offset:4096
    ds_read_b64_tr_b16 v[38:39], v15 offset:5120
    s_waitcnt lgkmcnt(12)
    s_waitcnt vmcnt(16)
    v_mfma_f32_32x32x16_bf16 v[16:31], v[44:47], v[172:175], v[16:31]
    ds_read_b64_tr_b16 v[40:41], v15 offset:8192
    ds_read_b64_tr_b16 v[42:43], v15 offset:9216
    s_waitcnt lgkmcnt(12)
    s_waitcnt vmcnt(15)
    v_mfma_f32_32x32x16_bf16 v[16:31], v[48:51], v[176:179], v[16:31]
    ds_read_b64_tr_b16 v[44:45], v15 offset:12288
    ds_read_b64_tr_b16 v[46:47], v15 offset:13312
    s_waitcnt lgkmcnt(12)
    s_waitcnt vmcnt(14)
    v_mfma_f32_32x32x16_bf16 v[16:31], v[52:55], v[180:183], v[16:31]
    ds_read_b64_tr_b16 v[48:49], v15 offset:16384
    ds_read_b64_tr_b16 v[50:51], v15 offset:17408
    s_waitcnt lgkmcnt(12)
    s_waitcnt vmcnt(13)
    v_mfma_f32_32x32x16_bf16 v[16:31], v[56:59], v[184:187], v[16:31]
    ds_read_b64_tr_b16 v[52:53], v15 offset:20480
    ds_read_b64_tr_b16 v[54:55], v15 offset:21504
    s_waitcnt lgkmcnt(12)
    s_waitcnt vmcnt(12)
    v_mfma_f32_32x32x16_bf16 v[16:31], v[60:63], v[188:191], v[16:31]
    ds_read_b64_tr_b16 v[56:57], v15 offset:24576
    ds_read_b64_tr_b16 v[58:59], v15 offset:25600
    s_waitcnt lgkmcnt(12)
    s_waitcnt vmcnt(11)
    v_mfma_f32_32x32x16_bf16 v[16:31], v[32:35], v[192:195], v[16:31]
    ds_read_b64_tr_b16 v[60:61], v15 offset:28672
    ds_read_b64_tr_b16 v[62:63], v15 offset:29696
    s_waitcnt lgkmcnt(12)
    s_waitcnt vmcnt(10)
    v_mfma_f32_32x32x16_bf16 v[16:31], v[36:39], v[196:199], v[16:31]
    ds_read_b64_tr_b16 v[32:33], v15 offset:32768
    ds_read_b64_tr_b16 v[34:35], v15 offset:33792
    s_waitcnt lgkmcnt(12)
    s_waitcnt vmcnt(9)
    v_mfma_f32_32x32x16_bf16 v[16:31], v[40:43], v[200:203], v[16:31]
    ds_read_b64_tr_b16 v[36:37], v15 offset:36864
    ds_read_b64_tr_b16 v[38:39], v15 offset:37888
    s_waitcnt lgkmcnt(12)
    s_waitcnt vmcnt(8)
    v_mfma_f32_32x32x16_bf16 v[16:31], v[44:47], v[204:207], v[16:31]
    ds_read_b64_tr_b16 v[40:41], v15 offset:40960
    ds_read_b64_tr_b16 v[42:43], v15 offset:41984
    s_waitcnt lgkmcnt(12)
    s_waitcnt vmcnt(7)
    v_mfma_f32_32x32x16_bf16 v[16:31], v[48:51], v[208:211], v[16:31]
    ds_read_b64_tr_b16 v[44:45], v15 offset:45056
    ds_read_b64_tr_b16 v[46:47], v15 offset:46080
    s_waitcnt lgkmcnt(12)
    s_waitcnt vmcnt(6)
    v_mfma_f32_32x32x16_bf16 v[16:31], v[52:55], v[212:215], v[16:31]
    s_waitcnt lgkmcnt(10)
    s_waitcnt vmcnt(5)
    v_mfma_f32_32x32x16_bf16 v[16:31], v[56:59], v[216:219], v[16:31]
    s_waitcnt lgkmcnt(8)
    s_waitcnt vmcnt(4)
    v_mfma_f32_32x32x16_bf16 v[16:31], v[60:63], v[220:223], v[16:31]
    s_waitcnt lgkmcnt(6)
    s_waitcnt vmcnt(3)
    v_mfma_f32_32x32x16_bf16 v[16:31], v[32:35], v[224:227], v[16:31]
    s_waitcnt lgkmcnt(4)
    s_waitcnt vmcnt(2)
    v_mfma_f32_32x32x16_bf16 v[16:31], v[36:39], v[228:231], v[16:31]
    s_waitcnt lgkmcnt(2)
    s_waitcnt vmcnt(1)
    v_mfma_f32_32x32x16_bf16 v[16:31], v[40:43], v[232:235], v[16:31]
    s_waitcnt lgkmcnt(0)
    s_waitcnt vmcnt(0)
    v_mfma_f32_32x32x16_bf16 v[16:31], v[44:47], v[236:239], v[16:31]
    v_lshlrev_b32 v10, 9, v241
    v_lshl_add_u32 v10, v242, 4, v10
    s_lshl_b32 s30, s28, 7
    v_add_u32 v10, s30, v10
    v_cmp_le_u32 vcc, 112, v12
    v_mov_b32 v6, 0
    v_mov_b32 v7, 10528
    v_cndmask_b32 v6, v6, v7, vcc
    v_lshl_add_u32 v6, v12, 1, v6
    v_mov_b32 v7, 64
    v_cndmask_b32 v7, 0, v7, vcc
    v_lshl_add_u32 v5, v12, 2, v7
    s_nop 7
    s_mov_b32 exec_lo, 3
    s_mov_b32 exec_hi, 3
    ds_write_b128 v10, v[16:19] offset:0
    ds_write_b128 v10, v[20:23] offset:32
    ds_write_b128 v10, v[24:27] offset:64
    ds_write_b128 v10, v[28:31] offset:96
    s_mov_b64 exec, -1
    s_waitcnt lgkmcnt(0)
    s_barrier
    v_cmp_gt_u32 vcc, 224, v12
    s_and_saveexec_b64 s[40:41], vcc
    ds_read_b32 v16, v5
    s_add_u32 s30, s52, s53
    s_waitcnt lgkmcnt(0)
    v_cvt_pk_bf16_f32 v17, 0, v16
    v_sub_f32 v16, v16, v17
    v_lshrrev_b32 v18, 16, v17
    buffer_store_short v18, v6, s[24:27], s30 offen sc1
    s_add_u32 s30, s30, 3584
    v_cvt_pk_bf16_f32 v17, 0, v16
    v_sub_f32 v16, v16, v17
    v_lshrrev_b32 v19, 16, v17
    buffer_store_short v19, v6, s[24:27], s30 offen sc1
    s_add_u32 s30, s30, 3584
    v_cvt_pk_bf16_f32 v17, 0, v16
    v_sub_f32 v16, v16, v17
    v_lshrrev_b32 v20, 16, v17
    buffer_store_short v20, v6, s[24:27], s30 offen sc1
    s_add_u32 s30, s30, 3584
    s_mov_b64 exec, -1
    s_waitcnt vmcnt(0)
    s_barrier
    s_cmp_lg_u32 s28, 0
    s_cbranch_scc1 ALL_END
    s_mov_b64 exec, 0xffff
    v_lshlrev_b32 v0, 8, v12
    v_add_u32 v0, 4096, v0
    v_mov_b32 v1, 1
    buffer_atomic_add v1, v0, s[68:71], 0 offen sc1
    s_branch ALL_WAIT
ATT_RS0_0:
    v_mov_b32 v190, v189
    s_nop 15
    v_permlane32_swap_b32 v189, v190
    v_max_f32 v189, v189, v190
    v_max_f32 v189, v189, v184
    v_sub_f32 v190, v184, v189
    v_mul_f32 v190, s46, v190
    v_exp_f32 v190, v190
    v_mov_b32 v184, v189
    v_mul_f32 v185, s46, v184
    v_add_f32 v185, 0x42c80000, v185
    v_add_f32 v188, 0x445dce9e, v184
    v_mul_f32 v186, v186, v190
    v_mul_f32 v187, v187, v190
    v_mul_f32 v0, v0, v190
    v_mul_f32 v1, v1, v190
    v_mul_f32 v2, v2, v190
    v_mul_f32 v3, v3, v190
    v_mul_f32 v4, v4, v190
    v_mul_f32 v5, v5, v190
    v_mul_f32 v6, v6, v190
    v_mul_f32 v7, v7, v190
    v_mul_f32 v8, v8, v190
    v_mul_f32 v9, v9, v190
    v_mul_f32 v10, v10, v190
    v_mul_f32 v11, v11, v190
    v_mul_f32 v12, v12, v190
    v_mul_f32 v13, v13, v190
    v_mul_f32 v14, v14, v190
    v_mul_f32 v15, v15, v190
    v_mul_f32 v16, v16, v190
    v_mul_f32 v17, v17, v190
    v_mul_f32 v18, v18, v190
    v_mul_f32 v19, v19, v190
    v_mul_f32 v20, v20, v190
    v_mul_f32 v21, v21, v190
    v_mul_f32 v22, v22, v190
    v_mul_f32 v23, v23, v190
    v_mul_f32 v24, v24, v190
    v_mul_f32 v25, v25, v190
    v_mul_f32 v26, v26, v190
    v_mul_f32 v27, v27, v190
    v_mul_f32 v28, v28, v190
    v_mul_f32 v29, v29, v190
    v_mul_f32 v30, v30, v190
    v_mul_f32 v31, v31, v190
    v_mul_f32 v32, v32, v190
    v_mul_f32 v33, v33, v190
    v_mul_f32 v34, v34, v190
    v_mul_f32 v35, v35, v190
    v_mul_f32 v36, v36, v190
    v_mul_f32 v37, v37, v190
    v_mul_f32 v38, v38, v190
    v_mul_f32 v39, v39, v190
    v_mul_f32 v40, v40, v190
    v_mul_f32 v41, v41, v190
    v_mul_f32 v42, v42, v190
    v_mul_f32 v43, v43, v190
    v_mul_f32 v44, v44, v190
    v_mul_f32 v45, v45, v190
    v_mul_f32 v46, v46, v190
    v_mul_f32 v47, v47, v190
    v_mul_f32 v48, v48, v190
    v_mul_f32 v49, v49, v190
    v_mul_f32 v50, v50, v190
    v_mul_f32 v51, v51, v190
    v_mul_f32 v52, v52, v190
    v_mul_f32 v53, v53, v190
    v_mul_f32 v54, v54, v190
    v_mul_f32 v55, v55, v190
    v_mul_f32 v56, v56, v190
    v_mul_f32 v57, v57, v190
    v_mul_f32 v58, v58, v190
    v_mul_f32 v59, v59, v190
    v_mul_f32 v60, v60, v190
    v_mul_f32 v61, v61, v190
    v_mul_f32 v62, v62, v190
    v_mul_f32 v63, v63, v190
    v_mul_f32 v64, v64, v190
    v_mul_f32 v65, v65, v190
    v_mul_f32 v66, v66, v190
    v_mul_f32 v67, v67, v190
    v_mul_f32 v68, v68, v190
    v_mul_f32 v69, v69, v190
    v_mul_f32 v70, v70, v190
    v_mul_f32 v71, v71, v190
    v_mul_f32 v72, v72, v190
    v_mul_f32 v73, v73, v190
    v_mul_f32 v74, v74, v190
    v_mul_f32 v75, v75, v190
    v_mul_f32 v76, v76, v190
    v_mul_f32 v77, v77, v190
    v_mul_f32 v78, v78, v190
    v_mul_f32 v79, v79, v190
    v_mul_f32 v80, v80, v190
    v_mul_f32 v81, v81, v190
    v_mul_f32 v82, v82, v190
    v_mul_f32 v83, v83, v190
    v_mul_f32 v84, v84, v190
    v_mul_f32 v85, v85, v190
    v_mul_f32 v86, v86, v190
    v_mul_f32 v87, v87, v190
    v_mul_f32 v88, v88, v190
    v_mul_f32 v89, v89, v190
    v_mul_f32 v90, v90, v190
    v_mul_f32 v91, v91, v190
    v_mul_f32 v92, v92, v190
    v_mul_f32 v93, v93, v190
    v_mul_f32 v94, v94, v190
    v_mul_f32 v95, v95, v190
    v_mul_f32 v96, v96, v190
    v_mul_f32 v97, v97, v190
    v_mul_f32 v98, v98, v190
    v_mul_f32 v99, v99, v190
    v_mul_f32 v100, v100, v190
    v_mul_f32 v101, v101, v190
    v_mul_f32 v102, v102, v190
    v_mul_f32 v103, v103, v190
    v_mul_f32 v104, v104, v190
    v_mul_f32 v105, v105, v190
    v_mul_f32 v106, v106, v190
    v_mul_f32 v107, v107, v190
    v_mul_f32 v108, v108, v190
    v_mul_f32 v109, v109, v190
    v_mul_f32 v110, v110, v190
    v_mul_f32 v111, v111, v190
    v_mul_f32 v112, v112, v190
    v_mul_f32 v113, v113, v190
    v_mul_f32 v114, v114, v190
    v_mul_f32 v115, v115, v190
    v_mul_f32 v116, v116, v190
    v_mul_f32 v117, v117, v190
    v_mul_f32 v118, v118, v190
    v_mul_f32 v119, v119, v190
    v_mul_f32 v120, v120, v190
    v_mul_f32 v121, v121, v190
    v_mul_f32 v122, v122, v190
    v_mul_f32 v123, v123, v190
    v_mul_f32 v124, v124, v190
    v_mul_f32 v125, v125, v190
    v_mul_f32 v126, v126, v190
    v_mul_f32 v127, v127, v190
    s_branch ATT_BK0_0
ATT_RS0_1:
    v_mov_b32 v190, v189
    s_nop 15
    v_permlane32_swap_b32 v189, v190
    v_max_f32 v189, v189, v190
    v_max_f32 v189, v189, v184
    v_sub_f32 v190, v184, v189
    v_mul_f32 v190, s46, v190
    v_exp_f32 v190, v190
    v_mov_b32 v184, v189
    v_mul_f32 v185, s46, v184
    v_add_f32 v185, 0x42c80000, v185
    v_add_f32 v188, 0x445dce9e, v184
    v_mul_f32 v186, v186, v190
    v_mul_f32 v187, v187, v190
    v_mul_f32 v0, v0, v190
    v_mul_f32 v1, v1, v190
    v_mul_f32 v2, v2, v190
    v_mul_f32 v3, v3, v190
    v_mul_f32 v4, v4, v190
    v_mul_f32 v5, v5, v190
    v_mul_f32 v6, v6, v190
    v_mul_f32 v7, v7, v190
    v_mul_f32 v8, v8, v190
    v_mul_f32 v9, v9, v190
    v_mul_f32 v10, v10, v190
    v_mul_f32 v11, v11, v190
    v_mul_f32 v12, v12, v190
    v_mul_f32 v13, v13, v190
    v_mul_f32 v14, v14, v190
    v_mul_f32 v15, v15, v190
    v_mul_f32 v16, v16, v190
    v_mul_f32 v17, v17, v190
    v_mul_f32 v18, v18, v190
    v_mul_f32 v19, v19, v190
    v_mul_f32 v20, v20, v190
    v_mul_f32 v21, v21, v190
    v_mul_f32 v22, v22, v190
    v_mul_f32 v23, v23, v190
    v_mul_f32 v24, v24, v190
    v_mul_f32 v25, v25, v190
    v_mul_f32 v26, v26, v190
    v_mul_f32 v27, v27, v190
    v_mul_f32 v28, v28, v190
    v_mul_f32 v29, v29, v190
    v_mul_f32 v30, v30, v190
    v_mul_f32 v31, v31, v190
    v_mul_f32 v32, v32, v190
    v_mul_f32 v33, v33, v190
    v_mul_f32 v34, v34, v190
    v_mul_f32 v35, v35, v190
    v_mul_f32 v36, v36, v190
    v_mul_f32 v37, v37, v190
    v_mul_f32 v38, v38, v190
    v_mul_f32 v39, v39, v190
    v_mul_f32 v40, v40, v190
    v_mul_f32 v41, v41, v190
    v_mul_f32 v42, v42, v190
    v_mul_f32 v43, v43, v190
    v_mul_f32 v44, v44, v190
    v_mul_f32 v45, v45, v190
    v_mul_f32 v46, v46, v190
    v_mul_f32 v47, v47, v190
    v_mul_f32 v48, v48, v190
    v_mul_f32 v49, v49, v190
    v_mul_f32 v50, v50, v190
    v_mul_f32 v51, v51, v190
    v_mul_f32 v52, v52, v190
    v_mul_f32 v53, v53, v190
    v_mul_f32 v54, v54, v190
    v_mul_f32 v55, v55, v190
    v_mul_f32 v56, v56, v190
    v_mul_f32 v57, v57, v190
    v_mul_f32 v58, v58, v190
    v_mul_f32 v59, v59, v190
    v_mul_f32 v60, v60, v190
    v_mul_f32 v61, v61, v190
    v_mul_f32 v62, v62, v190
    v_mul_f32 v63, v63, v190
    v_mul_f32 v64, v64, v190
    v_mul_f32 v65, v65, v190
    v_mul_f32 v66, v66, v190
    v_mul_f32 v67, v67, v190
    v_mul_f32 v68, v68, v190
    v_mul_f32 v69, v69, v190
    v_mul_f32 v70, v70, v190
    v_mul_f32 v71, v71, v190
    v_mul_f32 v72, v72, v190
    v_mul_f32 v73, v73, v190
    v_mul_f32 v74, v74, v190
    v_mul_f32 v75, v75, v190
    v_mul_f32 v76, v76, v190
    v_mul_f32 v77, v77, v190
    v_mul_f32 v78, v78, v190
    v_mul_f32 v79, v79, v190
    v_mul_f32 v80, v80, v190
    v_mul_f32 v81, v81, v190
    v_mul_f32 v82, v82, v190
    v_mul_f32 v83, v83, v190
    v_mul_f32 v84, v84, v190
    v_mul_f32 v85, v85, v190
    v_mul_f32 v86, v86, v190
    v_mul_f32 v87, v87, v190
    v_mul_f32 v88, v88, v190
    v_mul_f32 v89, v89, v190
    v_mul_f32 v90, v90, v190
    v_mul_f32 v91, v91, v190
    v_mul_f32 v92, v92, v190
    v_mul_f32 v93, v93, v190
    v_mul_f32 v94, v94, v190
    v_mul_f32 v95, v95, v190
    v_mul_f32 v96, v96, v190
    v_mul_f32 v97, v97, v190
    v_mul_f32 v98, v98, v190
    v_mul_f32 v99, v99, v190
    v_mul_f32 v100, v100, v190
    v_mul_f32 v101, v101, v190
    v_mul_f32 v102, v102, v190
    v_mul_f32 v103, v103, v190
    v_mul_f32 v104, v104, v190
    v_mul_f32 v105, v105, v190
    v_mul_f32 v106, v106, v190
    v_mul_f32 v107, v107, v190
    v_mul_f32 v108, v108, v190
    v_mul_f32 v109, v109, v190
    v_mul_f32 v110, v110, v190
    v_mul_f32 v111, v111, v190
    v_mul_f32 v112, v112, v190
    v_mul_f32 v113, v113, v190
    v_mul_f32 v114, v114, v190
    v_mul_f32 v115, v115, v190
    v_mul_f32 v116, v116, v190
    v_mul_f32 v117, v117, v190
    v_mul_f32 v118, v118, v190
    v_mul_f32 v119, v119, v190
    v_mul_f32 v120, v120, v190
    v_mul_f32 v121, v121, v190
    v_mul_f32 v122, v122, v190
    v_mul_f32 v123, v123, v190
    v_mul_f32 v124, v124, v190
    v_mul_f32 v125, v125, v190
    v_mul_f32 v126, v126, v190
    v_mul_f32 v127, v127, v190
    s_branch ATT_BK0_1
ATT_RS0_2:
    v_mov_b32 v190, v189
    s_nop 15
    v_permlane32_swap_b32 v189, v190
    v_max_f32 v189, v189, v190
    v_max_f32 v189, v189, v184
    v_sub_f32 v190, v184, v189
    v_mul_f32 v190, s46, v190
    v_exp_f32 v190, v190
    v_mov_b32 v184, v189
    v_mul_f32 v185, s46, v184
    v_add_f32 v185, 0x42c80000, v185
    v_add_f32 v188, 0x445dce9e, v184
    v_mul_f32 v186, v186, v190
    v_mul_f32 v187, v187, v190
    v_mul_f32 v0, v0, v190
    v_mul_f32 v1, v1, v190
    v_mul_f32 v2, v2, v190
    v_mul_f32 v3, v3, v190
    v_mul_f32 v4, v4, v190
    v_mul_f32 v5, v5, v190
    v_mul_f32 v6, v6, v190
    v_mul_f32 v7, v7, v190
    v_mul_f32 v8, v8, v190
    v_mul_f32 v9, v9, v190
    v_mul_f32 v10, v10, v190
    v_mul_f32 v11, v11, v190
    v_mul_f32 v12, v12, v190
    v_mul_f32 v13, v13, v190
    v_mul_f32 v14, v14, v190
    v_mul_f32 v15, v15, v190
    v_mul_f32 v16, v16, v190
    v_mul_f32 v17, v17, v190
    v_mul_f32 v18, v18, v190
    v_mul_f32 v19, v19, v190
    v_mul_f32 v20, v20, v190
    v_mul_f32 v21, v21, v190
    v_mul_f32 v22, v22, v190
    v_mul_f32 v23, v23, v190
    v_mul_f32 v24, v24, v190
    v_mul_f32 v25, v25, v190
    v_mul_f32 v26, v26, v190
    v_mul_f32 v27, v27, v190
    v_mul_f32 v28, v28, v190
    v_mul_f32 v29, v29, v190
    v_mul_f32 v30, v30, v190
    v_mul_f32 v31, v31, v190
    v_mul_f32 v32, v32, v190
    v_mul_f32 v33, v33, v190
    v_mul_f32 v34, v34, v190
    v_mul_f32 v35, v35, v190
    v_mul_f32 v36, v36, v190
    v_mul_f32 v37, v37, v190
    v_mul_f32 v38, v38, v190
    v_mul_f32 v39, v39, v190
    v_mul_f32 v40, v40, v190
    v_mul_f32 v41, v41, v190
    v_mul_f32 v42, v42, v190
    v_mul_f32 v43, v43, v190
    v_mul_f32 v44, v44, v190
    v_mul_f32 v45, v45, v190
    v_mul_f32 v46, v46, v190
    v_mul_f32 v47, v47, v190
    v_mul_f32 v48, v48, v190
    v_mul_f32 v49, v49, v190
    v_mul_f32 v50, v50, v190
    v_mul_f32 v51, v51, v190
    v_mul_f32 v52, v52, v190
    v_mul_f32 v53, v53, v190
    v_mul_f32 v54, v54, v190
    v_mul_f32 v55, v55, v190
    v_mul_f32 v56, v56, v190
    v_mul_f32 v57, v57, v190
    v_mul_f32 v58, v58, v190
    v_mul_f32 v59, v59, v190
    v_mul_f32 v60, v60, v190
    v_mul_f32 v61, v61, v190
    v_mul_f32 v62, v62, v190
    v_mul_f32 v63, v63, v190
    v_mul_f32 v64, v64, v190
    v_mul_f32 v65, v65, v190
    v_mul_f32 v66, v66, v190
    v_mul_f32 v67, v67, v190
    v_mul_f32 v68, v68, v190
    v_mul_f32 v69, v69, v190
    v_mul_f32 v70, v70, v190
    v_mul_f32 v71, v71, v190
    v_mul_f32 v72, v72, v190
    v_mul_f32 v73, v73, v190
    v_mul_f32 v74, v74, v190
    v_mul_f32 v75, v75, v190
    v_mul_f32 v76, v76, v190
    v_mul_f32 v77, v77, v190
    v_mul_f32 v78, v78, v190
    v_mul_f32 v79, v79, v190
    v_mul_f32 v80, v80, v190
    v_mul_f32 v81, v81, v190
    v_mul_f32 v82, v82, v190
    v_mul_f32 v83, v83, v190
    v_mul_f32 v84, v84, v190
    v_mul_f32 v85, v85, v190
    v_mul_f32 v86, v86, v190
    v_mul_f32 v87, v87, v190
    v_mul_f32 v88, v88, v190
    v_mul_f32 v89, v89, v190
    v_mul_f32 v90, v90, v190
    v_mul_f32 v91, v91, v190
    v_mul_f32 v92, v92, v190
    v_mul_f32 v93, v93, v190
    v_mul_f32 v94, v94, v190
    v_mul_f32 v95, v95, v190
    v_mul_f32 v96, v96, v190
    v_mul_f32 v97, v97, v190
    v_mul_f32 v98, v98, v190
    v_mul_f32 v99, v99, v190
    v_mul_f32 v100, v100, v190
    v_mul_f32 v101, v101, v190
    v_mul_f32 v102, v102, v190
    v_mul_f32 v103, v103, v190
    v_mul_f32 v104, v104, v190
    v_mul_f32 v105, v105, v190
    v_mul_f32 v106, v106, v190
    v_mul_f32 v107, v107, v190
    v_mul_f32 v108, v108, v190
    v_mul_f32 v109, v109, v190
    v_mul_f32 v110, v110, v190
    v_mul_f32 v111, v111, v190
    v_mul_f32 v112, v112, v190
    v_mul_f32 v113, v113, v190
    v_mul_f32 v114, v114, v190
    v_mul_f32 v115, v115, v190
    v_mul_f32 v116, v116, v190
    v_mul_f32 v117, v117, v190
    v_mul_f32 v118, v118, v190
    v_mul_f32 v119, v119, v190
    v_mul_f32 v120, v120, v190
    v_mul_f32 v121, v121, v190
    v_mul_f32 v122, v122, v190
    v_mul_f32 v123, v123, v190
    v_mul_f32 v124, v124, v190
    v_mul_f32 v125, v125, v190
    v_mul_f32 v126, v126, v190
    v_mul_f32 v127, v127, v190
    s_branch ATT_BK0_2
ATT_RS0_3:
    v_mov_b32 v190, v189
    s_nop 15
    v_permlane32_swap_b32 v189, v190
    v_max_f32 v189, v189, v190
    v_max_f32 v189, v189, v184
    v_sub_f32 v190, v184, v189
    v_mul_f32 v190, s46, v190
    v_exp_f32 v190, v190
    v_mov_b32 v184, v189
    v_mul_f32 v185, s46, v184
    v_add_f32 v185, 0x42c80000, v185
    v_add_f32 v188, 0x445dce9e, v184
    v_mul_f32 v186, v186, v190
    v_mul_f32 v187, v187, v190
    v_mul_f32 v0, v0, v190
    v_mul_f32 v1, v1, v190
    v_mul_f32 v2, v2, v190
    v_mul_f32 v3, v3, v190
    v_mul_f32 v4, v4, v190
    v_mul_f32 v5, v5, v190
    v_mul_f32 v6, v6, v190
    v_mul_f32 v7, v7, v190
    v_mul_f32 v8, v8, v190
    v_mul_f32 v9, v9, v190
    v_mul_f32 v10, v10, v190
    v_mul_f32 v11, v11, v190
    v_mul_f32 v12, v12, v190
    v_mul_f32 v13, v13, v190
    v_mul_f32 v14, v14, v190
    v_mul_f32 v15, v15, v190
    v_mul_f32 v16, v16, v190
    v_mul_f32 v17, v17, v190
    v_mul_f32 v18, v18, v190
    v_mul_f32 v19, v19, v190
    v_mul_f32 v20, v20, v190
    v_mul_f32 v21, v21, v190
    v_mul_f32 v22, v22, v190
    v_mul_f32 v23, v23, v190
    v_mul_f32 v24, v24, v190
    v_mul_f32 v25, v25, v190
    v_mul_f32 v26, v26, v190
    v_mul_f32 v27, v27, v190
    v_mul_f32 v28, v28, v190
    v_mul_f32 v29, v29, v190
    v_mul_f32 v30, v30, v190
    v_mul_f32 v31, v31, v190
    v_mul_f32 v32, v32, v190
    v_mul_f32 v33, v33, v190
    v_mul_f32 v34, v34, v190
    v_mul_f32 v35, v35, v190
    v_mul_f32 v36, v36, v190
    v_mul_f32 v37, v37, v190
    v_mul_f32 v38, v38, v190
    v_mul_f32 v39, v39, v190
    v_mul_f32 v40, v40, v190
    v_mul_f32 v41, v41, v190
    v_mul_f32 v42, v42, v190
    v_mul_f32 v43, v43, v190
    v_mul_f32 v44, v44, v190
    v_mul_f32 v45, v45, v190
    v_mul_f32 v46, v46, v190
    v_mul_f32 v47, v47, v190
    v_mul_f32 v48, v48, v190
    v_mul_f32 v49, v49, v190
    v_mul_f32 v50, v50, v190
    v_mul_f32 v51, v51, v190
    v_mul_f32 v52, v52, v190
    v_mul_f32 v53, v53, v190
    v_mul_f32 v54, v54, v190
    v_mul_f32 v55, v55, v190
    v_mul_f32 v56, v56, v190
    v_mul_f32 v57, v57, v190
    v_mul_f32 v58, v58, v190
    v_mul_f32 v59, v59, v190
    v_mul_f32 v60, v60, v190
    v_mul_f32 v61, v61, v190
    v_mul_f32 v62, v62, v190
    v_mul_f32 v63, v63, v190
    v_mul_f32 v64, v64, v190
    v_mul_f32 v65, v65, v190
    v_mul_f32 v66, v66, v190
    v_mul_f32 v67, v67, v190
    v_mul_f32 v68, v68, v190
    v_mul_f32 v69, v69, v190
    v_mul_f32 v70, v70, v190
    v_mul_f32 v71, v71, v190
    v_mul_f32 v72, v72, v190
    v_mul_f32 v73, v73, v190
    v_mul_f32 v74, v74, v190
    v_mul_f32 v75, v75, v190
    v_mul_f32 v76, v76, v190
    v_mul_f32 v77, v77, v190
    v_mul_f32 v78, v78, v190
    v_mul_f32 v79, v79, v190
    v_mul_f32 v80, v80, v190
    v_mul_f32 v81, v81, v190
    v_mul_f32 v82, v82, v190
    v_mul_f32 v83, v83, v190
    v_mul_f32 v84, v84, v190
    v_mul_f32 v85, v85, v190
    v_mul_f32 v86, v86, v190
    v_mul_f32 v87, v87, v190
    v_mul_f32 v88, v88, v190
    v_mul_f32 v89, v89, v190
    v_mul_f32 v90, v90, v190
    v_mul_f32 v91, v91, v190
    v_mul_f32 v92, v92, v190
    v_mul_f32 v93, v93, v190
    v_mul_f32 v94, v94, v190
    v_mul_f32 v95, v95, v190
    v_mul_f32 v96, v96, v190
    v_mul_f32 v97, v97, v190
    v_mul_f32 v98, v98, v190
    v_mul_f32 v99, v99, v190
    v_mul_f32 v100, v100, v190
    v_mul_f32 v101, v101, v190
    v_mul_f32 v102, v102, v190
    v_mul_f32 v103, v103, v190
    v_mul_f32 v104, v104, v190
    v_mul_f32 v105, v105, v190
    v_mul_f32 v106, v106, v190
    v_mul_f32 v107, v107, v190
    v_mul_f32 v108, v108, v190
    v_mul_f32 v109, v109, v190
    v_mul_f32 v110, v110, v190
    v_mul_f32 v111, v111, v190
    v_mul_f32 v112, v112, v190
    v_mul_f32 v113, v113, v190
    v_mul_f32 v114, v114, v190
    v_mul_f32 v115, v115, v190
    v_mul_f32 v116, v116, v190
    v_mul_f32 v117, v117, v190
    v_mul_f32 v118, v118, v190
    v_mul_f32 v119, v119, v190
    v_mul_f32 v120, v120, v190
    v_mul_f32 v121, v121, v190
    v_mul_f32 v122, v122, v190
    v_mul_f32 v123, v123, v190
    v_mul_f32 v124, v124, v190
    v_mul_f32 v125, v125, v190
    v_mul_f32 v126, v126, v190
    v_mul_f32 v127, v127, v190
    s_branch ATT_BK0_3
ATT_RSp_0:
    v_mov_b32 v190, v189
    s_nop 15
    v_permlane32_swap_b32 v189, v190
    v_max_f32 v189, v189, v190
    v_max_f32 v189, v189, v184
    v_sub_f32 v190, v184, v189
    v_mul_f32 v190, s46, v190
    v_exp_f32 v190, v190
    v_mov_b32 v184, v189
    v_mul_f32 v185, s46, v184
    v_add_f32 v185, 0x42c80000, v185
    v_add_f32 v188, 0x445dce9e, v184
    v_mul_f32 v186, v186, v190
    v_mul_f32 v187, v187, v190
    v_mul_f32 v0, v0, v190
    v_mul_f32 v1, v1, v190
    v_mul_f32 v2, v2, v190
    v_mul_f32 v3, v3, v190
    v_mul_f32 v4, v4, v190
    v_mul_f32 v5, v5, v190
    v_mul_f32 v6, v6, v190
    v_mul_f32 v7, v7, v190
    v_mul_f32 v8, v8, v190
    v_mul_f32 v9, v9, v190
    v_mul_f32 v10, v10, v190
    v_mul_f32 v11, v11, v190
    v_mul_f32 v12, v12, v190
    v_mul_f32 v13, v13, v190
    v_mul_f32 v14, v14, v190
    v_mul_f32 v15, v15, v190
    v_mul_f32 v16, v16, v190
    v_mul_f32 v17, v17, v190
    v_mul_f32 v18, v18, v190
    v_mul_f32 v19, v19, v190
    v_mul_f32 v20, v20, v190
    v_mul_f32 v21, v21, v190
    v_mul_f32 v22, v22, v190
    v_mul_f32 v23, v23, v190
    v_mul_f32 v24, v24, v190
    v_mul_f32 v25, v25, v190
    v_mul_f32 v26, v26, v190
    v_mul_f32 v27, v27, v190
    v_mul_f32 v28, v28, v190
    v_mul_f32 v29, v29, v190
    v_mul_f32 v30, v30, v190
    v_mul_f32 v31, v31, v190
    v_mul_f32 v32, v32, v190
    v_mul_f32 v33, v33, v190
    v_mul_f32 v34, v34, v190
    v_mul_f32 v35, v35, v190
    v_mul_f32 v36, v36, v190
    v_mul_f32 v37, v37, v190
    v_mul_f32 v38, v38, v190
    v_mul_f32 v39, v39, v190
    v_mul_f32 v40, v40, v190
    v_mul_f32 v41, v41, v190
    v_mul_f32 v42, v42, v190
    v_mul_f32 v43, v43, v190
    v_mul_f32 v44, v44, v190
    v_mul_f32 v45, v45, v190
    v_mul_f32 v46, v46, v190
    v_mul_f32 v47, v47, v190
    v_mul_f32 v48, v48, v190
    v_mul_f32 v49, v49, v190
    v_mul_f32 v50, v50, v190
    v_mul_f32 v51, v51, v190
    v_mul_f32 v52, v52, v190
    v_mul_f32 v53, v53, v190
    v_mul_f32 v54, v54, v190
    v_mul_f32 v55, v55, v190
    v_mul_f32 v56, v56, v190
    v_mul_f32 v57, v57, v190
    v_mul_f32 v58, v58, v190
    v_mul_f32 v59, v59, v190
    v_mul_f32 v60, v60, v190
    v_mul_f32 v61, v61, v190
    v_mul_f32 v62, v62, v190
    v_mul_f32 v63, v63, v190
    v_mul_f32 v64, v64, v190
    v_mul_f32 v65, v65, v190
    v_mul_f32 v66, v66, v190
    v_mul_f32 v67, v67, v190
    v_mul_f32 v68, v68, v190
    v_mul_f32 v69, v69, v190
    v_mul_f32 v70, v70, v190
    v_mul_f32 v71, v71, v190
    v_mul_f32 v72, v72, v190
    v_mul_f32 v73, v73, v190
    v_mul_f32 v74, v74, v190
    v_mul_f32 v75, v75, v190
    v_mul_f32 v76, v76, v190
    v_mul_f32 v77, v77, v190
    v_mul_f32 v78, v78, v190
    v_mul_f32 v79, v79, v190
    v_mul_f32 v80, v80, v190
    v_mul_f32 v81, v81, v190
    v_mul_f32 v82, v82, v190
    v_mul_f32 v83, v83, v190
    v_mul_f32 v84, v84, v190
    v_mul_f32 v85, v85, v190
    v_mul_f32 v86, v86, v190
    v_mul_f32 v87, v87, v190
    v_mul_f32 v88, v88, v190
    v_mul_f32 v89, v89, v190
    v_mul_f32 v90, v90, v190
    v_mul_f32 v91, v91, v190
    v_mul_f32 v92, v92, v190
    v_mul_f32 v93, v93, v190
    v_mul_f32 v94, v94, v190
    v_mul_f32 v95, v95, v190
    v_mul_f32 v96, v96, v190
    v_mul_f32 v97, v97, v190
    v_mul_f32 v98, v98, v190
    v_mul_f32 v99, v99, v190
    v_mul_f32 v100, v100, v190
    v_mul_f32 v101, v101, v190
    v_mul_f32 v102, v102, v190
    v_mul_f32 v103, v103, v190
    v_mul_f32 v104, v104, v190
    v_mul_f32 v105, v105, v190
    v_mul_f32 v106, v106, v190
    v_mul_f32 v107, v107, v190
    v_mul_f32 v108, v108, v190
    v_mul_f32 v109, v109, v190
    v_mul_f32 v110, v110, v190
    v_mul_f32 v111, v111, v190
    v_mul_f32 v112, v112, v190
    v_mul_f32 v113, v113, v190
    v_mul_f32 v114, v114, v190
    v_mul_f32 v115, v115, v190
    v_mul_f32 v116, v116, v190
    v_mul_f32 v117, v117, v190
    v_mul_f32 v118, v118, v190
    v_mul_f32 v119, v119, v190
    v_mul_f32 v120, v120, v190
    v_mul_f32 v121, v121, v190
    v_mul_f32 v122, v122, v190
    v_mul_f32 v123, v123, v190
    v_mul_f32 v124, v124, v190
    v_mul_f32 v125, v125, v190
    v_mul_f32 v126, v126, v190
    v_mul_f32 v127, v127, v190
    s_branch ATT_BKp_0
ATT_RSp_1:
    v_mov_b32 v190, v189
    s_nop 15
    v_permlane32_swap_b32 v189, v190
    v_max_f32 v189, v189, v190
    v_max_f32 v189, v189, v184
    v_sub_f32 v190, v184, v189
    v_mul_f32 v190, s46, v190
    v_exp_f32 v190, v190
    v_mov_b32 v184, v189
    v_mul_f32 v185, s46, v184
    v_add_f32 v185, 0x42c80000, v185
    v_add_f32 v188, 0x445dce9e, v184
    v_mul_f32 v186, v186, v190
    v_mul_f32 v187, v187, v190
    v_mul_f32 v0, v0, v190
    v_mul_f32 v1, v1, v190
    v_mul_f32 v2, v2, v190
    v_mul_f32 v3, v3, v190
    v_mul_f32 v4, v4, v190
    v_mul_f32 v5, v5, v190
    v_mul_f32 v6, v6, v190
    v_mul_f32 v7, v7, v190
    v_mul_f32 v8, v8, v190
    v_mul_f32 v9, v9, v190
    v_mul_f32 v10, v10, v190
    v_mul_f32 v11, v11, v190
    v_mul_f32 v12, v12, v190
    v_mul_f32 v13, v13, v190
    v_mul_f32 v14, v14, v190
    v_mul_f32 v15, v15, v190
    v_mul_f32 v16, v16, v190
    v_mul_f32 v17, v17, v190
    v_mul_f32 v18, v18, v190
    v_mul_f32 v19, v19, v190
    v_mul_f32 v20, v20, v190
    v_mul_f32 v21, v21, v190
    v_mul_f32 v22, v22, v190
    v_mul_f32 v23, v23, v190
    v_mul_f32 v24, v24, v190
    v_mul_f32 v25, v25, v190
    v_mul_f32 v26, v26, v190
    v_mul_f32 v27, v27, v190
    v_mul_f32 v28, v28, v190
    v_mul_f32 v29, v29, v190
    v_mul_f32 v30, v30, v190
    v_mul_f32 v31, v31, v190
    v_mul_f32 v32, v32, v190
    v_mul_f32 v33, v33, v190
    v_mul_f32 v34, v34, v190
    v_mul_f32 v35, v35, v190
    v_mul_f32 v36, v36, v190
    v_mul_f32 v37, v37, v190
    v_mul_f32 v38, v38, v190
    v_mul_f32 v39, v39, v190
    v_mul_f32 v40, v40, v190
    v_mul_f32 v41, v41, v190
    v_mul_f32 v42, v42, v190
    v_mul_f32 v43, v43, v190
    v_mul_f32 v44, v44, v190
    v_mul_f32 v45, v45, v190
    v_mul_f32 v46, v46, v190
    v_mul_f32 v47, v47, v190
    v_mul_f32 v48, v48, v190
    v_mul_f32 v49, v49, v190
    v_mul_f32 v50, v50, v190
    v_mul_f32 v51, v51, v190
    v_mul_f32 v52, v52, v190
    v_mul_f32 v53, v53, v190
    v_mul_f32 v54, v54, v190
    v_mul_f32 v55, v55, v190
    v_mul_f32 v56, v56, v190
    v_mul_f32 v57, v57, v190
    v_mul_f32 v58, v58, v190
    v_mul_f32 v59, v59, v190
    v_mul_f32 v60, v60, v190
    v_mul_f32 v61, v61, v190
    v_mul_f32 v62, v62, v190
    v_mul_f32 v63, v63, v190
    v_mul_f32 v64, v64, v190
    v_mul_f32 v65, v65, v190
    v_mul_f32 v66, v66, v190
    v_mul_f32 v67, v67, v190
    v_mul_f32 v68, v68, v190
    v_mul_f32 v69, v69, v190
    v_mul_f32 v70, v70, v190
    v_mul_f32 v71, v71, v190
    v_mul_f32 v72, v72, v190
    v_mul_f32 v73, v73, v190
    v_mul_f32 v74, v74, v190
    v_mul_f32 v75, v75, v190
    v_mul_f32 v76, v76, v190
    v_mul_f32 v77, v77, v190
    v_mul_f32 v78, v78, v190
    v_mul_f32 v79, v79, v190
    v_mul_f32 v80, v80, v190
    v_mul_f32 v81, v81, v190
    v_mul_f32 v82, v82, v190
    v_mul_f32 v83, v83, v190
    v_mul_f32 v84, v84, v190
    v_mul_f32 v85, v85, v190
    v_mul_f32 v86, v86, v190
    v_mul_f32 v87, v87, v190
    v_mul_f32 v88, v88, v190
    v_mul_f32 v89, v89, v190
    v_mul_f32 v90, v90, v190
    v_mul_f32 v91, v91, v190
    v_mul_f32 v92, v92, v190
    v_mul_f32 v93, v93, v190
    v_mul_f32 v94, v94, v190
    v_mul_f32 v95, v95, v190
    v_mul_f32 v96, v96, v190
    v_mul_f32 v97, v97, v190
    v_mul_f32 v98, v98, v190
    v_mul_f32 v99, v99, v190
    v_mul_f32 v100, v100, v190
    v_mul_f32 v101, v101, v190
    v_mul_f32 v102, v102, v190
    v_mul_f32 v103, v103, v190
    v_mul_f32 v104, v104, v190
    v_mul_f32 v105, v105, v190
    v_mul_f32 v106, v106, v190
    v_mul_f32 v107, v107, v190
    v_mul_f32 v108, v108, v190
    v_mul_f32 v109, v109, v190
    v_mul_f32 v110, v110, v190
    v_mul_f32 v111, v111, v190
    v_mul_f32 v112, v112, v190
    v_mul_f32 v113, v113, v190
    v_mul_f32 v114, v114, v190
    v_mul_f32 v115, v115, v190
    v_mul_f32 v116, v116, v190
    v_mul_f32 v117, v117, v190
    v_mul_f32 v118, v118, v190
    v_mul_f32 v119, v119, v190
    v_mul_f32 v120, v120, v190
    v_mul_f32 v121, v121, v190
    v_mul_f32 v122, v122, v190
    v_mul_f32 v123, v123, v190
    v_mul_f32 v124, v124, v190
    v_mul_f32 v125, v125, v190
    v_mul_f32 v126, v126, v190
    v_mul_f32 v127, v127, v190
    s_branch ATT_BKp_1
ATT_RSp_2:
    v_mov_b32 v190, v189
    s_nop 15
    v_permlane32_swap_b32 v189, v190
    v_max_f32 v189, v189, v190
    v_max_f32 v189, v189, v184
    v_sub_f32 v190, v184, v189
    v_mul_f32 v190, s46, v190
    v_exp_f32 v190, v190
    v_mov_b32 v184, v189
    v_mul_f32 v185, s46, v184
    v_add_f32 v185, 0x42c80000, v185
    v_add_f32 v188, 0x445dce9e, v184
    v_mul_f32 v186, v186, v190
    v_mul_f32 v187, v187, v190
    v_mul_f32 v0, v0, v190
    v_mul_f32 v1, v1, v190
    v_mul_f32 v2, v2, v190
    v_mul_f32 v3, v3, v190
    v_mul_f32 v4, v4, v190
    v_mul_f32 v5, v5, v190
    v_mul_f32 v6, v6, v190
    v_mul_f32 v7, v7, v190
    v_mul_f32 v8, v8, v190
    v_mul_f32 v9, v9, v190
    v_mul_f32 v10, v10, v190
    v_mul_f32 v11, v11, v190
    v_mul_f32 v12, v12, v190
    v_mul_f32 v13, v13, v190
    v_mul_f32 v14, v14, v190
    v_mul_f32 v15, v15, v190
    v_mul_f32 v16, v16, v190
    v_mul_f32 v17, v17, v190
    v_mul_f32 v18, v18, v190
    v_mul_f32 v19, v19, v190
    v_mul_f32 v20, v20, v190
    v_mul_f32 v21, v21, v190
    v_mul_f32 v22, v22, v190
    v_mul_f32 v23, v23, v190
    v_mul_f32 v24, v24, v190
    v_mul_f32 v25, v25, v190
    v_mul_f32 v26, v26, v190
    v_mul_f32 v27, v27, v190
    v_mul_f32 v28, v28, v190
    v_mul_f32 v29, v29, v190
    v_mul_f32 v30, v30, v190
    v_mul_f32 v31, v31, v190
    v_mul_f32 v32, v32, v190
    v_mul_f32 v33, v33, v190
    v_mul_f32 v34, v34, v190
    v_mul_f32 v35, v35, v190
    v_mul_f32 v36, v36, v190
    v_mul_f32 v37, v37, v190
    v_mul_f32 v38, v38, v190
    v_mul_f32 v39, v39, v190
    v_mul_f32 v40, v40, v190
    v_mul_f32 v41, v41, v190
    v_mul_f32 v42, v42, v190
    v_mul_f32 v43, v43, v190
    v_mul_f32 v44, v44, v190
    v_mul_f32 v45, v45, v190
    v_mul_f32 v46, v46, v190
    v_mul_f32 v47, v47, v190
    v_mul_f32 v48, v48, v190
    v_mul_f32 v49, v49, v190
    v_mul_f32 v50, v50, v190
    v_mul_f32 v51, v51, v190
    v_mul_f32 v52, v52, v190
    v_mul_f32 v53, v53, v190
    v_mul_f32 v54, v54, v190
    v_mul_f32 v55, v55, v190
    v_mul_f32 v56, v56, v190
    v_mul_f32 v57, v57, v190
    v_mul_f32 v58, v58, v190
    v_mul_f32 v59, v59, v190
    v_mul_f32 v60, v60, v190
    v_mul_f32 v61, v61, v190
    v_mul_f32 v62, v62, v190
    v_mul_f32 v63, v63, v190
    v_mul_f32 v64, v64, v190
    v_mul_f32 v65, v65, v190
    v_mul_f32 v66, v66, v190
    v_mul_f32 v67, v67, v190
    v_mul_f32 v68, v68, v190
    v_mul_f32 v69, v69, v190
    v_mul_f32 v70, v70, v190
    v_mul_f32 v71, v71, v190
    v_mul_f32 v72, v72, v190
    v_mul_f32 v73, v73, v190
    v_mul_f32 v74, v74, v190
    v_mul_f32 v75, v75, v190
    v_mul_f32 v76, v76, v190
    v_mul_f32 v77, v77, v190
    v_mul_f32 v78, v78, v190
    v_mul_f32 v79, v79, v190
    v_mul_f32 v80, v80, v190
    v_mul_f32 v81, v81, v190
    v_mul_f32 v82, v82, v190
    v_mul_f32 v83, v83, v190
    v_mul_f32 v84, v84, v190
    v_mul_f32 v85, v85, v190
    v_mul_f32 v86, v86, v190
    v_mul_f32 v87, v87, v190
    v_mul_f32 v88, v88, v190
    v_mul_f32 v89, v89, v190
    v_mul_f32 v90, v90, v190
    v_mul_f32 v91, v91, v190
    v_mul_f32 v92, v92, v190
    v_mul_f32 v93, v93, v190
    v_mul_f32 v94, v94, v190
    v_mul_f32 v95, v95, v190
    v_mul_f32 v96, v96, v190
    v_mul_f32 v97, v97, v190
    v_mul_f32 v98, v98, v190
    v_mul_f32 v99, v99, v190
    v_mul_f32 v100, v100, v190
    v_mul_f32 v101, v101, v190
    v_mul_f32 v102, v102, v190
    v_mul_f32 v103, v103, v190
    v_mul_f32 v104, v104, v190
    v_mul_f32 v105, v105, v190
    v_mul_f32 v106, v106, v190
    v_mul_f32 v107, v107, v190
    v_mul_f32 v108, v108, v190
    v_mul_f32 v109, v109, v190
    v_mul_f32 v110, v110, v190
    v_mul_f32 v111, v111, v190
    v_mul_f32 v112, v112, v190
    v_mul_f32 v113, v113, v190
    v_mul_f32 v114, v114, v190
    v_mul_f32 v115, v115, v190
    v_mul_f32 v116, v116, v190
    v_mul_f32 v117, v117, v190
    v_mul_f32 v118, v118, v190
    v_mul_f32 v119, v119, v190
    v_mul_f32 v120, v120, v190
    v_mul_f32 v121, v121, v190
    v_mul_f32 v122, v122, v190
    v_mul_f32 v123, v123, v190
    v_mul_f32 v124, v124, v190
    v_mul_f32 v125, v125, v190
    v_mul_f32 v126, v126, v190
    v_mul_f32 v127, v127, v190
    s_branch ATT_BKp_2
ATT_RSp_3:
    v_mov_b32 v190, v189
    s_nop 15
    v_permlane32_swap_b32 v189, v190
    v_max_f32 v189, v189, v190
    v_max_f32 v189, v189, v184
    v_sub_f32 v190, v184, v189
    v_mul_f32 v190, s46, v190
    v_exp_f32 v190, v190
    v_mov_b32 v184, v189
    v_mul_f32 v185, s46, v184
    v_add_f32 v185, 0x42c80000, v185
    v_add_f32 v188, 0x445dce9e, v184
    v_mul_f32 v186, v186, v190
    v_mul_f32 v187, v187, v190
    v_mul_f32 v0, v0, v190
    v_mul_f32 v1, v1, v190
    v_mul_f32 v2, v2, v190
    v_mul_f32 v3, v3, v190
    v_mul_f32 v4, v4, v190
    v_mul_f32 v5, v5, v190
    v_mul_f32 v6, v6, v190
    v_mul_f32 v7, v7, v190
    v_mul_f32 v8, v8, v190
    v_mul_f32 v9, v9, v190
    v_mul_f32 v10, v10, v190
    v_mul_f32 v11, v11, v190
    v_mul_f32 v12, v12, v190
    v_mul_f32 v13, v13, v190
    v_mul_f32 v14, v14, v190
    v_mul_f32 v15, v15, v190
    v_mul_f32 v16, v16, v190
    v_mul_f32 v17, v17, v190
    v_mul_f32 v18, v18, v190
    v_mul_f32 v19, v19, v190
    v_mul_f32 v20, v20, v190
    v_mul_f32 v21, v21, v190
    v_mul_f32 v22, v22, v190
    v_mul_f32 v23, v23, v190
    v_mul_f32 v24, v24, v190
    v_mul_f32 v25, v25, v190
    v_mul_f32 v26, v26, v190
    v_mul_f32 v27, v27, v190
    v_mul_f32 v28, v28, v190
    v_mul_f32 v29, v29, v190
    v_mul_f32 v30, v30, v190
    v_mul_f32 v31, v31, v190
    v_mul_f32 v32, v32, v190
    v_mul_f32 v33, v33, v190
    v_mul_f32 v34, v34, v190
    v_mul_f32 v35, v35, v190
    v_mul_f32 v36, v36, v190
    v_mul_f32 v37, v37, v190
    v_mul_f32 v38, v38, v190
    v_mul_f32 v39, v39, v190
    v_mul_f32 v40, v40, v190
    v_mul_f32 v41, v41, v190
    v_mul_f32 v42, v42, v190
    v_mul_f32 v43, v43, v190
    v_mul_f32 v44, v44, v190
    v_mul_f32 v45, v45, v190
    v_mul_f32 v46, v46, v190
    v_mul_f32 v47, v47, v190
    v_mul_f32 v48, v48, v190
    v_mul_f32 v49, v49, v190
    v_mul_f32 v50, v50, v190
    v_mul_f32 v51, v51, v190
    v_mul_f32 v52, v52, v190
    v_mul_f32 v53, v53, v190
    v_mul_f32 v54, v54, v190
    v_mul_f32 v55, v55, v190
    v_mul_f32 v56, v56, v190
    v_mul_f32 v57, v57, v190
    v_mul_f32 v58, v58, v190
    v_mul_f32 v59, v59, v190
    v_mul_f32 v60, v60, v190
    v_mul_f32 v61, v61, v190
    v_mul_f32 v62, v62, v190
    v_mul_f32 v63, v63, v190
    v_mul_f32 v64, v64, v190
    v_mul_f32 v65, v65, v190
    v_mul_f32 v66, v66, v190
    v_mul_f32 v67, v67, v190
    v_mul_f32 v68, v68, v190
    v_mul_f32 v69, v69, v190
    v_mul_f32 v70, v70, v190
    v_mul_f32 v71, v71, v190
    v_mul_f32 v72, v72, v190
    v_mul_f32 v73, v73, v190
    v_mul_f32 v74, v74, v190
    v_mul_f32 v75, v75, v190
    v_mul_f32 v76, v76, v190
    v_mul_f32 v77, v77, v190
    v_mul_f32 v78, v78, v190
    v_mul_f32 v79, v79, v190
    v_mul_f32 v80, v80, v190
    v_mul_f32 v81, v81, v190
    v_mul_f32 v82, v82, v190
    v_mul_f32 v83, v83, v190
    v_mul_f32 v84, v84, v190
    v_mul_f32 v85, v85, v190
    v_mul_f32 v86, v86, v190
    v_mul_f32 v87, v87, v190
    v_mul_f32 v88, v88, v190
    v_mul_f32 v89, v89, v190
    v_mul_f32 v90, v90, v190
    v_mul_f32 v91, v91, v190
    v_mul_f32 v92, v92, v190
    v_mul_f32 v93, v93, v190
    v_mul_f32 v94, v94, v190
    v_mul_f32 v95, v95, v190
    v_mul_f32 v96, v96, v190
    v_mul_f32 v97, v97, v190
    v_mul_f32 v98, v98, v190
    v_mul_f32 v99, v99, v190
    v_mul_f32 v100, v100, v190
    v_mul_f32 v101, v101, v190
    v_mul_f32 v102, v102, v190
    v_mul_f32 v103, v103, v190
    v_mul_f32 v104, v104, v190
    v_mul_f32 v105, v105, v190
    v_mul_f32 v106, v106, v190
    v_mul_f32 v107, v107, v190
    v_mul_f32 v108, v108, v190
    v_mul_f32 v109, v109, v190
    v_mul_f32 v110, v110, v190
    v_mul_f32 v111, v111, v190
    v_mul_f32 v112, v112, v190
    v_mul_f32 v113, v113, v190
    v_mul_f32 v114, v114, v190
    v_mul_f32 v115, v115, v190
    v_mul_f32 v116, v116, v190
    v_mul_f32 v117, v117, v190
    v_mul_f32 v118, v118, v190
    v_mul_f32 v119, v119, v190
    v_mul_f32 v120, v120, v190
    v_mul_f32 v121, v121, v190
    v_mul_f32 v122, v122, v190
    v_mul_f32 v123, v123, v190
    v_mul_f32 v124, v124, v190
    v_mul_f32 v125, v125, v190
    v_mul_f32 v126, v126, v190
    v_mul_f32 v127, v127, v190
    s_branch ATT_BKp_3
ATT_RSp_4:
    v_mov_b32 v190, v189
    s_nop 15
    v_permlane32_swap_b32 v189, v190
    v_max_f32 v189, v189, v190
    v_max_f32 v189, v189, v184
    v_sub_f32 v190, v184, v189
    v_mul_f32 v190, s46, v190
    v_exp_f32 v190, v190
    v_mov_b32 v184, v189
    v_mul_f32 v185, s46, v184
    v_add_f32 v185, 0x42c80000, v185
    v_add_f32 v188, 0x445dce9e, v184
    v_mul_f32 v186, v186, v190
    v_mul_f32 v187, v187, v190
    v_mul_f32 v0, v0, v190
    v_mul_f32 v1, v1, v190
    v_mul_f32 v2, v2, v190
    v_mul_f32 v3, v3, v190
    v_mul_f32 v4, v4, v190
    v_mul_f32 v5, v5, v190
    v_mul_f32 v6, v6, v190
    v_mul_f32 v7, v7, v190
    v_mul_f32 v8, v8, v190
    v_mul_f32 v9, v9, v190
    v_mul_f32 v10, v10, v190
    v_mul_f32 v11, v11, v190
    v_mul_f32 v12, v12, v190
    v_mul_f32 v13, v13, v190
    v_mul_f32 v14, v14, v190
    v_mul_f32 v15, v15, v190
    v_mul_f32 v16, v16, v190
    v_mul_f32 v17, v17, v190
    v_mul_f32 v18, v18, v190
    v_mul_f32 v19, v19, v190
    v_mul_f32 v20, v20, v190
    v_mul_f32 v21, v21, v190
    v_mul_f32 v22, v22, v190
    v_mul_f32 v23, v23, v190
    v_mul_f32 v24, v24, v190
    v_mul_f32 v25, v25, v190
    v_mul_f32 v26, v26, v190
    v_mul_f32 v27, v27, v190
    v_mul_f32 v28, v28, v190
    v_mul_f32 v29, v29, v190
    v_mul_f32 v30, v30, v190
    v_mul_f32 v31, v31, v190
    v_mul_f32 v32, v32, v190
    v_mul_f32 v33, v33, v190
    v_mul_f32 v34, v34, v190
    v_mul_f32 v35, v35, v190
    v_mul_f32 v36, v36, v190
    v_mul_f32 v37, v37, v190
    v_mul_f32 v38, v38, v190
    v_mul_f32 v39, v39, v190
    v_mul_f32 v40, v40, v190
    v_mul_f32 v41, v41, v190
    v_mul_f32 v42, v42, v190
    v_mul_f32 v43, v43, v190
    v_mul_f32 v44, v44, v190
    v_mul_f32 v45, v45, v190
    v_mul_f32 v46, v46, v190
    v_mul_f32 v47, v47, v190
    v_mul_f32 v48, v48, v190
    v_mul_f32 v49, v49, v190
    v_mul_f32 v50, v50, v190
    v_mul_f32 v51, v51, v190
    v_mul_f32 v52, v52, v190
    v_mul_f32 v53, v53, v190
    v_mul_f32 v54, v54, v190
    v_mul_f32 v55, v55, v190
    v_mul_f32 v56, v56, v190
    v_mul_f32 v57, v57, v190
    v_mul_f32 v58, v58, v190
    v_mul_f32 v59, v59, v190
    v_mul_f32 v60, v60, v190
    v_mul_f32 v61, v61, v190
    v_mul_f32 v62, v62, v190
    v_mul_f32 v63, v63, v190
    v_mul_f32 v64, v64, v190
    v_mul_f32 v65, v65, v190
    v_mul_f32 v66, v66, v190
    v_mul_f32 v67, v67, v190
    v_mul_f32 v68, v68, v190
    v_mul_f32 v69, v69, v190
    v_mul_f32 v70, v70, v190
    v_mul_f32 v71, v71, v190
    v_mul_f32 v72, v72, v190
    v_mul_f32 v73, v73, v190
    v_mul_f32 v74, v74, v190
    v_mul_f32 v75, v75, v190
    v_mul_f32 v76, v76, v190
    v_mul_f32 v77, v77, v190
    v_mul_f32 v78, v78, v190
    v_mul_f32 v79, v79, v190
    v_mul_f32 v80, v80, v190
    v_mul_f32 v81, v81, v190
    v_mul_f32 v82, v82, v190
    v_mul_f32 v83, v83, v190
    v_mul_f32 v84, v84, v190
    v_mul_f32 v85, v85, v190
    v_mul_f32 v86, v86, v190
    v_mul_f32 v87, v87, v190
    v_mul_f32 v88, v88, v190
    v_mul_f32 v89, v89, v190
    v_mul_f32 v90, v90, v190
    v_mul_f32 v91, v91, v190
    v_mul_f32 v92, v92, v190
    v_mul_f32 v93, v93, v190
    v_mul_f32 v94, v94, v190
    v_mul_f32 v95, v95, v190
    v_mul_f32 v96, v96, v190
    v_mul_f32 v97, v97, v190
    v_mul_f32 v98, v98, v190
    v_mul_f32 v99, v99, v190
    v_mul_f32 v100, v100, v190
    v_mul_f32 v101, v101, v190
    v_mul_f32 v102, v102, v190
    v_mul_f32 v103, v103, v190
    v_mul_f32 v104, v104, v190
    v_mul_f32 v105, v105, v190
    v_mul_f32 v106, v106, v190
    v_mul_f32 v107, v107, v190
    v_mul_f32 v108, v108, v190
    v_mul_f32 v109, v109, v190
    v_mul_f32 v110, v110, v190
    v_mul_f32 v111, v111, v190
    v_mul_f32 v112, v112, v190
    v_mul_f32 v113, v113, v190
    v_mul_f32 v114, v114, v190
    v_mul_f32 v115, v115, v190
    v_mul_f32 v116, v116, v190
    v_mul_f32 v117, v117, v190
    v_mul_f32 v118, v118, v190
    v_mul_f32 v119, v119, v190
    v_mul_f32 v120, v120, v190
    v_mul_f32 v121, v121, v190
    v_mul_f32 v122, v122, v190
    v_mul_f32 v123, v123, v190
    v_mul_f32 v124, v124, v190
    v_mul_f32 v125, v125, v190
    v_mul_f32 v126, v126, v190
    v_mul_f32 v127, v127, v190
    s_branch ATT_BKp_4
ATT_RSp_5:
    v_mov_b32 v190, v189
    s_nop 15
    v_permlane32_swap_b32 v189, v190
    v_max_f32 v189, v189, v190
    v_max_f32 v189, v189, v184
    v_sub_f32 v190, v184, v189
    v_mul_f32 v190, s46, v190
    v_exp_f32 v190, v190
    v_mov_b32 v184, v189
    v_mul_f32 v185, s46, v184
    v_add_f32 v185, 0x42c80000, v185
    v_add_f32 v188, 0x445dce9e, v184
    v_mul_f32 v186, v186, v190
    v_mul_f32 v187, v187, v190
    v_mul_f32 v0, v0, v190
    v_mul_f32 v1, v1, v190
    v_mul_f32 v2, v2, v190
    v_mul_f32 v3, v3, v190
    v_mul_f32 v4, v4, v190
    v_mul_f32 v5, v5, v190
    v_mul_f32 v6, v6, v190
    v_mul_f32 v7, v7, v190
    v_mul_f32 v8, v8, v190
    v_mul_f32 v9, v9, v190
    v_mul_f32 v10, v10, v190
    v_mul_f32 v11, v11, v190
    v_mul_f32 v12, v12, v190
    v_mul_f32 v13, v13, v190
    v_mul_f32 v14, v14, v190
    v_mul_f32 v15, v15, v190
    v_mul_f32 v16, v16, v190
    v_mul_f32 v17, v17, v190
    v_mul_f32 v18, v18, v190
    v_mul_f32 v19, v19, v190
    v_mul_f32 v20, v20, v190
    v_mul_f32 v21, v21, v190
    v_mul_f32 v22, v22, v190
    v_mul_f32 v23, v23, v190
    v_mul_f32 v24, v24, v190
    v_mul_f32 v25, v25, v190
    v_mul_f32 v26, v26, v190
    v_mul_f32 v27, v27, v190
    v_mul_f32 v28, v28, v190
    v_mul_f32 v29, v29, v190
    v_mul_f32 v30, v30, v190
    v_mul_f32 v31, v31, v190
    v_mul_f32 v32, v32, v190
    v_mul_f32 v33, v33, v190
    v_mul_f32 v34, v34, v190
    v_mul_f32 v35, v35, v190
    v_mul_f32 v36, v36, v190
    v_mul_f32 v37, v37, v190
    v_mul_f32 v38, v38, v190
    v_mul_f32 v39, v39, v190
    v_mul_f32 v40, v40, v190
    v_mul_f32 v41, v41, v190
    v_mul_f32 v42, v42, v190
    v_mul_f32 v43, v43, v190
    v_mul_f32 v44, v44, v190
    v_mul_f32 v45, v45, v190
    v_mul_f32 v46, v46, v190
    v_mul_f32 v47, v47, v190
    v_mul_f32 v48, v48, v190
    v_mul_f32 v49, v49, v190
    v_mul_f32 v50, v50, v190
    v_mul_f32 v51, v51, v190
    v_mul_f32 v52, v52, v190
    v_mul_f32 v53, v53, v190
    v_mul_f32 v54, v54, v190
    v_mul_f32 v55, v55, v190
    v_mul_f32 v56, v56, v190
    v_mul_f32 v57, v57, v190
    v_mul_f32 v58, v58, v190
    v_mul_f32 v59, v59, v190
    v_mul_f32 v60, v60, v190
    v_mul_f32 v61, v61, v190
    v_mul_f32 v62, v62, v190
    v_mul_f32 v63, v63, v190
    v_mul_f32 v64, v64, v190
    v_mul_f32 v65, v65, v190
    v_mul_f32 v66, v66, v190
    v_mul_f32 v67, v67, v190
    v_mul_f32 v68, v68, v190
    v_mul_f32 v69, v69, v190
    v_mul_f32 v70, v70, v190
    v_mul_f32 v71, v71, v190
    v_mul_f32 v72, v72, v190
    v_mul_f32 v73, v73, v190
    v_mul_f32 v74, v74, v190
    v_mul_f32 v75, v75, v190
    v_mul_f32 v76, v76, v190
    v_mul_f32 v77, v77, v190
    v_mul_f32 v78, v78, v190
    v_mul_f32 v79, v79, v190
    v_mul_f32 v80, v80, v190
    v_mul_f32 v81, v81, v190
    v_mul_f32 v82, v82, v190
    v_mul_f32 v83, v83, v190
    v_mul_f32 v84, v84, v190
    v_mul_f32 v85, v85, v190
    v_mul_f32 v86, v86, v190
    v_mul_f32 v87, v87, v190
    v_mul_f32 v88, v88, v190
    v_mul_f32 v89, v89, v190
    v_mul_f32 v90, v90, v190
    v_mul_f32 v91, v91, v190
    v_mul_f32 v92, v92, v190
    v_mul_f32 v93, v93, v190
    v_mul_f32 v94, v94, v190
    v_mul_f32 v95, v95, v190
    v_mul_f32 v96, v96, v190
    v_mul_f32 v97, v97, v190
    v_mul_f32 v98, v98, v190
    v_mul_f32 v99, v99, v190
    v_mul_f32 v100, v100, v190
    v_mul_f32 v101, v101, v190
    v_mul_f32 v102, v102, v190
    v_mul_f32 v103, v103, v190
    v_mul_f32 v104, v104, v190
    v_mul_f32 v105, v105, v190
    v_mul_f32 v106, v106, v190
    v_mul_f32 v107, v107, v190
    v_mul_f32 v108, v108, v190
    v_mul_f32 v109, v109, v190
    v_mul_f32 v110, v110, v190
    v_mul_f32 v111, v111, v190
    v_mul_f32 v112, v112, v190
    v_mul_f32 v113, v113, v190
    v_mul_f32 v114, v114, v190
    v_mul_f32 v115, v115, v190
    v_mul_f32 v116, v116, v190
    v_mul_f32 v117, v117, v190
    v_mul_f32 v118, v118, v190
    v_mul_f32 v119, v119, v190
    v_mul_f32 v120, v120, v190
    v_mul_f32 v121, v121, v190
    v_mul_f32 v122, v122, v190
    v_mul_f32 v123, v123, v190
    v_mul_f32 v124, v124, v190
    v_mul_f32 v125, v125, v190
    v_mul_f32 v126, v126, v190
    v_mul_f32 v127, v127, v190
    s_branch ATT_BKp_5
ATT_RSp_6:
    v_mov_b32 v190, v189
    s_nop 15
    v_permlane32_swap_b32 v189, v190
    v_max_f32 v189, v189, v190
    v_max_f32 v189, v189, v184
    v_sub_f32 v190, v184, v189
    v_mul_f32 v190, s46, v190
    v_exp_f32 v190, v190
    v_mov_b32 v184, v189
    v_mul_f32 v185, s46, v184
    v_add_f32 v185, 0x42c80000, v185
    v_add_f32 v188, 0x445dce9e, v184
    v_mul_f32 v186, v186, v190
    v_mul_f32 v187, v187, v190
    v_mul_f32 v0, v0, v190
    v_mul_f32 v1, v1, v190
    v_mul_f32 v2, v2, v190
    v_mul_f32 v3, v3, v190
    v_mul_f32 v4, v4, v190
    v_mul_f32 v5, v5, v190
    v_mul_f32 v6, v6, v190
    v_mul_f32 v7, v7, v190
    v_mul_f32 v8, v8, v190
    v_mul_f32 v9, v9, v190
    v_mul_f32 v10, v10, v190
    v_mul_f32 v11, v11, v190
    v_mul_f32 v12, v12, v190
    v_mul_f32 v13, v13, v190
    v_mul_f32 v14, v14, v190
    v_mul_f32 v15, v15, v190
    v_mul_f32 v16, v16, v190
    v_mul_f32 v17, v17, v190
    v_mul_f32 v18, v18, v190
    v_mul_f32 v19, v19, v190
    v_mul_f32 v20, v20, v190
    v_mul_f32 v21, v21, v190
    v_mul_f32 v22, v22, v190
    v_mul_f32 v23, v23, v190
    v_mul_f32 v24, v24, v190
    v_mul_f32 v25, v25, v190
    v_mul_f32 v26, v26, v190
    v_mul_f32 v27, v27, v190
    v_mul_f32 v28, v28, v190
    v_mul_f32 v29, v29, v190
    v_mul_f32 v30, v30, v190
    v_mul_f32 v31, v31, v190
    v_mul_f32 v32, v32, v190
    v_mul_f32 v33, v33, v190
    v_mul_f32 v34, v34, v190
    v_mul_f32 v35, v35, v190
    v_mul_f32 v36, v36, v190
    v_mul_f32 v37, v37, v190
    v_mul_f32 v38, v38, v190
    v_mul_f32 v39, v39, v190
    v_mul_f32 v40, v40, v190
    v_mul_f32 v41, v41, v190
    v_mul_f32 v42, v42, v190
    v_mul_f32 v43, v43, v190
    v_mul_f32 v44, v44, v190
    v_mul_f32 v45, v45, v190
    v_mul_f32 v46, v46, v190
    v_mul_f32 v47, v47, v190
    v_mul_f32 v48, v48, v190
    v_mul_f32 v49, v49, v190
    v_mul_f32 v50, v50, v190
    v_mul_f32 v51, v51, v190
    v_mul_f32 v52, v52, v190
    v_mul_f32 v53, v53, v190
    v_mul_f32 v54, v54, v190
    v_mul_f32 v55, v55, v190
    v_mul_f32 v56, v56, v190
    v_mul_f32 v57, v57, v190
    v_mul_f32 v58, v58, v190
    v_mul_f32 v59, v59, v190
    v_mul_f32 v60, v60, v190
    v_mul_f32 v61, v61, v190
    v_mul_f32 v62, v62, v190
    v_mul_f32 v63, v63, v190
    v_mul_f32 v64, v64, v190
    v_mul_f32 v65, v65, v190
    v_mul_f32 v66, v66, v190
    v_mul_f32 v67, v67, v190
    v_mul_f32 v68, v68, v190
    v_mul_f32 v69, v69, v190
    v_mul_f32 v70, v70, v190
    v_mul_f32 v71, v71, v190
    v_mul_f32 v72, v72, v190
    v_mul_f32 v73, v73, v190
    v_mul_f32 v74, v74, v190
    v_mul_f32 v75, v75, v190
    v_mul_f32 v76, v76, v190
    v_mul_f32 v77, v77, v190
    v_mul_f32 v78, v78, v190
    v_mul_f32 v79, v79, v190
    v_mul_f32 v80, v80, v190
    v_mul_f32 v81, v81, v190
    v_mul_f32 v82, v82, v190
    v_mul_f32 v83, v83, v190
    v_mul_f32 v84, v84, v190
    v_mul_f32 v85, v85, v190
    v_mul_f32 v86, v86, v190
    v_mul_f32 v87, v87, v190
    v_mul_f32 v88, v88, v190
    v_mul_f32 v89, v89, v190
    v_mul_f32 v90, v90, v190
    v_mul_f32 v91, v91, v190
    v_mul_f32 v92, v92, v190
    v_mul_f32 v93, v93, v190
    v_mul_f32 v94, v94, v190
    v_mul_f32 v95, v95, v190
    v_mul_f32 v96, v96, v190
    v_mul_f32 v97, v97, v190
    v_mul_f32 v98, v98, v190
    v_mul_f32 v99, v99, v190
    v_mul_f32 v100, v100, v190
    v_mul_f32 v101, v101, v190
    v_mul_f32 v102, v102, v190
    v_mul_f32 v103, v103, v190
    v_mul_f32 v104, v104, v190
    v_mul_f32 v105, v105, v190
    v_mul_f32 v106, v106, v190
    v_mul_f32 v107, v107, v190
    v_mul_f32 v108, v108, v190
    v_mul_f32 v109, v109, v190
    v_mul_f32 v110, v110, v190
    v_mul_f32 v111, v111, v190
    v_mul_f32 v112, v112, v190
    v_mul_f32 v113, v113, v190
    v_mul_f32 v114, v114, v190
    v_mul_f32 v115, v115, v190
    v_mul_f32 v116, v116, v190
    v_mul_f32 v117, v117, v190
    v_mul_f32 v118, v118, v190
    v_mul_f32 v119, v119, v190
    v_mul_f32 v120, v120, v190
    v_mul_f32 v121, v121, v190
    v_mul_f32 v122, v122, v190
    v_mul_f32 v123, v123, v190
    v_mul_f32 v124, v124, v190
    v_mul_f32 v125, v125, v190
    v_mul_f32 v126, v126, v190
    v_mul_f32 v127, v127, v190
    s_branch ATT_BKp_6
ATT_RSp_7:
    v_mov_b32 v190, v189
    s_nop 15
    v_permlane32_swap_b32 v189, v190
    v_max_f32 v189, v189, v190
    v_max_f32 v189, v189, v184
    v_sub_f32 v190, v184, v189
    v_mul_f32 v190, s46, v190
    v_exp_f32 v190, v190
    v_mov_b32 v184, v189
    v_mul_f32 v185, s46, v184
    v_add_f32 v185, 0x42c80000, v185
    v_add_f32 v188, 0x445dce9e, v184
    v_mul_f32 v186, v186, v190
    v_mul_f32 v187, v187, v190
    v_mul_f32 v0, v0, v190
    v_mul_f32 v1, v1, v190
    v_mul_f32 v2, v2, v190
    v_mul_f32 v3, v3, v190
    v_mul_f32 v4, v4, v190
    v_mul_f32 v5, v5, v190
    v_mul_f32 v6, v6, v190
    v_mul_f32 v7, v7, v190
    v_mul_f32 v8, v8, v190
    v_mul_f32 v9, v9, v190
    v_mul_f32 v10, v10, v190
    v_mul_f32 v11, v11, v190
    v_mul_f32 v12, v12, v190
    v_mul_f32 v13, v13, v190
    v_mul_f32 v14, v14, v190
    v_mul_f32 v15, v15, v190
    v_mul_f32 v16, v16, v190
    v_mul_f32 v17, v17, v190
    v_mul_f32 v18, v18, v190
    v_mul_f32 v19, v19, v190
    v_mul_f32 v20, v20, v190
    v_mul_f32 v21, v21, v190
    v_mul_f32 v22, v22, v190
    v_mul_f32 v23, v23, v190
    v_mul_f32 v24, v24, v190
    v_mul_f32 v25, v25, v190
    v_mul_f32 v26, v26, v190
    v_mul_f32 v27, v27, v190
    v_mul_f32 v28, v28, v190
    v_mul_f32 v29, v29, v190
    v_mul_f32 v30, v30, v190
    v_mul_f32 v31, v31, v190
    v_mul_f32 v32, v32, v190
    v_mul_f32 v33, v33, v190
    v_mul_f32 v34, v34, v190
    v_mul_f32 v35, v35, v190
    v_mul_f32 v36, v36, v190
    v_mul_f32 v37, v37, v190
    v_mul_f32 v38, v38, v190
    v_mul_f32 v39, v39, v190
    v_mul_f32 v40, v40, v190
    v_mul_f32 v41, v41, v190
    v_mul_f32 v42, v42, v190
    v_mul_f32 v43, v43, v190
    v_mul_f32 v44, v44, v190
    v_mul_f32 v45, v45, v190
    v_mul_f32 v46, v46, v190
    v_mul_f32 v47, v47, v190
    v_mul_f32 v48, v48, v190
    v_mul_f32 v49, v49, v190
    v_mul_f32 v50, v50, v190
    v_mul_f32 v51, v51, v190
    v_mul_f32 v52, v52, v190
    v_mul_f32 v53, v53, v190
    v_mul_f32 v54, v54, v190
    v_mul_f32 v55, v55, v190
    v_mul_f32 v56, v56, v190
    v_mul_f32 v57, v57, v190
    v_mul_f32 v58, v58, v190
    v_mul_f32 v59, v59, v190
    v_mul_f32 v60, v60, v190
    v_mul_f32 v61, v61, v190
    v_mul_f32 v62, v62, v190
    v_mul_f32 v63, v63, v190
    v_mul_f32 v64, v64, v190
    v_mul_f32 v65, v65, v190
    v_mul_f32 v66, v66, v190
    v_mul_f32 v67, v67, v190
    v_mul_f32 v68, v68, v190
    v_mul_f32 v69, v69, v190
    v_mul_f32 v70, v70, v190
    v_mul_f32 v71, v71, v190
    v_mul_f32 v72, v72, v190
    v_mul_f32 v73, v73, v190
    v_mul_f32 v74, v74, v190
    v_mul_f32 v75, v75, v190
    v_mul_f32 v76, v76, v190
    v_mul_f32 v77, v77, v190
    v_mul_f32 v78, v78, v190
    v_mul_f32 v79, v79, v190
    v_mul_f32 v80, v80, v190
    v_mul_f32 v81, v81, v190
    v_mul_f32 v82, v82, v190
    v_mul_f32 v83, v83, v190
    v_mul_f32 v84, v84, v190
    v_mul_f32 v85, v85, v190
    v_mul_f32 v86, v86, v190
    v_mul_f32 v87, v87, v190
    v_mul_f32 v88, v88, v190
    v_mul_f32 v89, v89, v190
    v_mul_f32 v90, v90, v190
    v_mul_f32 v91, v91, v190
    v_mul_f32 v92, v92, v190
    v_mul_f32 v93, v93, v190
    v_mul_f32 v94, v94, v190
    v_mul_f32 v95, v95, v190
    v_mul_f32 v96, v96, v190
    v_mul_f32 v97, v97, v190
    v_mul_f32 v98, v98, v190
    v_mul_f32 v99, v99, v190
    v_mul_f32 v100, v100, v190
    v_mul_f32 v101, v101, v190
    v_mul_f32 v102, v102, v190
    v_mul_f32 v103, v103, v190
    v_mul_f32 v104, v104, v190
    v_mul_f32 v105, v105, v190
    v_mul_f32 v106, v106, v190
    v_mul_f32 v107, v107, v190
    v_mul_f32 v108, v108, v190
    v_mul_f32 v109, v109, v190
    v_mul_f32 v110, v110, v190
    v_mul_f32 v111, v111, v190
    v_mul_f32 v112, v112, v190
    v_mul_f32 v113, v113, v190
    v_mul_f32 v114, v114, v190
    v_mul_f32 v115, v115, v190
    v_mul_f32 v116, v116, v190
    v_mul_f32 v117, v117, v190
    v_mul_f32 v118, v118, v190
    v_mul_f32 v119, v119, v190
    v_mul_f32 v120, v120, v190
    v_mul_f32 v121, v121, v190
    v_mul_f32 v122, v122, v190
    v_mul_f32 v123, v123, v190
    v_mul_f32 v124, v124, v190
    v_mul_f32 v125, v125, v190
    v_mul_f32 v126, v126, v190
    v_mul_f32 v127, v127, v190
    s_branch ATT_BKp_7
ATT_RSp_8:
    v_mov_b32 v190, v189
    s_nop 15
    v_permlane32_swap_b32 v189, v190
    v_max_f32 v189, v189, v190
    v_max_f32 v189, v189, v184
    v_sub_f32 v190, v184, v189
    v_mul_f32 v190, s46, v190
    v_exp_f32 v190, v190
    v_mov_b32 v184, v189
    v_mul_f32 v185, s46, v184
    v_add_f32 v185, 0x42c80000, v185
    v_add_f32 v188, 0x445dce9e, v184
    v_mul_f32 v186, v186, v190
    v_mul_f32 v187, v187, v190
    v_mul_f32 v0, v0, v190
    v_mul_f32 v1, v1, v190
    v_mul_f32 v2, v2, v190
    v_mul_f32 v3, v3, v190
    v_mul_f32 v4, v4, v190
    v_mul_f32 v5, v5, v190
    v_mul_f32 v6, v6, v190
    v_mul_f32 v7, v7, v190
    v_mul_f32 v8, v8, v190
    v_mul_f32 v9, v9, v190
    v_mul_f32 v10, v10, v190
    v_mul_f32 v11, v11, v190
    v_mul_f32 v12, v12, v190
    v_mul_f32 v13, v13, v190
    v_mul_f32 v14, v14, v190
    v_mul_f32 v15, v15, v190
    v_mul_f32 v16, v16, v190
    v_mul_f32 v17, v17, v190
    v_mul_f32 v18, v18, v190
    v_mul_f32 v19, v19, v190
    v_mul_f32 v20, v20, v190
    v_mul_f32 v21, v21, v190
    v_mul_f32 v22, v22, v190
    v_mul_f32 v23, v23, v190
    v_mul_f32 v24, v24, v190
    v_mul_f32 v25, v25, v190
    v_mul_f32 v26, v26, v190
    v_mul_f32 v27, v27, v190
    v_mul_f32 v28, v28, v190
    v_mul_f32 v29, v29, v190
    v_mul_f32 v30, v30, v190
    v_mul_f32 v31, v31, v190
    v_mul_f32 v32, v32, v190
    v_mul_f32 v33, v33, v190
    v_mul_f32 v34, v34, v190
    v_mul_f32 v35, v35, v190
    v_mul_f32 v36, v36, v190
    v_mul_f32 v37, v37, v190
    v_mul_f32 v38, v38, v190
    v_mul_f32 v39, v39, v190
    v_mul_f32 v40, v40, v190
    v_mul_f32 v41, v41, v190
    v_mul_f32 v42, v42, v190
    v_mul_f32 v43, v43, v190
    v_mul_f32 v44, v44, v190
    v_mul_f32 v45, v45, v190
    v_mul_f32 v46, v46, v190
    v_mul_f32 v47, v47, v190
    v_mul_f32 v48, v48, v190
    v_mul_f32 v49, v49, v190
    v_mul_f32 v50, v50, v190
    v_mul_f32 v51, v51, v190
    v_mul_f32 v52, v52, v190
    v_mul_f32 v53, v53, v190
    v_mul_f32 v54, v54, v190
    v_mul_f32 v55, v55, v190
    v_mul_f32 v56, v56, v190
    v_mul_f32 v57, v57, v190
    v_mul_f32 v58, v58, v190
    v_mul_f32 v59, v59, v190
    v_mul_f32 v60, v60, v190
    v_mul_f32 v61, v61, v190
    v_mul_f32 v62, v62, v190
    v_mul_f32 v63, v63, v190
    v_mul_f32 v64, v64, v190
    v_mul_f32 v65, v65, v190
    v_mul_f32 v66, v66, v190
    v_mul_f32 v67, v67, v190
    v_mul_f32 v68, v68, v190
    v_mul_f32 v69, v69, v190
    v_mul_f32 v70, v70, v190
    v_mul_f32 v71, v71, v190
    v_mul_f32 v72, v72, v190
    v_mul_f32 v73, v73, v190
    v_mul_f32 v74, v74, v190
    v_mul_f32 v75, v75, v190
    v_mul_f32 v76, v76, v190
    v_mul_f32 v77, v77, v190
    v_mul_f32 v78, v78, v190
    v_mul_f32 v79, v79, v190
    v_mul_f32 v80, v80, v190
    v_mul_f32 v81, v81, v190
    v_mul_f32 v82, v82, v190
    v_mul_f32 v83, v83, v190
    v_mul_f32 v84, v84, v190
    v_mul_f32 v85, v85, v190
    v_mul_f32 v86, v86, v190
    v_mul_f32 v87, v87, v190
    v_mul_f32 v88, v88, v190
    v_mul_f32 v89, v89, v190
    v_mul_f32 v90, v90, v190
    v_mul_f32 v91, v91, v190
    v_mul_f32 v92, v92, v190
    v_mul_f32 v93, v93, v190
    v_mul_f32 v94, v94, v190
    v_mul_f32 v95, v95, v190
    v_mul_f32 v96, v96, v190
    v_mul_f32 v97, v97, v190
    v_mul_f32 v98, v98, v190
    v_mul_f32 v99, v99, v190
    v_mul_f32 v100, v100, v190
    v_mul_f32 v101, v101, v190
    v_mul_f32 v102, v102, v190
    v_mul_f32 v103, v103, v190
    v_mul_f32 v104, v104, v190
    v_mul_f32 v105, v105, v190
    v_mul_f32 v106, v106, v190
    v_mul_f32 v107, v107, v190
    v_mul_f32 v108, v108, v190
    v_mul_f32 v109, v109, v190
    v_mul_f32 v110, v110, v190
    v_mul_f32 v111, v111, v190
    v_mul_f32 v112, v112, v190
    v_mul_f32 v113, v113, v190
    v_mul_f32 v114, v114, v190
    v_mul_f32 v115, v115, v190
    v_mul_f32 v116, v116, v190
    v_mul_f32 v117, v117, v190
    v_mul_f32 v118, v118, v190
    v_mul_f32 v119, v119, v190
    v_mul_f32 v120, v120, v190
    v_mul_f32 v121, v121, v190
    v_mul_f32 v122, v122, v190
    v_mul_f32 v123, v123, v190
    v_mul_f32 v124, v124, v190
    v_mul_f32 v125, v125, v190
    v_mul_f32 v126, v126, v190
    v_mul_f32 v127, v127, v190
    s_branch ATT_BKp_8
ATT_RSp_9:
    v_mov_b32 v190, v189
    s_nop 15
    v_permlane32_swap_b32 v189, v190
    v_max_f32 v189, v189, v190
    v_max_f32 v189, v189, v184
    v_sub_f32 v190, v184, v189
    v_mul_f32 v190, s46, v190
    v_exp_f32 v190, v190
    v_mov_b32 v184, v189
    v_mul_f32 v185, s46, v184
    v_add_f32 v185, 0x42c80000, v185
    v_add_f32 v188, 0x445dce9e, v184
    v_mul_f32 v186, v186, v190
    v_mul_f32 v187, v187, v190
    v_mul_f32 v0, v0, v190
    v_mul_f32 v1, v1, v190
    v_mul_f32 v2, v2, v190
    v_mul_f32 v3, v3, v190
    v_mul_f32 v4, v4, v190
    v_mul_f32 v5, v5, v190
    v_mul_f32 v6, v6, v190
    v_mul_f32 v7, v7, v190
    v_mul_f32 v8, v8, v190
    v_mul_f32 v9, v9, v190
    v_mul_f32 v10, v10, v190
    v_mul_f32 v11, v11, v190
    v_mul_f32 v12, v12, v190
    v_mul_f32 v13, v13, v190
    v_mul_f32 v14, v14, v190
    v_mul_f32 v15, v15, v190
    v_mul_f32 v16, v16, v190
    v_mul_f32 v17, v17, v190
    v_mul_f32 v18, v18, v190
    v_mul_f32 v19, v19, v190
    v_mul_f32 v20, v20, v190
    v_mul_f32 v21, v21, v190
    v_mul_f32 v22, v22, v190
    v_mul_f32 v23, v23, v190
    v_mul_f32 v24, v24, v190
    v_mul_f32 v25, v25, v190
    v_mul_f32 v26, v26, v190
    v_mul_f32 v27, v27, v190
    v_mul_f32 v28, v28, v190
    v_mul_f32 v29, v29, v190
    v_mul_f32 v30, v30, v190
    v_mul_f32 v31, v31, v190
    v_mul_f32 v32, v32, v190
    v_mul_f32 v33, v33, v190
    v_mul_f32 v34, v34, v190
    v_mul_f32 v35, v35, v190
    v_mul_f32 v36, v36, v190
    v_mul_f32 v37, v37, v190
    v_mul_f32 v38, v38, v190
    v_mul_f32 v39, v39, v190
    v_mul_f32 v40, v40, v190
    v_mul_f32 v41, v41, v190
    v_mul_f32 v42, v42, v190
    v_mul_f32 v43, v43, v190
    v_mul_f32 v44, v44, v190
    v_mul_f32 v45, v45, v190
    v_mul_f32 v46, v46, v190
    v_mul_f32 v47, v47, v190
    v_mul_f32 v48, v48, v190
    v_mul_f32 v49, v49, v190
    v_mul_f32 v50, v50, v190
    v_mul_f32 v51, v51, v190
    v_mul_f32 v52, v52, v190
    v_mul_f32 v53, v53, v190
    v_mul_f32 v54, v54, v190
    v_mul_f32 v55, v55, v190
    v_mul_f32 v56, v56, v190
    v_mul_f32 v57, v57, v190
    v_mul_f32 v58, v58, v190
    v_mul_f32 v59, v59, v190
    v_mul_f32 v60, v60, v190
    v_mul_f32 v61, v61, v190
    v_mul_f32 v62, v62, v190
    v_mul_f32 v63, v63, v190
    v_mul_f32 v64, v64, v190
    v_mul_f32 v65, v65, v190
    v_mul_f32 v66, v66, v190
    v_mul_f32 v67, v67, v190
    v_mul_f32 v68, v68, v190
    v_mul_f32 v69, v69, v190
    v_mul_f32 v70, v70, v190
    v_mul_f32 v71, v71, v190
    v_mul_f32 v72, v72, v190
    v_mul_f32 v73, v73, v190
    v_mul_f32 v74, v74, v190
    v_mul_f32 v75, v75, v190
    v_mul_f32 v76, v76, v190
    v_mul_f32 v77, v77, v190
    v_mul_f32 v78, v78, v190
    v_mul_f32 v79, v79, v190
    v_mul_f32 v80, v80, v190
    v_mul_f32 v81, v81, v190
    v_mul_f32 v82, v82, v190
    v_mul_f32 v83, v83, v190
    v_mul_f32 v84, v84, v190
    v_mul_f32 v85, v85, v190
    v_mul_f32 v86, v86, v190
    v_mul_f32 v87, v87, v190
    v_mul_f32 v88, v88, v190
    v_mul_f32 v89, v89, v190
    v_mul_f32 v90, v90, v190
    v_mul_f32 v91, v91, v190
    v_mul_f32 v92, v92, v190
    v_mul_f32 v93, v93, v190
    v_mul_f32 v94, v94, v190
    v_mul_f32 v95, v95, v190
    v_mul_f32 v96, v96, v190
    v_mul_f32 v97, v97, v190
    v_mul_f32 v98, v98, v190
    v_mul_f32 v99, v99, v190
    v_mul_f32 v100, v100, v190
    v_mul_f32 v101, v101, v190
    v_mul_f32 v102, v102, v190
    v_mul_f32 v103, v103, v190
    v_mul_f32 v104, v104, v190
    v_mul_f32 v105, v105, v190
    v_mul_f32 v106, v106, v190
    v_mul_f32 v107, v107, v190
    v_mul_f32 v108, v108, v190
    v_mul_f32 v109, v109, v190
    v_mul_f32 v110, v110, v190
    v_mul_f32 v111, v111, v190
    v_mul_f32 v112, v112, v190
    v_mul_f32 v113, v113, v190
    v_mul_f32 v114, v114, v190
    v_mul_f32 v115, v115, v190
    v_mul_f32 v116, v116, v190
    v_mul_f32 v117, v117, v190
    v_mul_f32 v118, v118, v190
    v_mul_f32 v119, v119, v190
    v_mul_f32 v120, v120, v190
    v_mul_f32 v121, v121, v190
    v_mul_f32 v122, v122, v190
    v_mul_f32 v123, v123, v190
    v_mul_f32 v124, v124, v190
    v_mul_f32 v125, v125, v190
    v_mul_f32 v126, v126, v190
    v_mul_f32 v127, v127, v190
    s_branch ATT_BKp_9
ATT_RSh_0:
    v_mov_b32 v190, v189
    s_nop 15
    v_permlane32_swap_b32 v189, v190
    v_max_f32 v189, v189, v190
    v_max_f32 v189, v189, v184
    v_sub_f32 v190, v184, v189
    v_mul_f32 v190, s46, v190
    v_exp_f32 v190, v190
    v_mov_b32 v184, v189
    v_mul_f32 v185, s46, v184
    v_add_f32 v185, 0x42c80000, v185
    v_add_f32 v188, 0x445dce9e, v184
    v_mul_f32 v186, v186, v190
    v_mul_f32 v187, v187, v190
    v_mul_f32 v0, v0, v190
    v_mul_f32 v1, v1, v190
    v_mul_f32 v2, v2, v190
    v_mul_f32 v3, v3, v190
    v_mul_f32 v4, v4, v190
    v_mul_f32 v5, v5, v190
    v_mul_f32 v6, v6, v190
    v_mul_f32 v7, v7, v190
    v_mul_f32 v8, v8, v190
    v_mul_f32 v9, v9, v190
    v_mul_f32 v10, v10, v190
    v_mul_f32 v11, v11, v190
    v_mul_f32 v12, v12, v190
    v_mul_f32 v13, v13, v190
    v_mul_f32 v14, v14, v190
    v_mul_f32 v15, v15, v190
    v_mul_f32 v16, v16, v190
    v_mul_f32 v17, v17, v190
    v_mul_f32 v18, v18, v190
    v_mul_f32 v19, v19, v190
    v_mul_f32 v20, v20, v190
    v_mul_f32 v21, v21, v190
    v_mul_f32 v22, v22, v190
    v_mul_f32 v23, v23, v190
    v_mul_f32 v24, v24, v190
    v_mul_f32 v25, v25, v190
    v_mul_f32 v26, v26, v190
    v_mul_f32 v27, v27, v190
    v_mul_f32 v28, v28, v190
    v_mul_f32 v29, v29, v190
    v_mul_f32 v30, v30, v190
    v_mul_f32 v31, v31, v190
    v_mul_f32 v32, v32, v190
    v_mul_f32 v33, v33, v190
    v_mul_f32 v34, v34, v190
    v_mul_f32 v35, v35, v190
    v_mul_f32 v36, v36, v190
    v_mul_f32 v37, v37, v190
    v_mul_f32 v38, v38, v190
    v_mul_f32 v39, v39, v190
    v_mul_f32 v40, v40, v190
    v_mul_f32 v41, v41, v190
    v_mul_f32 v42, v42, v190
    v_mul_f32 v43, v43, v190
    v_mul_f32 v44, v44, v190
    v_mul_f32 v45, v45, v190
    v_mul_f32 v46, v46, v190
    v_mul_f32 v47, v47, v190
    v_mul_f32 v48, v48, v190
    v_mul_f32 v49, v49, v190
    v_mul_f32 v50, v50, v190
    v_mul_f32 v51, v51, v190
    v_mul_f32 v52, v52, v190
    v_mul_f32 v53, v53, v190
    v_mul_f32 v54, v54, v190
    v_mul_f32 v55, v55, v190
    v_mul_f32 v56, v56, v190
    v_mul_f32 v57, v57, v190
    v_mul_f32 v58, v58, v190
    v_mul_f32 v59, v59, v190
    v_mul_f32 v60, v60, v190
    v_mul_f32 v61, v61, v190
    v_mul_f32 v62, v62, v190
    v_mul_f32 v63, v63, v190
    v_mul_f32 v64, v64, v190
    v_mul_f32 v65, v65, v190
    v_mul_f32 v66, v66, v190
    v_mul_f32 v67, v67, v190
    v_mul_f32 v68, v68, v190
    v_mul_f32 v69, v69, v190
    v_mul_f32 v70, v70, v190
    v_mul_f32 v71, v71, v190
    v_mul_f32 v72, v72, v190
    v_mul_f32 v73, v73, v190
    v_mul_f32 v74, v74, v190
    v_mul_f32 v75, v75, v190
    v_mul_f32 v76, v76, v190
    v_mul_f32 v77, v77, v190
    v_mul_f32 v78, v78, v190
    v_mul_f32 v79, v79, v190
    v_mul_f32 v80, v80, v190
    v_mul_f32 v81, v81, v190
    v_mul_f32 v82, v82, v190
    v_mul_f32 v83, v83, v190
    v_mul_f32 v84, v84, v190
    v_mul_f32 v85, v85, v190
    v_mul_f32 v86, v86, v190
    v_mul_f32 v87, v87, v190
    v_mul_f32 v88, v88, v190
    v_mul_f32 v89, v89, v190
    v_mul_f32 v90, v90, v190
    v_mul_f32 v91, v91, v190
    v_mul_f32 v92, v92, v190
    v_mul_f32 v93, v93, v190
    v_mul_f32 v94, v94, v190
    v_mul_f32 v95, v95, v190
    v_mul_f32 v96, v96, v190
    v_mul_f32 v97, v97, v190
    v_mul_f32 v98, v98, v190
    v_mul_f32 v99, v99, v190
    v_mul_f32 v100, v100, v190
    v_mul_f32 v101, v101, v190
    v_mul_f32 v102, v102, v190
    v_mul_f32 v103, v103, v190
    v_mul_f32 v104, v104, v190
    v_mul_f32 v105, v105, v190
    v_mul_f32 v106, v106, v190
    v_mul_f32 v107, v107, v190
    v_mul_f32 v108, v108, v190
    v_mul_f32 v109, v109, v190
    v_mul_f32 v110, v110, v190
    v_mul_f32 v111, v111, v190
    v_mul_f32 v112, v112, v190
    v_mul_f32 v113, v113, v190
    v_mul_f32 v114, v114, v190
    v_mul_f32 v115, v115, v190
    v_mul_f32 v116, v116, v190
    v_mul_f32 v117, v117, v190
    v_mul_f32 v118, v118, v190
    v_mul_f32 v119, v119, v190
    v_mul_f32 v120, v120, v190
    v_mul_f32 v121, v121, v190
    v_mul_f32 v122, v122, v190
    v_mul_f32 v123, v123, v190
    v_mul_f32 v124, v124, v190
    v_mul_f32 v125, v125, v190
    v_mul_f32 v126, v126, v190
    v_mul_f32 v127, v127, v190
    s_branch ATT_BKh_0
.section .rodata,"a"
.p2align 6
.amdhsa_kernel adaLN_cond__gqa_block_cached__swiglu_ffn__prompt_kernel
  .amdhsa_next_free_vgpr 512
  .amdhsa_next_free_sgpr 102
  .amdhsa_accum_offset 256
  .amdhsa_group_segment_fixed_size 0
  .amdhsa_kernarg_size 112
  .amdhsa_user_sgpr_count 2
  .amdhsa_user_sgpr_kernarg_segment_ptr 1
  .amdhsa_system_sgpr_workgroup_id_x 1
.end_amdhsa_kernel
```
